```python
import torch

def _softmax(x, axis=-1):
    return torch.softmax(x, dim=axis)
def _gelu(x):
    return torch.nn.functional.gelu(x, approximate="tanh")
def _silu(x):
    return torch.nn.functional.silu(x)
def _sigmoid(x):
    return torch.sigmoid(x)
def _layernorm(x, axis=-1, eps=1e-5):
    m = x.mean(dim=axis, keepdim=True)
    v = x.var(dim=axis, keepdim=True, unbiased=False)
    return (x - m) / torch.sqrt(v + eps)
def _scatter_add(tgt, idx, src, axis=0):
    return tgt.clone().index_add_(axis, idx, src)
def _segment_sum(src, seg, n):
    out = torch.zeros((n,) + src.shape[1:], dtype=src.dtype)
    return out.index_add_(0, seg, src)
def _pad(x, pw):
    flat = tuple(v for pair in reversed(pw) for v in pair)
    return torch.nn.functional.pad(x, flat)

kernel_name = 'recurrent_scan__sliding_block_cached__glu_gated_glu__prompt'

def setup_inputs():

    _w = (lambda a: (lambda t: t.to(torch.bfloat16) if t.is_floating_point() else t)(torch.as_tensor(a)))
    def _A_setup():
        B, Sq, D = 1, 2048, 1024
        Hq, Hkv, Sk, Dh = 32, 4, 2048, 128
        assert Hq % Hkv == 0, (Hq, Hkv)
        return {
            "x": _w((lambda *s: torch.randn(*s, dtype=torch.bfloat16) * 0.05)(B, Sq, D)),
            "k_cache": _w((lambda *s: torch.randn(*s, dtype=torch.bfloat16) * 0.8)(B, Hkv, Sk, Dh)),
            "v_cache": _w((lambda *s: torch.randn(*s, dtype=torch.bfloat16) * 0.2)(B, Hkv, Sk, Dh)),
            "wq": _w((lambda *s: torch.randn(*s, dtype=torch.bfloat16) * 0.8)(D, Hq * Dh) * (D ** -0.5)),
            "wo": _w((lambda *s: torch.randn(*s, dtype=torch.bfloat16) * 0.2)(Hq * Dh, D) * ((Hq * Dh) ** -0.5)),
        }
    _A_in = _A_setup()

    def _B_setup():
        B, S, D, F = 1, 2048, 1024, 3584
        return {
            "x": _w((lambda *s: torch.randn(*s, dtype=torch.bfloat16) * 0.05)(B, S, D)),
            "w_gate": _w((lambda *s: torch.randn(*s, dtype=torch.bfloat16) * 0.2)(D, F)),
            "w_up": _w((lambda *s: torch.randn(*s, dtype=torch.bfloat16) * 0.1)(D, F)),
            "w_down": _w((lambda *s: torch.randn(*s, dtype=torch.bfloat16) * 0.1)(F, D)),
        }
    _B_in = _B_setup()

    return {
        "A_x": _A_in["x"],
        "A_k_cache": _A_in["k_cache"],
        "A_v_cache": _A_in["v_cache"],
        "A_wq": _A_in["wq"],
        "A_wo": _A_in["wo"],
        "B_x": _B_in["x"],
        "B_w_gate": _B_in["w_gate"],
        "B_w_up": _B_in["w_up"],
        "B_w_down": _B_in["w_down"],
    }

def reference(A_x, A_k_cache, A_v_cache, A_wq, A_wo, B_x, B_w_gate, B_w_up, B_w_down):
    def _A_ref(x, k_cache, v_cache, wq, wo):
        B, Sq, D = x.shape
        Hq, Dh = 32, 128
        Hkv, Sk = k_cache.shape[1], k_cache.shape[2]
        W = min(4096, max(256, Sk // 4))
        rep = Hq // Hkv
        q = (lambda x, *d: x.permute(*d))((x @ wq).reshape(B, Sq, Hq, Dh), 0, 2, 1, 3)
        k = (lambda x, n, axis: torch.repeat_interleave(x, n, dim=axis))(k_cache[:, :, Sk - W:, :], rep, axis=1)
        v = (lambda x, n, axis: torch.repeat_interleave(x, n, dim=axis))(v_cache[:, :, Sk - W:, :], rep, axis=1)
        scores = torch.einsum("bhqd,bhkd->bhqk", q, k) * (Dh ** -0.5)
        p = _softmax(scores, axis=-1)
        o = torch.einsum("bhqk,bhkd->bhqd", p, v)
        return (lambda x, *d: x.permute(*d))(o, 0, 2, 1, 3).reshape(B, Sq, Hq * Dh) @ wo

    def _B_ref(x, w_gate, w_up, w_down):
        g = torch.einsum("bsd,df->bsf", x, w_gate)
        u = torch.einsum("bsd,df->bsf", x, w_up)
        h = _sigmoid(g) * u
        return torch.einsum("bsf,fd->bsd", h, w_down)

    x = A_x
    xn = _layernorm(x, axis=-1)
    s = _A_ref(xn, A_k_cache, A_v_cache, A_wq, A_wo)
    g = _silu(_B_ref(xn, B_w_gate, B_w_up, B_w_down))
    return x + s * g
```

```asm
; @launch grid=(256,1,1) block=(256,1,1) lds=163840
.amdgcn_target "amdgcn-amd-amdhsa--gfx950"
.text
.globl recurrent_scan__sliding_block_cached__glu_gated_glu__prompt_kernel
.p2align 8
.type recurrent_scan__sliding_block_cached__glu_gated_glu__prompt_kernel,@function
recurrent_scan__sliding_block_cached__glu_gated_glu__prompt_kernel:

    s_cmp_ge_u32 s2, 256
    s_cbranch_scc1 recurrent_scan__sliding_block_cached__glu_gated_glu__prompt_kernel_end
    s_load_dwordx16 s[16:31], s[0:1], 0
    s_load_dwordx8 s[32:39], s[0:1], 64
    s_getpc_b64 s[76:77]
recurrent_scan__sliding_block_cached__glu_gated_glu__prompt_kernel_pc0:
    s_sub_u32 s76, s76, recurrent_scan__sliding_block_cached__glu_gated_glu__prompt_kernel_pc0-recurrent_scan__sliding_block_cached__glu_gated_glu__prompt_kernel
    s_subb_u32 s77, s77, 0
    s_lshr_b32 s78, s2, 3
    s_lshl_b32 s78, s78, 11
    v_and_b32 v30, 0xc0, v0
    v_lshlrev_b32 v31, 3, v30
    v_and_b32 v30, 7, v0
    v_mul_u32_u24 v30, 0x4080, v30
    v_and_b32 v30, 0x10180, v30
    v_add_u32 v30, v31, v30
    v_add_u32 v30, s78, v30
    v_min_u32 v30, recurrent_scan__sliding_block_cached__glu_gated_glu__prompt_kernel_codeend-recurrent_scan__sliding_block_cached__glu_gated_glu__prompt_kernel-4, v30
    global_load_dword a238, v30, s[76:77]
    v_lshrrev_b32 v1, 6, v0
    v_and_b32 v0, 63, v0
    s_nop 0
    v_readfirstlane_b32 s3, v1
    s_and_b32 s10, s2, 7
    s_lshr_b32 s11, s2, 3
    s_and_b32 s4, s11, 7
    s_lshr_b32 s11, s11, 3
    s_lshl_b32 s5, s10, 2
    s_add_u32 s5, s5, s11
    s_mul_i32 s14, s11, 2
    s_mul_i32 s12, s4, 1
    s_add_u32 s14, s14, s12
    v_and_b32 v40, 7, v0
    v_lshrrev_b32 v41, 3, v0
    s_lshl_b32 s12, s3, 5
    v_add_u32 v41, s12, v41
    v_lshlrev_b32 v42, 11, v40
    v_lshl_add_u32 v42, v41, 4, v42
    s_lshl_b32 s12, s4, 5
    s_add_u32 s91, s12, s5
    s_lshl_b32 s12, s91, 14
    s_waitcnt lgkmcnt(0)
    s_mov_b32 s64, s16
    s_and_b32 s65, s17, 0xffff
    s_mov_b32 s66, 0x400000
    s_mov_b32 s67, 0x20000
    buffer_load_dwordx4 v[48:51], v42, s[64:67], s12 offen offset:0
    buffer_load_dwordx4 v[52:55], v42, s[64:67], s12 offen offset:128
    buffer_load_dwordx4 v[56:59], v42, s[64:67], s12 offen offset:256
    buffer_load_dwordx4 v[60:63], v42, s[64:67], s12 offen offset:384
    s_mov_b32 s60, s36
    s_and_b32 s61, s37, 0xffff
    s_mov_b32 s62, 0x100
    s_mov_b32 s63, 0x20000
    v_mov_b32 v47, 0
    s_or_b32 s12, s2, s3
    s_cmp_lg_u32 s12, 0
    s_cbranch_scc1 recurrent_scan__sliding_block_cached__glu_gated_glu__prompt_kernel_nn
    s_memrealtime s[12:13]
    s_getreg_b32 s9, hwreg(HW_REG_XCC_ID, 0, 1)
    s_lshl_b32 s9, s9, 1
    s_or_b32 s9, s9, 1
    s_waitcnt lgkmcnt(0)
    s_andn2_b32 s12, s12, 2
    s_or_b32 s12, s12, s9
    s_or_b32 s13, s13, 0x80000000
    v_mov_b32 v38, s12
    v_mov_b32 v39, s13
    s_mov_b64 exec, 1
    buffer_store_dwordx2 v[38:39], v47, s[60:63], 0 offen sc0 sc1
    s_mov_b64 exec, -1
recurrent_scan__sliding_block_cached__glu_gated_glu__prompt_kernel_nn:
    v_lshrrev_b32 v30, 4, v0
    v_and_b32 v31, 15, v0
    s_lshr_b32 s12, s3, 1
    s_lshl_b32 s12, s12, 1
    v_lshlrev_b32 v1, 2, v30
    v_or_b32 v1, s12, v1
    v_xor_b32 v31, v31, v1
    s_lshl_b32 s12, s3, 2
    v_add_u32 v30, s12, v30
    v_lshlrev_b32 v2, 13, v30
    s_lshl_b32 s12, s5, 8
    v_lshl_add_u32 v2, v31, 4, v2
    v_add_u32 v2, s12, v2
    v_lshrrev_b32 v1, 1, v31
    v_min_u32 v1, 6, v1
    s_and_b32 s13, s5, 1
    v_add_u32 v1, s13, v1
    v_cmp_eq_u32 vcc, 7, v1
    v_and_b32 v31, 1, v31
    s_nop 0
    v_cndmask_b32 v1, v1, 0, vcc
    v_lshl_or_b32 v1, v1, 1, v31
    v_mul_u32_u24 v3, 7168, v30
    s_mul_i32 s12, s5, 224
    v_add_u32 v3, s12, v3
    v_lshl_add_u32 v3, v1, 4, v3
    s_lshl_b32 s12, s4, 4
    s_lshl_b32 s13, s3, 2
    s_add_u32 s15, s12, s13
    s_lshl_b32 s12, s15, 15
    v_lshlrev_b32 v4, 4, v0
    v_add_u32 v5, s12, v4
    v_add_u32 v6, 0x8000, v5
    v_add_u32 v7, 0x10000, v5
    v_add_u32 v8, 0x18000, v5
    s_mul_i32 s95, s3, 3072
    s_add_u32 s95, s95, 16384
    s_mov_b32 s10, s95
    s_mov_b32 s72, 98304
    s_mov_b32 s11, 0
    s_mov_b32 s75, 0
    s_waitcnt lgkmcnt(0)
    s_mov_b32 s44, s22
    s_and_b32 s45, s23, 0xffff
    s_mov_b32 s46, 0x800000
    s_mov_b32 s47, 0x20000
    s_sub_u32 s48, s28, 0x400
    s_subb_u32 s49, s29, 0
    s_and_b32 s49, s49, 0xffff
    s_mov_b32 s50, 0x700400
    s_mov_b32 s51, 0x20000
    s_sub_u32 s52, s30, 0x800
    s_subb_u32 s53, s31, 0
    s_and_b32 s53, s53, 0xffff
    s_mov_b32 s54, 0x700800
    s_mov_b32 s55, 0x20000
    s_mov_b32 s40, s38
    s_and_b32 s41, s39, 0xffff
    s_mov_b32 s42, 0x400000
    s_mov_b32 s43, 0x20000
    s_cmp_lt_u32 s11, 8
    s_cselect_b32 s13, 1, 7
    s_and_b32 s13, s13, s14
    s_add_u32 s12, s11, s13
    s_and_b32 s12, s12, 7
    s_and_b32 s13, s11, 0x18
    s_or_b32 s12, s12, s13
    s_add_u32 s11, s11, 1
    s_lshl_b32 s6, s12, 18
    s_mul_i32 s7, s12, 229376
    s_lshl_b32 s8, s12, 10
    s_mov_b32 s88, s8
    s_add_u32 m0, s10, 0
    s_nop 0
    buffer_load_dwordx4 v2, s[44:47], s6 offen lds
    s_add_u32 s6, s6, 131072
    buffer_load_dwordx4 v3, s[48:51], s7 offen offset:1024 lds
    buffer_load_dwordx4 v3, s[52:55], s7 offen offset:2048 lds
    s_add_u32 s7, s7, 114688
    s_add_u32 m0, s10, 12288
    s_nop 0
    buffer_load_dwordx4 v2, s[44:47], s6 offen lds
    buffer_load_dwordx4 v3, s[48:51], s7 offen offset:1024 lds
    buffer_load_dwordx4 v3, s[52:55], s7 offen offset:2048 lds
    s_add_u32 s84, s38, 0x2600000
    s_addc_u32 s85, s39, 0
    s_and_b32 s85, s85, 0xffff
    s_mov_b32 s86, 0xe000
    s_mov_b32 s87, 0x20000
    s_lshr_b32 s12, s91, 1
    s_lshl_b32 s12, s12, 15
    s_and_b32 s13, s91, 1
    s_lshl_b32 s13, s13, 7
    s_add_u32 s90, s12, s13
    v_lshlrev_b32 v43, 8, v41
    v_lshl_add_u32 v43, v40, 4, v43
    v_lshlrev_b32 v44, 5, v40
    s_lshl_b32 s12, s3, 3
    v_add_u32 v45, s12, v44
    s_lshl_b32 s91, s91, 5
    s_add_u32 s91, s91, 16384
    v_mov_b32 v132, 0
    v_mov_b32 v133, 0
    v_mov_b32 v134, 0
    v_mov_b32 v135, 0
    v_mov_b32 v136, 0
    v_mov_b32 v137, 0
    v_mov_b32 v138, 0
    v_mov_b32 v139, 0
    v_mov_b32 v140, 0
    v_mov_b32 v141, 0
    v_mov_b32 v142, 0
    v_mov_b32 v143, 0
    buffer_load_dwordx2 v[128:129], v47, s[60:63], 0 offen sc0 sc1
    v_mfma_f32_32x32x16_bf16 a[0:15], v[132:135], v[132:135], 0
    v_mfma_f32_32x32x16_bf16 a[16:31], v[132:135], v[132:135], 0
    v_mfma_f32_32x32x16_bf16 a[32:47], v[132:135], v[132:135], 0
    v_mfma_f32_32x32x16_bf16 a[48:63], v[132:135], v[132:135], 0
    v_mfma_f32_32x32x16_bf16 a[64:79], v[132:135], v[132:135], 0
    v_mfma_f32_32x32x16_bf16 a[80:95], v[132:135], v[132:135], 0
    v_mfma_f32_32x32x16_bf16 a[96:111], v[132:135], v[132:135], 0
    v_mfma_f32_32x32x16_bf16 a[112:127], v[132:135], v[132:135], 0
    v_mfma_f32_32x32x16_bf16 v[144:159], v[132:135], v[132:135], 0
    v_mfma_f32_32x32x16_bf16 v[160:175], v[132:135], v[132:135], 0
    v_mfma_f32_32x32x16_bf16 v[176:191], v[132:135], v[132:135], 0
    v_mfma_f32_32x32x16_bf16 v[192:207], v[132:135], v[132:135], 0
    v_mfma_f32_32x32x16_bf16 v[208:223], v[132:135], v[132:135], 0
    v_mfma_f32_32x32x16_bf16 v[224:239], v[132:135], v[132:135], 0
    v_mfma_f32_32x32x16_bf16 v[240:255], v[132:135], v[132:135], 0
    s_memrealtime s[92:93]
    s_waitcnt vmcnt(7)
    v_lshlrev_b32 v64, 16, v48
    v_and_b32 v65, 0xffff0000, v48
    v_lshlrev_b32 v66, 16, v49
    v_and_b32 v67, 0xffff0000, v49
    v_lshlrev_b32 v68, 16, v50
    v_and_b32 v69, 0xffff0000, v50
    v_lshlrev_b32 v70, 16, v51
    v_and_b32 v71, 0xffff0000, v51
    v_lshlrev_b32 v72, 16, v52
    v_and_b32 v73, 0xffff0000, v52
    v_lshlrev_b32 v74, 16, v53
    v_and_b32 v75, 0xffff0000, v53
    v_lshlrev_b32 v76, 16, v54
    v_and_b32 v77, 0xffff0000, v54
    v_lshlrev_b32 v78, 16, v55
    v_and_b32 v79, 0xffff0000, v55
    v_lshlrev_b32 v80, 16, v56
    v_and_b32 v81, 0xffff0000, v56
    v_lshlrev_b32 v82, 16, v57
    v_and_b32 v83, 0xffff0000, v57
    v_lshlrev_b32 v84, 16, v58
    v_and_b32 v85, 0xffff0000, v58
    v_lshlrev_b32 v86, 16, v59
    v_and_b32 v87, 0xffff0000, v59
    v_lshlrev_b32 v88, 16, v60
    v_and_b32 v89, 0xffff0000, v60
    v_lshlrev_b32 v90, 16, v61
    v_and_b32 v91, 0xffff0000, v61
    v_lshlrev_b32 v92, 16, v62
    v_and_b32 v93, 0xffff0000, v62
    v_lshlrev_b32 v94, 16, v63
    v_and_b32 v95, 0xffff0000, v63
    v_pk_add_f32 v[32:33], v[64:65], v[66:67]
    v_pk_add_f32 v[34:35], v[68:69], v[70:71]
    v_pk_add_f32 v[32:33], v[32:33], v[72:73]
    v_pk_add_f32 v[34:35], v[34:35], v[74:75]
    v_pk_add_f32 v[32:33], v[32:33], v[76:77]
    v_pk_add_f32 v[34:35], v[34:35], v[78:79]
    v_pk_add_f32 v[32:33], v[32:33], v[80:81]
    v_pk_add_f32 v[34:35], v[34:35], v[82:83]
    v_pk_add_f32 v[32:33], v[32:33], v[84:85]
    v_pk_add_f32 v[34:35], v[34:35], v[86:87]
    v_pk_add_f32 v[32:33], v[32:33], v[88:89]
    v_pk_add_f32 v[34:35], v[34:35], v[90:91]
    v_pk_add_f32 v[32:33], v[32:33], v[92:93]
    v_pk_add_f32 v[34:35], v[34:35], v[94:95]
    v_pk_add_f32 v[32:33], v[32:33], v[34:35]
    v_add_f32 v32, v32, v33
    s_nop 1
    v_add_f32_dpp v32, v32, v32 row_ror:8 row_mask:0xf bank_mask:0xf
    v_mov_b32 v46, v32
    s_nop 1
    v_permlane16_swap_b32 v46, v32
    v_add_f32 v32, v46, v32
    v_mov_b32 v46, v32
    s_nop 1
    v_permlane32_swap_b32 v46, v32
    v_add_f32 v32, v46, v32
    v_mul_f32 v32, 0x3b800000, v32
    v_mov_b32 v34, v32
    v_mov_b32 v35, v32
    v_pk_add_f32 v[96:97], v[64:65], v[34:35] neg_lo:[0,1] neg_hi:[0,1]
    v_pk_add_f32 v[98:99], v[66:67], v[34:35] neg_lo:[0,1] neg_hi:[0,1]
    v_pk_add_f32 v[100:101], v[68:69], v[34:35] neg_lo:[0,1] neg_hi:[0,1]
    v_pk_add_f32 v[102:103], v[70:71], v[34:35] neg_lo:[0,1] neg_hi:[0,1]
    v_pk_add_f32 v[104:105], v[72:73], v[34:35] neg_lo:[0,1] neg_hi:[0,1]
    v_pk_add_f32 v[106:107], v[74:75], v[34:35] neg_lo:[0,1] neg_hi:[0,1]
    v_pk_add_f32 v[108:109], v[76:77], v[34:35] neg_lo:[0,1] neg_hi:[0,1]
    v_pk_add_f32 v[110:111], v[78:79], v[34:35] neg_lo:[0,1] neg_hi:[0,1]
    v_pk_add_f32 v[112:113], v[80:81], v[34:35] neg_lo:[0,1] neg_hi:[0,1]
    v_pk_add_f32 v[114:115], v[82:83], v[34:35] neg_lo:[0,1] neg_hi:[0,1]
    v_pk_add_f32 v[116:117], v[84:85], v[34:35] neg_lo:[0,1] neg_hi:[0,1]
    v_pk_add_f32 v[118:119], v[86:87], v[34:35] neg_lo:[0,1] neg_hi:[0,1]
    v_pk_add_f32 v[120:121], v[88:89], v[34:35] neg_lo:[0,1] neg_hi:[0,1]
    v_pk_add_f32 v[122:123], v[90:91], v[34:35] neg_lo:[0,1] neg_hi:[0,1]
    v_pk_add_f32 v[124:125], v[92:93], v[34:35] neg_lo:[0,1] neg_hi:[0,1]
    v_pk_add_f32 v[126:127], v[94:95], v[34:35] neg_lo:[0,1] neg_hi:[0,1]
    v_pk_mul_f32 v[34:35], v[96:97], v[96:97]
    v_pk_mul_f32 v[36:37], v[98:99], v[98:99]
    v_pk_fma_f32 v[34:35], v[100:101], v[100:101], v[34:35]
    v_pk_fma_f32 v[36:37], v[102:103], v[102:103], v[36:37]
    v_pk_fma_f32 v[34:35], v[104:105], v[104:105], v[34:35]
    v_pk_fma_f32 v[36:37], v[106:107], v[106:107], v[36:37]
    v_pk_fma_f32 v[34:35], v[108:109], v[108:109], v[34:35]
    v_pk_fma_f32 v[36:37], v[110:111], v[110:111], v[36:37]
    v_pk_fma_f32 v[34:35], v[112:113], v[112:113], v[34:35]
    v_pk_fma_f32 v[36:37], v[114:115], v[114:115], v[36:37]
    v_pk_fma_f32 v[34:35], v[116:117], v[116:117], v[34:35]
    v_pk_fma_f32 v[36:37], v[118:119], v[118:119], v[36:37]
    v_pk_fma_f32 v[34:35], v[120:121], v[120:121], v[34:35]
    v_pk_fma_f32 v[36:37], v[122:123], v[122:123], v[36:37]
    v_pk_fma_f32 v[34:35], v[124:125], v[124:125], v[34:35]
    v_pk_fma_f32 v[36:37], v[126:127], v[126:127], v[36:37]
    v_pk_add_f32 v[34:35], v[34:35], v[36:37]
    v_add_f32 v33, v34, v35
    s_nop 1
    v_add_f32_dpp v33, v33, v33 row_ror:8 row_mask:0xf bank_mask:0xf
    v_mov_b32 v46, v33
    s_nop 1
    v_permlane16_swap_b32 v46, v33
    v_add_f32 v33, v46, v33
    v_mov_b32 v46, v33
    s_nop 1
    v_permlane32_swap_b32 v46, v33
    v_add_f32 v33, v46, v33
    ds_write_b64 v45, v[32:33]
    s_waitcnt lgkmcnt(0)
    s_barrier
    ds_read_b128 v[96:99], v44
    ds_read_b128 v[100:103], v44 offset:16
    s_waitcnt lgkmcnt(0)
    v_add_f32 v32, v96, v98
    v_add_f32 v33, v100, v102
    v_add_f32 v34, v97, v99
    v_add_f32 v35, v101, v103
    v_add_f32 v32, v32, v33
    v_add_f32 v34, v34, v35
    v_mul_f32 v32, 0x3e800000, v32
    v_sub_f32 v96, v96, v32
    v_sub_f32 v98, v98, v32
    v_sub_f32 v100, v100, v32
    v_sub_f32 v102, v102, v32
    v_mul_f32 v35, v96, v96
    v_fmac_f32 v35, v98, v98
    v_fmac_f32 v35, v100, v100
    v_fmac_f32 v35, v102, v102
    v_mul_f32 v34, 0x3a800000, v34
    v_fmac_f32 v34, 0x3e800000, v35
    v_cvt_pk_bf16_f32 v34, v34, v32
    v_and_b32 v32, 0xffff0000, v34
    v_lshlrev_b32 v34, 16, v34
    v_add_f32 v34, 0x3727c5ac, v34
    v_cvt_pk_bf16_f32 v34, v34, v34
    v_lshlrev_b32 v34, 16, v34
    v_sqrt_f32 v34, v34
    v_mov_b32 v33, v32
    v_cvt_pk_bf16_f32 v34, v34, v34
    v_lshlrev_b32 v34, 16, v34
    v_rcp_f32 v34, v34
    s_nop 0
    v_mov_b32 v35, v34
    v_pk_add_f32 v[64:65], v[64:65], v[32:33] neg_lo:[0,1] neg_hi:[0,1]
    v_cvt_pk_bf16_f32 v48, v64, v65
    v_lshlrev_b32 v64, 16, v48
    v_and_b32 v65, 0xffff0000, v48
    v_pk_mul_f32 v[64:65], v[64:65], v[34:35]
    v_cvt_pk_bf16_f32 v48, v64, v65
    v_pk_add_f32 v[66:67], v[66:67], v[32:33] neg_lo:[0,1] neg_hi:[0,1]
    v_cvt_pk_bf16_f32 v49, v66, v67
    v_lshlrev_b32 v66, 16, v49
    v_and_b32 v67, 0xffff0000, v49
    v_pk_mul_f32 v[66:67], v[66:67], v[34:35]
    v_cvt_pk_bf16_f32 v49, v66, v67
    v_pk_add_f32 v[68:69], v[68:69], v[32:33] neg_lo:[0,1] neg_hi:[0,1]
    v_cvt_pk_bf16_f32 v50, v68, v69
    v_lshlrev_b32 v68, 16, v50
    v_and_b32 v69, 0xffff0000, v50
    v_pk_mul_f32 v[68:69], v[68:69], v[34:35]
    v_cvt_pk_bf16_f32 v50, v68, v69
    v_pk_add_f32 v[70:71], v[70:71], v[32:33] neg_lo:[0,1] neg_hi:[0,1]
    v_cvt_pk_bf16_f32 v51, v70, v71
    v_lshlrev_b32 v70, 16, v51
    v_and_b32 v71, 0xffff0000, v51
    v_pk_mul_f32 v[70:71], v[70:71], v[34:35]
    v_cvt_pk_bf16_f32 v51, v70, v71
    buffer_store_dwordx4 v[48:51], v43, s[40:43], s90 offen offset:0 sc0 sc1
    v_pk_add_f32 v[72:73], v[72:73], v[32:33] neg_lo:[0,1] neg_hi:[0,1]
    v_cvt_pk_bf16_f32 v52, v72, v73
    v_lshlrev_b32 v72, 16, v52
    v_and_b32 v73, 0xffff0000, v52
    v_pk_mul_f32 v[72:73], v[72:73], v[34:35]
    v_cvt_pk_bf16_f32 v52, v72, v73
    v_pk_add_f32 v[74:75], v[74:75], v[32:33] neg_lo:[0,1] neg_hi:[0,1]
    v_cvt_pk_bf16_f32 v53, v74, v75
    v_lshlrev_b32 v74, 16, v53
    v_and_b32 v75, 0xffff0000, v53
    v_pk_mul_f32 v[74:75], v[74:75], v[34:35]
    v_cvt_pk_bf16_f32 v53, v74, v75
    v_pk_add_f32 v[76:77], v[76:77], v[32:33] neg_lo:[0,1] neg_hi:[0,1]
    v_cvt_pk_bf16_f32 v54, v76, v77
    v_lshlrev_b32 v76, 16, v54
    v_and_b32 v77, 0xffff0000, v54
    v_pk_mul_f32 v[76:77], v[76:77], v[34:35]
    v_cvt_pk_bf16_f32 v54, v76, v77
    v_pk_add_f32 v[78:79], v[78:79], v[32:33] neg_lo:[0,1] neg_hi:[0,1]
    v_cvt_pk_bf16_f32 v55, v78, v79
    v_lshlrev_b32 v78, 16, v55
    v_and_b32 v79, 0xffff0000, v55
    v_pk_mul_f32 v[78:79], v[78:79], v[34:35]
    v_cvt_pk_bf16_f32 v55, v78, v79
    buffer_store_dwordx4 v[52:55], v43, s[40:43], s90 offen offset:2048 sc0 sc1
    s_add_u32 s90, s90, 4096
    v_pk_add_f32 v[80:81], v[80:81], v[32:33] neg_lo:[0,1] neg_hi:[0,1]
    v_cvt_pk_bf16_f32 v56, v80, v81
    v_lshlrev_b32 v80, 16, v56
    v_and_b32 v81, 0xffff0000, v56
    v_pk_mul_f32 v[80:81], v[80:81], v[34:35]
    v_cvt_pk_bf16_f32 v56, v80, v81
    v_pk_add_f32 v[82:83], v[82:83], v[32:33] neg_lo:[0,1] neg_hi:[0,1]
    v_cvt_pk_bf16_f32 v57, v82, v83
    v_lshlrev_b32 v82, 16, v57
    v_and_b32 v83, 0xffff0000, v57
    v_pk_mul_f32 v[82:83], v[82:83], v[34:35]
    v_cvt_pk_bf16_f32 v57, v82, v83
    v_pk_add_f32 v[84:85], v[84:85], v[32:33] neg_lo:[0,1] neg_hi:[0,1]
    v_cvt_pk_bf16_f32 v58, v84, v85
    v_lshlrev_b32 v84, 16, v58
    v_and_b32 v85, 0xffff0000, v58
    v_pk_mul_f32 v[84:85], v[84:85], v[34:35]
    v_cvt_pk_bf16_f32 v58, v84, v85
    v_pk_add_f32 v[86:87], v[86:87], v[32:33] neg_lo:[0,1] neg_hi:[0,1]
    v_cvt_pk_bf16_f32 v59, v86, v87
    v_lshlrev_b32 v86, 16, v59
    v_and_b32 v87, 0xffff0000, v59
    v_pk_mul_f32 v[86:87], v[86:87], v[34:35]
    v_cvt_pk_bf16_f32 v59, v86, v87
    buffer_store_dwordx4 v[56:59], v43, s[40:43], s90 offen offset:0 sc0 sc1
    v_pk_add_f32 v[88:89], v[88:89], v[32:33] neg_lo:[0,1] neg_hi:[0,1]
    v_cvt_pk_bf16_f32 v60, v88, v89
    v_lshlrev_b32 v88, 16, v60
    v_and_b32 v89, 0xffff0000, v60
    v_pk_mul_f32 v[88:89], v[88:89], v[34:35]
    v_cvt_pk_bf16_f32 v60, v88, v89
    v_pk_add_f32 v[90:91], v[90:91], v[32:33] neg_lo:[0,1] neg_hi:[0,1]
    v_cvt_pk_bf16_f32 v61, v90, v91
    v_lshlrev_b32 v90, 16, v61
    v_and_b32 v91, 0xffff0000, v61
    v_pk_mul_f32 v[90:91], v[90:91], v[34:35]
    v_cvt_pk_bf16_f32 v61, v90, v91
    v_pk_add_f32 v[92:93], v[92:93], v[32:33] neg_lo:[0,1] neg_hi:[0,1]
    v_cvt_pk_bf16_f32 v62, v92, v93
    v_lshlrev_b32 v92, 16, v62
    v_and_b32 v93, 0xffff0000, v62
    v_pk_mul_f32 v[92:93], v[92:93], v[34:35]
    v_cvt_pk_bf16_f32 v62, v92, v93
    v_pk_add_f32 v[94:95], v[94:95], v[32:33] neg_lo:[0,1] neg_hi:[0,1]
    v_cvt_pk_bf16_f32 v63, v94, v95
    v_lshlrev_b32 v94, 16, v63
    v_and_b32 v95, 0xffff0000, v63
    v_pk_mul_f32 v[94:95], v[94:95], v[34:35]
    v_cvt_pk_bf16_f32 v63, v94, v95
    buffer_store_dwordx4 v[60:63], v43, s[40:43], s90 offen offset:2048 sc0 sc1
    s_waitcnt vmcnt(4)
    s_mov_b32 s12, 0x10000
    s_sub_u32 s92, s92, 3000
recurrent_scan__sliding_block_cached__glu_gated_glu__prompt_kernel_pollN:
    v_readfirstlane_b32 s98, v128
    v_readfirstlane_b32 s99, v129
    s_cmp_eq_u32 s99, 0
    s_cbranch_scc1 recurrent_scan__sliding_block_cached__glu_gated_glu__prompt_kernel_retN
    s_cmp_eq_u32 s98, 0
    s_cbranch_scc1 recurrent_scan__sliding_block_cached__glu_gated_glu__prompt_kernel_retN
    s_sub_u32 s13, s98, s92
    s_cmp_ge_i32 s13, 0
    s_cbranch_scc1 recurrent_scan__sliding_block_cached__glu_gated_glu__prompt_kernel_gotN
    s_cmp_lt_u32 s12, 0xffc0
    s_cbranch_scc1 recurrent_scan__sliding_block_cached__glu_gated_glu__prompt_kernel_gotN
recurrent_scan__sliding_block_cached__glu_gated_glu__prompt_kernel_retN:
    s_sub_u32 s12, s12, 1
    s_cbranch_scc1 recurrent_scan__sliding_block_cached__glu_gated_glu__prompt_kernel_gotN
    buffer_load_dwordx2 v[128:129], v47, s[60:63], 0 offen sc0 sc1
    s_waitcnt vmcnt(0)
    s_branch recurrent_scan__sliding_block_cached__glu_gated_glu__prompt_kernel_pollN
recurrent_scan__sliding_block_cached__glu_gated_glu__prompt_kernel_gotN:
    v_mfma_f32_32x32x16_bf16 v[64:79], v[132:135], v[132:135], 0
    v_mfma_f32_32x32x16_bf16 v[80:95], v[132:135], v[132:135], 0
    v_mfma_f32_32x32x16_bf16 v[96:111], v[132:135], v[132:135], 0
    v_mfma_f32_32x32x16_bf16 v[112:127], v[132:135], v[132:135], 0
    s_waitcnt vmcnt(0)
    s_barrier
    s_cmp_lg_u32 s3, 0
    s_cbranch_scc1 recurrent_scan__sliding_block_cached__glu_gated_glu__prompt_kernel_nf
    s_mov_b64 exec, 1
    buffer_store_dwordx2 v[128:129], v47, s[84:87], s91 offen sc0 sc1
    s_mov_b64 exec, -1
recurrent_scan__sliding_block_cached__glu_gated_glu__prompt_kernel_nf:
    s_cmp_lt_u32 s11, 8
    s_cselect_b32 s13, 1, 7
    s_and_b32 s13, s13, s14
    s_add_u32 s12, s11, s13
    s_and_b32 s12, s12, 7
    s_and_b32 s13, s11, 0x18
    s_or_b32 s12, s12, s13
    s_add_u32 s11, s11, 1
    s_lshl_b32 s6, s12, 18
    s_mul_i32 s7, s12, 229376
    s_lshl_b32 s8, s12, 10
    s_mov_b32 s89, s8
    s_add_u32 m0, s10, 24576
    s_nop 0
    buffer_load_dwordx4 v2, s[44:47], s6 offen lds
    s_add_u32 s6, s6, 131072
    buffer_load_dwordx4 v3, s[48:51], s7 offen offset:1024 lds
    buffer_load_dwordx4 v3, s[52:55], s7 offen offset:2048 lds
    s_add_u32 s7, s7, 114688
    s_add_u32 m0, s10, 36864
    s_nop 0
    buffer_load_dwordx4 v2, s[44:47], s6 offen lds
    buffer_load_dwordx4 v3, s[48:51], s7 offen offset:1024 lds
    buffer_load_dwordx4 v3, s[52:55], s7 offen offset:2048 lds
    s_mov_b32 s90, s88
    s_cmp_lt_u32 s11, 8
    s_cselect_b32 s13, 1, 7
    s_and_b32 s13, s13, s14
    s_add_u32 s12, s11, s13
    s_and_b32 s12, s12, 7
    s_and_b32 s13, s11, 0x18
    s_or_b32 s12, s12, s13
    s_add_u32 s11, s11, 1
    s_lshl_b32 s6, s12, 18
    s_mul_i32 s7, s12, 229376
    s_lshl_b32 s8, s12, 10
    s_mov_b32 s88, s8
    s_add_u32 m0, s10, 49152
    s_nop 0
    buffer_load_dwordx4 v2, s[44:47], s6 offen lds
    s_add_u32 s6, s6, 131072
    buffer_load_dwordx4 v3, s[48:51], s7 offen offset:1024 lds
    buffer_load_dwordx4 v3, s[52:55], s7 offen offset:2048 lds
    s_add_u32 s7, s7, 114688
    s_add_u32 m0, s10, 61440
    s_nop 0
    buffer_load_dwordx4 v2, s[44:47], s6 offen lds
    buffer_load_dwordx4 v3, s[48:51], s7 offen offset:1024 lds
    buffer_load_dwordx4 v3, s[52:55], s7 offen offset:2048 lds
    v_mfma_f32_32x32x16_bf16 v[32:47], v[132:135], v[132:135], 0
    v_mfma_f32_32x32x16_bf16 v[48:63], v[132:135], v[132:135], 0
    v_lshrrev_b32 v1, 4, v0
    v_mul_u32_u24 v30, 6144, v1
    v_and_b32 v1, 1, v1
    v_bfe_u32 v31, v0, 2, 2
    v_lshl_add_u32 v30, v31, 8, v30
    v_lshl_or_b32 v31, v31, 1, v1
    v_and_b32 v1, 3, v0
    v_lshl_add_u32 v30, v1, 3, v30
    v_add_u32 v30, 0x4000, v30
    v_xor_b32 v1, 0, v31
    v_lshl_add_u32 v9, v1, 5, v30
    v_add_u32 v17, 98304, v9
    v_xor_b32 v1, 1, v31
    v_lshl_add_u32 v10, v1, 5, v30
    v_add_u32 v18, 98304, v10
    v_xor_b32 v1, 2, v31
    v_lshl_add_u32 v11, v1, 5, v30
    v_add_u32 v19, 98304, v11
    v_xor_b32 v1, 3, v31
    v_lshl_add_u32 v12, v1, 5, v30
    v_add_u32 v20, 98304, v12
    v_xor_b32 v1, 4, v31
    v_lshl_add_u32 v13, v1, 5, v30
    v_add_u32 v21, 98304, v13
    v_xor_b32 v1, 5, v31
    v_lshl_add_u32 v14, v1, 5, v30
    v_add_u32 v22, 98304, v14
    v_xor_b32 v1, 6, v31
    v_lshl_add_u32 v15, v1, 5, v30
    v_add_u32 v23, 98304, v15
    v_xor_b32 v1, 7, v31
    v_lshl_add_u32 v16, v1, 5, v30
    v_add_u32 v24, 98304, v16
    s_mov_b32 s64, s18
    s_and_b32 s65, s19, 0xffff
    s_mov_b32 s66, 0x200000
    s_mov_b32 s67, 0x20000
    s_mov_b32 s68, s20
    s_and_b32 s69, s21, 0xffff
    s_mov_b32 s70, 0x200000
    s_mov_b32 s71, 0x20000
    s_add_u32 s56, s38, 0x400000
    s_addc_u32 s57, s39, 0
    s_and_b32 s57, s57, 0xffff
    s_mov_b32 s58, 0xe00000
    s_mov_b32 s59, 0x20000
    s_add_u32 s60, s38, 0x1200000
    s_addc_u32 s61, s39, 0
    s_and_b32 s61, s61, 0xffff
    s_mov_b32 s62, 0x1000000
    s_mov_b32 s63, 0x20000
    v_lshrrev_b32 v30, 4, v0
    v_and_b32 v31, 15, v0
    v_xor_b32 v1, v31, v30
    v_xor_b32 v25, 0, v1
    v_lshlrev_b32 v25, 4, v25
    v_lshl_add_u32 v25, v30, 8, v25
    v_xor_b32 v26, 4, v1
    v_lshlrev_b32 v26, 4, v26
    v_lshl_add_u32 v26, v30, 8, v26
    v_xor_b32 v27, 8, v1
    v_lshlrev_b32 v27, 4, v27
    v_lshl_add_u32 v27, v30, 8, v27
    v_xor_b32 v28, 12, v1
    v_lshlrev_b32 v28, 4, v28
    v_lshl_add_u32 v28, v30, 8, v28
    v_lshlrev_b32 v1, 2, v30
    v_xor_b32 v1, v31, v1
    v_lshlrev_b32 v1, 4, v1
    v_lshl_add_u32 v29, v30, 8, v1
    s_lshr_b32 s12, s5, 3
    s_lshl_b32 s12, s12, 19
    s_lshl_b32 s92, s3, 12
    s_add_u32 s93, s12, s92
    s_add_u32 s93, s93, 393216
    s_mov_b32 s9, 7
    s_cmp_lg_u32 s3, 0
    s_cbranch_scc1 recurrent_scan__sliding_block_cached__glu_gated_glu__prompt_kernel_gotL
    v_and_b32 v1, 31, v0
    v_lshlrev_b32 v1, 5, v1
    s_lshl_b32 s13, s4, 10
    s_add_u32 s13, s13, 16384
    s_mov_b32 s12, 0x10000
recurrent_scan__sliding_block_cached__glu_gated_glu__prompt_kernel_pollL:
    buffer_load_dwordx2 v[128:129], v1, s[84:87], s13 offen sc0 sc1
    s_waitcnt vmcnt(0)
    s_sub_u32 s12, s12, 1
    s_cbranch_scc1 recurrent_scan__sliding_block_cached__glu_gated_glu__prompt_kernel_gotL
    v_cmp_ne_u64 vcc, s[98:99], v[128:129]
    s_cbranch_vccz recurrent_scan__sliding_block_cached__glu_gated_glu__prompt_kernel_gotL
    s_sleep 1
    s_branch recurrent_scan__sliding_block_cached__glu_gated_glu__prompt_kernel_pollL
recurrent_scan__sliding_block_cached__glu_gated_glu__prompt_kernel_gotL:
    s_waitcnt vmcnt(6)
    s_barrier
    buffer_load_dwordx4 a[128:131], v5, s[40:43], s90 offen sc0 sc1
    buffer_load_dwordx4 a[132:135], v6, s[40:43], s90 offen sc0 sc1
    buffer_load_dwordx4 a[136:139], v7, s[40:43], s90 offen sc0 sc1
    buffer_load_dwordx4 a[140:143], v8, s[40:43], s90 offen sc0 sc1
    buffer_load_dwordx4 a[144:147], v5, s[40:43], s89 offen sc0 sc1
    buffer_load_dwordx4 a[148:151], v6, s[40:43], s89 offen sc0 sc1
    buffer_load_dwordx4 a[152:155], v7, s[40:43], s89 offen sc0 sc1
    buffer_load_dwordx4 a[156:159], v8, s[40:43], s89 offen sc0 sc1
    s_cmp_lt_u32 s11, 8
    s_cselect_b32 s13, 1, 7
    s_and_b32 s13, s13, s14
    s_add_u32 s12, s11, s13
    s_and_b32 s12, s12, 7
    s_and_b32 s13, s11, 0x18
    s_or_b32 s12, s12, s13
    s_add_u32 s11, s11, 1
    s_lshl_b32 s6, s12, 18
    s_mul_i32 s7, s12, 229376
    s_lshl_b32 s8, s12, 10
    s_mov_b32 s89, s8
    s_add_u32 m0, s10, 73728
    s_nop 0
    buffer_load_dwordx4 v2, s[44:47], s6 offen lds
    s_add_u32 s6, s6, 131072
    buffer_load_dwordx4 v3, s[48:51], s7 offen offset:1024 lds
    buffer_load_dwordx4 v3, s[52:55], s7 offen offset:2048 lds
    s_add_u32 s7, s7, 114688
    s_add_u32 m0, s10, 86016
    s_nop 0
    buffer_load_dwordx4 v2, s[44:47], s6 offen lds
    buffer_load_dwordx4 v3, s[48:51], s7 offen offset:1024 lds
    buffer_load_dwordx4 v3, s[52:55], s7 offen offset:2048 lds
    ds_read_b64_tr_b16 a[192:193], v9 offset:1024
    ds_read_b64_tr_b16 a[194:195], v9 offset:4096
    ds_read_b64_tr_b16 a[196:197], v9 offset:25600
    ds_read_b64_tr_b16 a[198:199], v9 offset:28672
    ds_read_b64_tr_b16 a[200:201], v9 offset:2048
    ds_read_b64_tr_b16 a[202:203], v9 offset:5120
    ds_read_b64_tr_b16 a[204:205], v9 offset:26624
    ds_read_b64_tr_b16 a[206:207], v9 offset:29696
    ds_read_b64_tr_b16 a[208:209], v10 offset:1024
    ds_read_b64_tr_b16 a[210:211], v10 offset:4096
    ds_read_b64_tr_b16 a[212:213], v10 offset:25600
    ds_read_b64_tr_b16 a[214:215], v10 offset:28672
    ds_read_b64_tr_b16 a[216:217], v10 offset:2048
    ds_read_b64_tr_b16 a[218:219], v10 offset:5120
    ds_read_b64_tr_b16 a[220:221], v10 offset:26624
    ds_read_b64_tr_b16 a[222:223], v10 offset:29696
    v_mov_b32 v128, 0
    v_mov_b32 v129, 0
    v_mov_b32 v130, 0
    v_mov_b32 v131, 0
    s_waitcnt vmcnt(6)
.p2align 6
recurrent_scan__sliding_block_cached__glu_gated_glu__prompt_kernel_loop:
    s_waitcnt vmcnt(12)
    s_waitcnt lgkmcnt(10)
    v_mfma_f32_16x16x32_bf16 v[32:35], a[192:195], a[128:131], v[32:35]
    s_add_u32 s10, s72, s95
    s_add_u32 s73, s72, 98304
    v_mfma_f32_16x16x32_bf16 v[32:35], a[196:199], a[144:147], v[32:35]
    s_cmp_ge_u32 s73, 147456
    s_cselect_b32 s74, 147456, 0
    v_mfma_f32_16x16x32_bf16 v[36:39], a[192:195], a[132:135], v[36:39]
    buffer_load_dwordx4 a[160:163], v5, s[40:43], s88 offen sc0 sc1
    v_mfma_f32_16x16x32_bf16 v[36:39], a[196:199], a[148:151], v[36:39]
    s_sub_u32 s73, 98304, s74
    s_add_u32 s72, s72, 49152
    v_mfma_f32_16x16x32_bf16 v[40:43], a[192:195], a[136:139], v[40:43]
    s_cmp_ge_u32 s72, 147456
    s_cselect_b32 s72, 0, s72
    v_mfma_f32_16x16x32_bf16 v[40:43], a[196:199], a[152:155], v[40:43]
    v_add_u32 v17, s73, v17
    v_add_u32 v18, s73, v18
    v_mfma_f32_16x16x32_bf16 v[44:47], a[192:195], a[140:143], v[44:47]
    buffer_load_dwordx4 a[164:167], v6, s[40:43], s88 offen sc0 sc1
    v_mfma_f32_16x16x32_bf16 v[44:47], a[196:199], a[156:159], v[44:47]
    ds_read_b64_tr_b16 a[192:193], v11 offset:1024
    v_add_u32 v19, s73, v19
    s_waitcnt lgkmcnt(9)
    v_mfma_f32_16x16x32_bf16 v[48:51], a[200:203], a[128:131], v[48:51]
    ds_read_b64_tr_b16 a[194:195], v11 offset:4096
    v_add_u32 v20, s73, v20
    v_mfma_f32_16x16x32_bf16 v[48:51], a[204:207], a[144:147], v[48:51]
    ds_read_b64_tr_b16 a[196:197], v11 offset:25600
    v_add_u32 v21, s73, v21
    v_mfma_f32_16x16x32_bf16 v[52:55], a[200:203], a[132:135], v[52:55]
    buffer_load_dwordx4 a[168:171], v7, s[40:43], s88 offen sc0 sc1
    v_mfma_f32_16x16x32_bf16 v[52:55], a[204:207], a[148:151], v[52:55]
    ds_read_b64_tr_b16 a[198:199], v11 offset:28672
    v_add_u32 v22, s73, v22
    v_mfma_f32_16x16x32_bf16 v[56:59], a[200:203], a[136:139], v[56:59]
    v_add_u32 v23, s73, v23
    v_add_u32 v24, s73, v24
    v_mfma_f32_16x16x32_bf16 v[56:59], a[204:207], a[152:155], v[56:59]
    v_mfma_f32_16x16x32_bf16 v[60:63], a[200:203], a[140:143], v[60:63]
    buffer_load_dwordx4 a[172:175], v8, s[40:43], s88 offen sc0 sc1
    v_mfma_f32_16x16x32_bf16 v[60:63], a[204:207], a[156:159], v[60:63]
    ds_read_b64_tr_b16 a[200:201], v11 offset:2048
    s_waitcnt lgkmcnt(9)
    v_mfma_f32_16x16x32_bf16 v[64:67], a[208:211], a[128:131], v[64:67]
    ds_read_b64_tr_b16 a[202:203], v11 offset:5120
    v_mfma_f32_16x16x32_bf16 v[64:67], a[212:215], a[144:147], v[64:67]
    ds_read_b64_tr_b16 a[204:205], v11 offset:26624
    v_mfma_f32_16x16x32_bf16 v[68:71], a[208:211], a[132:135], v[68:71]
    buffer_load_dwordx4 a[176:179], v5, s[40:43], s89 offen sc0 sc1
    v_mfma_f32_16x16x32_bf16 v[68:71], a[212:215], a[148:151], v[68:71]
    ds_read_b64_tr_b16 a[206:207], v11 offset:29696
    v_mfma_f32_16x16x32_bf16 v[72:75], a[208:211], a[136:139], v[72:75]
    v_mfma_f32_16x16x32_bf16 v[72:75], a[212:215], a[152:155], v[72:75]
    v_mfma_f32_16x16x32_bf16 v[76:79], a[208:211], a[140:143], v[76:79]
    buffer_load_dwordx4 a[180:183], v6, s[40:43], s89 offen sc0 sc1
    v_mfma_f32_16x16x32_bf16 v[76:79], a[212:215], a[156:159], v[76:79]
    ds_read_b64_tr_b16 a[208:209], v12 offset:1024
    s_waitcnt lgkmcnt(9)
    v_mfma_f32_16x16x32_bf16 v[80:83], a[216:219], a[128:131], v[80:83]
    ds_read_b64_tr_b16 a[210:211], v12 offset:4096
    v_mfma_f32_16x16x32_bf16 v[80:83], a[220:223], a[144:147], v[80:83]
    ds_read_b64_tr_b16 a[212:213], v12 offset:25600
    v_mfma_f32_16x16x32_bf16 v[84:87], a[216:219], a[132:135], v[84:87]
    buffer_load_dwordx4 a[184:187], v7, s[40:43], s89 offen sc0 sc1
    v_mfma_f32_16x16x32_bf16 v[84:87], a[220:223], a[148:151], v[84:87]
    ds_read_b64_tr_b16 a[214:215], v12 offset:28672
    v_mfma_f32_16x16x32_bf16 v[88:91], a[216:219], a[136:139], v[88:91]
    v_mfma_f32_16x16x32_bf16 v[88:91], a[220:223], a[152:155], v[88:91]
    v_mfma_f32_16x16x32_bf16 v[92:95], a[216:219], a[140:143], v[92:95]
    buffer_load_dwordx4 a[188:191], v8, s[40:43], s89 offen sc0 sc1
    v_mfma_f32_16x16x32_bf16 v[92:95], a[220:223], a[156:159], v[92:95]
    ds_read_b64_tr_b16 a[216:217], v12 offset:2048
    s_cmp_lt_u32 s11, 8
    s_cselect_b32 s13, 1, 7
    s_waitcnt lgkmcnt(9)
    v_mfma_f32_16x16x32_bf16 v[96:99], a[192:195], a[128:131], v[96:99]
    ds_read_b64_tr_b16 a[218:219], v12 offset:5120
    s_and_b32 s13, s13, s14
    v_mfma_f32_16x16x32_bf16 v[96:99], a[196:199], a[144:147], v[96:99]
    ds_read_b64_tr_b16 a[220:221], v12 offset:26624
    s_add_u32 s12, s11, s13
    v_mfma_f32_16x16x32_bf16 v[100:103], a[192:195], a[132:135], v[100:103]
    ds_read_b64_tr_b16 a[222:223], v12 offset:29696
    s_and_b32 s12, s12, 7
    v_mfma_f32_16x16x32_bf16 v[100:103], a[196:199], a[148:151], v[100:103]
    s_and_b32 s13, s11, 0x18
    s_or_b32 s12, s12, s13
    v_mfma_f32_16x16x32_bf16 v[104:107], a[192:195], a[136:139], v[104:107]
    s_add_u32 s11, s11, 1
    s_lshl_b32 s6, s12, 18
    v_mfma_f32_16x16x32_bf16 v[104:107], a[196:199], a[152:155], v[104:107]
    s_mul_i32 s7, s12, 229376
    s_lshl_b32 s8, s12, 10
    v_mfma_f32_16x16x32_bf16 v[108:111], a[192:195], a[140:143], v[108:111]
    s_mov_b32 s88, s8
    s_add_u32 m0, s10, 0
    v_mfma_f32_16x16x32_bf16 v[108:111], a[196:199], a[156:159], v[108:111]
    ds_read_b64_tr_b16 a[192:193], v13 offset:1024
    s_waitcnt lgkmcnt(9)
    v_mfma_f32_16x16x32_bf16 v[112:115], a[200:203], a[128:131], v[112:115]
    ds_read_b64_tr_b16 a[194:195], v13 offset:4096
    v_mfma_f32_16x16x32_bf16 v[112:115], a[204:207], a[144:147], v[112:115]
    ds_read_b64_tr_b16 a[196:197], v13 offset:25600
    v_mfma_f32_16x16x32_bf16 v[116:119], a[200:203], a[132:135], v[116:119]
    buffer_load_dwordx4 v2, s[44:47], s6 offen lds
    v_mfma_f32_16x16x32_bf16 v[116:119], a[204:207], a[148:151], v[116:119]
    ds_read_b64_tr_b16 a[198:199], v13 offset:28672
    s_add_u32 s6, s6, 131072
    v_mfma_f32_16x16x32_bf16 v[120:123], a[200:203], a[136:139], v[120:123]
    v_mfma_f32_16x16x32_bf16 v[120:123], a[204:207], a[152:155], v[120:123]
    v_mfma_f32_16x16x32_bf16 v[124:127], a[200:203], a[140:143], v[124:127]
    v_mfma_f32_16x16x32_bf16 v[124:127], a[204:207], a[156:159], v[124:127]
    ds_read_b64_tr_b16 a[200:201], v13 offset:2048
    s_waitcnt lgkmcnt(9)
    v_mfma_f32_16x16x32_bf16 v[128:131], a[208:211], a[128:131], v[128:131]
    ds_read_b64_tr_b16 a[202:203], v13 offset:5120
    v_mfma_f32_16x16x32_bf16 v[128:131], a[212:215], a[144:147], v[128:131]
    ds_read_b64_tr_b16 a[204:205], v13 offset:26624
    v_mfma_f32_16x16x32_bf16 v[132:135], a[208:211], a[132:135], v[132:135]
    buffer_load_dwordx4 v3, s[48:51], s7 offen offset:1024 lds
    v_mfma_f32_16x16x32_bf16 v[132:135], a[212:215], a[148:151], v[132:135]
    ds_read_b64_tr_b16 a[206:207], v13 offset:29696
    v_mfma_f32_16x16x32_bf16 v[136:139], a[208:211], a[136:139], v[136:139]
    v_mfma_f32_16x16x32_bf16 v[136:139], a[212:215], a[152:155], v[136:139]
    v_mfma_f32_16x16x32_bf16 v[140:143], a[208:211], a[140:143], v[140:143]
    v_mfma_f32_16x16x32_bf16 v[140:143], a[212:215], a[156:159], v[140:143]
    ds_read_b64_tr_b16 a[208:209], v14 offset:1024
    s_waitcnt lgkmcnt(9)
    v_mfma_f32_16x16x32_bf16 v[144:147], a[216:219], a[128:131], v[144:147]
    ds_read_b64_tr_b16 a[210:211], v14 offset:4096
    v_mfma_f32_16x16x32_bf16 v[144:147], a[220:223], a[144:147], v[144:147]
    ds_read_b64_tr_b16 a[212:213], v14 offset:25600
    v_mfma_f32_16x16x32_bf16 v[148:151], a[216:219], a[132:135], v[148:151]
    buffer_load_dwordx4 v3, s[52:55], s7 offen offset:2048 lds
    v_mfma_f32_16x16x32_bf16 v[148:151], a[220:223], a[148:151], v[148:151]
    ds_read_b64_tr_b16 a[214:215], v14 offset:28672
    s_add_u32 s7, s7, 114688
    v_mfma_f32_16x16x32_bf16 v[152:155], a[216:219], a[136:139], v[152:155]
    s_add_u32 m0, s10, 12288
    v_mfma_f32_16x16x32_bf16 v[152:155], a[220:223], a[152:155], v[152:155]
    v_mfma_f32_16x16x32_bf16 v[156:159], a[216:219], a[140:143], v[156:159]
    v_mfma_f32_16x16x32_bf16 v[156:159], a[220:223], a[156:159], v[156:159]
    ds_read_b64_tr_b16 a[216:217], v14 offset:2048
    s_waitcnt lgkmcnt(9)
    v_mfma_f32_16x16x32_bf16 v[160:163], a[192:195], a[128:131], v[160:163]
    ds_read_b64_tr_b16 a[218:219], v14 offset:5120
    v_mfma_f32_16x16x32_bf16 v[160:163], a[196:199], a[144:147], v[160:163]
    ds_read_b64_tr_b16 a[220:221], v14 offset:26624
    v_mfma_f32_16x16x32_bf16 v[164:167], a[192:195], a[132:135], v[164:167]
    buffer_load_dwordx4 v2, s[44:47], s6 offen lds
    v_mfma_f32_16x16x32_bf16 v[164:167], a[196:199], a[148:151], v[164:167]
    ds_read_b64_tr_b16 a[222:223], v14 offset:29696
    v_mfma_f32_16x16x32_bf16 v[168:171], a[192:195], a[136:139], v[168:171]
    v_mfma_f32_16x16x32_bf16 v[168:171], a[196:199], a[152:155], v[168:171]
    v_mfma_f32_16x16x32_bf16 v[172:175], a[192:195], a[140:143], v[172:175]
    v_mfma_f32_16x16x32_bf16 v[172:175], a[196:199], a[156:159], v[172:175]
    ds_read_b64_tr_b16 a[192:193], v15 offset:1024
    s_waitcnt lgkmcnt(9)
    v_mfma_f32_16x16x32_bf16 v[176:179], a[200:203], a[128:131], v[176:179]
    ds_read_b64_tr_b16 a[194:195], v15 offset:4096
    v_mfma_f32_16x16x32_bf16 v[176:179], a[204:207], a[144:147], v[176:179]
    ds_read_b64_tr_b16 a[196:197], v15 offset:25600
    v_mfma_f32_16x16x32_bf16 v[180:183], a[200:203], a[132:135], v[180:183]
    ds_read_b64_tr_b16 a[198:199], v15 offset:28672
    v_mfma_f32_16x16x32_bf16 v[180:183], a[204:207], a[148:151], v[180:183]
    v_mfma_f32_16x16x32_bf16 v[184:187], a[200:203], a[136:139], v[184:187]
    v_mfma_f32_16x16x32_bf16 v[184:187], a[204:207], a[152:155], v[184:187]
    v_mfma_f32_16x16x32_bf16 v[188:191], a[200:203], a[140:143], v[188:191]
    buffer_load_dwordx4 v3, s[48:51], s7 offen offset:1024 lds
    v_mfma_f32_16x16x32_bf16 v[188:191], a[204:207], a[156:159], v[188:191]
    ds_read_b64_tr_b16 a[200:201], v15 offset:2048
    s_waitcnt lgkmcnt(9)
    v_mfma_f32_16x16x32_bf16 v[192:195], a[208:211], a[128:131], v[192:195]
    ds_read_b64_tr_b16 a[202:203], v15 offset:5120
    v_mfma_f32_16x16x32_bf16 v[192:195], a[212:215], a[144:147], v[192:195]
    ds_read_b64_tr_b16 a[204:205], v15 offset:26624
    v_mfma_f32_16x16x32_bf16 v[196:199], a[208:211], a[132:135], v[196:199]
    ds_read_b64_tr_b16 a[206:207], v15 offset:29696
    v_mfma_f32_16x16x32_bf16 v[196:199], a[212:215], a[148:151], v[196:199]
    v_mfma_f32_16x16x32_bf16 v[200:203], a[208:211], a[136:139], v[200:203]
    v_mfma_f32_16x16x32_bf16 v[200:203], a[212:215], a[152:155], v[200:203]
    v_mfma_f32_16x16x32_bf16 v[204:207], a[208:211], a[140:143], v[204:207]
    buffer_load_dwordx4 v3, s[52:55], s7 offen offset:2048 lds
    v_mfma_f32_16x16x32_bf16 v[204:207], a[212:215], a[156:159], v[204:207]
    ds_read_b64_tr_b16 a[208:209], v9 offset:0
    s_cmp_lt_u32 s11, 8
    s_cselect_b32 s13, 1, 7
    s_waitcnt lgkmcnt(9)
    v_mfma_f32_16x16x32_bf16 v[208:211], a[216:219], a[128:131], v[208:211]
    ds_read_b64_tr_b16 a[210:211], v9 offset:3072
    s_and_b32 s13, s13, s14
    v_mfma_f32_16x16x32_bf16 v[208:211], a[220:223], a[144:147], v[208:211]
    ds_read_b64_tr_b16 a[212:213], v9 offset:24576
    s_add_u32 s12, s11, s13
    v_mfma_f32_16x16x32_bf16 v[212:215], a[216:219], a[132:135], v[212:215]
    ds_read_b64_tr_b16 a[214:215], v9 offset:27648
    s_and_b32 s12, s12, 7
    v_mfma_f32_16x16x32_bf16 v[212:215], a[220:223], a[148:151], v[212:215]
    s_and_b32 s13, s11, 0x18
    s_or_b32 s12, s12, s13
    v_mfma_f32_16x16x32_bf16 v[216:219], a[216:219], a[136:139], v[216:219]
    s_add_u32 s11, s11, 1
    s_lshl_b32 s6, s12, 18
    v_mfma_f32_16x16x32_bf16 v[216:219], a[220:223], a[152:155], v[216:219]
    s_mul_i32 s7, s12, 229376
    s_lshl_b32 s8, s12, 10
    v_mfma_f32_16x16x32_bf16 v[220:223], a[216:219], a[140:143], v[220:223]
    s_mov_b32 s89, s8
    s_add_u32 m0, s10, 24576
    s_nop 0
    buffer_load_dwordx4 v2, s[44:47], s6 offen lds
    v_mfma_f32_16x16x32_bf16 v[220:223], a[220:223], a[156:159], v[220:223]
    ds_read_b64_tr_b16 a[216:217], v10 offset:0
    s_add_u32 s6, s6, 131072
    s_waitcnt lgkmcnt(9)
    v_mfma_f32_16x16x32_bf16 v[224:227], a[192:195], a[128:131], v[224:227]
    ds_read_b64_tr_b16 a[218:219], v10 offset:3072
    v_mfma_f32_16x16x32_bf16 v[224:227], a[196:199], a[144:147], v[224:227]
    ds_read_b64_tr_b16 a[220:221], v10 offset:24576
    v_mfma_f32_16x16x32_bf16 v[228:231], a[192:195], a[132:135], v[228:231]
    ds_read_b64_tr_b16 a[222:223], v10 offset:27648
    v_mfma_f32_16x16x32_bf16 v[228:231], a[196:199], a[148:151], v[228:231]
    v_mfma_f32_16x16x32_bf16 v[232:235], a[192:195], a[136:139], v[232:235]
    v_mfma_f32_16x16x32_bf16 v[232:235], a[196:199], a[152:155], v[232:235]
    v_mfma_f32_16x16x32_bf16 v[236:239], a[192:195], a[140:143], v[236:239]
    buffer_load_dwordx4 v3, s[48:51], s7 offen offset:1024 lds
    v_mfma_f32_16x16x32_bf16 v[236:239], a[196:199], a[156:159], v[236:239]
    ds_read_b64_tr_b16 a[192:193], v11 offset:0
    s_waitcnt lgkmcnt(9)
    v_mfma_f32_16x16x32_bf16 v[240:243], a[200:203], a[128:131], v[240:243]
    ds_read_b64_tr_b16 a[194:195], v11 offset:3072
    v_mfma_f32_16x16x32_bf16 v[240:243], a[204:207], a[144:147], v[240:243]
    ds_read_b64_tr_b16 a[196:197], v11 offset:24576
    v_mfma_f32_16x16x32_bf16 v[244:247], a[200:203], a[132:135], v[244:247]
    ds_read_b64_tr_b16 a[198:199], v11 offset:27648
    v_mfma_f32_16x16x32_bf16 v[244:247], a[204:207], a[148:151], v[244:247]
    v_mfma_f32_16x16x32_bf16 v[248:251], a[200:203], a[136:139], v[248:251]
    v_mfma_f32_16x16x32_bf16 v[248:251], a[204:207], a[152:155], v[248:251]
    v_mfma_f32_16x16x32_bf16 v[252:255], a[200:203], a[140:143], v[252:255]
    v_mfma_f32_16x16x32_bf16 v[252:255], a[204:207], a[156:159], v[252:255]
    ds_read_b64_tr_b16 a[200:201], v12 offset:0
    s_waitcnt lgkmcnt(9)
    v_mfma_f32_16x16x32_bf16 a[0:3], a[208:211], a[128:131], a[0:3]
    ds_read_b64_tr_b16 a[202:203], v12 offset:3072
    v_mfma_f32_16x16x32_bf16 a[0:3], a[212:215], a[144:147], a[0:3]
    ds_read_b64_tr_b16 a[204:205], v12 offset:24576
    v_mfma_f32_16x16x32_bf16 a[4:7], a[208:211], a[132:135], a[4:7]
    buffer_load_dwordx4 v3, s[52:55], s7 offen offset:2048 lds
    v_mfma_f32_16x16x32_bf16 a[4:7], a[212:215], a[148:151], a[4:7]
    ds_read_b64_tr_b16 a[206:207], v12 offset:27648
    s_add_u32 s7, s7, 114688
    v_mfma_f32_16x16x32_bf16 a[8:11], a[208:211], a[136:139], a[8:11]
    s_add_u32 m0, s10, 36864
    v_mfma_f32_16x16x32_bf16 a[8:11], a[212:215], a[152:155], a[8:11]
    v_mfma_f32_16x16x32_bf16 a[12:15], a[208:211], a[140:143], a[12:15]
    v_mfma_f32_16x16x32_bf16 a[12:15], a[212:215], a[156:159], a[12:15]
    ds_read_b64_tr_b16 a[208:209], v13 offset:0
    s_waitcnt lgkmcnt(9)
    v_mfma_f32_16x16x32_bf16 a[16:19], a[216:219], a[128:131], a[16:19]
    ds_read_b64_tr_b16 a[210:211], v13 offset:3072
    v_mfma_f32_16x16x32_bf16 a[16:19], a[220:223], a[144:147], a[16:19]
    ds_read_b64_tr_b16 a[212:213], v13 offset:24576
    v_mfma_f32_16x16x32_bf16 a[20:23], a[216:219], a[132:135], a[20:23]
    buffer_load_dwordx4 v2, s[44:47], s6 offen lds
    v_mfma_f32_16x16x32_bf16 a[20:23], a[220:223], a[148:151], a[20:23]
    ds_read_b64_tr_b16 a[214:215], v13 offset:27648
    v_mfma_f32_16x16x32_bf16 a[24:27], a[216:219], a[136:139], a[24:27]
    v_mfma_f32_16x16x32_bf16 a[24:27], a[220:223], a[152:155], a[24:27]
    v_mfma_f32_16x16x32_bf16 a[28:31], a[216:219], a[140:143], a[28:31]
    v_mfma_f32_16x16x32_bf16 a[28:31], a[220:223], a[156:159], a[28:31]
    ds_read_b64_tr_b16 a[216:217], v14 offset:0
    s_waitcnt lgkmcnt(9)
    v_mfma_f32_16x16x32_bf16 a[32:35], a[192:195], a[128:131], a[32:35]
    ds_read_b64_tr_b16 a[218:219], v14 offset:3072
    v_mfma_f32_16x16x32_bf16 a[32:35], a[196:199], a[144:147], a[32:35]
    ds_read_b64_tr_b16 a[220:221], v14 offset:24576
    v_mfma_f32_16x16x32_bf16 a[36:39], a[192:195], a[132:135], a[36:39]
    buffer_load_dwordx4 v3, s[48:51], s7 offen offset:1024 lds
    v_mfma_f32_16x16x32_bf16 a[36:39], a[196:199], a[148:151], a[36:39]
    ds_read_b64_tr_b16 a[222:223], v14 offset:27648
    v_mfma_f32_16x16x32_bf16 a[40:43], a[192:195], a[136:139], a[40:43]
    v_mfma_f32_16x16x32_bf16 a[40:43], a[196:199], a[152:155], a[40:43]
    v_mfma_f32_16x16x32_bf16 a[44:47], a[192:195], a[140:143], a[44:47]
    v_mfma_f32_16x16x32_bf16 a[44:47], a[196:199], a[156:159], a[44:47]
    ds_read_b64_tr_b16 a[192:193], v15 offset:0
    s_waitcnt lgkmcnt(9)
    v_mfma_f32_16x16x32_bf16 a[48:51], a[200:203], a[128:131], a[48:51]
    ds_read_b64_tr_b16 a[194:195], v15 offset:3072
    v_mfma_f32_16x16x32_bf16 a[48:51], a[204:207], a[144:147], a[48:51]
    ds_read_b64_tr_b16 a[196:197], v15 offset:24576
    v_mfma_f32_16x16x32_bf16 a[52:55], a[200:203], a[132:135], a[52:55]
    buffer_load_dwordx4 v3, s[52:55], s7 offen offset:2048 lds
    v_mfma_f32_16x16x32_bf16 a[52:55], a[204:207], a[148:151], a[52:55]
    ds_read_b64_tr_b16 a[198:199], v15 offset:27648
    v_mfma_f32_16x16x32_bf16 a[56:59], a[200:203], a[136:139], a[56:59]
    v_mfma_f32_16x16x32_bf16 a[56:59], a[204:207], a[152:155], a[56:59]
    v_mfma_f32_16x16x32_bf16 a[60:63], a[200:203], a[140:143], a[60:63]
    v_mfma_f32_16x16x32_bf16 a[60:63], a[204:207], a[156:159], a[60:63]
    ds_read_b64_tr_b16 a[200:201], v16 offset:0
    s_waitcnt lgkmcnt(9)
    v_mfma_f32_16x16x32_bf16 a[64:67], a[208:211], a[128:131], a[64:67]
    ds_read_b64_tr_b16 a[202:203], v16 offset:3072
    v_mfma_f32_16x16x32_bf16 a[64:67], a[212:215], a[144:147], a[64:67]
    ds_read_b64_tr_b16 a[204:205], v16 offset:24576
    v_mfma_f32_16x16x32_bf16 a[68:71], a[208:211], a[132:135], a[68:71]
    ds_read_b64_tr_b16 a[206:207], v16 offset:27648
    v_mfma_f32_16x16x32_bf16 a[68:71], a[212:215], a[148:151], a[68:71]
    v_mfma_f32_16x16x32_bf16 a[72:75], a[208:211], a[136:139], a[72:75]
    v_mfma_f32_16x16x32_bf16 a[72:75], a[212:215], a[152:155], a[72:75]
    v_mfma_f32_16x16x32_bf16 a[76:79], a[208:211], a[140:143], a[76:79]
    v_mfma_f32_16x16x32_bf16 a[76:79], a[212:215], a[156:159], a[76:79]
    s_waitcnt vmcnt(20)
    s_waitcnt lgkmcnt(0)
    s_barrier
    ds_read_b64_tr_b16 a[208:209], v17 offset:1024
    v_mfma_f32_16x16x32_bf16 a[80:83], a[216:219], a[128:131], a[80:83]
    ds_read_b64_tr_b16 a[210:211], v17 offset:4096
    v_mfma_f32_16x16x32_bf16 a[80:83], a[220:223], a[144:147], a[80:83]
    ds_read_b64_tr_b16 a[212:213], v17 offset:25600
    v_mfma_f32_16x16x32_bf16 a[84:87], a[216:219], a[132:135], a[84:87]
    ds_read_b64_tr_b16 a[214:215], v17 offset:28672
    v_mfma_f32_16x16x32_bf16 a[84:87], a[220:223], a[148:151], a[84:87]
    v_mfma_f32_16x16x32_bf16 a[88:91], a[216:219], a[136:139], a[88:91]
    v_mfma_f32_16x16x32_bf16 a[88:91], a[220:223], a[152:155], a[88:91]
    v_mfma_f32_16x16x32_bf16 a[92:95], a[216:219], a[140:143], a[92:95]
    v_mfma_f32_16x16x32_bf16 a[92:95], a[220:223], a[156:159], a[92:95]
    ds_read_b64_tr_b16 a[216:217], v17 offset:2048
    v_mfma_f32_16x16x32_bf16 a[96:99], a[192:195], a[128:131], a[96:99]
    ds_read_b64_tr_b16 a[218:219], v17 offset:5120
    v_mfma_f32_16x16x32_bf16 a[96:99], a[196:199], a[144:147], a[96:99]
    ds_read_b64_tr_b16 a[220:221], v17 offset:26624
    v_mfma_f32_16x16x32_bf16 a[100:103], a[192:195], a[132:135], a[100:103]
    ds_read_b64_tr_b16 a[222:223], v17 offset:29696
    v_mfma_f32_16x16x32_bf16 a[100:103], a[196:199], a[148:151], a[100:103]
    v_mfma_f32_16x16x32_bf16 a[104:107], a[192:195], a[136:139], a[104:107]
    v_mfma_f32_16x16x32_bf16 a[104:107], a[196:199], a[152:155], a[104:107]
    v_mfma_f32_16x16x32_bf16 a[108:111], a[192:195], a[140:143], a[108:111]
    v_mfma_f32_16x16x32_bf16 a[108:111], a[196:199], a[156:159], a[108:111]
    ds_read_b64_tr_b16 a[192:193], v18 offset:1024
    v_mfma_f32_16x16x32_bf16 a[112:115], a[200:203], a[128:131], a[112:115]
    ds_read_b64_tr_b16 a[194:195], v18 offset:4096
    v_mfma_f32_16x16x32_bf16 a[112:115], a[204:207], a[144:147], a[112:115]
    ds_read_b64_tr_b16 a[196:197], v18 offset:25600
    v_mfma_f32_16x16x32_bf16 a[116:119], a[200:203], a[132:135], a[116:119]
    ds_read_b64_tr_b16 a[198:199], v18 offset:28672
    v_mfma_f32_16x16x32_bf16 a[116:119], a[204:207], a[148:151], a[116:119]
    v_mfma_f32_16x16x32_bf16 a[120:123], a[200:203], a[136:139], a[120:123]
    v_mfma_f32_16x16x32_bf16 a[120:123], a[204:207], a[152:155], a[120:123]
    v_mfma_f32_16x16x32_bf16 a[124:127], a[200:203], a[140:143], a[124:127]
    v_mfma_f32_16x16x32_bf16 a[124:127], a[204:207], a[156:159], a[124:127]
    ds_read_b64_tr_b16 a[200:201], v18 offset:2048
    ds_read_b64_tr_b16 a[202:203], v18 offset:5120
    ds_read_b64_tr_b16 a[204:205], v18 offset:26624
    ds_read_b64_tr_b16 a[206:207], v18 offset:29696
    s_waitcnt vmcnt(12)
    s_waitcnt lgkmcnt(10)
    v_mfma_f32_16x16x32_bf16 v[32:35], a[208:211], a[160:163], v[32:35]
    s_add_u32 s10, s72, s95
    s_add_u32 s73, s72, 98304
    v_mfma_f32_16x16x32_bf16 v[32:35], a[212:215], a[176:179], v[32:35]
    s_cmp_ge_u32 s73, 147456
    s_cselect_b32 s74, 147456, 0
    v_mfma_f32_16x16x32_bf16 v[36:39], a[208:211], a[164:167], v[36:39]
    buffer_load_dwordx4 a[128:131], v5, s[40:43], s88 offen sc0 sc1
    v_mfma_f32_16x16x32_bf16 v[36:39], a[212:215], a[180:183], v[36:39]
    s_sub_u32 s73, 98304, s74
    s_add_u32 s72, s72, 49152
    v_mfma_f32_16x16x32_bf16 v[40:43], a[208:211], a[168:171], v[40:43]
    s_cmp_ge_u32 s72, 147456
    s_cselect_b32 s72, 0, s72
    v_mfma_f32_16x16x32_bf16 v[40:43], a[212:215], a[184:187], v[40:43]
    v_add_u32 v9, s73, v9
    v_add_u32 v10, s73, v10
    v_mfma_f32_16x16x32_bf16 v[44:47], a[208:211], a[172:175], v[44:47]
    buffer_load_dwordx4 a[132:135], v6, s[40:43], s88 offen sc0 sc1
    v_mfma_f32_16x16x32_bf16 v[44:47], a[212:215], a[188:191], v[44:47]
    ds_read_b64_tr_b16 a[208:209], v19 offset:1024
    v_add_u32 v11, s73, v11
    s_waitcnt lgkmcnt(9)
    v_mfma_f32_16x16x32_bf16 v[48:51], a[216:219], a[160:163], v[48:51]
    ds_read_b64_tr_b16 a[210:211], v19 offset:4096
    v_add_u32 v12, s73, v12
    v_mfma_f32_16x16x32_bf16 v[48:51], a[220:223], a[176:179], v[48:51]
    ds_read_b64_tr_b16 a[212:213], v19 offset:25600
    v_add_u32 v13, s73, v13
    v_mfma_f32_16x16x32_bf16 v[52:55], a[216:219], a[164:167], v[52:55]
    buffer_load_dwordx4 a[136:139], v7, s[40:43], s88 offen sc0 sc1
    v_mfma_f32_16x16x32_bf16 v[52:55], a[220:223], a[180:183], v[52:55]
    ds_read_b64_tr_b16 a[214:215], v19 offset:28672
    v_add_u32 v14, s73, v14
    v_mfma_f32_16x16x32_bf16 v[56:59], a[216:219], a[168:171], v[56:59]
    v_add_u32 v15, s73, v15
    v_add_u32 v16, s73, v16
    v_mfma_f32_16x16x32_bf16 v[56:59], a[220:223], a[184:187], v[56:59]
    v_mfma_f32_16x16x32_bf16 v[60:63], a[216:219], a[172:175], v[60:63]
    buffer_load_dwordx4 a[140:143], v8, s[40:43], s88 offen sc0 sc1
    v_mfma_f32_16x16x32_bf16 v[60:63], a[220:223], a[188:191], v[60:63]
    ds_read_b64_tr_b16 a[216:217], v19 offset:2048
    s_waitcnt lgkmcnt(9)
    v_mfma_f32_16x16x32_bf16 v[64:67], a[192:195], a[160:163], v[64:67]
    ds_read_b64_tr_b16 a[218:219], v19 offset:5120
    v_mfma_f32_16x16x32_bf16 v[64:67], a[196:199], a[176:179], v[64:67]
    ds_read_b64_tr_b16 a[220:221], v19 offset:26624
    v_mfma_f32_16x16x32_bf16 v[68:71], a[192:195], a[164:167], v[68:71]
    buffer_load_dwordx4 a[144:147], v5, s[40:43], s89 offen sc0 sc1
    v_mfma_f32_16x16x32_bf16 v[68:71], a[196:199], a[180:183], v[68:71]
    ds_read_b64_tr_b16 a[222:223], v19 offset:29696
    v_mfma_f32_16x16x32_bf16 v[72:75], a[192:195], a[168:171], v[72:75]
    v_mfma_f32_16x16x32_bf16 v[72:75], a[196:199], a[184:187], v[72:75]
    v_mfma_f32_16x16x32_bf16 v[76:79], a[192:195], a[172:175], v[76:79]
    buffer_load_dwordx4 a[148:151], v6, s[40:43], s89 offen sc0 sc1
    v_mfma_f32_16x16x32_bf16 v[76:79], a[196:199], a[188:191], v[76:79]
    ds_read_b64_tr_b16 a[192:193], v20 offset:1024
    s_waitcnt lgkmcnt(9)
    v_mfma_f32_16x16x32_bf16 v[80:83], a[200:203], a[160:163], v[80:83]
    ds_read_b64_tr_b16 a[194:195], v20 offset:4096
    v_mfma_f32_16x16x32_bf16 v[80:83], a[204:207], a[176:179], v[80:83]
    ds_read_b64_tr_b16 a[196:197], v20 offset:25600
    v_mfma_f32_16x16x32_bf16 v[84:87], a[200:203], a[164:167], v[84:87]
    buffer_load_dwordx4 a[152:155], v7, s[40:43], s89 offen sc0 sc1
    v_mfma_f32_16x16x32_bf16 v[84:87], a[204:207], a[180:183], v[84:87]
    ds_read_b64_tr_b16 a[198:199], v20 offset:28672
    v_mfma_f32_16x16x32_bf16 v[88:91], a[200:203], a[168:171], v[88:91]
    v_mfma_f32_16x16x32_bf16 v[88:91], a[204:207], a[184:187], v[88:91]
    v_mfma_f32_16x16x32_bf16 v[92:95], a[200:203], a[172:175], v[92:95]
    buffer_load_dwordx4 a[156:159], v8, s[40:43], s89 offen sc0 sc1
    v_mfma_f32_16x16x32_bf16 v[92:95], a[204:207], a[188:191], v[92:95]
    ds_read_b64_tr_b16 a[200:201], v20 offset:2048
    s_cmp_lt_u32 s11, 8
    s_cselect_b32 s13, 1, 7
    s_waitcnt lgkmcnt(9)
    v_mfma_f32_16x16x32_bf16 v[96:99], a[208:211], a[160:163], v[96:99]
    ds_read_b64_tr_b16 a[202:203], v20 offset:5120
    s_and_b32 s13, s13, s14
    v_mfma_f32_16x16x32_bf16 v[96:99], a[212:215], a[176:179], v[96:99]
    ds_read_b64_tr_b16 a[204:205], v20 offset:26624
    s_add_u32 s12, s11, s13
    v_mfma_f32_16x16x32_bf16 v[100:103], a[208:211], a[164:167], v[100:103]
    ds_read_b64_tr_b16 a[206:207], v20 offset:29696
    s_and_b32 s12, s12, 7
    v_mfma_f32_16x16x32_bf16 v[100:103], a[212:215], a[180:183], v[100:103]
    s_and_b32 s13, s11, 0x18
    s_or_b32 s12, s12, s13
    v_mfma_f32_16x16x32_bf16 v[104:107], a[208:211], a[168:171], v[104:107]
    s_add_u32 s11, s11, 1
    s_lshl_b32 s6, s12, 18
    v_mfma_f32_16x16x32_bf16 v[104:107], a[212:215], a[184:187], v[104:107]
    s_mul_i32 s7, s12, 229376
    s_lshl_b32 s8, s12, 10
    v_mfma_f32_16x16x32_bf16 v[108:111], a[208:211], a[172:175], v[108:111]
    s_mov_b32 s88, s8
    s_add_u32 m0, s10, 0
    v_mfma_f32_16x16x32_bf16 v[108:111], a[212:215], a[188:191], v[108:111]
    ds_read_b64_tr_b16 a[208:209], v21 offset:1024
    s_waitcnt lgkmcnt(9)
    v_mfma_f32_16x16x32_bf16 v[112:115], a[216:219], a[160:163], v[112:115]
    ds_read_b64_tr_b16 a[210:211], v21 offset:4096
    v_mfma_f32_16x16x32_bf16 v[112:115], a[220:223], a[176:179], v[112:115]
    ds_read_b64_tr_b16 a[212:213], v21 offset:25600
    v_mfma_f32_16x16x32_bf16 v[116:119], a[216:219], a[164:167], v[116:119]
    buffer_load_dwordx4 v2, s[44:47], s6 offen lds
    v_mfma_f32_16x16x32_bf16 v[116:119], a[220:223], a[180:183], v[116:119]
    ds_read_b64_tr_b16 a[214:215], v21 offset:28672
    s_add_u32 s6, s6, 131072
    v_mfma_f32_16x16x32_bf16 v[120:123], a[216:219], a[168:171], v[120:123]
    v_mfma_f32_16x16x32_bf16 v[120:123], a[220:223], a[184:187], v[120:123]
    v_mfma_f32_16x16x32_bf16 v[124:127], a[216:219], a[172:175], v[124:127]
    v_mfma_f32_16x16x32_bf16 v[124:127], a[220:223], a[188:191], v[124:127]
    ds_read_b64_tr_b16 a[216:217], v21 offset:2048
    s_waitcnt lgkmcnt(9)
    v_mfma_f32_16x16x32_bf16 v[128:131], a[192:195], a[160:163], v[128:131]
    ds_read_b64_tr_b16 a[218:219], v21 offset:5120
    v_mfma_f32_16x16x32_bf16 v[128:131], a[196:199], a[176:179], v[128:131]
    ds_read_b64_tr_b16 a[220:221], v21 offset:26624
    v_mfma_f32_16x16x32_bf16 v[132:135], a[192:195], a[164:167], v[132:135]
    buffer_load_dwordx4 v3, s[48:51], s7 offen offset:1024 lds
    v_mfma_f32_16x16x32_bf16 v[132:135], a[196:199], a[180:183], v[132:135]
    ds_read_b64_tr_b16 a[222:223], v21 offset:29696
    v_mfma_f32_16x16x32_bf16 v[136:139], a[192:195], a[168:171], v[136:139]
    v_mfma_f32_16x16x32_bf16 v[136:139], a[196:199], a[184:187], v[136:139]
    v_mfma_f32_16x16x32_bf16 v[140:143], a[192:195], a[172:175], v[140:143]
    v_mfma_f32_16x16x32_bf16 v[140:143], a[196:199], a[188:191], v[140:143]
    ds_read_b64_tr_b16 a[192:193], v22 offset:1024
    s_waitcnt lgkmcnt(9)
    v_mfma_f32_16x16x32_bf16 v[144:147], a[200:203], a[160:163], v[144:147]
    ds_read_b64_tr_b16 a[194:195], v22 offset:4096
    v_mfma_f32_16x16x32_bf16 v[144:147], a[204:207], a[176:179], v[144:147]
    ds_read_b64_tr_b16 a[196:197], v22 offset:25600
    v_mfma_f32_16x16x32_bf16 v[148:151], a[200:203], a[164:167], v[148:151]
    buffer_load_dwordx4 v3, s[52:55], s7 offen offset:2048 lds
    v_mfma_f32_16x16x32_bf16 v[148:151], a[204:207], a[180:183], v[148:151]
    ds_read_b64_tr_b16 a[198:199], v22 offset:28672
    s_add_u32 s7, s7, 114688
    v_mfma_f32_16x16x32_bf16 v[152:155], a[200:203], a[168:171], v[152:155]
    s_add_u32 m0, s10, 12288
    v_mfma_f32_16x16x32_bf16 v[152:155], a[204:207], a[184:187], v[152:155]
    v_mfma_f32_16x16x32_bf16 v[156:159], a[200:203], a[172:175], v[156:159]
    v_mfma_f32_16x16x32_bf16 v[156:159], a[204:207], a[188:191], v[156:159]
    ds_read_b64_tr_b16 a[200:201], v22 offset:2048
    s_waitcnt lgkmcnt(9)
    v_mfma_f32_16x16x32_bf16 v[160:163], a[208:211], a[160:163], v[160:163]
    ds_read_b64_tr_b16 a[202:203], v22 offset:5120
    v_mfma_f32_16x16x32_bf16 v[160:163], a[212:215], a[176:179], v[160:163]
    ds_read_b64_tr_b16 a[204:205], v22 offset:26624
    v_mfma_f32_16x16x32_bf16 v[164:167], a[208:211], a[164:167], v[164:167]
    buffer_load_dwordx4 v2, s[44:47], s6 offen lds
    v_mfma_f32_16x16x32_bf16 v[164:167], a[212:215], a[180:183], v[164:167]
    ds_read_b64_tr_b16 a[206:207], v22 offset:29696
    v_mfma_f32_16x16x32_bf16 v[168:171], a[208:211], a[168:171], v[168:171]
    v_mfma_f32_16x16x32_bf16 v[168:171], a[212:215], a[184:187], v[168:171]
    v_mfma_f32_16x16x32_bf16 v[172:175], a[208:211], a[172:175], v[172:175]
    v_mfma_f32_16x16x32_bf16 v[172:175], a[212:215], a[188:191], v[172:175]
    ds_read_b64_tr_b16 a[208:209], v23 offset:1024
    s_waitcnt lgkmcnt(9)
    v_mfma_f32_16x16x32_bf16 v[176:179], a[216:219], a[160:163], v[176:179]
    ds_read_b64_tr_b16 a[210:211], v23 offset:4096
    v_mfma_f32_16x16x32_bf16 v[176:179], a[220:223], a[176:179], v[176:179]
    ds_read_b64_tr_b16 a[212:213], v23 offset:25600
    v_mfma_f32_16x16x32_bf16 v[180:183], a[216:219], a[164:167], v[180:183]
    ds_read_b64_tr_b16 a[214:215], v23 offset:28672
    v_mfma_f32_16x16x32_bf16 v[180:183], a[220:223], a[180:183], v[180:183]
    v_mfma_f32_16x16x32_bf16 v[184:187], a[216:219], a[168:171], v[184:187]
    v_mfma_f32_16x16x32_bf16 v[184:187], a[220:223], a[184:187], v[184:187]
    v_mfma_f32_16x16x32_bf16 v[188:191], a[216:219], a[172:175], v[188:191]
    buffer_load_dwordx4 v3, s[48:51], s7 offen offset:1024 lds
    v_mfma_f32_16x16x32_bf16 v[188:191], a[220:223], a[188:191], v[188:191]
    ds_read_b64_tr_b16 a[216:217], v23 offset:2048
    s_waitcnt lgkmcnt(9)
    v_mfma_f32_16x16x32_bf16 v[192:195], a[192:195], a[160:163], v[192:195]
    ds_read_b64_tr_b16 a[218:219], v23 offset:5120
    v_mfma_f32_16x16x32_bf16 v[192:195], a[196:199], a[176:179], v[192:195]
    ds_read_b64_tr_b16 a[220:221], v23 offset:26624
    v_mfma_f32_16x16x32_bf16 v[196:199], a[192:195], a[164:167], v[196:199]
    ds_read_b64_tr_b16 a[222:223], v23 offset:29696
    v_mfma_f32_16x16x32_bf16 v[196:199], a[196:199], a[180:183], v[196:199]
    v_mfma_f32_16x16x32_bf16 v[200:203], a[192:195], a[168:171], v[200:203]
    v_mfma_f32_16x16x32_bf16 v[200:203], a[196:199], a[184:187], v[200:203]
    v_mfma_f32_16x16x32_bf16 v[204:207], a[192:195], a[172:175], v[204:207]
    buffer_load_dwordx4 v3, s[52:55], s7 offen offset:2048 lds
    v_mfma_f32_16x16x32_bf16 v[204:207], a[196:199], a[188:191], v[204:207]
    ds_read_b64_tr_b16 a[192:193], v17 offset:0
    s_cmp_lt_u32 s11, 8
    s_cselect_b32 s13, 1, 7
    s_waitcnt lgkmcnt(9)
    v_mfma_f32_16x16x32_bf16 v[208:211], a[200:203], a[160:163], v[208:211]
    ds_read_b64_tr_b16 a[194:195], v17 offset:3072
    s_and_b32 s13, s13, s14
    v_mfma_f32_16x16x32_bf16 v[208:211], a[204:207], a[176:179], v[208:211]
    ds_read_b64_tr_b16 a[196:197], v17 offset:24576
    s_add_u32 s12, s11, s13
    v_mfma_f32_16x16x32_bf16 v[212:215], a[200:203], a[164:167], v[212:215]
    ds_read_b64_tr_b16 a[198:199], v17 offset:27648
    s_and_b32 s12, s12, 7
    v_mfma_f32_16x16x32_bf16 v[212:215], a[204:207], a[180:183], v[212:215]
    s_and_b32 s13, s11, 0x18
    s_or_b32 s12, s12, s13
    v_mfma_f32_16x16x32_bf16 v[216:219], a[200:203], a[168:171], v[216:219]
    s_add_u32 s11, s11, 1
    s_lshl_b32 s6, s12, 18
    v_mfma_f32_16x16x32_bf16 v[216:219], a[204:207], a[184:187], v[216:219]
    s_mul_i32 s7, s12, 229376
    s_lshl_b32 s8, s12, 10
    v_mfma_f32_16x16x32_bf16 v[220:223], a[200:203], a[172:175], v[220:223]
    s_mov_b32 s89, s8
    s_add_u32 m0, s10, 24576
    s_nop 0
    buffer_load_dwordx4 v2, s[44:47], s6 offen lds
    v_mfma_f32_16x16x32_bf16 v[220:223], a[204:207], a[188:191], v[220:223]
    ds_read_b64_tr_b16 a[200:201], v18 offset:0
    s_add_u32 s6, s6, 131072
    s_waitcnt lgkmcnt(9)
    v_mfma_f32_16x16x32_bf16 v[224:227], a[208:211], a[160:163], v[224:227]
    ds_read_b64_tr_b16 a[202:203], v18 offset:3072
    v_mfma_f32_16x16x32_bf16 v[224:227], a[212:215], a[176:179], v[224:227]
    ds_read_b64_tr_b16 a[204:205], v18 offset:24576
    v_mfma_f32_16x16x32_bf16 v[228:231], a[208:211], a[164:167], v[228:231]
    ds_read_b64_tr_b16 a[206:207], v18 offset:27648
    v_mfma_f32_16x16x32_bf16 v[228:231], a[212:215], a[180:183], v[228:231]
    v_mfma_f32_16x16x32_bf16 v[232:235], a[208:211], a[168:171], v[232:235]
    v_mfma_f32_16x16x32_bf16 v[232:235], a[212:215], a[184:187], v[232:235]
    v_mfma_f32_16x16x32_bf16 v[236:239], a[208:211], a[172:175], v[236:239]
    buffer_load_dwordx4 v3, s[48:51], s7 offen offset:1024 lds
    v_mfma_f32_16x16x32_bf16 v[236:239], a[212:215], a[188:191], v[236:239]
    ds_read_b64_tr_b16 a[208:209], v19 offset:0
    s_waitcnt lgkmcnt(9)
    v_mfma_f32_16x16x32_bf16 v[240:243], a[216:219], a[160:163], v[240:243]
    ds_read_b64_tr_b16 a[210:211], v19 offset:3072
    v_mfma_f32_16x16x32_bf16 v[240:243], a[220:223], a[176:179], v[240:243]
    ds_read_b64_tr_b16 a[212:213], v19 offset:24576
    v_mfma_f32_16x16x32_bf16 v[244:247], a[216:219], a[164:167], v[244:247]
    ds_read_b64_tr_b16 a[214:215], v19 offset:27648
    v_mfma_f32_16x16x32_bf16 v[244:247], a[220:223], a[180:183], v[244:247]
    v_mfma_f32_16x16x32_bf16 v[248:251], a[216:219], a[168:171], v[248:251]
    v_mfma_f32_16x16x32_bf16 v[248:251], a[220:223], a[184:187], v[248:251]
    v_mfma_f32_16x16x32_bf16 v[252:255], a[216:219], a[172:175], v[252:255]
    v_mfma_f32_16x16x32_bf16 v[252:255], a[220:223], a[188:191], v[252:255]
    ds_read_b64_tr_b16 a[216:217], v20 offset:0
    s_waitcnt lgkmcnt(9)
    v_mfma_f32_16x16x32_bf16 a[0:3], a[192:195], a[160:163], a[0:3]
    ds_read_b64_tr_b16 a[218:219], v20 offset:3072
    v_mfma_f32_16x16x32_bf16 a[0:3], a[196:199], a[176:179], a[0:3]
    ds_read_b64_tr_b16 a[220:221], v20 offset:24576
    v_mfma_f32_16x16x32_bf16 a[4:7], a[192:195], a[164:167], a[4:7]
    buffer_load_dwordx4 v3, s[52:55], s7 offen offset:2048 lds
    v_mfma_f32_16x16x32_bf16 a[4:7], a[196:199], a[180:183], a[4:7]
    ds_read_b64_tr_b16 a[222:223], v20 offset:27648
    s_add_u32 s7, s7, 114688
    v_mfma_f32_16x16x32_bf16 a[8:11], a[192:195], a[168:171], a[8:11]
    s_add_u32 m0, s10, 36864
    v_mfma_f32_16x16x32_bf16 a[8:11], a[196:199], a[184:187], a[8:11]
    v_mfma_f32_16x16x32_bf16 a[12:15], a[192:195], a[172:175], a[12:15]
    v_mfma_f32_16x16x32_bf16 a[12:15], a[196:199], a[188:191], a[12:15]
    ds_read_b64_tr_b16 a[192:193], v21 offset:0
    s_waitcnt lgkmcnt(9)
    v_mfma_f32_16x16x32_bf16 a[16:19], a[200:203], a[160:163], a[16:19]
    ds_read_b64_tr_b16 a[194:195], v21 offset:3072
    v_mfma_f32_16x16x32_bf16 a[16:19], a[204:207], a[176:179], a[16:19]
    ds_read_b64_tr_b16 a[196:197], v21 offset:24576
    v_mfma_f32_16x16x32_bf16 a[20:23], a[200:203], a[164:167], a[20:23]
    buffer_load_dwordx4 v2, s[44:47], s6 offen lds
    v_mfma_f32_16x16x32_bf16 a[20:23], a[204:207], a[180:183], a[20:23]
    ds_read_b64_tr_b16 a[198:199], v21 offset:27648
    v_mfma_f32_16x16x32_bf16 a[24:27], a[200:203], a[168:171], a[24:27]
    v_mfma_f32_16x16x32_bf16 a[24:27], a[204:207], a[184:187], a[24:27]
    v_mfma_f32_16x16x32_bf16 a[28:31], a[200:203], a[172:175], a[28:31]
    v_mfma_f32_16x16x32_bf16 a[28:31], a[204:207], a[188:191], a[28:31]
    ds_read_b64_tr_b16 a[200:201], v22 offset:0
    s_waitcnt lgkmcnt(9)
    v_mfma_f32_16x16x32_bf16 a[32:35], a[208:211], a[160:163], a[32:35]
    ds_read_b64_tr_b16 a[202:203], v22 offset:3072
    v_mfma_f32_16x16x32_bf16 a[32:35], a[212:215], a[176:179], a[32:35]
    ds_read_b64_tr_b16 a[204:205], v22 offset:24576
    v_mfma_f32_16x16x32_bf16 a[36:39], a[208:211], a[164:167], a[36:39]
    buffer_load_dwordx4 v3, s[48:51], s7 offen offset:1024 lds
    v_mfma_f32_16x16x32_bf16 a[36:39], a[212:215], a[180:183], a[36:39]
    ds_read_b64_tr_b16 a[206:207], v22 offset:27648
    v_mfma_f32_16x16x32_bf16 a[40:43], a[208:211], a[168:171], a[40:43]
    v_mfma_f32_16x16x32_bf16 a[40:43], a[212:215], a[184:187], a[40:43]
    v_mfma_f32_16x16x32_bf16 a[44:47], a[208:211], a[172:175], a[44:47]
    v_mfma_f32_16x16x32_bf16 a[44:47], a[212:215], a[188:191], a[44:47]
    ds_read_b64_tr_b16 a[208:209], v23 offset:0
    s_waitcnt lgkmcnt(9)
    v_mfma_f32_16x16x32_bf16 a[48:51], a[216:219], a[160:163], a[48:51]
    ds_read_b64_tr_b16 a[210:211], v23 offset:3072
    v_mfma_f32_16x16x32_bf16 a[48:51], a[220:223], a[176:179], a[48:51]
    ds_read_b64_tr_b16 a[212:213], v23 offset:24576
    v_mfma_f32_16x16x32_bf16 a[52:55], a[216:219], a[164:167], a[52:55]
    buffer_load_dwordx4 v3, s[52:55], s7 offen offset:2048 lds
    v_mfma_f32_16x16x32_bf16 a[52:55], a[220:223], a[180:183], a[52:55]
    ds_read_b64_tr_b16 a[214:215], v23 offset:27648
    v_mfma_f32_16x16x32_bf16 a[56:59], a[216:219], a[168:171], a[56:59]
    v_mfma_f32_16x16x32_bf16 a[56:59], a[220:223], a[184:187], a[56:59]
    v_mfma_f32_16x16x32_bf16 a[60:63], a[216:219], a[172:175], a[60:63]
    v_mfma_f32_16x16x32_bf16 a[60:63], a[220:223], a[188:191], a[60:63]
    ds_read_b64_tr_b16 a[216:217], v24 offset:0
    s_waitcnt lgkmcnt(9)
    v_mfma_f32_16x16x32_bf16 a[64:67], a[192:195], a[160:163], a[64:67]
    ds_read_b64_tr_b16 a[218:219], v24 offset:3072
    v_mfma_f32_16x16x32_bf16 a[64:67], a[196:199], a[176:179], a[64:67]
    ds_read_b64_tr_b16 a[220:221], v24 offset:24576
    v_mfma_f32_16x16x32_bf16 a[68:71], a[192:195], a[164:167], a[68:71]
    ds_read_b64_tr_b16 a[222:223], v24 offset:27648
    v_mfma_f32_16x16x32_bf16 a[68:71], a[196:199], a[180:183], a[68:71]
    v_mfma_f32_16x16x32_bf16 a[72:75], a[192:195], a[168:171], a[72:75]
    v_mfma_f32_16x16x32_bf16 a[72:75], a[196:199], a[184:187], a[72:75]
    v_mfma_f32_16x16x32_bf16 a[76:79], a[192:195], a[172:175], a[76:79]
    v_mfma_f32_16x16x32_bf16 a[76:79], a[196:199], a[188:191], a[76:79]
    s_waitcnt vmcnt(20)
    s_waitcnt lgkmcnt(0)
    s_barrier
    ds_read_b64_tr_b16 a[192:193], v9 offset:1024
    v_mfma_f32_16x16x32_bf16 a[80:83], a[200:203], a[160:163], a[80:83]
    ds_read_b64_tr_b16 a[194:195], v9 offset:4096
    v_mfma_f32_16x16x32_bf16 a[80:83], a[204:207], a[176:179], a[80:83]
    ds_read_b64_tr_b16 a[196:197], v9 offset:25600
    v_mfma_f32_16x16x32_bf16 a[84:87], a[200:203], a[164:167], a[84:87]
    ds_read_b64_tr_b16 a[198:199], v9 offset:28672
    v_mfma_f32_16x16x32_bf16 a[84:87], a[204:207], a[180:183], a[84:87]
    v_mfma_f32_16x16x32_bf16 a[88:91], a[200:203], a[168:171], a[88:91]
    v_mfma_f32_16x16x32_bf16 a[88:91], a[204:207], a[184:187], a[88:91]
    v_mfma_f32_16x16x32_bf16 a[92:95], a[200:203], a[172:175], a[92:95]
    v_mfma_f32_16x16x32_bf16 a[92:95], a[204:207], a[188:191], a[92:95]
    ds_read_b64_tr_b16 a[200:201], v9 offset:2048
    v_mfma_f32_16x16x32_bf16 a[96:99], a[208:211], a[160:163], a[96:99]
    ds_read_b64_tr_b16 a[202:203], v9 offset:5120
    v_mfma_f32_16x16x32_bf16 a[96:99], a[212:215], a[176:179], a[96:99]
    ds_read_b64_tr_b16 a[204:205], v9 offset:26624
    v_mfma_f32_16x16x32_bf16 a[100:103], a[208:211], a[164:167], a[100:103]
    ds_read_b64_tr_b16 a[206:207], v9 offset:29696
    v_mfma_f32_16x16x32_bf16 a[100:103], a[212:215], a[180:183], a[100:103]
    v_mfma_f32_16x16x32_bf16 a[104:107], a[208:211], a[168:171], a[104:107]
    v_mfma_f32_16x16x32_bf16 a[104:107], a[212:215], a[184:187], a[104:107]
    v_mfma_f32_16x16x32_bf16 a[108:111], a[208:211], a[172:175], a[108:111]
    v_mfma_f32_16x16x32_bf16 a[108:111], a[212:215], a[188:191], a[108:111]
    ds_read_b64_tr_b16 a[208:209], v10 offset:1024
    v_mfma_f32_16x16x32_bf16 a[112:115], a[216:219], a[160:163], a[112:115]
    ds_read_b64_tr_b16 a[210:211], v10 offset:4096
    v_mfma_f32_16x16x32_bf16 a[112:115], a[220:223], a[176:179], a[112:115]
    ds_read_b64_tr_b16 a[212:213], v10 offset:25600
    v_mfma_f32_16x16x32_bf16 a[116:119], a[216:219], a[164:167], a[116:119]
    ds_read_b64_tr_b16 a[214:215], v10 offset:28672
    v_mfma_f32_16x16x32_bf16 a[116:119], a[220:223], a[180:183], a[116:119]
    v_mfma_f32_16x16x32_bf16 a[120:123], a[216:219], a[168:171], a[120:123]
    v_mfma_f32_16x16x32_bf16 a[120:123], a[220:223], a[184:187], a[120:123]
    v_mfma_f32_16x16x32_bf16 a[124:127], a[216:219], a[172:175], a[124:127]
    v_mfma_f32_16x16x32_bf16 a[124:127], a[220:223], a[188:191], a[124:127]
    ds_read_b64_tr_b16 a[216:217], v10 offset:2048
    ds_read_b64_tr_b16 a[218:219], v10 offset:5120
    ds_read_b64_tr_b16 a[220:221], v10 offset:26624
    ds_read_b64_tr_b16 a[222:223], v10 offset:29696
    s_sub_u32 s9, s9, 1
    s_cmp_lg_u32 s9, 0
    s_cbranch_scc1 recurrent_scan__sliding_block_cached__glu_gated_glu__prompt_kernel_loop
    s_getpc_b64 s[76:77]
recurrent_scan__sliding_block_cached__glu_gated_glu__prompt_kernel_pc1:
    s_sub_u32 s76, s76, recurrent_scan__sliding_block_cached__glu_gated_glu__prompt_kernel_pc1-recurrent_scan__sliding_block_cached__glu_gated_glu__prompt_kernel
    s_subb_u32 s77, s77, 0
    s_lshr_b32 s78, s2, 3
    s_lshl_b32 s78, s78, 11
    s_lshl_b32 s79, s3, 9
    s_add_u32 s78, s78, s79
    v_and_b32 v30, 7, v0
    v_mul_u32_u24 v30, 0x4080, v30
    v_and_b32 v30, 0x10180, v30
    v_add_u32 v30, s78, v30
    v_min_u32 v30, recurrent_scan__sliding_block_cached__glu_gated_glu__prompt_kernel_codeend-recurrent_scan__sliding_block_cached__glu_gated_glu__prompt_kernel-4, v30
    global_load_dword a238, v30, s[76:77]
    s_waitcnt vmcnt(13)
    s_waitcnt lgkmcnt(10)
    v_mfma_f32_16x16x32_bf16 v[32:35], a[192:195], a[128:131], v[32:35]
    s_add_u32 s10, s72, s95
    s_add_u32 s73, s72, 98304
    v_mfma_f32_16x16x32_bf16 v[32:35], a[196:199], a[144:147], v[32:35]
    s_cmp_ge_u32 s73, 147456
    s_cselect_b32 s74, 147456, 0
    v_mfma_f32_16x16x32_bf16 v[36:39], a[192:195], a[132:135], v[36:39]
    buffer_load_dwordx4 a[160:163], v5, s[40:43], s88 offen sc0 sc1
    v_mfma_f32_16x16x32_bf16 v[36:39], a[196:199], a[148:151], v[36:39]
    s_sub_u32 s73, 98304, s74
    s_add_u32 s72, s72, 49152
    v_mfma_f32_16x16x32_bf16 v[40:43], a[192:195], a[136:139], v[40:43]
    s_cmp_ge_u32 s72, 147456
    s_cselect_b32 s72, 0, s72
    v_mfma_f32_16x16x32_bf16 v[40:43], a[196:199], a[152:155], v[40:43]
    v_add_u32 v17, s73, v17
    v_add_u32 v18, s73, v18
    v_mfma_f32_16x16x32_bf16 v[44:47], a[192:195], a[140:143], v[44:47]
    buffer_load_dwordx4 a[164:167], v6, s[40:43], s88 offen sc0 sc1
    v_mfma_f32_16x16x32_bf16 v[44:47], a[196:199], a[156:159], v[44:47]
    ds_read_b64_tr_b16 a[192:193], v11 offset:1024
    v_add_u32 v19, s73, v19
    s_waitcnt lgkmcnt(9)
    v_mfma_f32_16x16x32_bf16 v[48:51], a[200:203], a[128:131], v[48:51]
    ds_read_b64_tr_b16 a[194:195], v11 offset:4096
    v_add_u32 v20, s73, v20
    v_mfma_f32_16x16x32_bf16 v[48:51], a[204:207], a[144:147], v[48:51]
    ds_read_b64_tr_b16 a[196:197], v11 offset:25600
    v_add_u32 v21, s73, v21
    v_mfma_f32_16x16x32_bf16 v[52:55], a[200:203], a[132:135], v[52:55]
    buffer_load_dwordx4 a[168:171], v7, s[40:43], s88 offen sc0 sc1
    v_mfma_f32_16x16x32_bf16 v[52:55], a[204:207], a[148:151], v[52:55]
    ds_read_b64_tr_b16 a[198:199], v11 offset:28672
    v_add_u32 v22, s73, v22
    v_mfma_f32_16x16x32_bf16 v[56:59], a[200:203], a[136:139], v[56:59]
    v_add_u32 v23, s73, v23
    v_add_u32 v24, s73, v24
    v_mfma_f32_16x16x32_bf16 v[56:59], a[204:207], a[152:155], v[56:59]
    v_mfma_f32_16x16x32_bf16 v[60:63], a[200:203], a[140:143], v[60:63]
    buffer_load_dwordx4 a[172:175], v8, s[40:43], s88 offen sc0 sc1
    v_mfma_f32_16x16x32_bf16 v[60:63], a[204:207], a[156:159], v[60:63]
    ds_read_b64_tr_b16 a[200:201], v11 offset:2048
    s_waitcnt lgkmcnt(9)
    v_mfma_f32_16x16x32_bf16 v[64:67], a[208:211], a[128:131], v[64:67]
    ds_read_b64_tr_b16 a[202:203], v11 offset:5120
    v_mfma_f32_16x16x32_bf16 v[64:67], a[212:215], a[144:147], v[64:67]
    ds_read_b64_tr_b16 a[204:205], v11 offset:26624
    v_mfma_f32_16x16x32_bf16 v[68:71], a[208:211], a[132:135], v[68:71]
    buffer_load_dwordx4 a[176:179], v5, s[40:43], s89 offen sc0 sc1
    v_mfma_f32_16x16x32_bf16 v[68:71], a[212:215], a[148:151], v[68:71]
    ds_read_b64_tr_b16 a[206:207], v11 offset:29696
    v_mfma_f32_16x16x32_bf16 v[72:75], a[208:211], a[136:139], v[72:75]
    v_mfma_f32_16x16x32_bf16 v[72:75], a[212:215], a[152:155], v[72:75]
    v_mfma_f32_16x16x32_bf16 v[76:79], a[208:211], a[140:143], v[76:79]
    buffer_load_dwordx4 a[180:183], v6, s[40:43], s89 offen sc0 sc1
    v_mfma_f32_16x16x32_bf16 v[76:79], a[212:215], a[156:159], v[76:79]
    ds_read_b64_tr_b16 a[208:209], v12 offset:1024
    s_waitcnt lgkmcnt(9)
    v_mfma_f32_16x16x32_bf16 v[80:83], a[216:219], a[128:131], v[80:83]
    ds_read_b64_tr_b16 a[210:211], v12 offset:4096
    v_mfma_f32_16x16x32_bf16 v[80:83], a[220:223], a[144:147], v[80:83]
    ds_read_b64_tr_b16 a[212:213], v12 offset:25600
    v_mfma_f32_16x16x32_bf16 v[84:87], a[216:219], a[132:135], v[84:87]
    buffer_load_dwordx4 a[184:187], v7, s[40:43], s89 offen sc0 sc1
    v_mfma_f32_16x16x32_bf16 v[84:87], a[220:223], a[148:151], v[84:87]
    ds_read_b64_tr_b16 a[214:215], v12 offset:28672
    v_mfma_f32_16x16x32_bf16 v[88:91], a[216:219], a[136:139], v[88:91]
    v_mfma_f32_16x16x32_bf16 v[88:91], a[220:223], a[152:155], v[88:91]
    v_mfma_f32_16x16x32_bf16 v[92:95], a[216:219], a[140:143], v[92:95]
    buffer_load_dwordx4 a[188:191], v8, s[40:43], s89 offen sc0 sc1
    v_mfma_f32_16x16x32_bf16 v[92:95], a[220:223], a[156:159], v[92:95]
    ds_read_b64_tr_b16 a[216:217], v12 offset:2048
    s_add_u32 m0, s92, 0
    s_waitcnt lgkmcnt(9)
    v_mfma_f32_16x16x32_bf16 v[96:99], a[192:195], a[128:131], v[96:99]
    ds_read_b64_tr_b16 a[218:219], v12 offset:5120
    s_add_u32 s94, s93, 0
    v_mfma_f32_16x16x32_bf16 v[96:99], a[196:199], a[144:147], v[96:99]
    ds_read_b64_tr_b16 a[220:221], v12 offset:26624
    v_mfma_f32_16x16x32_bf16 v[100:103], a[192:195], a[132:135], v[100:103]
    ds_read_b64_tr_b16 a[222:223], v12 offset:29696
    v_mfma_f32_16x16x32_bf16 v[100:103], a[196:199], a[148:151], v[100:103]
    v_mfma_f32_16x16x32_bf16 v[104:107], a[192:195], a[136:139], v[104:107]
    v_mfma_f32_16x16x32_bf16 v[104:107], a[196:199], a[152:155], v[104:107]
    v_mfma_f32_16x16x32_bf16 v[108:111], a[192:195], a[140:143], v[108:111]
    v_mfma_f32_16x16x32_bf16 v[108:111], a[196:199], a[156:159], v[108:111]
    ds_read_b64_tr_b16 a[192:193], v13 offset:1024
    s_waitcnt lgkmcnt(9)
    v_mfma_f32_16x16x32_bf16 v[112:115], a[200:203], a[128:131], v[112:115]
    ds_read_b64_tr_b16 a[194:195], v13 offset:4096
    v_mfma_f32_16x16x32_bf16 v[112:115], a[204:207], a[144:147], v[112:115]
    ds_read_b64_tr_b16 a[196:197], v13 offset:25600
    v_mfma_f32_16x16x32_bf16 v[116:119], a[200:203], a[132:135], v[116:119]
    buffer_load_dwordx4 v25, s[64:67], s94 offen offset:0 lds
    v_mfma_f32_16x16x32_bf16 v[116:119], a[204:207], a[148:151], v[116:119]
    ds_read_b64_tr_b16 a[198:199], v13 offset:28672
    v_mfma_f32_16x16x32_bf16 v[120:123], a[200:203], a[136:139], v[120:123]
    v_mfma_f32_16x16x32_bf16 v[120:123], a[204:207], a[152:155], v[120:123]
    v_mfma_f32_16x16x32_bf16 v[124:127], a[200:203], a[140:143], v[124:127]
    buffer_load_dwordx4 v26, s[64:67], s94 offen offset:1024 lds
    v_mfma_f32_16x16x32_bf16 v[124:127], a[204:207], a[156:159], v[124:127]
    ds_read_b64_tr_b16 a[200:201], v13 offset:2048
    s_waitcnt lgkmcnt(9)
    v_mfma_f32_16x16x32_bf16 v[128:131], a[208:211], a[128:131], v[128:131]
    ds_read_b64_tr_b16 a[202:203], v13 offset:5120
    v_mfma_f32_16x16x32_bf16 v[128:131], a[212:215], a[144:147], v[128:131]
    ds_read_b64_tr_b16 a[204:205], v13 offset:26624
    v_mfma_f32_16x16x32_bf16 v[132:135], a[208:211], a[132:135], v[132:135]
    ds_read_b64_tr_b16 a[206:207], v13 offset:29696
    v_mfma_f32_16x16x32_bf16 v[132:135], a[212:215], a[148:151], v[132:135]
    v_mfma_f32_16x16x32_bf16 v[136:139], a[208:211], a[136:139], v[136:139]
    v_mfma_f32_16x16x32_bf16 v[136:139], a[212:215], a[152:155], v[136:139]
    v_mfma_f32_16x16x32_bf16 v[140:143], a[208:211], a[140:143], v[140:143]
    buffer_load_dwordx4 v27, s[64:67], s94 offen offset:2048 lds
    v_mfma_f32_16x16x32_bf16 v[140:143], a[212:215], a[156:159], v[140:143]
    ds_read_b64_tr_b16 a[208:209], v14 offset:1024
    s_waitcnt lgkmcnt(9)
    v_mfma_f32_16x16x32_bf16 v[144:147], a[216:219], a[128:131], v[144:147]
    ds_read_b64_tr_b16 a[210:211], v14 offset:4096
    v_mfma_f32_16x16x32_bf16 v[144:147], a[220:223], a[144:147], v[144:147]
    ds_read_b64_tr_b16 a[212:213], v14 offset:25600
    v_mfma_f32_16x16x32_bf16 v[148:151], a[216:219], a[132:135], v[148:151]
    ds_read_b64_tr_b16 a[214:215], v14 offset:28672
    v_mfma_f32_16x16x32_bf16 v[148:151], a[220:223], a[148:151], v[148:151]
    v_mfma_f32_16x16x32_bf16 v[152:155], a[216:219], a[136:139], v[152:155]
    v_mfma_f32_16x16x32_bf16 v[152:155], a[220:223], a[152:155], v[152:155]
    v_mfma_f32_16x16x32_bf16 v[156:159], a[216:219], a[140:143], v[156:159]
    buffer_load_dwordx4 v28, s[64:67], s94 offen offset:3072 lds
    v_mfma_f32_16x16x32_bf16 v[156:159], a[220:223], a[156:159], v[156:159]
    ds_read_b64_tr_b16 a[216:217], v14 offset:2048
    s_add_u32 m0, s92, 65536
    s_waitcnt lgkmcnt(9)
    v_mfma_f32_16x16x32_bf16 v[160:163], a[192:195], a[128:131], v[160:163]
    ds_read_b64_tr_b16 a[218:219], v14 offset:5120
    s_add_u32 s94, s93, 0
    v_mfma_f32_16x16x32_bf16 v[160:163], a[196:199], a[144:147], v[160:163]
    ds_read_b64_tr_b16 a[220:221], v14 offset:26624
    v_mfma_f32_16x16x32_bf16 v[164:167], a[192:195], a[132:135], v[164:167]
    buffer_load_dwordx4 v29, s[68:71], s94 offen offset:0 lds
    v_mfma_f32_16x16x32_bf16 v[164:167], a[196:199], a[148:151], v[164:167]
    ds_read_b64_tr_b16 a[222:223], v14 offset:29696
    v_mfma_f32_16x16x32_bf16 v[168:171], a[192:195], a[136:139], v[168:171]
    v_mfma_f32_16x16x32_bf16 v[168:171], a[196:199], a[152:155], v[168:171]
    v_mfma_f32_16x16x32_bf16 v[172:175], a[192:195], a[140:143], v[172:175]
    v_mfma_f32_16x16x32_bf16 v[172:175], a[196:199], a[156:159], v[172:175]
    ds_read_b64_tr_b16 a[192:193], v15 offset:1024
    s_waitcnt lgkmcnt(9)
    v_mfma_f32_16x16x32_bf16 v[176:179], a[200:203], a[128:131], v[176:179]
    ds_read_b64_tr_b16 a[194:195], v15 offset:4096
    v_mfma_f32_16x16x32_bf16 v[176:179], a[204:207], a[144:147], v[176:179]
    ds_read_b64_tr_b16 a[196:197], v15 offset:25600
    v_mfma_f32_16x16x32_bf16 v[180:183], a[200:203], a[132:135], v[180:183]
    buffer_load_dwordx4 v29, s[68:71], s94 offen offset:1024 lds
    v_mfma_f32_16x16x32_bf16 v[180:183], a[204:207], a[148:151], v[180:183]
    ds_read_b64_tr_b16 a[198:199], v15 offset:28672
    v_mfma_f32_16x16x32_bf16 v[184:187], a[200:203], a[136:139], v[184:187]
    v_mfma_f32_16x16x32_bf16 v[184:187], a[204:207], a[152:155], v[184:187]
    v_mfma_f32_16x16x32_bf16 v[188:191], a[200:203], a[140:143], v[188:191]
    v_mfma_f32_16x16x32_bf16 v[188:191], a[204:207], a[156:159], v[188:191]
    ds_read_b64_tr_b16 a[200:201], v15 offset:2048
    s_waitcnt lgkmcnt(9)
    v_mfma_f32_16x16x32_bf16 v[192:195], a[208:211], a[128:131], v[192:195]
    ds_read_b64_tr_b16 a[202:203], v15 offset:5120
    v_mfma_f32_16x16x32_bf16 v[192:195], a[212:215], a[144:147], v[192:195]
    ds_read_b64_tr_b16 a[204:205], v15 offset:26624
    v_mfma_f32_16x16x32_bf16 v[196:199], a[208:211], a[132:135], v[196:199]
    buffer_load_dwordx4 v29, s[68:71], s94 offen offset:2048 lds
    v_mfma_f32_16x16x32_bf16 v[196:199], a[212:215], a[148:151], v[196:199]
    ds_read_b64_tr_b16 a[206:207], v15 offset:29696
    v_mfma_f32_16x16x32_bf16 v[200:203], a[208:211], a[136:139], v[200:203]
    v_mfma_f32_16x16x32_bf16 v[200:203], a[212:215], a[152:155], v[200:203]
    v_mfma_f32_16x16x32_bf16 v[204:207], a[208:211], a[140:143], v[204:207]
    buffer_load_dwordx4 v29, s[68:71], s94 offen offset:3072 lds
    v_mfma_f32_16x16x32_bf16 v[204:207], a[212:215], a[156:159], v[204:207]
    ds_read_b64_tr_b16 a[208:209], v9 offset:0
    s_add_u32 m0, s92, 81920
    s_waitcnt lgkmcnt(9)
    v_mfma_f32_16x16x32_bf16 v[208:211], a[216:219], a[128:131], v[208:211]
    ds_read_b64_tr_b16 a[210:211], v9 offset:3072
    s_add_u32 s94, s93, 16384
    v_mfma_f32_16x16x32_bf16 v[208:211], a[220:223], a[144:147], v[208:211]
    ds_read_b64_tr_b16 a[212:213], v9 offset:24576
    v_mfma_f32_16x16x32_bf16 v[212:215], a[216:219], a[132:135], v[212:215]
    ds_read_b64_tr_b16 a[214:215], v9 offset:27648
    v_mfma_f32_16x16x32_bf16 v[212:215], a[220:223], a[148:151], v[212:215]
    v_mfma_f32_16x16x32_bf16 v[216:219], a[216:219], a[136:139], v[216:219]
    v_mfma_f32_16x16x32_bf16 v[216:219], a[220:223], a[152:155], v[216:219]
    v_mfma_f32_16x16x32_bf16 v[220:223], a[216:219], a[140:143], v[220:223]
    buffer_load_dwordx4 v29, s[68:71], s94 offen offset:0 lds
    v_mfma_f32_16x16x32_bf16 v[220:223], a[220:223], a[156:159], v[220:223]
    ds_read_b64_tr_b16 a[216:217], v10 offset:0
    s_waitcnt lgkmcnt(9)
    v_mfma_f32_16x16x32_bf16 v[224:227], a[192:195], a[128:131], v[224:227]
    ds_read_b64_tr_b16 a[218:219], v10 offset:3072
    v_mfma_f32_16x16x32_bf16 v[224:227], a[196:199], a[144:147], v[224:227]
    ds_read_b64_tr_b16 a[220:221], v10 offset:24576
    v_mfma_f32_16x16x32_bf16 v[228:231], a[192:195], a[132:135], v[228:231]
    ds_read_b64_tr_b16 a[222:223], v10 offset:27648
    v_mfma_f32_16x16x32_bf16 v[228:231], a[196:199], a[148:151], v[228:231]
    v_mfma_f32_16x16x32_bf16 v[232:235], a[192:195], a[136:139], v[232:235]
    v_mfma_f32_16x16x32_bf16 v[232:235], a[196:199], a[152:155], v[232:235]
    v_mfma_f32_16x16x32_bf16 v[236:239], a[192:195], a[140:143], v[236:239]
    buffer_load_dwordx4 v29, s[68:71], s94 offen offset:1024 lds
    v_mfma_f32_16x16x32_bf16 v[236:239], a[196:199], a[156:159], v[236:239]
    ds_read_b64_tr_b16 a[192:193], v11 offset:0
    s_waitcnt lgkmcnt(9)
    v_mfma_f32_16x16x32_bf16 v[240:243], a[200:203], a[128:131], v[240:243]
    ds_read_b64_tr_b16 a[194:195], v11 offset:3072
    v_mfma_f32_16x16x32_bf16 v[240:243], a[204:207], a[144:147], v[240:243]
    ds_read_b64_tr_b16 a[196:197], v11 offset:24576
    v_mfma_f32_16x16x32_bf16 v[244:247], a[200:203], a[132:135], v[244:247]
    buffer_load_dwordx4 v29, s[68:71], s94 offen offset:2048 lds
    v_mfma_f32_16x16x32_bf16 v[244:247], a[204:207], a[148:151], v[244:247]
    ds_read_b64_tr_b16 a[198:199], v11 offset:27648
    v_mfma_f32_16x16x32_bf16 v[248:251], a[200:203], a[136:139], v[248:251]
    v_mfma_f32_16x16x32_bf16 v[248:251], a[204:207], a[152:155], v[248:251]
    v_mfma_f32_16x16x32_bf16 v[252:255], a[200:203], a[140:143], v[252:255]
    v_mfma_f32_16x16x32_bf16 v[252:255], a[204:207], a[156:159], v[252:255]
    ds_read_b64_tr_b16 a[200:201], v12 offset:0
    s_waitcnt lgkmcnt(9)
    v_mfma_f32_16x16x32_bf16 a[0:3], a[208:211], a[128:131], a[0:3]
    ds_read_b64_tr_b16 a[202:203], v12 offset:3072
    v_mfma_f32_16x16x32_bf16 a[0:3], a[212:215], a[144:147], a[0:3]
    ds_read_b64_tr_b16 a[204:205], v12 offset:24576
    v_mfma_f32_16x16x32_bf16 a[4:7], a[208:211], a[132:135], a[4:7]
    buffer_load_dwordx4 v29, s[68:71], s94 offen offset:3072 lds
    v_mfma_f32_16x16x32_bf16 a[4:7], a[212:215], a[148:151], a[4:7]
    ds_read_b64_tr_b16 a[206:207], v12 offset:27648
    s_add_u32 m0, s92, 98304
    v_mfma_f32_16x16x32_bf16 a[8:11], a[208:211], a[136:139], a[8:11]
    s_add_u32 s94, s93, 32768
    v_mfma_f32_16x16x32_bf16 a[8:11], a[212:215], a[152:155], a[8:11]
    v_mfma_f32_16x16x32_bf16 a[12:15], a[208:211], a[140:143], a[12:15]
    v_mfma_f32_16x16x32_bf16 a[12:15], a[212:215], a[156:159], a[12:15]
    ds_read_b64_tr_b16 a[208:209], v13 offset:0
    s_waitcnt lgkmcnt(9)
    v_mfma_f32_16x16x32_bf16 a[16:19], a[216:219], a[128:131], a[16:19]
    ds_read_b64_tr_b16 a[210:211], v13 offset:3072
    v_mfma_f32_16x16x32_bf16 a[16:19], a[220:223], a[144:147], a[16:19]
    ds_read_b64_tr_b16 a[212:213], v13 offset:24576
    v_mfma_f32_16x16x32_bf16 a[20:23], a[216:219], a[132:135], a[20:23]
    buffer_load_dwordx4 v29, s[68:71], s94 offen offset:0 lds
    v_mfma_f32_16x16x32_bf16 a[20:23], a[220:223], a[148:151], a[20:23]
    ds_read_b64_tr_b16 a[214:215], v13 offset:27648
    v_mfma_f32_16x16x32_bf16 a[24:27], a[216:219], a[136:139], a[24:27]
    v_mfma_f32_16x16x32_bf16 a[24:27], a[220:223], a[152:155], a[24:27]
    v_mfma_f32_16x16x32_bf16 a[28:31], a[216:219], a[140:143], a[28:31]
    buffer_load_dwordx4 v29, s[68:71], s94 offen offset:1024 lds
    v_mfma_f32_16x16x32_bf16 a[28:31], a[220:223], a[156:159], a[28:31]
    ds_read_b64_tr_b16 a[216:217], v14 offset:0
    s_waitcnt lgkmcnt(9)
    v_mfma_f32_16x16x32_bf16 a[32:35], a[192:195], a[128:131], a[32:35]
    ds_read_b64_tr_b16 a[218:219], v14 offset:3072
    v_mfma_f32_16x16x32_bf16 a[32:35], a[196:199], a[144:147], a[32:35]
    ds_read_b64_tr_b16 a[220:221], v14 offset:24576
    v_mfma_f32_16x16x32_bf16 a[36:39], a[192:195], a[132:135], a[36:39]
    ds_read_b64_tr_b16 a[222:223], v14 offset:27648
    v_mfma_f32_16x16x32_bf16 a[36:39], a[196:199], a[148:151], a[36:39]
    v_mfma_f32_16x16x32_bf16 a[40:43], a[192:195], a[136:139], a[40:43]
    v_mfma_f32_16x16x32_bf16 a[40:43], a[196:199], a[152:155], a[40:43]
    v_mfma_f32_16x16x32_bf16 a[44:47], a[192:195], a[140:143], a[44:47]
    buffer_load_dwordx4 v29, s[68:71], s94 offen offset:2048 lds
    v_mfma_f32_16x16x32_bf16 a[44:47], a[196:199], a[156:159], a[44:47]
    ds_read_b64_tr_b16 a[192:193], v15 offset:0
    s_waitcnt lgkmcnt(9)
    v_mfma_f32_16x16x32_bf16 a[48:51], a[200:203], a[128:131], a[48:51]
    ds_read_b64_tr_b16 a[194:195], v15 offset:3072
    v_mfma_f32_16x16x32_bf16 a[48:51], a[204:207], a[144:147], a[48:51]
    ds_read_b64_tr_b16 a[196:197], v15 offset:24576
    v_mfma_f32_16x16x32_bf16 a[52:55], a[200:203], a[132:135], a[52:55]
    ds_read_b64_tr_b16 a[198:199], v15 offset:27648
    v_mfma_f32_16x16x32_bf16 a[52:55], a[204:207], a[148:151], a[52:55]
    v_mfma_f32_16x16x32_bf16 a[56:59], a[200:203], a[136:139], a[56:59]
    v_mfma_f32_16x16x32_bf16 a[56:59], a[204:207], a[152:155], a[56:59]
    v_mfma_f32_16x16x32_bf16 a[60:63], a[200:203], a[140:143], a[60:63]
    buffer_load_dwordx4 v29, s[68:71], s94 offen offset:3072 lds
    v_mfma_f32_16x16x32_bf16 a[60:63], a[204:207], a[156:159], a[60:63]
    ds_read_b64_tr_b16 a[200:201], v16 offset:0
    s_waitcnt lgkmcnt(9)
    v_mfma_f32_16x16x32_bf16 a[64:67], a[208:211], a[128:131], a[64:67]
    ds_read_b64_tr_b16 a[202:203], v16 offset:3072
    v_mfma_f32_16x16x32_bf16 a[64:67], a[212:215], a[144:147], a[64:67]
    ds_read_b64_tr_b16 a[204:205], v16 offset:24576
    v_mfma_f32_16x16x32_bf16 a[68:71], a[208:211], a[132:135], a[68:71]
    ds_read_b64_tr_b16 a[206:207], v16 offset:27648
    v_mfma_f32_16x16x32_bf16 a[68:71], a[212:215], a[148:151], a[68:71]
    v_mfma_f32_16x16x32_bf16 a[72:75], a[208:211], a[136:139], a[72:75]
    v_mfma_f32_16x16x32_bf16 a[72:75], a[212:215], a[152:155], a[72:75]
    v_mfma_f32_16x16x32_bf16 a[76:79], a[208:211], a[140:143], a[76:79]
    v_mfma_f32_16x16x32_bf16 a[76:79], a[212:215], a[156:159], a[76:79]
    s_waitcnt vmcnt(25)
    s_waitcnt lgkmcnt(0)
    s_barrier
    ds_read_b64_tr_b16 a[208:209], v17 offset:1024
    v_mfma_f32_16x16x32_bf16 a[80:83], a[216:219], a[128:131], a[80:83]
    ds_read_b64_tr_b16 a[210:211], v17 offset:4096
    v_mfma_f32_16x16x32_bf16 a[80:83], a[220:223], a[144:147], a[80:83]
    ds_read_b64_tr_b16 a[212:213], v17 offset:25600
    v_mfma_f32_16x16x32_bf16 a[84:87], a[216:219], a[132:135], a[84:87]
    ds_read_b64_tr_b16 a[214:215], v17 offset:28672
    v_mfma_f32_16x16x32_bf16 a[84:87], a[220:223], a[148:151], a[84:87]
    v_mfma_f32_16x16x32_bf16 a[88:91], a[216:219], a[136:139], a[88:91]
    v_mfma_f32_16x16x32_bf16 a[88:91], a[220:223], a[152:155], a[88:91]
    v_mfma_f32_16x16x32_bf16 a[92:95], a[216:219], a[140:143], a[92:95]
    v_mfma_f32_16x16x32_bf16 a[92:95], a[220:223], a[156:159], a[92:95]
    ds_read_b64_tr_b16 a[216:217], v17 offset:2048
    v_mfma_f32_16x16x32_bf16 a[96:99], a[192:195], a[128:131], a[96:99]
    ds_read_b64_tr_b16 a[218:219], v17 offset:5120
    v_mfma_f32_16x16x32_bf16 a[96:99], a[196:199], a[144:147], a[96:99]
    ds_read_b64_tr_b16 a[220:221], v17 offset:26624
    v_mfma_f32_16x16x32_bf16 a[100:103], a[192:195], a[132:135], a[100:103]
    ds_read_b64_tr_b16 a[222:223], v17 offset:29696
    v_mfma_f32_16x16x32_bf16 a[100:103], a[196:199], a[148:151], a[100:103]
    v_mfma_f32_16x16x32_bf16 a[104:107], a[192:195], a[136:139], a[104:107]
    v_mfma_f32_16x16x32_bf16 a[104:107], a[196:199], a[152:155], a[104:107]
    v_mfma_f32_16x16x32_bf16 a[108:111], a[192:195], a[140:143], a[108:111]
    v_mfma_f32_16x16x32_bf16 a[108:111], a[196:199], a[156:159], a[108:111]
    ds_read_b64_tr_b16 a[192:193], v18 offset:1024
    v_mfma_f32_16x16x32_bf16 a[112:115], a[200:203], a[128:131], a[112:115]
    ds_read_b64_tr_b16 a[194:195], v18 offset:4096
    v_mfma_f32_16x16x32_bf16 a[112:115], a[204:207], a[144:147], a[112:115]
    ds_read_b64_tr_b16 a[196:197], v18 offset:25600
    v_mfma_f32_16x16x32_bf16 a[116:119], a[200:203], a[132:135], a[116:119]
    ds_read_b64_tr_b16 a[198:199], v18 offset:28672
    v_mfma_f32_16x16x32_bf16 a[116:119], a[204:207], a[148:151], a[116:119]
    v_mfma_f32_16x16x32_bf16 a[120:123], a[200:203], a[136:139], a[120:123]
    v_mfma_f32_16x16x32_bf16 a[120:123], a[204:207], a[152:155], a[120:123]
    v_mfma_f32_16x16x32_bf16 a[124:127], a[200:203], a[140:143], a[124:127]
    v_mfma_f32_16x16x32_bf16 a[124:127], a[204:207], a[156:159], a[124:127]
    ds_read_b64_tr_b16 a[200:201], v18 offset:2048
    ds_read_b64_tr_b16 a[202:203], v18 offset:5120
    ds_read_b64_tr_b16 a[204:205], v18 offset:26624
    ds_read_b64_tr_b16 a[206:207], v18 offset:29696
    s_waitcnt vmcnt(16)
    s_waitcnt lgkmcnt(10)
    v_mfma_f32_16x16x32_bf16 v[32:35], a[208:211], a[160:163], v[32:35]
    s_add_u32 m0, s92, 114688
    s_add_u32 s94, s93, 49152
    v_mfma_f32_16x16x32_bf16 v[32:35], a[212:215], a[176:179], v[32:35]
    v_mfma_f32_16x16x32_bf16 v[36:39], a[208:211], a[164:167], v[36:39]
    v_mfma_f32_16x16x32_bf16 v[36:39], a[212:215], a[180:183], v[36:39]
    v_mfma_f32_16x16x32_bf16 v[40:43], a[208:211], a[168:171], v[40:43]
    v_mfma_f32_16x16x32_bf16 v[40:43], a[212:215], a[184:187], v[40:43]
    v_mfma_f32_16x16x32_bf16 v[44:47], a[208:211], a[172:175], v[44:47]
    v_mfma_f32_16x16x32_bf16 v[44:47], a[212:215], a[188:191], v[44:47]
    ds_read_b64_tr_b16 a[208:209], v19 offset:1024
    s_waitcnt lgkmcnt(9)
    v_mfma_f32_16x16x32_bf16 v[48:51], a[216:219], a[160:163], v[48:51]
    ds_read_b64_tr_b16 a[210:211], v19 offset:4096
    v_mfma_f32_16x16x32_bf16 v[48:51], a[220:223], a[176:179], v[48:51]
    ds_read_b64_tr_b16 a[212:213], v19 offset:25600
    v_mfma_f32_16x16x32_bf16 v[52:55], a[216:219], a[164:167], v[52:55]
    buffer_load_dwordx4 v29, s[68:71], s94 offen offset:0 lds
    v_mfma_f32_16x16x32_bf16 v[52:55], a[220:223], a[180:183], v[52:55]
    ds_read_b64_tr_b16 a[214:215], v19 offset:28672
    v_mfma_f32_16x16x32_bf16 v[56:59], a[216:219], a[168:171], v[56:59]
    v_mfma_f32_16x16x32_bf16 v[56:59], a[220:223], a[184:187], v[56:59]
    v_mfma_f32_16x16x32_bf16 v[60:63], a[216:219], a[172:175], v[60:63]
    v_mfma_f32_16x16x32_bf16 v[60:63], a[220:223], a[188:191], v[60:63]
    ds_read_b64_tr_b16 a[216:217], v19 offset:2048
    s_waitcnt lgkmcnt(9)
    v_mfma_f32_16x16x32_bf16 v[64:67], a[192:195], a[160:163], v[64:67]
    ds_read_b64_tr_b16 a[218:219], v19 offset:5120
    v_mfma_f32_16x16x32_bf16 v[64:67], a[196:199], a[176:179], v[64:67]
    ds_read_b64_tr_b16 a[220:221], v19 offset:26624
    v_mfma_f32_16x16x32_bf16 v[68:71], a[192:195], a[164:167], v[68:71]
    ds_read_b64_tr_b16 a[222:223], v19 offset:29696
    v_mfma_f32_16x16x32_bf16 v[68:71], a[196:199], a[180:183], v[68:71]
    v_mfma_f32_16x16x32_bf16 v[72:75], a[192:195], a[168:171], v[72:75]
    v_mfma_f32_16x16x32_bf16 v[72:75], a[196:199], a[184:187], v[72:75]
    v_mfma_f32_16x16x32_bf16 v[76:79], a[192:195], a[172:175], v[76:79]
    v_mfma_f32_16x16x32_bf16 v[76:79], a[196:199], a[188:191], v[76:79]
    ds_read_b64_tr_b16 a[192:193], v20 offset:1024
    s_waitcnt lgkmcnt(9)
    v_mfma_f32_16x16x32_bf16 v[80:83], a[200:203], a[160:163], v[80:83]
    ds_read_b64_tr_b16 a[194:195], v20 offset:4096
    v_mfma_f32_16x16x32_bf16 v[80:83], a[204:207], a[176:179], v[80:83]
    ds_read_b64_tr_b16 a[196:197], v20 offset:25600
    v_mfma_f32_16x16x32_bf16 v[84:87], a[200:203], a[164:167], v[84:87]
    ds_read_b64_tr_b16 a[198:199], v20 offset:28672
    v_mfma_f32_16x16x32_bf16 v[84:87], a[204:207], a[180:183], v[84:87]
    v_mfma_f32_16x16x32_bf16 v[88:91], a[200:203], a[168:171], v[88:91]
    v_mfma_f32_16x16x32_bf16 v[88:91], a[204:207], a[184:187], v[88:91]
    v_mfma_f32_16x16x32_bf16 v[92:95], a[200:203], a[172:175], v[92:95]
    v_mfma_f32_16x16x32_bf16 v[92:95], a[204:207], a[188:191], v[92:95]
    ds_read_b64_tr_b16 a[200:201], v20 offset:2048
    s_waitcnt lgkmcnt(9)
    v_mfma_f32_16x16x32_bf16 v[96:99], a[208:211], a[160:163], v[96:99]
    ds_read_b64_tr_b16 a[202:203], v20 offset:5120
    v_mfma_f32_16x16x32_bf16 v[96:99], a[212:215], a[176:179], v[96:99]
    ds_read_b64_tr_b16 a[204:205], v20 offset:26624
    v_mfma_f32_16x16x32_bf16 v[100:103], a[208:211], a[164:167], v[100:103]
    ds_read_b64_tr_b16 a[206:207], v20 offset:29696
    v_mfma_f32_16x16x32_bf16 v[100:103], a[212:215], a[180:183], v[100:103]
    v_mfma_f32_16x16x32_bf16 v[104:107], a[208:211], a[168:171], v[104:107]
    v_mfma_f32_16x16x32_bf16 v[104:107], a[212:215], a[184:187], v[104:107]
    v_mfma_f32_16x16x32_bf16 v[108:111], a[208:211], a[172:175], v[108:111]
    v_mfma_f32_16x16x32_bf16 v[108:111], a[212:215], a[188:191], v[108:111]
    ds_read_b64_tr_b16 a[208:209], v21 offset:1024
    s_waitcnt lgkmcnt(9)
    v_mfma_f32_16x16x32_bf16 v[112:115], a[216:219], a[160:163], v[112:115]
    ds_read_b64_tr_b16 a[210:211], v21 offset:4096
    s_mul_i32 s6, s15, 114688
    v_mfma_f32_16x16x32_bf16 v[112:115], a[220:223], a[176:179], v[112:115]
    ds_read_b64_tr_b16 a[212:213], v21 offset:25600
    s_mul_i32 s12, s5, 7
    v_mfma_f32_16x16x32_bf16 v[116:119], a[216:219], a[164:167], v[116:119]
    buffer_load_dwordx4 v29, s[68:71], s94 offen offset:1024 lds
    v_mfma_f32_16x16x32_bf16 v[116:119], a[220:223], a[180:183], v[116:119]
    ds_read_b64_tr_b16 a[214:215], v21 offset:28672
    s_add_u32 s12, s12, 1
    v_mfma_f32_16x16x32_bf16 v[120:123], a[216:219], a[168:171], v[120:123]
    s_lshr_b32 s12, s12, 1
    s_lshl_b32 s12, s12, 10
    v_mfma_f32_16x16x32_bf16 v[120:123], a[220:223], a[184:187], v[120:123]
    s_add_u32 s6, s6, s12
    s_and_b32 s13, s5, 1
    v_mfma_f32_16x16x32_bf16 v[124:127], a[216:219], a[172:175], v[124:127]
    s_mov_b32 s7, 0xfffffc08
    v_mfma_f32_16x16x32_bf16 v[124:127], a[220:223], a[188:191], v[124:127]
    ds_read_b64_tr_b16 a[216:217], v21 offset:2048
    s_waitcnt lgkmcnt(9)
    v_mfma_f32_16x16x32_bf16 v[128:131], a[192:195], a[160:163], v[128:131]
    ds_read_b64_tr_b16 a[218:219], v21 offset:5120
    v_mfma_f32_16x16x32_bf16 v[128:131], a[196:199], a[176:179], v[128:131]
    ds_read_b64_tr_b16 a[220:221], v21 offset:26624
    v_mfma_f32_16x16x32_bf16 v[132:135], a[192:195], a[164:167], v[132:135]
    ds_read_b64_tr_b16 a[222:223], v21 offset:29696
    v_mfma_f32_16x16x32_bf16 v[132:135], a[196:199], a[180:183], v[132:135]
    s_cmp_eq_u32 s13, 0
    s_cselect_b32 s7, 0xc00, s7
    v_mfma_f32_16x16x32_bf16 v[136:139], a[192:195], a[168:171], v[136:139]
    s_add_u32 s7, s6, s7
    s_mov_b32 s8, 0xbfb8aa3b
    v_mfma_f32_16x16x32_bf16 v[136:139], a[196:199], a[184:187], v[136:139]
    s_mov_b32 s9, 0xbfb8aa3b
    v_mul_f32 v32, s8, v32
    v_mfma_f32_16x16x32_bf16 v[140:143], a[192:195], a[172:175], v[140:143]
    v_mul_f32 v33, s8, v33
    v_mul_f32 v34, s8, v34
    v_mfma_f32_16x16x32_bf16 v[140:143], a[196:199], a[188:191], v[140:143]
    ds_read_b64_tr_b16 a[192:193], v22 offset:1024
    v_mul_f32 v35, s8, v35
    s_waitcnt lgkmcnt(9)
    v_mfma_f32_16x16x32_bf16 v[144:147], a[200:203], a[160:163], v[144:147]
    ds_read_b64_tr_b16 a[194:195], v22 offset:4096
    v_mfma_f32_16x16x32_bf16 v[144:147], a[204:207], a[176:179], v[144:147]
    ds_read_b64_tr_b16 a[196:197], v22 offset:25600
    v_mfma_f32_16x16x32_bf16 v[148:151], a[200:203], a[164:167], v[148:151]
    ds_read_b64_tr_b16 a[198:199], v22 offset:28672
    v_mfma_f32_16x16x32_bf16 v[148:151], a[204:207], a[180:183], v[148:151]
    v_exp_f32 v32, v32
    v_mfma_f32_16x16x32_bf16 v[152:155], a[200:203], a[168:171], v[152:155]
    v_exp_f32 v33, v33
    v_mfma_f32_16x16x32_bf16 v[152:155], a[204:207], a[184:187], v[152:155]
    v_exp_f32 v34, v34
    v_mfma_f32_16x16x32_bf16 v[156:159], a[200:203], a[172:175], v[156:159]
    v_exp_f32 v35, v35
    v_mfma_f32_16x16x32_bf16 v[156:159], a[204:207], a[188:191], v[156:159]
    ds_read_b64_tr_b16 a[200:201], v22 offset:2048
    v_add_f32 v32, 1.0, v32
    s_waitcnt lgkmcnt(9)
    v_mfma_f32_16x16x32_bf16 v[160:163], a[208:211], a[160:163], v[160:163]
    ds_read_b64_tr_b16 a[202:203], v22 offset:5120
    v_add_f32 v33, 1.0, v33
    v_mfma_f32_16x16x32_bf16 v[160:163], a[212:215], a[176:179], v[160:163]
    ds_read_b64_tr_b16 a[204:205], v22 offset:26624
    v_add_f32 v34, 1.0, v34
    v_mfma_f32_16x16x32_bf16 v[164:167], a[208:211], a[164:167], v[164:167]
    ds_read_b64_tr_b16 a[206:207], v22 offset:29696
    v_add_f32 v35, 1.0, v35
    v_mfma_f32_16x16x32_bf16 v[164:167], a[212:215], a[180:183], v[164:167]
    v_rcp_f32 v32, v32
    v_mfma_f32_16x16x32_bf16 v[168:171], a[208:211], a[168:171], v[168:171]
    v_rcp_f32 v33, v33
    v_mfma_f32_16x16x32_bf16 v[168:171], a[212:215], a[184:187], v[168:171]
    v_rcp_f32 v34, v34
    v_mfma_f32_16x16x32_bf16 v[172:175], a[208:211], a[172:175], v[172:175]
    v_rcp_f32 v35, v35
    v_mfma_f32_16x16x32_bf16 v[172:175], a[212:215], a[188:191], v[172:175]
    ds_read_b64_tr_b16 a[208:209], v23 offset:1024
    v_mul_f32 v32, v32, v48
    s_waitcnt lgkmcnt(9)
    v_mfma_f32_16x16x32_bf16 v[176:179], a[216:219], a[160:163], v[176:179]
    ds_read_b64_tr_b16 a[210:211], v23 offset:4096
    v_mul_f32 v33, v33, v49
    v_mfma_f32_16x16x32_bf16 v[176:179], a[220:223], a[176:179], v[176:179]
    ds_read_b64_tr_b16 a[212:213], v23 offset:25600
    v_mul_f32 v34, v34, v50
    v_mfma_f32_16x16x32_bf16 v[180:183], a[216:219], a[164:167], v[180:183]
    ds_read_b64_tr_b16 a[214:215], v23 offset:28672
    v_mul_f32 v35, v35, v51
    v_mfma_f32_16x16x32_bf16 v[180:183], a[220:223], a[180:183], v[180:183]
    v_cvt_pk_bf16_f32 v48, v32, v33
    v_cvt_pk_bf16_f32 v49, v34, v35
    v_mfma_f32_16x16x32_bf16 v[184:187], a[216:219], a[168:171], v[184:187]
    v_mul_f32 v64, s8, v64
    v_mul_f32 v65, s8, v65
    v_mfma_f32_16x16x32_bf16 v[184:187], a[220:223], a[184:187], v[184:187]
    v_mul_f32 v66, s8, v66
    v_mul_f32 v67, s8, v67
    v_mfma_f32_16x16x32_bf16 v[188:191], a[216:219], a[172:175], v[188:191]
    buffer_load_dwordx4 v29, s[68:71], s94 offen offset:2048 lds
    v_mfma_f32_16x16x32_bf16 v[188:191], a[220:223], a[188:191], v[188:191]
    ds_read_b64_tr_b16 a[216:217], v23 offset:2048
    s_waitcnt lgkmcnt(9)
    v_mfma_f32_16x16x32_bf16 v[192:195], a[192:195], a[160:163], v[192:195]
    ds_read_b64_tr_b16 a[218:219], v23 offset:5120
    v_mfma_f32_16x16x32_bf16 v[192:195], a[196:199], a[176:179], v[192:195]
    ds_read_b64_tr_b16 a[220:221], v23 offset:26624
    v_mfma_f32_16x16x32_bf16 v[196:199], a[192:195], a[164:167], v[196:199]
    ds_read_b64_tr_b16 a[222:223], v23 offset:29696
    v_mfma_f32_16x16x32_bf16 v[196:199], a[196:199], a[180:183], v[196:199]
    v_exp_f32 v64, v64
    v_mfma_f32_16x16x32_bf16 v[200:203], a[192:195], a[168:171], v[200:203]
    v_exp_f32 v65, v65
    v_mfma_f32_16x16x32_bf16 v[200:203], a[196:199], a[184:187], v[200:203]
    v_exp_f32 v66, v66
    v_mfma_f32_16x16x32_bf16 v[204:207], a[192:195], a[172:175], v[204:207]
    v_exp_f32 v67, v67
    v_mfma_f32_16x16x32_bf16 v[204:207], a[196:199], a[188:191], v[204:207]
    ds_read_b64_tr_b16 a[192:193], v17 offset:0
    v_add_f32 v64, 1.0, v64
    s_waitcnt lgkmcnt(9)
    v_mfma_f32_16x16x32_bf16 v[208:211], a[200:203], a[160:163], v[208:211]
    ds_read_b64_tr_b16 a[194:195], v17 offset:3072
    v_add_f32 v65, 1.0, v65
    v_mfma_f32_16x16x32_bf16 v[208:211], a[204:207], a[176:179], v[208:211]
    ds_read_b64_tr_b16 a[196:197], v17 offset:24576
    v_add_f32 v66, 1.0, v66
    v_mfma_f32_16x16x32_bf16 v[212:215], a[200:203], a[164:167], v[212:215]
    ds_read_b64_tr_b16 a[198:199], v17 offset:27648
    v_add_f32 v67, 1.0, v67
    v_mfma_f32_16x16x32_bf16 v[212:215], a[204:207], a[180:183], v[212:215]
    v_rcp_f32 v64, v64
    v_mfma_f32_16x16x32_bf16 v[216:219], a[200:203], a[168:171], v[216:219]
    v_rcp_f32 v65, v65
    v_mfma_f32_16x16x32_bf16 v[216:219], a[204:207], a[184:187], v[216:219]
    v_rcp_f32 v66, v66
    v_mfma_f32_16x16x32_bf16 v[220:223], a[200:203], a[172:175], v[220:223]
    v_rcp_f32 v67, v67
    v_mfma_f32_16x16x32_bf16 v[220:223], a[204:207], a[188:191], v[220:223]
    ds_read_b64_tr_b16 a[200:201], v18 offset:0
    v_mul_f32 v64, v64, v80
    s_waitcnt lgkmcnt(9)
    v_mfma_f32_16x16x32_bf16 v[224:227], a[208:211], a[160:163], v[224:227]
    ds_read_b64_tr_b16 a[202:203], v18 offset:3072
    v_mul_f32 v65, v65, v81
    v_mfma_f32_16x16x32_bf16 v[224:227], a[212:215], a[176:179], v[224:227]
    ds_read_b64_tr_b16 a[204:205], v18 offset:24576
    v_mul_f32 v66, v66, v82
    v_mfma_f32_16x16x32_bf16 v[228:231], a[208:211], a[164:167], v[228:231]
    ds_read_b64_tr_b16 a[206:207], v18 offset:27648
    v_mul_f32 v67, v67, v83
    v_mfma_f32_16x16x32_bf16 v[228:231], a[212:215], a[180:183], v[228:231]
    v_cvt_pk_bf16_f32 v50, v64, v65
    v_cvt_pk_bf16_f32 v51, v66, v67
    v_mfma_f32_16x16x32_bf16 v[232:235], a[208:211], a[168:171], v[232:235]
    s_add_u32 s11, s6, 0
    v_mfma_f32_16x16x32_bf16 v[232:235], a[212:215], a[184:187], v[232:235]
    buffer_store_dwordx4 v[48:51], v4, s[56:59], s11 offen sc0 sc1
    v_mfma_f32_16x16x32_bf16 v[236:239], a[208:211], a[172:175], v[236:239]
    v_mul_f32 v36, s8, v36
    v_mul_f32 v37, s8, v37
    v_mfma_f32_16x16x32_bf16 v[236:239], a[212:215], a[188:191], v[236:239]
    ds_read_b64_tr_b16 a[208:209], v19 offset:0
    v_mul_f32 v38, s8, v38
    s_waitcnt lgkmcnt(9)
    v_mfma_f32_16x16x32_bf16 v[240:243], a[216:219], a[160:163], v[240:243]
    ds_read_b64_tr_b16 a[210:211], v19 offset:3072
    v_mul_f32 v39, s8, v39
    v_mfma_f32_16x16x32_bf16 v[240:243], a[220:223], a[176:179], v[240:243]
    ds_read_b64_tr_b16 a[212:213], v19 offset:24576
    v_mfma_f32_16x16x32_bf16 v[244:247], a[216:219], a[164:167], v[244:247]
    ds_read_b64_tr_b16 a[214:215], v19 offset:27648
    v_mfma_f32_16x16x32_bf16 v[244:247], a[220:223], a[180:183], v[244:247]
    v_exp_f32 v36, v36
    v_mfma_f32_16x16x32_bf16 v[248:251], a[216:219], a[168:171], v[248:251]
    v_exp_f32 v37, v37
    v_mfma_f32_16x16x32_bf16 v[248:251], a[220:223], a[184:187], v[248:251]
    v_exp_f32 v38, v38
    v_mfma_f32_16x16x32_bf16 v[252:255], a[216:219], a[172:175], v[252:255]
    v_exp_f32 v39, v39
    v_mfma_f32_16x16x32_bf16 v[252:255], a[220:223], a[188:191], v[252:255]
    ds_read_b64_tr_b16 a[216:217], v20 offset:0
    v_add_f32 v36, 1.0, v36
    s_waitcnt lgkmcnt(9)
    v_mfma_f32_16x16x32_bf16 a[0:3], a[192:195], a[160:163], a[0:3]
    ds_read_b64_tr_b16 a[218:219], v20 offset:3072
    v_add_f32 v37, 1.0, v37
    v_mfma_f32_16x16x32_bf16 a[0:3], a[196:199], a[176:179], a[0:3]
    ds_read_b64_tr_b16 a[220:221], v20 offset:24576
    v_add_f32 v38, 1.0, v38
    v_mfma_f32_16x16x32_bf16 a[4:7], a[192:195], a[164:167], a[4:7]
    buffer_load_dwordx4 v29, s[68:71], s94 offen offset:3072 lds
    v_mfma_f32_16x16x32_bf16 a[4:7], a[196:199], a[180:183], a[4:7]
    ds_read_b64_tr_b16 a[222:223], v20 offset:27648
    v_add_f32 v39, 1.0, v39
    v_mfma_f32_16x16x32_bf16 a[8:11], a[192:195], a[168:171], a[8:11]
    v_rcp_f32 v36, v36
    v_mfma_f32_16x16x32_bf16 a[8:11], a[196:199], a[184:187], a[8:11]
    v_rcp_f32 v37, v37
    v_mfma_f32_16x16x32_bf16 a[12:15], a[192:195], a[172:175], a[12:15]
    v_rcp_f32 v38, v38
    v_mfma_f32_16x16x32_bf16 a[12:15], a[196:199], a[188:191], a[12:15]
    ds_read_b64_tr_b16 a[192:193], v21 offset:0
    s_waitcnt lgkmcnt(9)
    v_mfma_f32_16x16x32_bf16 a[16:19], a[200:203], a[160:163], a[16:19]
    ds_read_b64_tr_b16 a[194:195], v21 offset:3072
    v_mfma_f32_16x16x32_bf16 a[16:19], a[204:207], a[176:179], a[16:19]
    ds_read_b64_tr_b16 a[196:197], v21 offset:24576
    v_mfma_f32_16x16x32_bf16 a[20:23], a[200:203], a[164:167], a[20:23]
    ds_read_b64_tr_b16 a[198:199], v21 offset:27648
    v_mfma_f32_16x16x32_bf16 a[20:23], a[204:207], a[180:183], a[20:23]
    v_rcp_f32 v39, v39
    v_mfma_f32_16x16x32_bf16 a[24:27], a[200:203], a[168:171], a[24:27]
    v_mul_f32 v36, v36, v52
    v_mul_f32 v37, v37, v53
    v_mfma_f32_16x16x32_bf16 a[24:27], a[204:207], a[184:187], a[24:27]
    v_mul_f32 v38, v38, v54
    v_mul_f32 v39, v39, v55
    v_mfma_f32_16x16x32_bf16 a[28:31], a[200:203], a[172:175], a[28:31]
    v_cvt_pk_bf16_f32 v52, v36, v37
    v_cvt_pk_bf16_f32 v53, v38, v39
    v_mfma_f32_16x16x32_bf16 a[28:31], a[204:207], a[188:191], a[28:31]
    ds_read_b64_tr_b16 a[200:201], v22 offset:0
    v_mul_f32 v68, s8, v68
    s_waitcnt lgkmcnt(9)
    v_mfma_f32_16x16x32_bf16 a[32:35], a[208:211], a[160:163], a[32:35]
    ds_read_b64_tr_b16 a[202:203], v22 offset:3072
    v_mul_f32 v69, s8, v69
    v_mfma_f32_16x16x32_bf16 a[32:35], a[212:215], a[176:179], a[32:35]
    ds_read_b64_tr_b16 a[204:205], v22 offset:24576
    v_mul_f32 v70, s8, v70
    v_mfma_f32_16x16x32_bf16 a[36:39], a[208:211], a[164:167], a[36:39]
    ds_read_b64_tr_b16 a[206:207], v22 offset:27648
    v_mul_f32 v71, s8, v71
    v_mfma_f32_16x16x32_bf16 a[36:39], a[212:215], a[180:183], a[36:39]
    v_exp_f32 v68, v68
    v_mfma_f32_16x16x32_bf16 a[40:43], a[208:211], a[168:171], a[40:43]
    v_exp_f32 v69, v69
    v_mfma_f32_16x16x32_bf16 a[40:43], a[212:215], a[184:187], a[40:43]
    v_exp_f32 v70, v70
    v_mfma_f32_16x16x32_bf16 a[44:47], a[208:211], a[172:175], a[44:47]
    v_exp_f32 v71, v71
    v_mfma_f32_16x16x32_bf16 a[44:47], a[212:215], a[188:191], a[44:47]
    ds_read_b64_tr_b16 a[208:209], v23 offset:0
    v_add_f32 v68, 1.0, v68
    s_waitcnt lgkmcnt(9)
    v_mfma_f32_16x16x32_bf16 a[48:51], a[216:219], a[160:163], a[48:51]
    ds_read_b64_tr_b16 a[210:211], v23 offset:3072
    v_add_f32 v69, 1.0, v69
    v_mfma_f32_16x16x32_bf16 a[48:51], a[220:223], a[176:179], a[48:51]
    ds_read_b64_tr_b16 a[212:213], v23 offset:24576
    v_add_f32 v70, 1.0, v70
    v_mfma_f32_16x16x32_bf16 a[52:55], a[216:219], a[164:167], a[52:55]
    ds_read_b64_tr_b16 a[214:215], v23 offset:27648
    v_add_f32 v71, 1.0, v71
    v_mfma_f32_16x16x32_bf16 a[52:55], a[220:223], a[180:183], a[52:55]
    v_rcp_f32 v68, v68
    v_mfma_f32_16x16x32_bf16 a[56:59], a[216:219], a[168:171], a[56:59]
    v_rcp_f32 v69, v69
    v_mfma_f32_16x16x32_bf16 a[56:59], a[220:223], a[184:187], a[56:59]
    v_rcp_f32 v70, v70
    v_mfma_f32_16x16x32_bf16 a[60:63], a[216:219], a[172:175], a[60:63]
    v_rcp_f32 v71, v71
    v_mfma_f32_16x16x32_bf16 a[60:63], a[220:223], a[188:191], a[60:63]
    ds_read_b64_tr_b16 a[216:217], v24 offset:0
    v_mul_f32 v68, v68, v84
    s_waitcnt lgkmcnt(9)
    v_mfma_f32_16x16x32_bf16 a[64:67], a[192:195], a[160:163], a[64:67]
    ds_read_b64_tr_b16 a[218:219], v24 offset:3072
    v_mul_f32 v69, v69, v85
    v_mfma_f32_16x16x32_bf16 a[64:67], a[196:199], a[176:179], a[64:67]
    ds_read_b64_tr_b16 a[220:221], v24 offset:24576
    v_mul_f32 v70, v70, v86
    v_mfma_f32_16x16x32_bf16 a[68:71], a[192:195], a[164:167], a[68:71]
    ds_read_b64_tr_b16 a[222:223], v24 offset:27648
    v_mul_f32 v71, v71, v87
    v_mfma_f32_16x16x32_bf16 a[68:71], a[196:199], a[180:183], a[68:71]
    v_cvt_pk_bf16_f32 v54, v68, v69
    v_cvt_pk_bf16_f32 v55, v70, v71
    v_mfma_f32_16x16x32_bf16 a[72:75], a[192:195], a[168:171], a[72:75]
    s_add_u32 s11, s6, 114688
    v_mfma_f32_16x16x32_bf16 a[72:75], a[196:199], a[184:187], a[72:75]
    buffer_store_dwordx4 v[52:55], v4, s[56:59], s11 offen sc0 sc1
    v_mfma_f32_16x16x32_bf16 a[76:79], a[192:195], a[172:175], a[76:79]
    v_mul_f32 v40, s8, v40
    v_mul_f32 v41, s8, v41
    v_mfma_f32_16x16x32_bf16 a[76:79], a[196:199], a[188:191], a[76:79]
    s_waitcnt lgkmcnt(0)
    s_barrier
    s_add_u32 m0, s92, 16384
    s_add_u32 s94, s93, 16384
    v_mfma_f32_16x16x32_bf16 a[80:83], a[200:203], a[160:163], a[80:83]
    v_mul_f32 v42, s8, v42
    v_mul_f32 v43, s8, v43
    v_mfma_f32_16x16x32_bf16 a[80:83], a[204:207], a[176:179], a[80:83]
    buffer_load_dwordx4 v25, s[64:67], s94 offen offset:0 lds
    v_mfma_f32_16x16x32_bf16 a[84:87], a[200:203], a[164:167], a[84:87]
    v_exp_f32 v40, v40
    v_mfma_f32_16x16x32_bf16 a[84:87], a[204:207], a[180:183], a[84:87]
    buffer_load_dwordx4 v26, s[64:67], s94 offen offset:1024 lds
    v_mfma_f32_16x16x32_bf16 a[88:91], a[200:203], a[168:171], a[88:91]
    v_exp_f32 v41, v41
    v_mfma_f32_16x16x32_bf16 a[88:91], a[204:207], a[184:187], a[88:91]
    buffer_load_dwordx4 v27, s[64:67], s94 offen offset:2048 lds
    v_mfma_f32_16x16x32_bf16 a[92:95], a[200:203], a[172:175], a[92:95]
    v_exp_f32 v42, v42
    v_mfma_f32_16x16x32_bf16 a[92:95], a[204:207], a[188:191], a[92:95]
    buffer_load_dwordx4 v28, s[64:67], s94 offen offset:3072 lds
    v_mfma_f32_16x16x32_bf16 a[96:99], a[208:211], a[160:163], a[96:99]
    s_add_u32 m0, s92, 32768
    s_add_u32 s94, s93, 32768
    v_mfma_f32_16x16x32_bf16 a[96:99], a[212:215], a[176:179], a[96:99]
    buffer_load_dwordx4 v25, s[64:67], s94 offen offset:0 lds
    v_mfma_f32_16x16x32_bf16 a[100:103], a[208:211], a[164:167], a[100:103]
    v_exp_f32 v43, v43
    v_mfma_f32_16x16x32_bf16 a[100:103], a[212:215], a[180:183], a[100:103]
    buffer_load_dwordx4 v26, s[64:67], s94 offen offset:1024 lds
    v_mfma_f32_16x16x32_bf16 a[104:107], a[208:211], a[168:171], a[104:107]
    v_add_f32 v40, 1.0, v40
    v_add_f32 v41, 1.0, v41
    v_mfma_f32_16x16x32_bf16 a[104:107], a[212:215], a[184:187], a[104:107]
    buffer_load_dwordx4 v27, s[64:67], s94 offen offset:2048 lds
    v_mfma_f32_16x16x32_bf16 a[108:111], a[208:211], a[172:175], a[108:111]
    v_add_f32 v42, 1.0, v42
    v_add_f32 v43, 1.0, v43
    v_mfma_f32_16x16x32_bf16 a[108:111], a[212:215], a[188:191], a[108:111]
    buffer_load_dwordx4 v28, s[64:67], s94 offen offset:3072 lds
    v_mfma_f32_16x16x32_bf16 a[112:115], a[216:219], a[160:163], a[112:115]
    s_add_u32 m0, s92, 49152
    s_add_u32 s94, s93, 49152
    v_mfma_f32_16x16x32_bf16 a[112:115], a[220:223], a[176:179], a[112:115]
    buffer_load_dwordx4 v25, s[64:67], s94 offen offset:0 lds
    v_mfma_f32_16x16x32_bf16 a[116:119], a[216:219], a[164:167], a[116:119]
    v_rcp_f32 v40, v40
    v_mfma_f32_16x16x32_bf16 a[116:119], a[220:223], a[180:183], a[116:119]
    buffer_load_dwordx4 v26, s[64:67], s94 offen offset:1024 lds
    v_mfma_f32_16x16x32_bf16 a[120:123], a[216:219], a[168:171], a[120:123]
    v_rcp_f32 v41, v41
    v_mfma_f32_16x16x32_bf16 a[120:123], a[220:223], a[184:187], a[120:123]
    buffer_load_dwordx4 v27, s[64:67], s94 offen offset:2048 lds
    v_mfma_f32_16x16x32_bf16 a[124:127], a[216:219], a[172:175], a[124:127]
    v_rcp_f32 v42, v42
    v_mfma_f32_16x16x32_bf16 a[124:127], a[220:223], a[188:191], a[124:127]
    buffer_load_dwordx4 v28, s[64:67], s94 offen offset:3072 lds
    v_rcp_f32 v43, v43
    v_mul_f32 v40, v40, v56
    v_mul_f32 v41, v41, v57
    v_mul_f32 v42, v42, v58
    v_mul_f32 v43, v43, v59
    v_cvt_pk_bf16_f32 v56, v40, v41
    v_cvt_pk_bf16_f32 v57, v42, v43
    v_mul_f32 v72, s8, v72
    v_mul_f32 v73, s8, v73
    v_mul_f32 v74, s8, v74
    v_mul_f32 v75, s8, v75
    v_exp_f32 v72, v72
    v_exp_f32 v73, v73
    v_exp_f32 v74, v74
    v_exp_f32 v75, v75
    v_add_f32 v72, 1.0, v72
    v_add_f32 v73, 1.0, v73
    v_add_f32 v74, 1.0, v74
    v_add_f32 v75, 1.0, v75
    v_rcp_f32 v72, v72
    v_rcp_f32 v73, v73
    v_rcp_f32 v74, v74
    v_rcp_f32 v75, v75
    v_mul_f32 v72, v72, v88
    v_mul_f32 v73, v73, v89
    v_mul_f32 v74, v74, v90
    v_mul_f32 v75, v75, v91
    v_cvt_pk_bf16_f32 v58, v72, v73
    v_cvt_pk_bf16_f32 v59, v74, v75
    s_add_u32 s11, s6, 229376
    buffer_store_dwordx4 v[56:59], v4, s[56:59], s11 offen sc0 sc1
    v_mul_f32 v44, s8, v44
    v_mul_f32 v45, s8, v45
    v_mul_f32 v46, s8, v46
    v_mul_f32 v47, s8, v47
    v_exp_f32 v44, v44
    v_exp_f32 v45, v45
    v_exp_f32 v46, v46
    v_exp_f32 v47, v47
    v_add_f32 v44, 1.0, v44
    v_add_f32 v45, 1.0, v45
    v_add_f32 v46, 1.0, v46
    v_add_f32 v47, 1.0, v47
    v_rcp_f32 v44, v44
    v_rcp_f32 v45, v45
    v_rcp_f32 v46, v46
    v_rcp_f32 v47, v47
    v_mul_f32 v44, v44, v60
    v_mul_f32 v45, v45, v61
    v_mul_f32 v46, v46, v62
    v_mul_f32 v47, v47, v63
    v_cvt_pk_bf16_f32 v60, v44, v45
    v_cvt_pk_bf16_f32 v61, v46, v47
    v_mul_f32 v76, s8, v76
    v_mul_f32 v77, s8, v77
    v_mul_f32 v78, s8, v78
    v_mul_f32 v79, s8, v79
    v_exp_f32 v76, v76
    v_exp_f32 v77, v77
    v_exp_f32 v78, v78
    v_exp_f32 v79, v79
    v_add_f32 v76, 1.0, v76
    v_add_f32 v77, 1.0, v77
    v_add_f32 v78, 1.0, v78
    v_add_f32 v79, 1.0, v79
    v_rcp_f32 v76, v76
    v_rcp_f32 v77, v77
    v_rcp_f32 v78, v78
    v_rcp_f32 v79, v79
    v_mul_f32 v76, v76, v92
    v_mul_f32 v77, v77, v93
    v_mul_f32 v78, v78, v94
    v_mul_f32 v79, v79, v95
    v_cvt_pk_bf16_f32 v62, v76, v77
    v_cvt_pk_bf16_f32 v63, v78, v79
    s_add_u32 s11, s6, 344064
    buffer_store_dwordx4 v[60:63], v4, s[56:59], s11 offen sc0 sc1
    v_pk_mul_f32 v[96:97], v[96:97], s[8:9]
    v_pk_mul_f32 v[98:99], v[98:99], s[8:9]
    v_exp_f32 v96, v96
    v_exp_f32 v97, v97
    v_exp_f32 v98, v98
    v_exp_f32 v99, v99
    v_pk_add_f32 v[96:97], v[96:97], 1.0 op_sel_hi:[1,0]
    v_pk_add_f32 v[98:99], v[98:99], 1.0 op_sel_hi:[1,0]
    v_rcp_f32 v96, v96
    v_rcp_f32 v97, v97
    v_rcp_f32 v98, v98
    v_rcp_f32 v99, v99
    v_pk_mul_f32 v[96:97], v[96:97], v[112:113]
    v_pk_mul_f32 v[98:99], v[98:99], v[114:115]
    v_cvt_pk_bf16_f32 v112, v96, v97
    v_cvt_pk_bf16_f32 v113, v98, v99
    v_pk_mul_f32 v[128:129], v[128:129], s[8:9]
    v_pk_mul_f32 v[130:131], v[130:131], s[8:9]
    v_exp_f32 v128, v128
    v_exp_f32 v129, v129
    v_exp_f32 v130, v130
    v_exp_f32 v131, v131
    v_pk_add_f32 v[128:129], v[128:129], 1.0 op_sel_hi:[1,0]
    v_pk_add_f32 v[130:131], v[130:131], 1.0 op_sel_hi:[1,0]
    v_rcp_f32 v128, v128
    v_rcp_f32 v129, v129
    v_rcp_f32 v130, v130
    v_rcp_f32 v131, v131
    v_pk_mul_f32 v[128:129], v[128:129], v[144:145]
    v_pk_mul_f32 v[130:131], v[130:131], v[146:147]
    v_cvt_pk_bf16_f32 v114, v128, v129
    v_cvt_pk_bf16_f32 v115, v130, v131
    s_add_u32 s13, s6, 0
    buffer_store_dwordx4 v[112:115], v4, s[56:59], s13 offen offset:1024 sc0 sc1
    v_pk_mul_f32 v[100:101], v[100:101], s[8:9]
    v_pk_mul_f32 v[102:103], v[102:103], s[8:9]
    v_exp_f32 v100, v100
    v_exp_f32 v101, v101
    v_exp_f32 v102, v102
    v_exp_f32 v103, v103
    v_pk_add_f32 v[100:101], v[100:101], 1.0 op_sel_hi:[1,0]
    v_pk_add_f32 v[102:103], v[102:103], 1.0 op_sel_hi:[1,0]
    v_rcp_f32 v100, v100
    v_rcp_f32 v101, v101
    v_rcp_f32 v102, v102
    v_rcp_f32 v103, v103
    v_pk_mul_f32 v[100:101], v[100:101], v[116:117]
    v_pk_mul_f32 v[102:103], v[102:103], v[118:119]
    v_cvt_pk_bf16_f32 v116, v100, v101
    v_cvt_pk_bf16_f32 v117, v102, v103
    v_pk_mul_f32 v[132:133], v[132:133], s[8:9]
    v_pk_mul_f32 v[134:135], v[134:135], s[8:9]
    v_exp_f32 v132, v132
    v_exp_f32 v133, v133
    v_exp_f32 v134, v134
    v_exp_f32 v135, v135
    v_pk_add_f32 v[132:133], v[132:133], 1.0 op_sel_hi:[1,0]
    v_pk_add_f32 v[134:135], v[134:135], 1.0 op_sel_hi:[1,0]
    v_rcp_f32 v132, v132
    v_rcp_f32 v133, v133
    v_rcp_f32 v134, v134
    v_rcp_f32 v135, v135
    v_pk_mul_f32 v[132:133], v[132:133], v[148:149]
    v_pk_mul_f32 v[134:135], v[134:135], v[150:151]
    v_cvt_pk_bf16_f32 v118, v132, v133
    v_cvt_pk_bf16_f32 v119, v134, v135
    s_add_u32 s13, s6, 114688
    buffer_store_dwordx4 v[116:119], v4, s[56:59], s13 offen offset:1024 sc0 sc1
    v_pk_mul_f32 v[104:105], v[104:105], s[8:9]
    v_pk_mul_f32 v[106:107], v[106:107], s[8:9]
    v_exp_f32 v104, v104
    v_exp_f32 v105, v105
    v_exp_f32 v106, v106
    v_exp_f32 v107, v107
    v_pk_add_f32 v[104:105], v[104:105], 1.0 op_sel_hi:[1,0]
    v_pk_add_f32 v[106:107], v[106:107], 1.0 op_sel_hi:[1,0]
    v_rcp_f32 v104, v104
    v_rcp_f32 v105, v105
    v_rcp_f32 v106, v106
    v_rcp_f32 v107, v107
    v_pk_mul_f32 v[104:105], v[104:105], v[120:121]
    v_pk_mul_f32 v[106:107], v[106:107], v[122:123]
    v_cvt_pk_bf16_f32 v120, v104, v105
    v_cvt_pk_bf16_f32 v121, v106, v107
    v_pk_mul_f32 v[136:137], v[136:137], s[8:9]
    v_pk_mul_f32 v[138:139], v[138:139], s[8:9]
    v_exp_f32 v136, v136
    v_exp_f32 v137, v137
    v_exp_f32 v138, v138
    v_exp_f32 v139, v139
    v_pk_add_f32 v[136:137], v[136:137], 1.0 op_sel_hi:[1,0]
    v_pk_add_f32 v[138:139], v[138:139], 1.0 op_sel_hi:[1,0]
    v_rcp_f32 v136, v136
    v_rcp_f32 v137, v137
    v_rcp_f32 v138, v138
    v_rcp_f32 v139, v139
    v_pk_mul_f32 v[136:137], v[136:137], v[152:153]
    v_pk_mul_f32 v[138:139], v[138:139], v[154:155]
    v_cvt_pk_bf16_f32 v122, v136, v137
    v_cvt_pk_bf16_f32 v123, v138, v139
    s_add_u32 s13, s6, 229376
    buffer_store_dwordx4 v[120:123], v4, s[56:59], s13 offen offset:1024 sc0 sc1
    v_pk_mul_f32 v[108:109], v[108:109], s[8:9]
    v_pk_mul_f32 v[110:111], v[110:111], s[8:9]
    v_exp_f32 v108, v108
    v_exp_f32 v109, v109
    v_exp_f32 v110, v110
    v_exp_f32 v111, v111
    v_pk_add_f32 v[108:109], v[108:109], 1.0 op_sel_hi:[1,0]
    v_pk_add_f32 v[110:111], v[110:111], 1.0 op_sel_hi:[1,0]
    v_rcp_f32 v108, v108
    v_rcp_f32 v109, v109
    v_rcp_f32 v110, v110
    v_rcp_f32 v111, v111
    v_pk_mul_f32 v[108:109], v[108:109], v[124:125]
    v_pk_mul_f32 v[110:111], v[110:111], v[126:127]
    v_cvt_pk_bf16_f32 v124, v108, v109
    v_cvt_pk_bf16_f32 v125, v110, v111
    v_pk_mul_f32 v[140:141], v[140:141], s[8:9]
    v_pk_mul_f32 v[142:143], v[142:143], s[8:9]
    v_exp_f32 v140, v140
    v_exp_f32 v141, v141
    v_exp_f32 v142, v142
    v_exp_f32 v143, v143
    v_pk_add_f32 v[140:141], v[140:141], 1.0 op_sel_hi:[1,0]
    v_pk_add_f32 v[142:143], v[142:143], 1.0 op_sel_hi:[1,0]
    v_rcp_f32 v140, v140
    v_rcp_f32 v141, v141
    v_rcp_f32 v142, v142
    v_rcp_f32 v143, v143
    v_pk_mul_f32 v[140:141], v[140:141], v[156:157]
    v_pk_mul_f32 v[142:143], v[142:143], v[158:159]
    v_cvt_pk_bf16_f32 v126, v140, v141
    v_cvt_pk_bf16_f32 v127, v142, v143
    s_add_u32 s13, s6, 344064
    buffer_store_dwordx4 v[124:127], v4, s[56:59], s13 offen offset:1024 sc0 sc1
    s_mov_b32 s12, 0x3e0293ee
    s_mov_b32 s13, 0x3e0293ee
    s_mov_b32 s95, 0x49800000
    v_accvgpr_read_b32 v96, a0
    v_accvgpr_read_b32 v97, a1
    v_accvgpr_read_b32 v98, a2
    v_accvgpr_read_b32 v99, a3
    v_accvgpr_read_b32 v100, a4
    v_accvgpr_read_b32 v101, a5
    v_accvgpr_read_b32 v102, a6
    v_accvgpr_read_b32 v103, a7
    v_pk_mul_f32 v[96:97], v[96:97], s[12:13]
    v_pk_mul_f32 v[98:99], v[98:99], s[12:13]
    v_pk_mul_f32 v[100:101], v[100:101], s[12:13]
    v_pk_mul_f32 v[102:103], v[102:103], s[12:13]
    v_cvt_pk_bf16_f32 v32, v96, v97
    v_cvt_pk_bf16_f32 v33, v98, v99
    v_cvt_pk_bf16_f32 v34, v100, v101
    v_cvt_pk_bf16_f32 v35, v102, v103
    v_accvgpr_read_b32 v104, a8
    v_accvgpr_read_b32 v105, a9
    v_accvgpr_read_b32 v106, a10
    v_accvgpr_read_b32 v107, a11
    v_accvgpr_read_b32 v108, a12
    v_accvgpr_read_b32 v109, a13
    v_accvgpr_read_b32 v110, a14
    v_accvgpr_read_b32 v111, a15
    v_pk_mul_f32 v[104:105], v[104:105], s[12:13]
    v_pk_mul_f32 v[106:107], v[106:107], s[12:13]
    v_pk_mul_f32 v[108:109], v[108:109], s[12:13]
    v_pk_mul_f32 v[110:111], v[110:111], s[12:13]
    v_cvt_pk_bf16_f32 v64, v104, v105
    v_cvt_pk_bf16_f32 v65, v106, v107
    v_cvt_pk_bf16_f32 v66, v108, v109
    v_cvt_pk_bf16_f32 v67, v110, v111
    v_permlane16_swap_b32 v32, v34
    v_permlane16_swap_b32 v33, v35
    v_accvgpr_read_b32 v112, a16
    v_accvgpr_read_b32 v113, a17
    v_accvgpr_read_b32 v114, a18
    v_accvgpr_read_b32 v115, a19
    v_accvgpr_read_b32 v116, a20
    v_accvgpr_read_b32 v117, a21
    v_accvgpr_read_b32 v118, a22
    v_accvgpr_read_b32 v119, a23
    v_pk_mul_f32 v[112:113], v[112:113], s[12:13]
    v_pk_mul_f32 v[114:115], v[114:115], s[12:13]
    v_pk_mul_f32 v[116:117], v[116:117], s[12:13]
    v_pk_mul_f32 v[118:119], v[118:119], s[12:13]
    v_cvt_pk_bf16_f32 v36, v112, v113
    v_cvt_pk_bf16_f32 v37, v114, v115
    v_cvt_pk_bf16_f32 v38, v116, v117
    v_cvt_pk_bf16_f32 v39, v118, v119
    v_permlane16_swap_b32 v64, v66
    v_permlane16_swap_b32 v65, v67
    v_accvgpr_read_b32 v120, a24
    v_accvgpr_read_b32 v121, a25
    v_accvgpr_read_b32 v122, a26
    v_accvgpr_read_b32 v123, a27
    v_accvgpr_read_b32 v124, a28
    v_accvgpr_read_b32 v125, a29
    v_accvgpr_read_b32 v126, a30
    v_accvgpr_read_b32 v127, a31
    v_pk_mul_f32 v[120:121], v[120:121], s[12:13]
    v_pk_mul_f32 v[122:123], v[122:123], s[12:13]
    v_pk_mul_f32 v[124:125], v[124:125], s[12:13]
    v_pk_mul_f32 v[126:127], v[126:127], s[12:13]
    v_cvt_pk_bf16_f32 v68, v120, v121
    v_cvt_pk_bf16_f32 v69, v122, v123
    v_cvt_pk_bf16_f32 v70, v124, v125
    v_cvt_pk_bf16_f32 v71, v126, v127
    v_permlane16_swap_b32 v36, v38
    v_permlane16_swap_b32 v37, v39
    v_accvgpr_read_b32 v96, a32
    v_accvgpr_read_b32 v97, a33
    v_accvgpr_read_b32 v98, a34
    v_accvgpr_read_b32 v99, a35
    v_accvgpr_read_b32 v100, a36
    v_accvgpr_read_b32 v101, a37
    v_accvgpr_read_b32 v102, a38
    v_accvgpr_read_b32 v103, a39
    v_pk_mul_f32 v[96:97], v[96:97], s[12:13]
    v_pk_mul_f32 v[98:99], v[98:99], s[12:13]
    v_pk_mul_f32 v[100:101], v[100:101], s[12:13]
    v_pk_mul_f32 v[102:103], v[102:103], s[12:13]
    v_cvt_pk_bf16_f32 v40, v96, v97
    v_cvt_pk_bf16_f32 v41, v98, v99
    v_cvt_pk_bf16_f32 v42, v100, v101
    v_cvt_pk_bf16_f32 v43, v102, v103
    v_permlane16_swap_b32 v68, v70
    v_permlane16_swap_b32 v69, v71
    v_accvgpr_read_b32 v104, a40
    v_accvgpr_read_b32 v105, a41
    v_accvgpr_read_b32 v106, a42
    v_accvgpr_read_b32 v107, a43
    v_accvgpr_read_b32 v108, a44
    v_accvgpr_read_b32 v109, a45
    v_accvgpr_read_b32 v110, a46
    v_accvgpr_read_b32 v111, a47
    v_pk_mul_f32 v[104:105], v[104:105], s[12:13]
    v_pk_mul_f32 v[106:107], v[106:107], s[12:13]
    v_pk_mul_f32 v[108:109], v[108:109], s[12:13]
    v_pk_mul_f32 v[110:111], v[110:111], s[12:13]
    v_cvt_pk_bf16_f32 v72, v104, v105
    v_cvt_pk_bf16_f32 v73, v106, v107
    v_cvt_pk_bf16_f32 v74, v108, v109
    v_cvt_pk_bf16_f32 v75, v110, v111
    v_permlane16_swap_b32 v40, v42
    v_permlane16_swap_b32 v41, v43
    v_accvgpr_read_b32 v112, a48
    v_accvgpr_read_b32 v113, a49
    v_accvgpr_read_b32 v114, a50
    v_accvgpr_read_b32 v115, a51
    v_accvgpr_read_b32 v116, a52
    v_accvgpr_read_b32 v117, a53
    v_accvgpr_read_b32 v118, a54
    v_accvgpr_read_b32 v119, a55
    v_pk_mul_f32 v[112:113], v[112:113], s[12:13]
    v_pk_mul_f32 v[114:115], v[114:115], s[12:13]
    v_pk_mul_f32 v[116:117], v[116:117], s[12:13]
    v_pk_mul_f32 v[118:119], v[118:119], s[12:13]
    v_cvt_pk_bf16_f32 v44, v112, v113
    v_cvt_pk_bf16_f32 v45, v114, v115
    v_cvt_pk_bf16_f32 v46, v116, v117
    v_cvt_pk_bf16_f32 v47, v118, v119
    v_permlane16_swap_b32 v72, v74
    v_permlane16_swap_b32 v73, v75
    v_accvgpr_read_b32 v120, a56
    v_accvgpr_read_b32 v121, a57
    v_accvgpr_read_b32 v122, a58
    v_accvgpr_read_b32 v123, a59
    v_accvgpr_read_b32 v124, a60
    v_accvgpr_read_b32 v125, a61
    v_accvgpr_read_b32 v126, a62
    v_accvgpr_read_b32 v127, a63
    v_pk_mul_f32 v[120:121], v[120:121], s[12:13]
    v_pk_mul_f32 v[122:123], v[122:123], s[12:13]
    v_pk_mul_f32 v[124:125], v[124:125], s[12:13]
    v_pk_mul_f32 v[126:127], v[126:127], s[12:13]
    v_cvt_pk_bf16_f32 v76, v120, v121
    v_cvt_pk_bf16_f32 v77, v122, v123
    v_cvt_pk_bf16_f32 v78, v124, v125
    v_cvt_pk_bf16_f32 v79, v126, v127
    v_permlane16_swap_b32 v44, v46
    v_permlane16_swap_b32 v45, v47
    v_accvgpr_read_b32 v96, a64
    v_accvgpr_read_b32 v97, a65
    v_accvgpr_read_b32 v98, a66
    v_accvgpr_read_b32 v99, a67
    v_accvgpr_read_b32 v100, a68
    v_accvgpr_read_b32 v101, a69
    v_accvgpr_read_b32 v102, a70
    v_accvgpr_read_b32 v103, a71
    v_pk_mul_f32 v[96:97], v[96:97], s[12:13]
    v_pk_mul_f32 v[98:99], v[98:99], s[12:13]
    v_pk_mul_f32 v[100:101], v[100:101], s[12:13]
    v_pk_mul_f32 v[102:103], v[102:103], s[12:13]
    v_cvt_pk_bf16_f32 v48, v96, v97
    v_cvt_pk_bf16_f32 v49, v98, v99
    v_cvt_pk_bf16_f32 v50, v100, v101
    v_cvt_pk_bf16_f32 v51, v102, v103
    v_permlane16_swap_b32 v76, v78
    v_permlane16_swap_b32 v77, v79
    v_accvgpr_read_b32 v104, a72
    v_accvgpr_read_b32 v105, a73
    v_accvgpr_read_b32 v106, a74
    v_accvgpr_read_b32 v107, a75
    v_accvgpr_read_b32 v108, a76
    v_accvgpr_read_b32 v109, a77
    v_accvgpr_read_b32 v110, a78
    v_accvgpr_read_b32 v111, a79
    v_pk_mul_f32 v[104:105], v[104:105], s[12:13]
    v_pk_mul_f32 v[106:107], v[106:107], s[12:13]
    v_pk_mul_f32 v[108:109], v[108:109], s[12:13]
    v_pk_mul_f32 v[110:111], v[110:111], s[12:13]
    v_cvt_pk_bf16_f32 v80, v104, v105
    v_cvt_pk_bf16_f32 v81, v106, v107
    v_cvt_pk_bf16_f32 v82, v108, v109
    v_cvt_pk_bf16_f32 v83, v110, v111
    v_permlane16_swap_b32 v48, v50
    v_permlane16_swap_b32 v49, v51
    v_accvgpr_read_b32 v112, a80
    v_accvgpr_read_b32 v113, a81
    v_accvgpr_read_b32 v114, a82
    v_accvgpr_read_b32 v115, a83
    v_accvgpr_read_b32 v116, a84
    v_accvgpr_read_b32 v117, a85
    v_accvgpr_read_b32 v118, a86
    v_accvgpr_read_b32 v119, a87
    v_pk_mul_f32 v[112:113], v[112:113], s[12:13]
    v_pk_mul_f32 v[114:115], v[114:115], s[12:13]
    v_pk_mul_f32 v[116:117], v[116:117], s[12:13]
    v_pk_mul_f32 v[118:119], v[118:119], s[12:13]
    v_cvt_pk_bf16_f32 v52, v112, v113
    v_cvt_pk_bf16_f32 v53, v114, v115
    v_cvt_pk_bf16_f32 v54, v116, v117
    v_cvt_pk_bf16_f32 v55, v118, v119
    v_permlane16_swap_b32 v80, v82
    v_permlane16_swap_b32 v81, v83
    v_accvgpr_read_b32 v120, a88
    v_accvgpr_read_b32 v121, a89
    v_accvgpr_read_b32 v122, a90
    v_accvgpr_read_b32 v123, a91
    v_accvgpr_read_b32 v124, a92
    v_accvgpr_read_b32 v125, a93
    v_accvgpr_read_b32 v126, a94
    v_accvgpr_read_b32 v127, a95
    v_pk_mul_f32 v[120:121], v[120:121], s[12:13]
    v_pk_mul_f32 v[122:123], v[122:123], s[12:13]
    v_pk_mul_f32 v[124:125], v[124:125], s[12:13]
    v_pk_mul_f32 v[126:127], v[126:127], s[12:13]
    v_cvt_pk_bf16_f32 v84, v120, v121
    v_cvt_pk_bf16_f32 v85, v122, v123
    v_cvt_pk_bf16_f32 v86, v124, v125
    v_cvt_pk_bf16_f32 v87, v126, v127
    v_permlane16_swap_b32 v52, v54
    v_permlane16_swap_b32 v53, v55
    v_accvgpr_read_b32 v96, a96
    v_accvgpr_read_b32 v97, a97
    v_accvgpr_read_b32 v98, a98
    v_accvgpr_read_b32 v99, a99
    v_accvgpr_read_b32 v100, a100
    v_accvgpr_read_b32 v101, a101
    v_accvgpr_read_b32 v102, a102
    v_accvgpr_read_b32 v103, a103
    v_pk_mul_f32 v[96:97], v[96:97], s[12:13]
    v_pk_mul_f32 v[98:99], v[98:99], s[12:13]
    v_pk_mul_f32 v[100:101], v[100:101], s[12:13]
    v_pk_mul_f32 v[102:103], v[102:103], s[12:13]
    v_cvt_pk_bf16_f32 v56, v96, v97
    v_cvt_pk_bf16_f32 v57, v98, v99
    v_cvt_pk_bf16_f32 v58, v100, v101
    v_cvt_pk_bf16_f32 v59, v102, v103
    v_permlane16_swap_b32 v84, v86
    v_permlane16_swap_b32 v85, v87
    v_accvgpr_read_b32 v104, a104
    v_accvgpr_read_b32 v105, a105
    v_accvgpr_read_b32 v106, a106
    v_accvgpr_read_b32 v107, a107
    v_accvgpr_read_b32 v108, a108
    v_accvgpr_read_b32 v109, a109
    v_accvgpr_read_b32 v110, a110
    v_accvgpr_read_b32 v111, a111
    v_pk_mul_f32 v[104:105], v[104:105], s[12:13]
    v_pk_mul_f32 v[106:107], v[106:107], s[12:13]
    v_pk_mul_f32 v[108:109], v[108:109], s[12:13]
    v_pk_mul_f32 v[110:111], v[110:111], s[12:13]
    v_cvt_pk_bf16_f32 v88, v104, v105
    v_cvt_pk_bf16_f32 v89, v106, v107
    v_cvt_pk_bf16_f32 v90, v108, v109
    v_cvt_pk_bf16_f32 v91, v110, v111
    v_permlane16_swap_b32 v56, v58
    v_permlane16_swap_b32 v57, v59
    v_accvgpr_read_b32 v112, a112
    v_accvgpr_read_b32 v113, a113
    v_accvgpr_read_b32 v114, a114
    v_accvgpr_read_b32 v115, a115
    v_accvgpr_read_b32 v116, a116
    v_accvgpr_read_b32 v117, a117
    v_accvgpr_read_b32 v118, a118
    v_accvgpr_read_b32 v119, a119
    v_pk_mul_f32 v[112:113], v[112:113], s[12:13]
    v_pk_mul_f32 v[114:115], v[114:115], s[12:13]
    v_pk_mul_f32 v[116:117], v[116:117], s[12:13]
    v_pk_mul_f32 v[118:119], v[118:119], s[12:13]
    v_cvt_pk_bf16_f32 v60, v112, v113
    v_cvt_pk_bf16_f32 v61, v114, v115
    v_cvt_pk_bf16_f32 v62, v116, v117
    v_cvt_pk_bf16_f32 v63, v118, v119
    v_permlane16_swap_b32 v88, v90
    v_permlane16_swap_b32 v89, v91
    v_accvgpr_read_b32 v120, a120
    v_accvgpr_read_b32 v121, a121
    v_accvgpr_read_b32 v122, a122
    v_accvgpr_read_b32 v123, a123
    v_accvgpr_read_b32 v124, a124
    v_accvgpr_read_b32 v125, a125
    v_accvgpr_read_b32 v126, a126
    v_accvgpr_read_b32 v127, a127
    v_pk_mul_f32 v[120:121], v[120:121], s[12:13]
    v_pk_mul_f32 v[122:123], v[122:123], s[12:13]
    v_pk_mul_f32 v[124:125], v[124:125], s[12:13]
    v_pk_mul_f32 v[126:127], v[126:127], s[12:13]
    v_cvt_pk_bf16_f32 v92, v120, v121
    v_cvt_pk_bf16_f32 v93, v122, v123
    v_cvt_pk_bf16_f32 v94, v124, v125
    v_cvt_pk_bf16_f32 v95, v126, v127
    v_permlane16_swap_b32 v60, v62
    v_permlane16_swap_b32 v61, v63
    v_and_b32 v30, 31, v0
    v_lshrrev_b32 v31, 5, v0
    v_and_b32 v1, 15, v0
    v_xor_b32 v1, v1, v31
    v_lshlrev_b32 v30, 8, v30
    v_permlane16_swap_b32 v92, v94
    v_permlane16_swap_b32 v93, v95
    v_xor_b32 v9, 0, v1
    v_lshl_add_u32 v9, v9, 4, v30
    v_xor_b32 v10, 2, v1
    v_lshl_add_u32 v10, v10, 4, v30
    v_xor_b32 v11, 4, v1
    v_lshl_add_u32 v11, v11, 4, v30
    v_xor_b32 v12, 6, v1
    v_lshl_add_u32 v12, v12, 4, v30
    v_xor_b32 v13, 8, v1
    v_lshl_add_u32 v13, v13, 4, v30
    v_xor_b32 v14, 10, v1
    v_lshl_add_u32 v14, v14, 4, v30
    v_xor_b32 v15, 12, v1
    v_lshl_add_u32 v15, v15, 4, v30
    v_xor_b32 v16, 14, v1
    v_lshl_add_u32 v16, v16, 4, v30
    v_bfe_u32 v1, v0, 2, 2
    v_lshlrev_b32 v30, 10, v31
    v_lshl_add_u32 v30, v1, 8, v30
    v_bfe_u32 v22, v0, 4, 1
    v_lshl_add_u32 v30, v22, 5, v30
    v_and_b32 v23, 3, v0
    v_lshl_add_u32 v30, v23, 3, v30
    v_add_u32 v30, 0x10000, v30
    v_xor_b32 v23, 0, v1
    v_lshl_add_u32 v17, v23, 6, v30
    v_xor_b32 v23, 1, v1
    v_lshl_add_u32 v18, v23, 6, v30
    v_xor_b32 v23, 2, v1
    v_lshl_add_u32 v19, v23, 6, v30
    v_xor_b32 v23, 3, v1
    v_lshl_add_u32 v20, v23, 6, v30
    v_lshlrev_b32 v21, 17, v22
    v_lshl_add_u32 v21, v31, 8, v21
    v_and_b32 v1, 15, v0
    v_lshl_add_u32 v21, v1, 4, v21
    s_waitcnt vmcnt(6)
    s_barrier
    ds_read_b128 a[128:131], v9 offset:0
    ds_read_b128 a[132:135], v10 offset:0
    ds_read_b128 a[136:139], v11 offset:0
    ds_read_b128 a[140:143], v12 offset:0
    ds_read_b128 a[144:147], v13 offset:0
    ds_read_b128 a[148:151], v14 offset:0
    ds_read_b128 a[152:155], v15 offset:0
    ds_read_b128 a[156:159], v16 offset:0
    v_pk_mul_f32 v[160:161], v[160:161], s[8:9]
    v_pk_mul_f32 v[162:163], v[162:163], s[8:9]
    v_exp_f32 v160, v160
    v_exp_f32 v161, v161
    v_exp_f32 v162, v162
    v_exp_f32 v163, v163
    v_pk_add_f32 v[160:161], v[160:161], 1.0 op_sel_hi:[1,0]
    v_pk_add_f32 v[162:163], v[162:163], 1.0 op_sel_hi:[1,0]
    v_rcp_f32 v160, v160
    v_rcp_f32 v161, v161
    v_rcp_f32 v162, v162
    v_rcp_f32 v163, v163
    s_waitcnt lgkmcnt(4)
    v_mfma_f32_32x32x16_bf16 v[96:111], a[128:131], v[32:35], 0
    v_pk_mul_f32 v[160:161], v[160:161], v[176:177]
    v_pk_mul_f32 v[162:163], v[162:163], v[178:179]
    v_cvt_pk_bf16_f32 v176, v160, v161
    v_cvt_pk_bf16_f32 v177, v162, v163
    v_mfma_f32_32x32x16_bf16 v[112:127], a[128:131], v[64:67], 0
    v_pk_mul_f32 v[192:193], v[192:193], s[8:9]
    v_pk_mul_f32 v[194:195], v[194:195], s[8:9]
    v_exp_f32 v192, v192
    v_exp_f32 v193, v193
    v_mfma_f32_32x32x16_bf16 v[96:111], a[132:135], v[36:39], v[96:111]
    v_exp_f32 v194, v194
    v_exp_f32 v195, v195
    v_pk_add_f32 v[192:193], v[192:193], 1.0 op_sel_hi:[1,0]
    v_pk_add_f32 v[194:195], v[194:195], 1.0 op_sel_hi:[1,0]
    v_mfma_f32_32x32x16_bf16 v[112:127], a[132:135], v[68:71], v[112:127]
    v_rcp_f32 v192, v192
    v_rcp_f32 v193, v193
    v_rcp_f32 v194, v194
    v_rcp_f32 v195, v195
    v_mfma_f32_32x32x16_bf16 v[96:111], a[136:139], v[40:43], v[96:111]
    v_pk_mul_f32 v[192:193], v[192:193], v[208:209]
    v_pk_mul_f32 v[194:195], v[194:195], v[210:211]
    v_cvt_pk_bf16_f32 v178, v192, v193
    v_cvt_pk_bf16_f32 v179, v194, v195
    v_mfma_f32_32x32x16_bf16 v[112:127], a[136:139], v[72:75], v[112:127]
    s_add_u32 s13, s6, 0
    buffer_store_dwordx4 v[176:179], v4, s[56:59], s13 offen offset:2048 sc0 sc1
    v_pk_mul_f32 v[164:165], v[164:165], s[8:9]
    v_pk_mul_f32 v[166:167], v[166:167], s[8:9]
    v_mfma_f32_32x32x16_bf16 v[96:111], a[140:143], v[44:47], v[96:111]
    v_exp_f32 v164, v164
    v_exp_f32 v165, v165
    v_exp_f32 v166, v166
    v_exp_f32 v167, v167
    v_mfma_f32_32x32x16_bf16 v[112:127], a[140:143], v[76:79], v[112:127]
    v_pk_add_f32 v[164:165], v[164:165], 1.0 op_sel_hi:[1,0]
    v_pk_add_f32 v[166:167], v[166:167], 1.0 op_sel_hi:[1,0]
    v_rcp_f32 v164, v164
    v_rcp_f32 v165, v165
    s_waitcnt lgkmcnt(3)
    v_mfma_f32_32x32x16_bf16 v[96:111], a[144:147], v[48:51], v[96:111]
    v_rcp_f32 v166, v166
    v_rcp_f32 v167, v167
    v_pk_mul_f32 v[164:165], v[164:165], v[180:181]
    v_pk_mul_f32 v[166:167], v[166:167], v[182:183]
    v_mfma_f32_32x32x16_bf16 v[112:127], a[144:147], v[80:83], v[112:127]
    v_cvt_pk_bf16_f32 v180, v164, v165
    v_cvt_pk_bf16_f32 v181, v166, v167
    v_pk_mul_f32 v[196:197], v[196:197], s[8:9]
    v_pk_mul_f32 v[198:199], v[198:199], s[8:9]
    s_waitcnt lgkmcnt(2)
    v_mfma_f32_32x32x16_bf16 v[96:111], a[148:151], v[52:55], v[96:111]
    v_exp_f32 v196, v196
    v_exp_f32 v197, v197
    v_exp_f32 v198, v198
    v_exp_f32 v199, v199
    v_mfma_f32_32x32x16_bf16 v[112:127], a[148:151], v[84:87], v[112:127]
    v_pk_add_f32 v[196:197], v[196:197], 1.0 op_sel_hi:[1,0]
    v_pk_add_f32 v[198:199], v[198:199], 1.0 op_sel_hi:[1,0]
    v_rcp_f32 v196, v196
    v_rcp_f32 v197, v197
    s_waitcnt lgkmcnt(1)
    v_mfma_f32_32x32x16_bf16 v[96:111], a[152:155], v[56:59], v[96:111]
    v_rcp_f32 v198, v198
    v_rcp_f32 v199, v199
    v_pk_mul_f32 v[196:197], v[196:197], v[212:213]
    v_pk_mul_f32 v[198:199], v[198:199], v[214:215]
    v_mfma_f32_32x32x16_bf16 v[112:127], a[152:155], v[88:91], v[112:127]
    v_cvt_pk_bf16_f32 v182, v196, v197
    v_cvt_pk_bf16_f32 v183, v198, v199
    s_add_u32 s13, s6, 114688
    buffer_store_dwordx4 v[180:183], v4, s[56:59], s13 offen offset:2048 sc0 sc1
    s_waitcnt lgkmcnt(0)
    v_mfma_f32_32x32x16_bf16 v[96:111], a[156:159], v[60:63], v[96:111]
    v_pk_mul_f32 v[168:169], v[168:169], s[8:9]
    v_pk_mul_f32 v[170:171], v[170:171], s[8:9]
    v_exp_f32 v168, v168
    v_exp_f32 v169, v169
    v_mfma_f32_32x32x16_bf16 v[112:127], a[156:159], v[92:95], v[112:127]
    v_exp_f32 v170, v170
    v_exp_f32 v171, v171
    v_pk_add_f32 v[168:169], v[168:169], 1.0 op_sel_hi:[1,0]
    v_pk_add_f32 v[170:171], v[170:171], 1.0 op_sel_hi:[1,0]
    ds_read_b128 a[128:131], v9 offset:8192
    ds_read_b128 a[132:135], v10 offset:8192
    ds_read_b128 a[136:139], v11 offset:8192
    ds_read_b128 a[140:143], v12 offset:8192
    ds_read_b128 a[144:147], v13 offset:8192
    ds_read_b128 a[148:151], v14 offset:8192
    ds_read_b128 a[152:155], v15 offset:8192
    ds_read_b128 a[156:159], v16 offset:8192
    v_rcp_f32 v168, v168
    v_rcp_f32 v169, v169
    v_rcp_f32 v170, v170
    v_rcp_f32 v171, v171
    v_pk_mul_f32 v[168:169], v[168:169], v[184:185]
    v_pk_mul_f32 v[170:171], v[170:171], v[186:187]
    v_cvt_pk_bf16_f32 v184, v168, v169
    v_cvt_pk_bf16_f32 v185, v170, v171
    v_pk_mul_f32 v[200:201], v[200:201], s[8:9]
    v_pk_mul_f32 v[202:203], v[202:203], s[8:9]
    v_exp_f32 v200, v200
    v_exp_f32 v201, v201
    v_exp_f32 v202, v202
    v_exp_f32 v203, v203
    v_pk_add_f32 v[200:201], v[200:201], 1.0 op_sel_hi:[1,0]
    v_pk_add_f32 v[202:203], v[202:203], 1.0 op_sel_hi:[1,0]
    v_rcp_f32 v200, v200
    v_rcp_f32 v201, v201
    v_rcp_f32 v202, v202
    v_rcp_f32 v203, v203
    v_pk_mul_f32 v[200:201], v[200:201], v[216:217]
    v_pk_mul_f32 v[202:203], v[202:203], v[218:219]
    v_cvt_pk_bf16_f32 v186, v200, v201
    v_cvt_pk_bf16_f32 v187, v202, v203
    s_add_u32 s13, s6, 229376
    buffer_store_dwordx4 v[184:187], v4, s[56:59], s13 offen offset:2048 sc0 sc1
    v_pk_mul_f32 v[172:173], v[172:173], s[8:9]
    v_pk_mul_f32 v[174:175], v[174:175], s[8:9]
    v_exp_f32 v172, v172
    v_exp_f32 v173, v173
    v_exp_f32 v174, v174
    v_exp_f32 v175, v175
    v_pk_add_f32 v[172:173], v[172:173], 1.0 op_sel_hi:[1,0]
    v_pk_add_f32 v[174:175], v[174:175], 1.0 op_sel_hi:[1,0]
    v_rcp_f32 v172, v172
    v_rcp_f32 v173, v173
    v_rcp_f32 v174, v174
    v_rcp_f32 v175, v175
    v_pk_mul_f32 v[172:173], v[172:173], v[188:189]
    v_pk_mul_f32 v[174:175], v[174:175], v[190:191]
    v_cvt_pk_bf16_f32 v188, v172, v173
    v_cvt_pk_bf16_f32 v189, v174, v175
    v_pk_mul_f32 v[204:205], v[204:205], s[8:9]
    v_pk_mul_f32 v[206:207], v[206:207], s[8:9]
    v_exp_f32 v204, v204
    v_exp_f32 v205, v205
    v_exp_f32 v206, v206
    v_exp_f32 v207, v207
    v_pk_add_f32 v[204:205], v[204:205], 1.0 op_sel_hi:[1,0]
    v_pk_add_f32 v[206:207], v[206:207], 1.0 op_sel_hi:[1,0]
    v_rcp_f32 v204, v204
    v_rcp_f32 v205, v205
    v_rcp_f32 v206, v206
    v_rcp_f32 v207, v207
    v_pk_mul_f32 v[204:205], v[204:205], v[220:221]
    v_pk_mul_f32 v[206:207], v[206:207], v[222:223]
    v_cvt_pk_bf16_f32 v190, v204, v205
    v_cvt_pk_bf16_f32 v191, v206, v207
    s_add_u32 s13, s6, 344064
    buffer_store_dwordx4 v[188:191], v4, s[56:59], s13 offen offset:2048 sc0 sc1
    v_pk_mul_f32 v[224:225], v[224:225], s[8:9]
    v_pk_mul_f32 v[226:227], v[226:227], s[8:9]
    v_exp_f32 v224, v224
    v_exp_f32 v225, v225
    v_exp_f32 v226, v226
    v_exp_f32 v227, v227
    v_pk_add_f32 v[224:225], v[224:225], 1.0 op_sel_hi:[1,0]
    v_pk_add_f32 v[226:227], v[226:227], 1.0 op_sel_hi:[1,0]
    v_rcp_f32 v224, v224
    v_rcp_f32 v225, v225
    v_rcp_f32 v226, v226
    v_rcp_f32 v227, v227
    v_pk_mul_f32 v[224:225], v[224:225], v[240:241]
    v_pk_mul_f32 v[226:227], v[226:227], v[242:243]
    v_cvt_pk_bf16_f32 v240, v224, v225
    v_cvt_pk_bf16_f32 v241, v226, v227
    s_add_u32 s13, s7, 0
    buffer_store_dwordx2 v[240:241], v4, s[56:59], s13 offen sc0 sc1
    v_pk_mul_f32 v[228:229], v[228:229], s[8:9]
    v_pk_mul_f32 v[230:231], v[230:231], s[8:9]
    v_exp_f32 v228, v228
    v_exp_f32 v229, v229
    v_exp_f32 v230, v230
    v_exp_f32 v231, v231
    v_pk_add_f32 v[228:229], v[228:229], 1.0 op_sel_hi:[1,0]
    v_pk_add_f32 v[230:231], v[230:231], 1.0 op_sel_hi:[1,0]
    v_rcp_f32 v228, v228
    v_rcp_f32 v229, v229
    v_rcp_f32 v230, v230
    v_rcp_f32 v231, v231
    v_pk_mul_f32 v[228:229], v[228:229], v[244:245]
    v_pk_mul_f32 v[230:231], v[230:231], v[246:247]
    v_cvt_pk_bf16_f32 v244, v228, v229
    v_cvt_pk_bf16_f32 v245, v230, v231
    s_add_u32 s13, s7, 114688
    buffer_store_dwordx2 v[244:245], v4, s[56:59], s13 offen sc0 sc1
    v_pk_mul_f32 v[232:233], v[232:233], s[8:9]
    v_pk_mul_f32 v[234:235], v[234:235], s[8:9]
    v_exp_f32 v232, v232
    v_exp_f32 v233, v233
    v_exp_f32 v234, v234
    v_exp_f32 v235, v235
    v_pk_add_f32 v[232:233], v[232:233], 1.0 op_sel_hi:[1,0]
    v_pk_add_f32 v[234:235], v[234:235], 1.0 op_sel_hi:[1,0]
    v_rcp_f32 v232, v232
    v_rcp_f32 v233, v233
    v_rcp_f32 v234, v234
    v_rcp_f32 v235, v235
    v_pk_mul_f32 v[232:233], v[232:233], v[248:249]
    v_pk_mul_f32 v[234:235], v[234:235], v[250:251]
    v_cvt_pk_bf16_f32 v248, v232, v233
    v_cvt_pk_bf16_f32 v249, v234, v235
    s_add_u32 s13, s7, 229376
    buffer_store_dwordx2 v[248:249], v4, s[56:59], s13 offen sc0 sc1
    v_pk_mul_f32 v[236:237], v[236:237], s[8:9]
    v_pk_mul_f32 v[238:239], v[238:239], s[8:9]
    v_exp_f32 v236, v236
    v_exp_f32 v237, v237
    v_exp_f32 v238, v238
    v_exp_f32 v239, v239
    v_pk_add_f32 v[236:237], v[236:237], 1.0 op_sel_hi:[1,0]
    v_pk_add_f32 v[238:239], v[238:239], 1.0 op_sel_hi:[1,0]
    v_rcp_f32 v236, v236
    v_rcp_f32 v237, v237
    v_rcp_f32 v238, v238
    v_rcp_f32 v239, v239
    v_pk_mul_f32 v[236:237], v[236:237], v[252:253]
    v_pk_mul_f32 v[238:239], v[238:239], v[254:255]
    v_cvt_pk_bf16_f32 v252, v236, v237
    v_cvt_pk_bf16_f32 v253, v238, v239
    s_add_u32 s13, s7, 344064
    buffer_store_dwordx2 v[252:253], v4, s[56:59], s13 offen sc0 sc1
    v_mov_b32 v232, 0
    v_mov_b32 v233, 0
    v_max3_f32 v236, v96, v97, v98
    v_max3_f32 v236, v236, v99, v100
    v_max3_f32 v236, v236, v101, v102
    v_max3_f32 v236, v236, v103, v104
    v_max3_f32 v236, v236, v105, v106
    v_max3_f32 v236, v236, v107, v108
    v_max3_f32 v236, v236, v109, v110
    v_max_f32 v236, v236, v111
    v_mov_b32 v238, v236
    s_nop 1
    v_permlane32_swap_b32 v238, v236
    v_max_f32 v236, v236, v238
    v_sub_f32 v160, 0, v236
    v_sub_f32 v161, 0, v236
    v_sub_f32 v162, 0, v236
    v_sub_f32 v163, 0, v236
    v_sub_f32 v164, 0, v236
    v_sub_f32 v165, 0, v236
    v_sub_f32 v166, 0, v236
    v_sub_f32 v167, 0, v236
    v_sub_f32 v168, 0, v236
    v_sub_f32 v169, 0, v236
    v_sub_f32 v170, 0, v236
    v_sub_f32 v171, 0, v236
    v_sub_f32 v172, 0, v236
    v_sub_f32 v173, 0, v236
    v_sub_f32 v174, 0, v236
    v_sub_f32 v175, 0, v236
    v_sub_f32 v96, v96, v236
    v_sub_f32 v97, v97, v236
    v_sub_f32 v98, v98, v236
    v_sub_f32 v99, v99, v236
    v_sub_f32 v100, v100, v236
    v_sub_f32 v101, v101, v236
    v_sub_f32 v102, v102, v236
    v_sub_f32 v103, v103, v236
    v_sub_f32 v104, v104, v236
    v_sub_f32 v105, v105, v236
    v_sub_f32 v106, v106, v236
    v_sub_f32 v107, v107, v236
    v_sub_f32 v108, v108, v236
    v_sub_f32 v109, v109, v236
    v_sub_f32 v110, v110, v236
    v_sub_f32 v111, v111, v236
    v_max3_f32 v237, v112, v113, v114
    v_max3_f32 v237, v237, v115, v116
    v_max3_f32 v237, v237, v117, v118
    v_max3_f32 v237, v237, v119, v120
    v_max3_f32 v237, v237, v121, v122
    v_max3_f32 v237, v237, v123, v124
    v_max3_f32 v237, v237, v125, v126
    v_max_f32 v237, v237, v127
    v_mov_b32 v238, v237
    s_nop 1
    v_permlane32_swap_b32 v238, v237
    v_max_f32 v237, v237, v238
    v_sub_f32 v176, 0, v237
    v_sub_f32 v177, 0, v237
    v_sub_f32 v178, 0, v237
    v_sub_f32 v179, 0, v237
    v_sub_f32 v180, 0, v237
    v_sub_f32 v181, 0, v237
    v_sub_f32 v182, 0, v237
    v_sub_f32 v183, 0, v237
    v_sub_f32 v184, 0, v237
    v_sub_f32 v185, 0, v237
    v_sub_f32 v186, 0, v237
    v_sub_f32 v187, 0, v237
    v_sub_f32 v188, 0, v237
    v_sub_f32 v189, 0, v237
    v_sub_f32 v190, 0, v237
    v_sub_f32 v191, 0, v237
    v_sub_f32 v112, v112, v237
    v_sub_f32 v113, v113, v237
    v_sub_f32 v114, v114, v237
    v_sub_f32 v115, v115, v237
    v_sub_f32 v116, v116, v237
    v_sub_f32 v117, v117, v237
    v_sub_f32 v118, v118, v237
    v_sub_f32 v119, v119, v237
    v_sub_f32 v120, v120, v237
    v_sub_f32 v121, v121, v237
    v_sub_f32 v122, v122, v237
    v_sub_f32 v123, v123, v237
    v_sub_f32 v124, v124, v237
    v_sub_f32 v125, v125, v237
    v_sub_f32 v126, v126, v237
    v_sub_f32 v127, v127, v237
    s_waitcnt lgkmcnt(0)
    s_barrier
    v_mfma_f32_32x32x16_bf16 v[128:143], a[128:131], v[32:35], v[160:175]
    s_add_u32 m0, s92, 0
    s_add_u32 s94, s93, 65536
    s_nop 0
    v_exp_f32 v224, v96
    v_exp_f32 v225, v97
    v_exp_f32 v226, v98
    v_mfma_f32_32x32x16_bf16 v[144:159], a[128:131], v[64:67], v[176:191]
    buffer_load_dwordx4 v25, s[64:67], s94 offen offset:0 lds
    v_exp_f32 v227, v99
    v_add_f32 v234, v224, v225
    v_cvt_pk_bf16_f32 v192, v224, v225
    v_exp_f32 v228, v100
    v_add_f32 v234, v234, v226
    v_mfma_f32_32x32x16_bf16 v[128:143], a[132:135], v[36:39], v[128:143]
    buffer_load_dwordx4 v26, s[64:67], s94 offen offset:1024 lds
    v_exp_f32 v229, v101
    v_add_f32 v234, v234, v227
    v_cvt_pk_bf16_f32 v193, v226, v227
    v_exp_f32 v230, v102
    v_add_f32 v234, v234, v228
    v_mfma_f32_32x32x16_bf16 v[144:159], a[132:135], v[68:71], v[144:159]
    buffer_load_dwordx4 v27, s[64:67], s94 offen offset:2048 lds
    v_exp_f32 v231, v103
    v_add_f32 v234, v234, v229
    v_cvt_pk_bf16_f32 v194, v228, v229
    v_exp_f32 v224, v104
    v_mfma_f32_32x32x16_bf16 v[128:143], a[136:139], v[40:43], v[128:143]
    buffer_load_dwordx4 v28, s[64:67], s94 offen offset:3072 lds
    v_add_f32 v234, v234, v230
    v_exp_f32 v225, v105
    v_add_f32 v234, v234, v231
    v_cvt_pk_bf16_f32 v195, v230, v231
    v_exp_f32 v226, v106
    v_mfma_f32_32x32x16_bf16 v[144:159], a[136:139], v[72:75], v[144:159]
    v_add_f32 v234, v234, v224
    v_exp_f32 v227, v107
    v_add_f32 v234, v234, v225
    v_cvt_pk_bf16_f32 v196, v224, v225
    v_exp_f32 v228, v108
    v_mfma_f32_32x32x16_bf16 v[128:143], a[140:143], v[44:47], v[128:143]
    v_add_f32 v234, v234, v226
    v_exp_f32 v229, v109
    v_add_f32 v234, v234, v227
    v_cvt_pk_bf16_f32 v197, v226, v227
    v_exp_f32 v230, v110
    v_add_f32 v234, v234, v228
    v_mfma_f32_32x32x16_bf16 v[144:159], a[140:143], v[76:79], v[144:159]
    v_exp_f32 v231, v111
    v_add_f32 v234, v234, v229
    v_cvt_pk_bf16_f32 v198, v228, v229
    v_exp_f32 v224, v112
    v_add_f32 v234, v234, v230
    v_exp_f32 v225, v113
    v_mfma_f32_32x32x16_bf16 v[128:143], a[144:147], v[48:51], v[128:143]
    v_add_f32 v234, v234, v231
    v_cvt_pk_bf16_f32 v199, v230, v231
    v_exp_f32 v226, v114
    v_exp_f32 v227, v115
    v_add_f32 v235, v224, v225
    v_cvt_pk_bf16_f32 v200, v224, v225
    v_mfma_f32_32x32x16_bf16 v[144:159], a[144:147], v[80:83], v[144:159]
    v_exp_f32 v228, v116
    v_add_f32 v235, v235, v226
    v_exp_f32 v229, v117
    v_add_f32 v235, v235, v227
    v_cvt_pk_bf16_f32 v201, v226, v227
    v_mfma_f32_32x32x16_bf16 v[128:143], a[148:151], v[52:55], v[128:143]
    v_exp_f32 v230, v118
    v_add_f32 v235, v235, v228
    v_exp_f32 v231, v119
    v_add_f32 v235, v235, v229
    v_cvt_pk_bf16_f32 v202, v228, v229
    v_mfma_f32_32x32x16_bf16 v[144:159], a[148:151], v[84:87], v[144:159]
    v_exp_f32 v224, v120
    v_add_f32 v235, v235, v230
    v_exp_f32 v225, v121
    v_add_f32 v235, v235, v231
    v_cvt_pk_bf16_f32 v203, v230, v231
    v_exp_f32 v226, v122
    v_mfma_f32_32x32x16_bf16 v[128:143], a[152:155], v[56:59], v[128:143]
    v_add_f32 v235, v235, v224
    v_exp_f32 v227, v123
    v_add_f32 v235, v235, v225
    v_cvt_pk_bf16_f32 v204, v224, v225
    v_exp_f32 v228, v124
    v_add_f32 v235, v235, v226
    v_mfma_f32_32x32x16_bf16 v[144:159], a[152:155], v[88:91], v[144:159]
    v_exp_f32 v229, v125
    v_add_f32 v235, v235, v227
    v_cvt_pk_bf16_f32 v205, v226, v227
    v_exp_f32 v230, v126
    v_add_f32 v235, v235, v228
    v_mfma_f32_32x32x16_bf16 v[128:143], a[156:159], v[60:63], v[128:143]
    v_exp_f32 v231, v127
    v_add_f32 v235, v235, v229
    v_cvt_pk_bf16_f32 v206, v228, v229
    v_add_f32 v235, v235, v230
    v_add_f32 v235, v235, v231
    v_cvt_pk_bf16_f32 v207, v230, v231
    v_max_f32 v236, v234, v235
    v_cmp_nge_f32 vcc, s95, v236
    v_mfma_f32_32x32x16_bf16 v[144:159], a[156:159], v[92:95], v[144:159]
    ds_read_b128 a[128:131], v9 offset:16384
    ds_read_b128 a[132:135], v10 offset:16384
    ds_read_b128 a[136:139], v11 offset:16384
    ds_read_b128 a[140:143], v12 offset:16384
    ds_read_b128 a[144:147], v13 offset:16384
    ds_read_b128 a[148:151], v14 offset:16384
    ds_read_b128 a[152:155], v15 offset:16384
    ds_read_b128 a[156:159], v16 offset:16384
    s_cbranch_vccnz recurrent_scan__sliding_block_cached__glu_gated_glu__prompt_kernel_rs0
recurrent_scan__sliding_block_cached__glu_gated_glu__prompt_kernel_rb0:
    s_waitcnt lgkmcnt(6)
    v_mfma_f32_32x32x16_bf16 v[96:111], a[128:131], v[32:35], v[160:175]
    ds_read_b64_tr_b16 a[160:161], v17 offset:0
    ds_read_b64_tr_b16 a[162:163], v17 offset:2048
    v_add_f32 v232, v232, v234
    s_lshr_b32 s72, s98, 1
    v_add_f32 v233, v233, v235
    s_xor_b32 s72, s72, s2
    v_mfma_f32_32x32x16_bf16 v[112:127], a[128:131], v[64:67], v[176:191]
    ds_read_b64_tr_b16 a[164:165], v17 offset:4096
    ds_read_b64_tr_b16 a[166:167], v17 offset:6144
    v_exp_f32 v224, v128
    s_and_b32 s72, s72, 1
    v_exp_f32 v225, v129
    v_mfma_f32_32x32x16_bf16 v[96:111], a[132:135], v[36:39], v[96:111]
    ds_read_b64_tr_b16 a[168:169], v18 offset:0
    s_bfe_u32 s13, s2, 0x10001
    v_exp_f32 v226, v130
    s_lshl_b32 s73, s4, 1
    v_exp_f32 v227, v131
    v_mfma_f32_32x32x16_bf16 v[112:127], a[132:135], v[68:71], v[112:127]
    ds_read_b64_tr_b16 a[170:171], v18 offset:2048
    s_add_u32 s73, s73, s13
    v_add_f32 v234, v224, v225
    s_bfe_u32 s13, s2, 0x10002
    v_cvt_pk_bf16_f32 v208, v224, v225
    s_lshl_b32 s13, s13, 2
    s_waitcnt lgkmcnt(6)
    v_mfma_f32_32x32x16_bf16 v[96:111], a[136:139], v[40:43], v[96:111]
    ds_read_b64_tr_b16 a[172:173], v18 offset:4096
    v_exp_f32 v228, v132
    s_lshr_b32 s74, s2, 6
    v_add_f32 v234, v234, v226
    s_add_u32 s74, s74, s13
    v_mfma_f32_32x32x16_bf16 v[112:127], a[136:139], v[72:75], v[112:127]
    ds_read_b64_tr_b16 a[174:175], v18 offset:6144
    v_exp_f32 v229, v133
    s_lshr_b32 s12, s3, 1
    v_add_f32 v234, v234, v227
    s_and_b32 s13, s3, 1
    v_mfma_f32_32x32x16_bf16 v[96:111], a[140:143], v[44:47], v[96:111]
    ds_read_b64_tr_b16 a[176:177], v19 offset:0
    v_cvt_pk_bf16_f32 v209, v226, v227
    s_cmp_eq_u32 s72, 0
    s_cselect_b32 s8, 32, 24
    s_cselect_b32 s9, 0, 64
    v_mfma_f32_32x32x16_bf16 v[112:127], a[140:143], v[76:79], v[112:127]
    ds_read_b64_tr_b16 a[178:179], v19 offset:2048
    v_exp_f32 v230, v134
    s_mul_i32 s8, s8, s12
    v_add_f32 v234, v234, v228
    s_add_u32 s8, s8, s9
    v_mfma_f32_32x32x16_bf16 v[96:111], a[144:147], v[48:51], v[96:111]
    ds_read_b64_tr_b16 a[180:181], v19 offset:4096
    v_exp_f32 v231, v135
    s_cmp_eq_u32 s72, 0
    s_cselect_b32 s75, 32, 32
    s_cselect_b32 s96, 0, 64
    v_add_f32 v234, v234, v229
    v_mfma_f32_32x32x16_bf16 v[112:127], a[144:147], v[80:83], v[112:127]
    ds_read_b64_tr_b16 a[182:183], v19 offset:6144
    s_mul_i32 s75, s75, s12
    v_cvt_pk_bf16_f32 v210, v228, v229
    s_add_u32 s75, s75, s96
    v_exp_f32 v224, v136
    v_mfma_f32_32x32x16_bf16 v[96:111], a[148:151], v[52:55], v[96:111]
    ds_read_b64_tr_b16 a[184:185], v20 offset:0
    s_lshl_b32 s9, s8, 10
    v_add_f32 v234, v234, v230
    s_lshl_b32 s8, s8, 16
    v_exp_f32 v225, v137
    s_lshl_b32 s96, s75, 10
    v_mfma_f32_32x32x16_bf16 v[112:127], a[148:151], v[84:87], v[112:127]
    ds_read_b64_tr_b16 a[186:187], v20 offset:2048
    v_add_f32 v234, v234, v231
    s_lshl_b32 s75, s75, 16
    v_cvt_pk_bf16_f32 v211, v230, v231
    s_lshl_b32 s13, s13, 12
    v_mfma_f32_32x32x16_bf16 v[96:111], a[152:155], v[56:59], v[96:111]
    ds_read_b64_tr_b16 a[188:189], v20 offset:4096
    v_exp_f32 v226, v138
    s_lshl_b32 s10, s12, 17
    v_add_f32 v234, v234, v224
    s_add_u32 s10, s10, s13
    v_mfma_f32_32x32x16_bf16 v[112:127], a[152:155], v[88:91], v[112:127]
    ds_read_b64_tr_b16 a[190:191], v20 offset:6144
    v_exp_f32 v227, v139
    s_lshl_b32 s11, s12, 16
    v_add_f32 v234, v234, v225
    s_add_u32 s11, s11, 0x8000
    v_mfma_f32_32x32x16_bf16 v[96:111], a[156:159], v[60:63], v[96:111]
    v_cvt_pk_bf16_f32 v212, v224, v225
    s_add_u32 s11, s11, s13
    v_exp_f32 v228, v140
    v_lshrrev_b32 v30, 4, v0
    v_add_f32 v234, v234, v226
    v_mfma_f32_32x32x16_bf16 v[112:127], a[156:159], v[92:95], v[112:127]
    v_and_b32 v31, 15, v0
    v_exp_f32 v229, v141
    v_lshlrev_b32 v1, 2, v30
    v_add_f32 v234, v234, v227
    v_xor_b32 v31, v31, v1
    s_waitcnt lgkmcnt(6)
    v_mfma_f32_32x32x16_bf16 a[0:15], a[160:163], v[192:195], 0
    ds_read_b128 a[128:131], v9 offset:24576
    v_cvt_pk_bf16_f32 v213, v226, v227
    s_lshl_b32 s13, s13, 3
    v_exp_f32 v230, v142
    v_mfma_f32_32x32x16_bf16 a[16:31], a[160:163], v[200:203], 0
    ds_read_b128 a[132:135], v10 offset:24576
    s_lshl_b32 s97, s74, 8
    v_add_f32 v234, v234, v228
    s_add_u32 s97, s97, s13
    v_exp_f32 v231, v143
    v_lshlrev_b32 v30, 11, v30
    v_mfma_f32_32x32x16_bf16 a[0:15], a[164:167], v[196:199], a[0:15]
    ds_read_b128 a[136:139], v11 offset:24576
    v_add_f32 v234, v234, v229
    v_add_u32 v30, s97, v30
    v_cvt_pk_bf16_f32 v214, v228, v229
    v_lshl_add_u32 v246, v31, 4, v30
    v_mfma_f32_32x32x16_bf16 a[16:31], a[164:167], v[204:207], a[16:31]
    ds_read_b128 a[140:143], v12 offset:24576
    v_exp_f32 v224, v144
    v_xor_b32 v31, 2, v31
    v_add_f32 v234, v234, v230
    v_lshl_add_u32 v247, v31, 4, v30
    v_mfma_f32_32x32x16_bf16 a[32:47], a[168:171], v[192:195], 0
    ds_read_b128 a[144:147], v13 offset:24576
    v_exp_f32 v225, v145
    v_add_u32 v247, 7168, v247
    v_add_f32 v234, v234, v231
    v_add_u32 v248, 14336, v246
    v_mfma_f32_32x32x16_bf16 a[48:63], a[168:171], v[200:203], 0
    ds_read_b128 a[148:151], v14 offset:24576
    v_cvt_pk_bf16_f32 v215, v230, v231
    v_add_u32 v249, 14336, v247
    v_exp_f32 v226, v146
    v_mov_b32 v250, s98
    v_mfma_f32_32x32x16_bf16 a[32:47], a[172:175], v[196:199], a[32:47]
    ds_read_b128 a[152:155], v15 offset:24576
    v_exp_f32 v227, v147
    v_mov_b32 v251, s99
    v_add_f32 v235, v224, v225
    v_mov_b32 v252, 0
    v_mfma_f32_32x32x16_bf16 a[48:63], a[172:175], v[204:207], a[48:63]
    ds_read_b128 a[156:159], v16 offset:24576
    v_cvt_pk_bf16_f32 v216, v224, v225
    s_lshl_b32 s97, s73, 3
    v_exp_f32 v228, v148
    s_and_b32 s13, s3, 1
    v_mfma_f32_32x32x16_bf16 a[64:79], a[176:179], v[192:195], 0
    v_add_f32 v235, v235, v226
    s_lshl_b32 s13, s13, 2
    v_exp_f32 v229, v149
    s_add_u32 s97, s97, s13
    v_add_f32 v235, v235, v227
    s_lshl_b32 s12, s12, 1
    v_mfma_f32_32x32x16_bf16 a[80:95], a[176:179], v[200:203], 0
    v_cvt_pk_bf16_f32 v217, v226, v227
    v_exp_f32 v230, v150
    v_add_f32 v235, v235, v228
    v_exp_f32 v231, v151
    s_waitcnt lgkmcnt(6)
    v_mfma_f32_32x32x16_bf16 a[64:79], a[180:183], v[196:199], a[64:79]
    v_add_f32 v235, v235, v229
    v_cvt_pk_bf16_f32 v218, v228, v229
    v_exp_f32 v224, v152
    v_add_f32 v235, v235, v230
    v_mfma_f32_32x32x16_bf16 a[80:95], a[180:183], v[204:207], a[80:95]
    v_exp_f32 v225, v153
    v_add_f32 v235, v235, v231
    v_cvt_pk_bf16_f32 v219, v230, v231
    v_exp_f32 v226, v154
    v_mfma_f32_32x32x16_bf16 a[96:111], a[184:187], v[192:195], 0
    v_add_f32 v235, v235, v224
    v_exp_f32 v227, v155
    v_add_f32 v235, v235, v225
    v_cvt_pk_bf16_f32 v220, v224, v225
    v_mfma_f32_32x32x16_bf16 a[112:127], a[184:187], v[200:203], 0
    v_exp_f32 v228, v156
    v_add_f32 v235, v235, v226
    v_exp_f32 v229, v157
    v_add_f32 v235, v235, v227
    v_cvt_pk_bf16_f32 v221, v226, v227
    v_mfma_f32_32x32x16_bf16 a[96:111], a[188:191], v[196:199], a[96:111]
    v_exp_f32 v230, v158
    v_add_f32 v235, v235, v228
    v_exp_f32 v231, v159
    v_add_f32 v235, v235, v229
    v_mfma_f32_32x32x16_bf16 a[112:127], a[188:191], v[204:207], a[112:127]
    v_cvt_pk_bf16_f32 v222, v228, v229
    v_add_f32 v235, v235, v230
    v_add_f32 v235, v235, v231
    v_cvt_pk_bf16_f32 v223, v230, v231
    v_max_f32 v236, v234, v235
    v_cmp_nge_f32 vcc, s95, v236
    s_cbranch_vccnz recurrent_scan__sliding_block_cached__glu_gated_glu__prompt_kernel_rs1
recurrent_scan__sliding_block_cached__glu_gated_glu__prompt_kernel_rb1:
    s_waitcnt lgkmcnt(0)
    s_barrier
    v_mfma_f32_32x32x16_bf16 v[128:143], a[128:131], v[32:35], v[160:175]
    ds_read_b64_tr_b16 a[160:161], v17 offset:8192
    ds_read_b64_tr_b16 a[162:163], v17 offset:10240
    v_add_f32 v232, v232, v234
    s_xor_b32 s13, s12, 0
    v_add_f32 v233, v233, v235
    s_add_u32 s13, s13, s97
    v_mfma_f32_32x32x16_bf16 v[144:159], a[128:131], v[64:67], v[176:191]
    ds_read_b64_tr_b16 a[164:165], v17 offset:12288
    ds_read_b64_tr_b16 a[166:167], v17 offset:14336
    v_exp_f32 v224, v96
    s_mul_i32 s90, s13, 114688
    v_exp_f32 v225, v97
    v_mfma_f32_32x32x16_bf16 v[128:143], a[132:135], v[36:39], v[128:143]
    ds_read_b64_tr_b16 a[168:169], v18 offset:8192
    v_add_u32 v5, s90, v4
    v_exp_f32 v226, v98
    s_lshl_b32 s90, s13, 17
    v_exp_f32 v227, v99
    v_mfma_f32_32x32x16_bf16 v[144:159], a[132:135], v[68:71], v[144:159]
    ds_read_b64_tr_b16 a[170:171], v18 offset:10240
    v_add_u32 v242, s90, v4
    v_add_f32 v234, v224, v225
    s_xor_b32 s13, s12, 1
    v_cvt_pk_bf16_f32 v192, v224, v225
    s_add_u32 s13, s13, s97
    v_mfma_f32_32x32x16_bf16 v[128:143], a[136:139], v[40:43], v[128:143]
    ds_read_b64_tr_b16 a[172:173], v18 offset:12288
    v_exp_f32 v228, v100
    s_mul_i32 s90, s13, 114688
    v_add_f32 v234, v234, v226
    v_add_u32 v6, s90, v4
    v_mfma_f32_32x32x16_bf16 v[144:159], a[136:139], v[72:75], v[144:159]
    ds_read_b64_tr_b16 a[174:175], v18 offset:14336
    v_exp_f32 v229, v101
    s_lshl_b32 s90, s13, 17
    v_add_f32 v234, v234, v227
    v_add_u32 v243, s90, v4
    v_cvt_pk_bf16_f32 v193, v226, v227
    v_mfma_f32_32x32x16_bf16 v[128:143], a[140:143], v[44:47], v[128:143]
    ds_read_b64_tr_b16 a[176:177], v19 offset:8192
    s_xor_b32 s13, s12, 2
    v_exp_f32 v230, v102
    s_add_u32 s13, s13, s97
    v_add_f32 v234, v234, v228
    s_mul_i32 s90, s13, 114688
    v_mfma_f32_32x32x16_bf16 v[144:159], a[140:143], v[76:79], v[144:159]
    ds_read_b64_tr_b16 a[178:179], v19 offset:10240
    v_exp_f32 v231, v103
    v_add_u32 v7, s90, v4
    v_add_f32 v234, v234, v229
    s_lshl_b32 s90, s13, 17
    v_cvt_pk_bf16_f32 v194, v228, v229
    v_mfma_f32_32x32x16_bf16 v[128:143], a[144:147], v[48:51], v[128:143]
    ds_read_b64_tr_b16 a[180:181], v19 offset:12288
    v_add_u32 v244, s90, v4
    v_exp_f32 v224, v104
    s_xor_b32 s13, s12, 3
    v_add_f32 v234, v234, v230
    v_mfma_f32_32x32x16_bf16 v[144:159], a[144:147], v[80:83], v[144:159]
    ds_read_b64_tr_b16 a[182:183], v19 offset:14336
    s_add_u32 s13, s13, s97
    v_exp_f32 v225, v105
    s_mul_i32 s90, s13, 114688
    v_add_f32 v234, v234, v231
    v_mfma_f32_32x32x16_bf16 v[128:143], a[148:151], v[52:55], v[128:143]
    ds_read_b64_tr_b16 a[184:185], v20 offset:8192
    v_add_u32 v8, s90, v4
    v_cvt_pk_bf16_f32 v195, v230, v231
    s_lshl_b32 s90, s13, 17
    v_exp_f32 v226, v106
    v_add_u32 v245, s90, v4
    v_mfma_f32_32x32x16_bf16 v[144:159], a[148:151], v[84:87], v[144:159]
    ds_read_b64_tr_b16 a[186:187], v20 offset:10240
    v_add_f32 v234, v234, v224
    v_lshlrev_b32 v24, 5, v0
    v_exp_f32 v227, v107
    v_and_b32 v24, 0x3e0, v24
    v_mfma_f32_32x32x16_bf16 v[128:143], a[152:155], v[56:59], v[128:143]
    ds_read_b64_tr_b16 a[188:189], v20 offset:12288
    v_add_f32 v234, v234, v225
    s_lshl_b32 s12, s4, 10
    v_cvt_pk_bf16_f32 v196, v224, v225
    s_add_u32 s91, s12, 24576
    v_exp_f32 v228, v108
    v_mfma_f32_32x32x16_bf16 v[144:159], a[152:155], v[88:91], v[144:159]
    ds_read_b64_tr_b16 a[190:191], v20 offset:14336
    s_add_u32 s97, s12, 32768
    v_add_f32 v234, v234, v226
    s_lshl_b32 s13, s5, 5
    v_exp_f32 v229, v109
    v_mfma_f32_32x32x16_bf16 v[128:143], a[156:159], v[60:63], v[128:143]
    s_add_u32 m0, s92, 16384
    s_add_u32 s94, s93, 81920
    s_nop 0
    s_add_u32 s88, s91, s13
    v_add_f32 v234, v234, v227
    s_add_u32 s89, s97, s13
    v_mfma_f32_32x32x16_bf16 v[144:159], a[156:159], v[92:95], v[144:159]
    buffer_load_dwordx4 v25, s[64:67], s94 offen offset:0 lds
    v_cvt_pk_bf16_f32 v197, v226, v227
    s_add_u32 s48, s38, 0x2600000
    s_addc_u32 s49, s39, 0
    v_exp_f32 v230, v110
    s_waitcnt lgkmcnt(6)
    v_mfma_f32_32x32x16_bf16 a[0:15], a[160:163], v[208:211], a[0:15]
    ds_read_b128 a[128:131], v9 offset:32768
    s_and_b32 s49, s49, 0xffff
    v_add_f32 v234, v234, v228
    s_mov_b32 s50, 0xe000
    v_exp_f32 v231, v111
    v_mfma_f32_32x32x16_bf16 a[16:31], a[160:163], v[216:219], a[16:31]
    ds_read_b128 a[132:135], v10 offset:32768
    s_mov_b32 s51, 0x20000
    v_add_f32 v234, v234, v229
    s_mov_b32 s44, s32
    v_cvt_pk_bf16_f32 v198, v228, v229
    s_and_b32 s45, s33, 0xffff
    v_mfma_f32_32x32x16_bf16 a[0:15], a[164:167], v[212:215], a[0:15]
    ds_read_b128 a[136:139], v11 offset:32768
    v_exp_f32 v224, v112
    s_mov_b32 s46, 0x700000
    v_add_f32 v234, v234, v230
    s_mov_b32 s47, 0x20000
    v_mfma_f32_32x32x16_bf16 a[16:31], a[164:167], v[220:223], a[16:31]
    ds_read_b128 a[140:143], v12 offset:32768
    v_exp_f32 v225, v113
    s_add_u32 s40, s38, 0x400000
    s_addc_u32 s41, s39, 0
    v_add_f32 v234, v234, v231
    s_and_b32 s41, s41, 0xffff
    v_mfma_f32_32x32x16_bf16 a[32:47], a[168:171], v[208:211], a[32:47]
    ds_read_b128 a[144:147], v13 offset:32768
    v_cvt_pk_bf16_f32 v199, v230, v231
    s_mov_b32 s42, 0xe00000
    v_exp_f32 v226, v114
    s_mov_b32 s43, 0x20000
    v_mfma_f32_32x32x16_bf16 a[48:63], a[168:171], v[216:219], a[48:63]
    ds_read_b128 a[148:151], v14 offset:32768
    v_exp_f32 v227, v115
    s_add_u32 s13, s14, 0
    v_add_f32 v235, v224, v225
    s_and_b32 s13, s13, 7
    v_mfma_f32_32x32x16_bf16 a[32:47], a[172:175], v[212:215], a[32:47]
    ds_read_b128 a[152:155], v15 offset:32768
    v_cvt_pk_bf16_f32 v200, v224, v225
    s_lshl_b32 s80, s13, 10
    v_exp_f32 v228, v116
    s_add_u32 s13, s14, 1
    v_add_f32 v235, v235, v226
    v_mfma_f32_32x32x16_bf16 a[48:63], a[172:175], v[220:223], a[48:63]
    ds_read_b128 a[156:159], v16 offset:32768
    s_and_b32 s13, s13, 7
    v_exp_f32 v229, v117
    s_lshl_b32 s81, s13, 10
    v_add_f32 v235, v235, v227
    v_mfma_f32_32x32x16_bf16 a[64:79], a[176:179], v[208:211], a[64:79]
    buffer_load_dwordx4 v26, s[64:67], s94 offen offset:1024 lds
    s_add_u32 s13, s14, 2
    v_cvt_pk_bf16_f32 v201, v226, v227
    v_exp_f32 v230, v118
    v_mfma_f32_32x32x16_bf16 a[80:95], a[176:179], v[216:219], a[80:95]
    buffer_load_dwordx4 v27, s[64:67], s94 offen offset:2048 lds
    v_add_f32 v235, v235, v228
    v_exp_f32 v231, v119
    v_add_f32 v235, v235, v229
    s_waitcnt lgkmcnt(6)
    v_mfma_f32_32x32x16_bf16 a[64:79], a[180:183], v[212:215], a[64:79]
    buffer_load_dwordx4 v28, s[64:67], s94 offen offset:3072 lds
    v_cvt_pk_bf16_f32 v202, v228, v229
    v_exp_f32 v224, v120
    v_mfma_f32_32x32x16_bf16 a[80:95], a[180:183], v[220:223], a[80:95]
    v_add_f32 v235, v235, v230
    v_exp_f32 v225, v121
    v_add_f32 v235, v235, v231
    v_cvt_pk_bf16_f32 v203, v230, v231
    v_exp_f32 v226, v122
    v_mfma_f32_32x32x16_bf16 a[96:111], a[184:187], v[208:211], a[96:111]
    v_add_f32 v235, v235, v224
    v_exp_f32 v227, v123
    v_add_f32 v235, v235, v225
    v_cvt_pk_bf16_f32 v204, v224, v225
    v_mfma_f32_32x32x16_bf16 a[112:127], a[184:187], v[216:219], a[112:127]
    v_exp_f32 v228, v124
    v_add_f32 v235, v235, v226
    v_exp_f32 v229, v125
    v_add_f32 v235, v235, v227
    v_cvt_pk_bf16_f32 v205, v226, v227
    v_mfma_f32_32x32x16_bf16 a[96:111], a[188:191], v[212:215], a[96:111]
    v_exp_f32 v230, v126
    v_add_f32 v235, v235, v228
    v_exp_f32 v231, v127
    v_add_f32 v235, v235, v229
    v_mfma_f32_32x32x16_bf16 a[112:127], a[188:191], v[220:223], a[112:127]
    v_cvt_pk_bf16_f32 v206, v228, v229
    v_add_f32 v235, v235, v230
    v_add_f32 v235, v235, v231
    v_cvt_pk_bf16_f32 v207, v230, v231
    v_max_f32 v236, v234, v235
    v_cmp_nge_f32 vcc, s95, v236
    s_cbranch_vccnz recurrent_scan__sliding_block_cached__glu_gated_glu__prompt_kernel_rs2
recurrent_scan__sliding_block_cached__glu_gated_glu__prompt_kernel_rb2:
    v_mfma_f32_32x32x16_bf16 v[96:111], a[128:131], v[32:35], v[160:175]
    ds_read_b64_tr_b16 a[160:161], v17 offset:16384
    ds_read_b64_tr_b16 a[162:163], v17 offset:18432
    v_add_f32 v232, v232, v234
    s_and_b32 s13, s13, 7
    v_add_f32 v233, v233, v235
    s_lshl_b32 s82, s13, 10
    v_mfma_f32_32x32x16_bf16 v[112:127], a[128:131], v[64:67], v[176:191]
    ds_read_b64_tr_b16 a[164:165], v17 offset:20480
    ds_read_b64_tr_b16 a[166:167], v17 offset:22528
    v_exp_f32 v224, v128
    s_add_u32 s13, s14, 3
    v_exp_f32 v225, v129
    v_mfma_f32_32x32x16_bf16 v[96:111], a[132:135], v[36:39], v[96:111]
    ds_read_b64_tr_b16 a[168:169], v18 offset:16384
    s_and_b32 s13, s13, 7
    v_exp_f32 v226, v130
    s_lshl_b32 s83, s13, 10
    v_mfma_f32_32x32x16_bf16 v[112:127], a[132:135], v[68:71], v[112:127]
    ds_read_b64_tr_b16 a[170:171], v18 offset:18432
    v_exp_f32 v227, v131
    s_add_u32 s13, s14, 4
    v_add_f32 v234, v224, v225
    s_and_b32 s13, s13, 7
    s_waitcnt lgkmcnt(6)
    v_mfma_f32_32x32x16_bf16 v[96:111], a[136:139], v[40:43], v[96:111]
    ds_read_b64_tr_b16 a[172:173], v18 offset:20480
    v_cvt_pk_bf16_f32 v208, v224, v225
    s_lshl_b32 s84, s13, 10
    v_exp_f32 v228, v132
    v_mfma_f32_32x32x16_bf16 v[112:127], a[136:139], v[72:75], v[112:127]
    ds_read_b64_tr_b16 a[174:175], v18 offset:22528
    s_add_u32 s13, s14, 5
    v_add_f32 v234, v234, v226
    s_and_b32 s13, s13, 7
    v_exp_f32 v229, v133
    s_lshl_b32 s85, s13, 10
    v_mfma_f32_32x32x16_bf16 v[96:111], a[140:143], v[44:47], v[96:111]
    ds_read_b64_tr_b16 a[176:177], v19 offset:16384
    v_add_f32 v234, v234, v227
    s_add_u32 s13, s14, 6
    v_cvt_pk_bf16_f32 v209, v226, v227
    s_and_b32 s13, s13, 7
    v_mfma_f32_32x32x16_bf16 v[112:127], a[140:143], v[76:79], v[112:127]
    ds_read_b64_tr_b16 a[178:179], v19 offset:18432
    v_exp_f32 v230, v134
    s_lshl_b32 s86, s13, 10
    v_add_f32 v234, v234, v228
    s_add_u32 s13, s14, 7
    v_mfma_f32_32x32x16_bf16 v[96:111], a[144:147], v[48:51], v[96:111]
    ds_read_b64_tr_b16 a[180:181], v19 offset:20480
    v_exp_f32 v231, v135
    s_and_b32 s13, s13, 7
    v_add_f32 v234, v234, v229
    s_lshl_b32 s87, s13, 10
    v_mfma_f32_32x32x16_bf16 v[112:127], a[144:147], v[80:83], v[112:127]
    ds_read_b64_tr_b16 a[182:183], v19 offset:22528
    v_cvt_pk_bf16_f32 v210, v228, v229
    s_mov_b32 s56, s16
    v_exp_f32 v224, v136
    s_and_b32 s57, s17, 0xffff
    v_mfma_f32_32x32x16_bf16 v[96:111], a[148:151], v[52:55], v[96:111]
    ds_read_b64_tr_b16 a[184:185], v20 offset:16384
    v_add_f32 v234, v234, v230
    s_mov_b32 s58, 0x400000
    v_exp_f32 v225, v137
    s_mov_b32 s59, 0x20000
    v_add_f32 v234, v234, v231
    v_mfma_f32_32x32x16_bf16 v[112:127], a[148:151], v[84:87], v[112:127]
    ds_read_b64_tr_b16 a[186:187], v20 offset:18432
    s_lshl_b32 s90, s73, 7
    v_cvt_pk_bf16_f32 v211, v230, v231
    s_and_b32 s12, s3, 1
    v_exp_f32 v226, v138
    v_mfma_f32_32x32x16_bf16 v[96:111], a[152:155], v[56:59], v[96:111]
    ds_read_b64_tr_b16 a[188:189], v20 offset:20480
    s_lshl_b32 s12, s12, 6
    v_add_f32 v234, v234, v224
    s_add_u32 s90, s90, s12
    v_exp_f32 v227, v139
    v_mfma_f32_32x32x16_bf16 v[112:127], a[152:155], v[88:91], v[112:127]
    ds_read_b64_tr_b16 a[190:191], v20 offset:22528
    s_lshr_b32 s12, s3, 1
    v_add_f32 v234, v234, v225
    s_lshl_b32 s12, s12, 5
    v_cvt_pk_bf16_f32 v212, v224, v225
    s_add_u32 s90, s90, s12
    v_mfma_f32_32x32x16_bf16 v[96:111], a[156:159], v[60:63], v[96:111]
    v_exp_f32 v228, v140
    s_lshl_b32 s90, s90, 11
    v_add_f32 v234, v234, v226
    s_lshl_b32 s12, s74, 8
    v_mfma_f32_32x32x16_bf16 v[112:127], a[156:159], v[92:95], v[112:127]
    v_exp_f32 v229, v141
    s_add_u32 s90, s90, s12
    v_add_f32 v234, v234, v227
    s_cmp_eq_u32 s72, 0
    s_cselect_b32 s90, s90, 0x7fff0000
    s_waitcnt lgkmcnt(6)
    v_mfma_f32_32x32x16_bf16 a[0:15], a[160:163], v[192:195], a[0:15]
    ds_read_b128 a[128:131], v9 offset:40960
    v_cvt_pk_bf16_f32 v213, v226, v227
    s_lshl_b32 s4, s3, 13
    v_exp_f32 v230, v142
    v_mfma_f32_32x32x16_bf16 a[16:31], a[160:163], v[200:203], a[16:31]
    ds_read_b128 a[132:135], v10 offset:40960
    s_add_u32 s4, s4, 0x20000
    v_add_f32 v234, v234, v228
    s_add_u32 s14, s90, 0x8000
    v_exp_f32 v231, v143
    v_lshrrev_b32 v30, 4, v0
    v_mfma_f32_32x32x16_bf16 a[0:15], a[164:167], v[196:199], a[0:15]
    ds_read_b128 a[136:139], v11 offset:40960
    v_add_f32 v234, v234, v229
    v_and_b32 v1, 15, v0
    v_cvt_pk_bf16_f32 v214, v228, v229
    v_xor_b32 v1, v1, v30
    v_mfma_f32_32x32x16_bf16 a[16:31], a[164:167], v[204:207], a[16:31]
    ds_read_b128 a[140:143], v12 offset:40960
    v_exp_f32 v224, v144
    v_lshlrev_b32 v30, 11, v30
    v_add_f32 v234, v234, v230
    v_xor_b32 v253, 4, v1
    v_mfma_f32_32x32x16_bf16 a[32:47], a[168:171], v[192:195], a[32:47]
    ds_read_b128 a[144:147], v13 offset:40960
    v_exp_f32 v225, v145
    v_lshl_add_u32 v253, v253, 4, v30
    v_add_f32 v234, v234, v231
    v_add_u32 v253, 7168, v253
    v_mfma_f32_32x32x16_bf16 a[48:63], a[168:171], v[200:203], a[48:63]
    ds_read_b128 a[148:151], v14 offset:40960
    v_cvt_pk_bf16_f32 v215, v230, v231
    v_xor_b32 v254, 8, v1
    v_exp_f32 v226, v146
    v_lshl_add_u32 v254, v254, 4, v30
    v_mfma_f32_32x32x16_bf16 a[32:47], a[172:175], v[196:199], a[32:47]
    ds_read_b128 a[152:155], v15 offset:40960
    v_exp_f32 v227, v147
    v_add_u32 v254, 14336, v254
    v_add_f32 v235, v224, v225
    v_xor_b32 v255, 12, v1
    v_mfma_f32_32x32x16_bf16 a[48:63], a[172:175], v[204:207], a[48:63]
    ds_read_b128 a[156:159], v16 offset:40960
    v_cvt_pk_bf16_f32 v216, v224, v225
    v_lshl_add_u32 v255, v255, 4, v30
    v_exp_f32 v228, v148
    v_add_u32 v255, 21504, v255
    v_mfma_f32_32x32x16_bf16 a[64:79], a[176:179], v[192:195], a[64:79]
    v_add_f32 v235, v235, v226
    v_xor_b32 v1, 0, v1
    v_exp_f32 v229, v149
    v_lshl_add_u32 v1, v1, 4, v30
    v_add_f32 v235, v235, v227
    v_mfma_f32_32x32x16_bf16 a[80:95], a[176:179], v[200:203], a[80:95]
    v_cvt_pk_bf16_f32 v217, v226, v227
    v_exp_f32 v230, v150
    v_add_f32 v235, v235, v228
    v_exp_f32 v231, v151
    s_waitcnt lgkmcnt(6)
    v_mfma_f32_32x32x16_bf16 a[64:79], a[180:183], v[196:199], a[64:79]
    v_add_f32 v235, v235, v229
    v_cvt_pk_bf16_f32 v218, v228, v229
    v_exp_f32 v224, v152
    v_add_f32 v235, v235, v230
    v_mfma_f32_32x32x16_bf16 a[80:95], a[180:183], v[204:207], a[80:95]
    v_exp_f32 v225, v153
    v_add_f32 v235, v235, v231
    v_cvt_pk_bf16_f32 v219, v230, v231
    v_exp_f32 v226, v154
    v_mfma_f32_32x32x16_bf16 a[96:111], a[184:187], v[192:195], a[96:111]
    v_add_f32 v235, v235, v224
    v_exp_f32 v227, v155
    v_add_f32 v235, v235, v225
    v_cvt_pk_bf16_f32 v220, v224, v225
    v_mfma_f32_32x32x16_bf16 a[112:127], a[184:187], v[200:203], a[112:127]
    v_exp_f32 v228, v156
    v_add_f32 v235, v235, v226
    v_exp_f32 v229, v157
    v_add_f32 v235, v235, v227
    v_cvt_pk_bf16_f32 v221, v226, v227
    v_mfma_f32_32x32x16_bf16 a[96:111], a[188:191], v[196:199], a[96:111]
    v_exp_f32 v230, v158
    v_add_f32 v235, v235, v228
    v_exp_f32 v231, v159
    v_add_f32 v235, v235, v229
    v_mfma_f32_32x32x16_bf16 a[112:127], a[188:191], v[204:207], a[112:127]
    v_cvt_pk_bf16_f32 v222, v228, v229
    v_add_f32 v235, v235, v230
    v_add_f32 v235, v235, v231
    v_cvt_pk_bf16_f32 v223, v230, v231
    v_max_f32 v236, v234, v235
    v_cmp_nge_f32 vcc, s95, v236
    s_cbranch_vccnz recurrent_scan__sliding_block_cached__glu_gated_glu__prompt_kernel_rs3
recurrent_scan__sliding_block_cached__glu_gated_glu__prompt_kernel_rb3:
    s_waitcnt vmcnt(8)
    s_waitcnt lgkmcnt(0)
    s_barrier
    s_cmp_lg_u32 s3, 0
    s_cbranch_scc1 recurrent_scan__sliding_block_cached__glu_gated_glu__prompt_kernel_fl0
    s_mov_b64 exec, 1
    buffer_store_dwordx2 v[250:251], v252, s[48:51], s88 offen sc0 sc1
    s_mov_b64 exec, -1
recurrent_scan__sliding_block_cached__glu_gated_glu__prompt_kernel_fl0:
    v_mfma_f32_32x32x16_bf16 v[128:143], a[128:131], v[32:35], v[160:175]
    ds_read_b64_tr_b16 a[160:161], v17 offset:24576
    ds_read_b64_tr_b16 a[162:163], v17 offset:26624
    v_add_f32 v232, v232, v234
    v_add_f32 v233, v233, v235
    v_exp_f32 v224, v96
    v_mfma_f32_32x32x16_bf16 v[144:159], a[128:131], v[64:67], v[176:191]
    ds_read_b64_tr_b16 a[164:165], v17 offset:28672
    ds_read_b64_tr_b16 a[166:167], v17 offset:30720
    v_exp_f32 v225, v97
    v_exp_f32 v226, v98
    v_mfma_f32_32x32x16_bf16 v[128:143], a[132:135], v[36:39], v[128:143]
    ds_read_b64_tr_b16 a[168:169], v18 offset:24576
    v_exp_f32 v227, v99
    v_add_f32 v234, v224, v225
    v_cvt_pk_bf16_f32 v192, v224, v225
    v_mfma_f32_32x32x16_bf16 v[144:159], a[132:135], v[68:71], v[144:159]
    ds_read_b64_tr_b16 a[170:171], v18 offset:26624
    v_exp_f32 v228, v100
    v_add_f32 v234, v234, v226
    v_exp_f32 v229, v101
    v_mfma_f32_32x32x16_bf16 v[128:143], a[136:139], v[40:43], v[128:143]
    ds_read_b64_tr_b16 a[172:173], v18 offset:28672
    v_add_f32 v234, v234, v227
    v_cvt_pk_bf16_f32 v193, v226, v227
    v_exp_f32 v230, v102
    v_add_f32 v234, v234, v228
    v_mfma_f32_32x32x16_bf16 v[144:159], a[136:139], v[72:75], v[144:159]
    ds_read_b64_tr_b16 a[174:175], v18 offset:30720
    v_exp_f32 v231, v103
    v_add_f32 v234, v234, v229
    v_cvt_pk_bf16_f32 v194, v228, v229
    v_mfma_f32_32x32x16_bf16 v[128:143], a[140:143], v[44:47], v[128:143]
    ds_read_b64_tr_b16 a[176:177], v19 offset:24576
    v_exp_f32 v224, v104
    v_add_f32 v234, v234, v230
    v_exp_f32 v225, v105
    v_mfma_f32_32x32x16_bf16 v[144:159], a[140:143], v[76:79], v[144:159]
    ds_read_b64_tr_b16 a[178:179], v19 offset:26624
    v_add_f32 v234, v234, v231
    v_cvt_pk_bf16_f32 v195, v230, v231
    v_exp_f32 v226, v106
    v_add_f32 v234, v234, v224
    v_mfma_f32_32x32x16_bf16 v[128:143], a[144:147], v[48:51], v[128:143]
    ds_read_b64_tr_b16 a[180:181], v19 offset:28672
    v_exp_f32 v227, v107
    v_add_f32 v234, v234, v225
    v_cvt_pk_bf16_f32 v196, v224, v225
    v_mfma_f32_32x32x16_bf16 v[144:159], a[144:147], v[80:83], v[144:159]
    ds_read_b64_tr_b16 a[182:183], v19 offset:30720
    v_exp_f32 v228, v108
    v_add_f32 v234, v234, v226
    v_exp_f32 v229, v109
    v_mfma_f32_32x32x16_bf16 v[128:143], a[148:151], v[52:55], v[128:143]
    ds_read_b64_tr_b16 a[184:185], v20 offset:24576
    v_add_f32 v234, v234, v227
    v_cvt_pk_bf16_f32 v197, v226, v227
    v_exp_f32 v230, v110
    v_mfma_f32_32x32x16_bf16 v[144:159], a[148:151], v[84:87], v[144:159]
    ds_read_b64_tr_b16 a[186:187], v20 offset:26624
    v_add_f32 v234, v234, v228
    v_exp_f32 v231, v111
    v_add_f32 v234, v234, v229
    v_mfma_f32_32x32x16_bf16 v[128:143], a[152:155], v[56:59], v[128:143]
    ds_read_b64_tr_b16 a[188:189], v20 offset:28672
    v_cvt_pk_bf16_f32 v198, v228, v229
    v_exp_f32 v224, v112
    v_add_f32 v234, v234, v230
    v_mfma_f32_32x32x16_bf16 v[144:159], a[152:155], v[88:91], v[144:159]
    ds_read_b64_tr_b16 a[190:191], v20 offset:30720
    v_exp_f32 v225, v113
    v_add_f32 v234, v234, v231
    v_cvt_pk_bf16_f32 v199, v230, v231
    v_mfma_f32_32x32x16_bf16 v[128:143], a[156:159], v[60:63], v[128:143]
    s_add_u32 m0, s92, 32768
    s_add_u32 s94, s93, 98304
    s_nop 0
    v_exp_f32 v226, v114
    v_mfma_f32_32x32x16_bf16 v[144:159], a[156:159], v[92:95], v[144:159]
    buffer_load_dwordx4 v25, s[64:67], s94 offen offset:0 lds
    v_exp_f32 v227, v115
    v_add_f32 v235, v224, v225
    v_cvt_pk_bf16_f32 v200, v224, v225
    s_waitcnt lgkmcnt(6)
    v_mfma_f32_32x32x16_bf16 a[0:15], a[160:163], v[208:211], a[0:15]
    ds_read_b128 a[128:131], v9 offset:49152
    v_exp_f32 v228, v116
    v_add_f32 v235, v235, v226
    v_mfma_f32_32x32x16_bf16 a[16:31], a[160:163], v[216:219], a[16:31]
    ds_read_b128 a[132:135], v10 offset:49152
    v_exp_f32 v229, v117
    v_add_f32 v235, v235, v227
    v_cvt_pk_bf16_f32 v201, v226, v227
    v_mfma_f32_32x32x16_bf16 a[0:15], a[164:167], v[212:215], a[0:15]
    ds_read_b128 a[136:139], v11 offset:49152
    v_exp_f32 v230, v118
    v_add_f32 v235, v235, v228
    v_exp_f32 v231, v119
    v_mfma_f32_32x32x16_bf16 a[16:31], a[164:167], v[220:223], a[16:31]
    ds_read_b128 a[140:143], v12 offset:49152
    v_add_f32 v235, v235, v229
    v_cvt_pk_bf16_f32 v202, v228, v229
    v_exp_f32 v224, v120
    v_add_f32 v235, v235, v230
    v_mfma_f32_32x32x16_bf16 a[32:47], a[168:171], v[208:211], a[32:47]
    ds_read_b128 a[144:147], v13 offset:49152
    v_exp_f32 v225, v121
    v_add_f32 v235, v235, v231
    v_cvt_pk_bf16_f32 v203, v230, v231
    v_mfma_f32_32x32x16_bf16 a[48:63], a[168:171], v[216:219], a[48:63]
    ds_read_b128 a[148:151], v14 offset:49152
    v_exp_f32 v226, v122
    v_add_f32 v235, v235, v224
    v_exp_f32 v227, v123
    v_mfma_f32_32x32x16_bf16 a[32:47], a[172:175], v[212:215], a[32:47]
    ds_read_b128 a[152:155], v15 offset:49152
    v_add_f32 v235, v235, v225
    v_cvt_pk_bf16_f32 v204, v224, v225
    v_exp_f32 v228, v124
    v_add_f32 v235, v235, v226
    v_mfma_f32_32x32x16_bf16 a[48:63], a[172:175], v[220:223], a[48:63]
    ds_read_b128 a[156:159], v16 offset:49152
    v_exp_f32 v229, v125
    v_add_f32 v235, v235, v227
    v_cvt_pk_bf16_f32 v205, v226, v227
    v_mfma_f32_32x32x16_bf16 a[64:79], a[176:179], v[208:211], a[64:79]
    buffer_load_dwordx4 v26, s[64:67], s94 offen offset:1024 lds
    v_exp_f32 v230, v126
    v_add_f32 v235, v235, v228
    v_mfma_f32_32x32x16_bf16 a[80:95], a[176:179], v[216:219], a[80:95]
    buffer_load_dwordx4 v27, s[64:67], s94 offen offset:2048 lds
    v_exp_f32 v231, v127
    v_add_f32 v235, v235, v229
    v_cvt_pk_bf16_f32 v206, v228, v229
    s_waitcnt lgkmcnt(6)
    v_mfma_f32_32x32x16_bf16 a[64:79], a[180:183], v[212:215], a[64:79]
    buffer_load_dwordx4 v28, s[64:67], s94 offen offset:3072 lds
    v_add_f32 v235, v235, v230
    v_add_f32 v235, v235, v231
    v_cvt_pk_bf16_f32 v207, v230, v231
    v_mfma_f32_32x32x16_bf16 a[80:95], a[180:183], v[220:223], a[80:95]
    s_add_u32 m0, s92, 65536
    s_add_u32 s94, s93, 65536
    s_nop 0
    v_max_f32 v236, v234, v235
    v_cmp_nge_f32 vcc, s95, v236
    v_mfma_f32_32x32x16_bf16 a[96:111], a[184:187], v[208:211], a[96:111]
    buffer_load_dwordx4 v29, s[68:71], s94 offen offset:0 lds
    v_mfma_f32_32x32x16_bf16 a[112:127], a[184:187], v[216:219], a[112:127]
    buffer_load_dwordx4 v29, s[68:71], s94 offen offset:1024 lds
    v_mfma_f32_32x32x16_bf16 a[96:111], a[188:191], v[212:215], a[96:111]
    buffer_load_dwordx4 v29, s[68:71], s94 offen offset:2048 lds
    v_mfma_f32_32x32x16_bf16 a[112:127], a[188:191], v[220:223], a[112:127]
    buffer_load_dwordx4 v29, s[68:71], s94 offen offset:3072 lds
    s_mov_b32 s52, s24
    s_and_b32 s53, s25, 0xffff
    s_mov_b32 s54, 0x800000
    s_lshl_b32 s12, s2, 2
    s_add_u32 s12, s12, s3
    s_lshl_b32 s100, s12, 13
    s_mul_i32 s101, s12, 7168
    v_and_b32 v2, 7, v0
    v_lshlrev_b32 v2, 7, v2
    v_add_u32 v3, 4096, v2
    s_nop 0
    buffer_load_dword v31, v2, s[44:47], s101 offen offset:0
    buffer_load_dword v31, v2, s[52:55], s100 offen offset:0
    s_cbranch_vccnz recurrent_scan__sliding_block_cached__glu_gated_glu__prompt_kernel_rs4
recurrent_scan__sliding_block_cached__glu_gated_glu__prompt_kernel_rb4:
    v_mfma_f32_32x32x16_bf16 v[96:111], a[128:131], v[32:35], v[160:175]
    ds_read_b64_tr_b16 a[160:161], v17 offset:32768
    ds_read_b64_tr_b16 a[162:163], v17 offset:34816
    v_add_f32 v232, v232, v234
    v_add_f32 v233, v233, v235
    v_exp_f32 v224, v128
    v_mfma_f32_32x32x16_bf16 v[112:127], a[128:131], v[64:67], v[176:191]
    ds_read_b64_tr_b16 a[164:165], v17 offset:36864
    ds_read_b64_tr_b16 a[166:167], v17 offset:38912
    v_exp_f32 v225, v129
    v_exp_f32 v226, v130
    v_mfma_f32_32x32x16_bf16 v[96:111], a[132:135], v[36:39], v[96:111]
    ds_read_b64_tr_b16 a[168:169], v18 offset:32768
    v_exp_f32 v227, v131
    v_add_f32 v234, v224, v225
    v_mfma_f32_32x32x16_bf16 v[112:127], a[132:135], v[68:71], v[112:127]
    ds_read_b64_tr_b16 a[170:171], v18 offset:34816
    v_cvt_pk_bf16_f32 v208, v224, v225
    v_exp_f32 v228, v132
    v_add_f32 v234, v234, v226
    s_waitcnt lgkmcnt(6)
    v_mfma_f32_32x32x16_bf16 v[96:111], a[136:139], v[40:43], v[96:111]
    ds_read_b64_tr_b16 a[172:173], v18 offset:36864
    v_exp_f32 v229, v133
    v_add_f32 v234, v234, v227
    v_mfma_f32_32x32x16_bf16 v[112:127], a[136:139], v[72:75], v[112:127]
    ds_read_b64_tr_b16 a[174:175], v18 offset:38912
    v_cvt_pk_bf16_f32 v209, v226, v227
    v_exp_f32 v230, v134
    v_add_f32 v234, v234, v228
    v_mfma_f32_32x32x16_bf16 v[96:111], a[140:143], v[44:47], v[96:111]
    ds_read_b64_tr_b16 a[176:177], v19 offset:32768
    v_exp_f32 v231, v135
    v_add_f32 v234, v234, v229
    v_cvt_pk_bf16_f32 v210, v228, v229
    v_mfma_f32_32x32x16_bf16 v[112:127], a[140:143], v[76:79], v[112:127]
    ds_read_b64_tr_b16 a[178:179], v19 offset:34816
    v_exp_f32 v224, v136
    v_add_f32 v234, v234, v230
    v_mfma_f32_32x32x16_bf16 v[96:111], a[144:147], v[48:51], v[96:111]
    ds_read_b64_tr_b16 a[180:181], v19 offset:36864
    v_exp_f32 v225, v137
    v_add_f32 v234, v234, v231
    v_cvt_pk_bf16_f32 v211, v230, v231
    v_mfma_f32_32x32x16_bf16 v[112:127], a[144:147], v[80:83], v[112:127]
    ds_read_b64_tr_b16 a[182:183], v19 offset:38912
    v_exp_f32 v226, v138
    v_add_f32 v234, v234, v224
    v_mfma_f32_32x32x16_bf16 v[96:111], a[148:151], v[52:55], v[96:111]
    ds_read_b64_tr_b16 a[184:185], v20 offset:32768
    v_exp_f32 v227, v139
    v_add_f32 v234, v234, v225
    v_cvt_pk_bf16_f32 v212, v224, v225
    v_mfma_f32_32x32x16_bf16 v[112:127], a[148:151], v[84:87], v[112:127]
    ds_read_b64_tr_b16 a[186:187], v20 offset:34816
    v_exp_f32 v228, v140
    v_add_f32 v234, v234, v226
    v_exp_f32 v229, v141
    v_mfma_f32_32x32x16_bf16 v[96:111], a[152:155], v[56:59], v[96:111]
    ds_read_b64_tr_b16 a[188:189], v20 offset:36864
    v_add_f32 v234, v234, v227
    v_cvt_pk_bf16_f32 v213, v226, v227
    v_mfma_f32_32x32x16_bf16 v[112:127], a[152:155], v[88:91], v[112:127]
    ds_read_b64_tr_b16 a[190:191], v20 offset:38912
    v_exp_f32 v230, v142
    v_add_f32 v234, v234, v228
    v_exp_f32 v231, v143
    v_mfma_f32_32x32x16_bf16 v[96:111], a[156:159], v[60:63], v[96:111]
    buffer_load_dword v31, v2, s[44:47], s101 offen offset:1024
    v_add_f32 v234, v234, v229
    v_cvt_pk_bf16_f32 v214, v228, v229
    v_mfma_f32_32x32x16_bf16 v[112:127], a[156:159], v[92:95], v[112:127]
    buffer_load_dword v31, v2, s[52:55], s100 offen offset:1024
    v_exp_f32 v224, v144
    s_waitcnt lgkmcnt(6)
    v_mfma_f32_32x32x16_bf16 a[0:15], a[160:163], v[192:195], a[0:15]
    ds_read_b128 a[128:131], v9 offset:57344
    v_add_f32 v234, v234, v230
    v_exp_f32 v225, v145
    v_add_f32 v234, v234, v231
    v_mfma_f32_32x32x16_bf16 a[16:31], a[160:163], v[200:203], a[16:31]
    ds_read_b128 a[132:135], v10 offset:57344
    v_cvt_pk_bf16_f32 v215, v230, v231
    v_exp_f32 v226, v146
    v_mfma_f32_32x32x16_bf16 a[0:15], a[164:167], v[196:199], a[0:15]
    ds_read_b128 a[136:139], v11 offset:57344
    v_exp_f32 v227, v147
    v_add_f32 v235, v224, v225
    v_cvt_pk_bf16_f32 v216, v224, v225
    v_mfma_f32_32x32x16_bf16 a[16:31], a[164:167], v[204:207], a[16:31]
    ds_read_b128 a[140:143], v12 offset:57344
    v_exp_f32 v228, v148
    v_add_f32 v235, v235, v226
    v_exp_f32 v229, v149
    v_mfma_f32_32x32x16_bf16 a[32:47], a[168:171], v[192:195], a[32:47]
    ds_read_b128 a[144:147], v13 offset:57344
    v_add_f32 v235, v235, v227
    v_cvt_pk_bf16_f32 v217, v226, v227
    v_mfma_f32_32x32x16_bf16 a[48:63], a[168:171], v[200:203], a[48:63]
    ds_read_b128 a[148:151], v14 offset:57344
    v_exp_f32 v230, v150
    v_add_f32 v235, v235, v228
    v_exp_f32 v231, v151
    v_mfma_f32_32x32x16_bf16 a[32:47], a[172:175], v[196:199], a[32:47]
    ds_read_b128 a[152:155], v15 offset:57344
    v_add_f32 v235, v235, v229
    v_cvt_pk_bf16_f32 v218, v228, v229
    v_mfma_f32_32x32x16_bf16 a[48:63], a[172:175], v[204:207], a[48:63]
    ds_read_b128 a[156:159], v16 offset:57344
    v_exp_f32 v224, v152
    v_add_f32 v235, v235, v230
    v_exp_f32 v225, v153
    v_mfma_f32_32x32x16_bf16 a[64:79], a[176:179], v[192:195], a[64:79]
    s_add_u32 m0, s4, 0
    s_nop 0
    buffer_load_dwordx4 v1, s[56:59], s90 offen offset:0 lds
    v_mfma_f32_32x32x16_bf16 a[80:95], a[176:179], v[200:203], a[80:95]
    buffer_load_dwordx4 v253, s[56:59], s90 offen offset:1024 lds
    v_add_f32 v235, v235, v231
    v_cvt_pk_bf16_f32 v219, v230, v231
    s_waitcnt lgkmcnt(6)
    v_mfma_f32_32x32x16_bf16 a[64:79], a[180:183], v[196:199], a[64:79]
    v_exp_f32 v226, v154
    v_add_f32 v235, v235, v224
    v_exp_f32 v227, v155
    v_mfma_f32_32x32x16_bf16 a[80:95], a[180:183], v[204:207], a[80:95]
    v_add_f32 v235, v235, v225
    v_cvt_pk_bf16_f32 v220, v224, v225
    v_exp_f32 v228, v156
    v_add_f32 v235, v235, v226
    v_mfma_f32_32x32x16_bf16 a[96:111], a[184:187], v[192:195], a[96:111]
    v_exp_f32 v229, v157
    v_add_f32 v235, v235, v227
    v_cvt_pk_bf16_f32 v221, v226, v227
    v_mfma_f32_32x32x16_bf16 a[112:127], a[184:187], v[200:203], a[112:127]
    v_exp_f32 v230, v158
    v_add_f32 v235, v235, v228
    v_exp_f32 v231, v159
    v_mfma_f32_32x32x16_bf16 a[96:111], a[188:191], v[196:199], a[96:111]
    v_add_f32 v235, v235, v229
    v_cvt_pk_bf16_f32 v222, v228, v229
    v_add_f32 v235, v235, v230
    v_add_f32 v235, v235, v231
    v_mfma_f32_32x32x16_bf16 a[112:127], a[188:191], v[204:207], a[112:127]
    v_cvt_pk_bf16_f32 v223, v230, v231
    v_max_f32 v236, v234, v235
    v_cmp_nge_f32 vcc, s95, v236
    s_cbranch_vccnz recurrent_scan__sliding_block_cached__glu_gated_glu__prompt_kernel_rs5
recurrent_scan__sliding_block_cached__glu_gated_glu__prompt_kernel_rb5:
    s_waitcnt vmcnt(18)
    s_waitcnt lgkmcnt(0)
    s_barrier
    v_mfma_f32_32x32x16_bf16 v[128:143], a[128:131], v[32:35], v[160:175]
    ds_read_b64_tr_b16 a[160:161], v17 offset:40960
    ds_read_b64_tr_b16 a[162:163], v17 offset:43008
    v_add_f32 v232, v232, v234
    v_add_f32 v233, v233, v235
    v_exp_f32 v224, v96
    v_mfma_f32_32x32x16_bf16 v[144:159], a[128:131], v[64:67], v[176:191]
    ds_read_b64_tr_b16 a[164:165], v17 offset:45056
    ds_read_b64_tr_b16 a[166:167], v17 offset:47104
    v_exp_f32 v225, v97
    v_exp_f32 v226, v98
    v_mfma_f32_32x32x16_bf16 v[128:143], a[132:135], v[36:39], v[128:143]
    ds_read_b64_tr_b16 a[168:169], v18 offset:40960
    v_exp_f32 v227, v99
    v_add_f32 v234, v224, v225
    v_cvt_pk_bf16_f32 v192, v224, v225
    v_mfma_f32_32x32x16_bf16 v[144:159], a[132:135], v[68:71], v[144:159]
    ds_read_b64_tr_b16 a[170:171], v18 offset:43008
    v_exp_f32 v228, v100
    v_add_f32 v234, v234, v226
    v_exp_f32 v229, v101
    v_mfma_f32_32x32x16_bf16 v[128:143], a[136:139], v[40:43], v[128:143]
    ds_read_b64_tr_b16 a[172:173], v18 offset:45056
    v_add_f32 v234, v234, v227
    v_cvt_pk_bf16_f32 v193, v226, v227
    v_exp_f32 v230, v102
    v_mfma_f32_32x32x16_bf16 v[144:159], a[136:139], v[72:75], v[144:159]
    ds_read_b64_tr_b16 a[174:175], v18 offset:47104
    v_add_f32 v234, v234, v228
    v_exp_f32 v231, v103
    v_add_f32 v234, v234, v229
    v_cvt_pk_bf16_f32 v194, v228, v229
    v_mfma_f32_32x32x16_bf16 v[128:143], a[140:143], v[44:47], v[128:143]
    ds_read_b64_tr_b16 a[176:177], v19 offset:40960
    v_exp_f32 v224, v104
    v_add_f32 v234, v234, v230
    v_exp_f32 v225, v105
    v_mfma_f32_32x32x16_bf16 v[144:159], a[140:143], v[76:79], v[144:159]
    ds_read_b64_tr_b16 a[178:179], v19 offset:43008
    v_add_f32 v234, v234, v231
    v_cvt_pk_bf16_f32 v195, v230, v231
    v_exp_f32 v226, v106
    v_mfma_f32_32x32x16_bf16 v[128:143], a[144:147], v[48:51], v[128:143]
    ds_read_b64_tr_b16 a[180:181], v19 offset:45056
    v_add_f32 v234, v234, v224
    v_exp_f32 v227, v107
    v_add_f32 v234, v234, v225
    v_mfma_f32_32x32x16_bf16 v[144:159], a[144:147], v[80:83], v[144:159]
    ds_read_b64_tr_b16 a[182:183], v19 offset:47104
    v_cvt_pk_bf16_f32 v196, v224, v225
    v_exp_f32 v228, v108
    v_add_f32 v234, v234, v226
    v_mfma_f32_32x32x16_bf16 v[128:143], a[148:151], v[52:55], v[128:143]
    ds_read_b64_tr_b16 a[184:185], v20 offset:40960
    v_exp_f32 v229, v109
    v_add_f32 v234, v234, v227
    v_cvt_pk_bf16_f32 v197, v226, v227
    v_mfma_f32_32x32x16_bf16 v[144:159], a[148:151], v[84:87], v[144:159]
    ds_read_b64_tr_b16 a[186:187], v20 offset:43008
    v_exp_f32 v230, v110
    v_add_f32 v234, v234, v228
    v_exp_f32 v231, v111
    v_mfma_f32_32x32x16_bf16 v[128:143], a[152:155], v[56:59], v[128:143]
    ds_read_b64_tr_b16 a[188:189], v20 offset:45056
    v_add_f32 v234, v234, v229
    v_cvt_pk_bf16_f32 v198, v228, v229
    v_exp_f32 v224, v112
    v_mfma_f32_32x32x16_bf16 v[144:159], a[152:155], v[88:91], v[144:159]
    ds_read_b64_tr_b16 a[190:191], v20 offset:47104
    v_add_f32 v234, v234, v230
    v_exp_f32 v225, v113
    v_add_f32 v234, v234, v231
    v_mfma_f32_32x32x16_bf16 v[128:143], a[156:159], v[60:63], v[128:143]
    s_add_u32 m0, s92, 49152
    s_add_u32 s94, s93, 114688
    s_nop 0
    v_cvt_pk_bf16_f32 v199, v230, v231
    v_exp_f32 v226, v114
    v_mfma_f32_32x32x16_bf16 v[144:159], a[156:159], v[92:95], v[144:159]
    buffer_load_dwordx4 v25, s[64:67], s94 offen offset:0 lds
    v_exp_f32 v227, v115
    v_add_f32 v235, v224, v225
    s_waitcnt lgkmcnt(6)
    v_mfma_f32_32x32x16_bf16 a[0:15], a[160:163], v[208:211], a[0:15]
    ds_read_b128 a[128:131], v9 offset:0
    v_cvt_pk_bf16_f32 v200, v224, v225
    v_exp_f32 v228, v116
    v_add_f32 v235, v235, v226
    v_mfma_f32_32x32x16_bf16 a[16:31], a[160:163], v[216:219], a[16:31]
    ds_read_b128 a[132:135], v10 offset:0
    v_exp_f32 v229, v117
    v_add_f32 v235, v235, v227
    v_cvt_pk_bf16_f32 v201, v226, v227
    v_mfma_f32_32x32x16_bf16 a[0:15], a[164:167], v[212:215], a[0:15]
    ds_read_b128 a[136:139], v11 offset:0
    v_exp_f32 v230, v118
    v_add_f32 v235, v235, v228
    v_exp_f32 v231, v119
    v_mfma_f32_32x32x16_bf16 a[16:31], a[164:167], v[220:223], a[16:31]
    ds_read_b128 a[140:143], v12 offset:0
    v_add_f32 v235, v235, v229
    v_cvt_pk_bf16_f32 v202, v228, v229
    v_exp_f32 v224, v120
    v_mfma_f32_32x32x16_bf16 a[32:47], a[168:171], v[208:211], a[32:47]
    ds_read_b128 a[144:147], v13 offset:0
    v_add_f32 v235, v235, v230
    v_exp_f32 v225, v121
    v_add_f32 v235, v235, v231
    v_mfma_f32_32x32x16_bf16 a[48:63], a[168:171], v[216:219], a[48:63]
    ds_read_b128 a[148:151], v14 offset:0
    v_cvt_pk_bf16_f32 v203, v230, v231
    v_exp_f32 v226, v122
    v_add_f32 v235, v235, v224
    v_mfma_f32_32x32x16_bf16 a[32:47], a[172:175], v[212:215], a[32:47]
    ds_read_b128 a[152:155], v15 offset:0
    v_exp_f32 v227, v123
    v_add_f32 v235, v235, v225
    v_cvt_pk_bf16_f32 v204, v224, v225
    v_mfma_f32_32x32x16_bf16 a[48:63], a[172:175], v[220:223], a[48:63]
    ds_read_b128 a[156:159], v16 offset:0
    v_exp_f32 v228, v124
    v_add_f32 v235, v235, v226
    v_exp_f32 v229, v125
    v_mfma_f32_32x32x16_bf16 a[64:79], a[176:179], v[208:211], a[64:79]
    buffer_load_dwordx4 v26, s[64:67], s94 offen offset:1024 lds
    v_add_f32 v235, v235, v227
    v_cvt_pk_bf16_f32 v205, v226, v227
    v_mfma_f32_32x32x16_bf16 a[80:95], a[176:179], v[216:219], a[80:95]
    buffer_load_dwordx4 v27, s[64:67], s94 offen offset:2048 lds
    v_exp_f32 v230, v126
    v_add_f32 v235, v235, v228
    s_waitcnt lgkmcnt(6)
    v_mfma_f32_32x32x16_bf16 a[64:79], a[180:183], v[212:215], a[64:79]
    buffer_load_dwordx4 v28, s[64:67], s94 offen offset:3072 lds
    v_exp_f32 v231, v127
    v_add_f32 v235, v235, v229
    v_mfma_f32_32x32x16_bf16 a[80:95], a[180:183], v[220:223], a[80:95]
    s_add_u32 m0, s92, 81920
    s_add_u32 s94, s93, 81920
    s_nop 0
    v_cvt_pk_bf16_f32 v206, v228, v229
    v_add_f32 v235, v235, v230
    v_add_f32 v235, v235, v231
    v_mfma_f32_32x32x16_bf16 a[96:111], a[184:187], v[208:211], a[96:111]
    buffer_load_dwordx4 v29, s[68:71], s94 offen offset:0 lds
    v_cvt_pk_bf16_f32 v207, v230, v231
    v_max_f32 v236, v234, v235
    v_cmp_nge_f32 vcc, s95, v236
    v_mfma_f32_32x32x16_bf16 a[112:127], a[184:187], v[216:219], a[112:127]
    buffer_load_dwordx4 v29, s[68:71], s94 offen offset:1024 lds
    v_mfma_f32_32x32x16_bf16 a[96:111], a[188:191], v[212:215], a[96:111]
    buffer_load_dwordx4 v29, s[68:71], s94 offen offset:2048 lds
    v_mfma_f32_32x32x16_bf16 a[112:127], a[188:191], v[220:223], a[112:127]
    buffer_load_dwordx4 v29, s[68:71], s94 offen offset:3072 lds
    buffer_load_dword v31, v2, s[44:47], s101 offen offset:2048
    buffer_load_dword v31, v2, s[52:55], s100 offen offset:2048
    s_add_u32 m0, s4, 0
    s_nop 0
    buffer_load_dwordx4 v254, s[56:59], s90 offen offset:2048 lds
    buffer_load_dwordx4 v255, s[56:59], s90 offen offset:3072 lds
    s_cbranch_vccnz recurrent_scan__sliding_block_cached__glu_gated_glu__prompt_kernel_rs6
recurrent_scan__sliding_block_cached__glu_gated_glu__prompt_kernel_rb6:
    v_mfma_f32_32x32x16_bf16 v[96:111], a[128:131], v[32:35], v[160:175]
    ds_read_b64_tr_b16 a[160:161], v17 offset:49152
    ds_read_b64_tr_b16 a[162:163], v17 offset:51200
    v_add_f32 v232, v232, v234
    v_add_f32 v233, v233, v235
    v_exp_f32 v224, v128
    v_mfma_f32_32x32x16_bf16 v[112:127], a[128:131], v[64:67], v[176:191]
    ds_read_b64_tr_b16 a[164:165], v17 offset:53248
    ds_read_b64_tr_b16 a[166:167], v17 offset:55296
    v_exp_f32 v225, v129
    v_exp_f32 v226, v130
    v_mfma_f32_32x32x16_bf16 v[96:111], a[132:135], v[36:39], v[96:111]
    ds_read_b64_tr_b16 a[168:169], v18 offset:49152
    v_exp_f32 v227, v131
    v_add_f32 v234, v224, v225
    v_mfma_f32_32x32x16_bf16 v[112:127], a[132:135], v[68:71], v[112:127]
    ds_read_b64_tr_b16 a[170:171], v18 offset:51200
    v_cvt_pk_bf16_f32 v208, v224, v225
    v_exp_f32 v228, v132
    v_add_f32 v234, v234, v226
    s_waitcnt lgkmcnt(6)
    v_mfma_f32_32x32x16_bf16 v[96:111], a[136:139], v[40:43], v[96:111]
    ds_read_b64_tr_b16 a[172:173], v18 offset:53248
    v_exp_f32 v229, v133
    v_add_f32 v234, v234, v227
    v_mfma_f32_32x32x16_bf16 v[112:127], a[136:139], v[72:75], v[112:127]
    ds_read_b64_tr_b16 a[174:175], v18 offset:55296
    v_cvt_pk_bf16_f32 v209, v226, v227
    v_exp_f32 v230, v134
    v_add_f32 v234, v234, v228
    v_mfma_f32_32x32x16_bf16 v[96:111], a[140:143], v[44:47], v[96:111]
    ds_read_b64_tr_b16 a[176:177], v19 offset:49152
    v_exp_f32 v231, v135
    v_add_f32 v234, v234, v229
    v_cvt_pk_bf16_f32 v210, v228, v229
    v_mfma_f32_32x32x16_bf16 v[112:127], a[140:143], v[76:79], v[112:127]
    ds_read_b64_tr_b16 a[178:179], v19 offset:51200
    v_exp_f32 v224, v136
    v_add_f32 v234, v234, v230
    v_mfma_f32_32x32x16_bf16 v[96:111], a[144:147], v[48:51], v[96:111]
    ds_read_b64_tr_b16 a[180:181], v19 offset:53248
    v_exp_f32 v225, v137
    v_add_f32 v234, v234, v231
    v_cvt_pk_bf16_f32 v211, v230, v231
    v_mfma_f32_32x32x16_bf16 v[112:127], a[144:147], v[80:83], v[112:127]
    ds_read_b64_tr_b16 a[182:183], v19 offset:55296
    v_exp_f32 v226, v138
    v_add_f32 v234, v234, v224
    v_mfma_f32_32x32x16_bf16 v[96:111], a[148:151], v[52:55], v[96:111]
    ds_read_b64_tr_b16 a[184:185], v20 offset:49152
    v_exp_f32 v227, v139
    v_add_f32 v234, v234, v225
    v_cvt_pk_bf16_f32 v212, v224, v225
    v_mfma_f32_32x32x16_bf16 v[112:127], a[148:151], v[84:87], v[112:127]
    ds_read_b64_tr_b16 a[186:187], v20 offset:51200
    v_exp_f32 v228, v140
    v_add_f32 v234, v234, v226
    v_exp_f32 v229, v141
    v_mfma_f32_32x32x16_bf16 v[96:111], a[152:155], v[56:59], v[96:111]
    ds_read_b64_tr_b16 a[188:189], v20 offset:53248
    v_add_f32 v234, v234, v227
    v_cvt_pk_bf16_f32 v213, v226, v227
    v_mfma_f32_32x32x16_bf16 v[112:127], a[152:155], v[88:91], v[112:127]
    ds_read_b64_tr_b16 a[190:191], v20 offset:55296
    v_exp_f32 v230, v142
    v_add_f32 v234, v234, v228
    v_exp_f32 v231, v143
    v_mfma_f32_32x32x16_bf16 v[96:111], a[156:159], v[60:63], v[96:111]
    buffer_load_dword v31, v2, s[44:47], s101 offen offset:3072
    v_add_f32 v234, v234, v229
    v_cvt_pk_bf16_f32 v214, v228, v229
    v_mfma_f32_32x32x16_bf16 v[112:127], a[156:159], v[92:95], v[112:127]
    buffer_load_dword v31, v2, s[52:55], s100 offen offset:3072
    v_exp_f32 v224, v144
    s_waitcnt lgkmcnt(6)
    v_mfma_f32_32x32x16_bf16 a[0:15], a[160:163], v[192:195], a[0:15]
    ds_read_b128 a[128:131], v9 offset:8192
    v_add_f32 v234, v234, v230
    v_exp_f32 v225, v145
    v_add_f32 v234, v234, v231
    v_mfma_f32_32x32x16_bf16 a[16:31], a[160:163], v[200:203], a[16:31]
    ds_read_b128 a[132:135], v10 offset:8192
    v_cvt_pk_bf16_f32 v215, v230, v231
    v_exp_f32 v226, v146
    v_mfma_f32_32x32x16_bf16 a[0:15], a[164:167], v[196:199], a[0:15]
    ds_read_b128 a[136:139], v11 offset:8192
    v_exp_f32 v227, v147
    v_add_f32 v235, v224, v225
    v_cvt_pk_bf16_f32 v216, v224, v225
    v_mfma_f32_32x32x16_bf16 a[16:31], a[164:167], v[204:207], a[16:31]
    ds_read_b128 a[140:143], v12 offset:8192
    v_exp_f32 v228, v148
    v_add_f32 v235, v235, v226
    v_exp_f32 v229, v149
    v_mfma_f32_32x32x16_bf16 a[32:47], a[168:171], v[192:195], a[32:47]
    ds_read_b128 a[144:147], v13 offset:8192
    v_add_f32 v235, v235, v227
    v_cvt_pk_bf16_f32 v217, v226, v227
    v_mfma_f32_32x32x16_bf16 a[48:63], a[168:171], v[200:203], a[48:63]
    ds_read_b128 a[148:151], v14 offset:8192
    v_exp_f32 v230, v150
    v_add_f32 v235, v235, v228
    v_exp_f32 v231, v151
    v_mfma_f32_32x32x16_bf16 a[32:47], a[172:175], v[196:199], a[32:47]
    ds_read_b128 a[152:155], v15 offset:8192
    v_add_f32 v235, v235, v229
    v_cvt_pk_bf16_f32 v218, v228, v229
    v_mfma_f32_32x32x16_bf16 a[48:63], a[172:175], v[204:207], a[48:63]
    ds_read_b128 a[156:159], v16 offset:8192
    v_exp_f32 v224, v152
    v_add_f32 v235, v235, v230
    v_exp_f32 v225, v153
    v_mfma_f32_32x32x16_bf16 a[64:79], a[176:179], v[192:195], a[64:79]
    s_add_u32 m0, s4, 4096
    s_nop 0
    buffer_load_dwordx4 v1, s[56:59], s14 offen offset:0 lds
    v_mfma_f32_32x32x16_bf16 a[80:95], a[176:179], v[200:203], a[80:95]
    buffer_load_dwordx4 v253, s[56:59], s14 offen offset:1024 lds
    v_add_f32 v235, v235, v231
    v_cvt_pk_bf16_f32 v219, v230, v231
    s_waitcnt lgkmcnt(6)
    v_mfma_f32_32x32x16_bf16 a[64:79], a[180:183], v[196:199], a[64:79]
    v_exp_f32 v226, v154
    v_add_f32 v235, v235, v224
    v_exp_f32 v227, v155
    v_mfma_f32_32x32x16_bf16 a[80:95], a[180:183], v[204:207], a[80:95]
    v_add_f32 v235, v235, v225
    v_cvt_pk_bf16_f32 v220, v224, v225
    v_exp_f32 v228, v156
    v_add_f32 v235, v235, v226
    v_mfma_f32_32x32x16_bf16 a[96:111], a[184:187], v[192:195], a[96:111]
    v_exp_f32 v229, v157
    v_add_f32 v235, v235, v227
    v_cvt_pk_bf16_f32 v221, v226, v227
    v_mfma_f32_32x32x16_bf16 a[112:127], a[184:187], v[200:203], a[112:127]
    v_exp_f32 v230, v158
    v_add_f32 v235, v235, v228
    v_exp_f32 v231, v159
    v_mfma_f32_32x32x16_bf16 a[96:111], a[188:191], v[196:199], a[96:111]
    v_add_f32 v235, v235, v229
    v_cvt_pk_bf16_f32 v222, v228, v229
    v_add_f32 v235, v235, v230
    v_add_f32 v235, v235, v231
    v_mfma_f32_32x32x16_bf16 a[112:127], a[188:191], v[204:207], a[112:127]
    v_cvt_pk_bf16_f32 v223, v230, v231
    v_max_f32 v236, v234, v235
    v_cmp_nge_f32 vcc, s95, v236
    s_cbranch_vccnz recurrent_scan__sliding_block_cached__glu_gated_glu__prompt_kernel_rs7
recurrent_scan__sliding_block_cached__glu_gated_glu__prompt_kernel_rb7:
    s_waitcnt vmcnt(22)
    s_waitcnt lgkmcnt(0)
    s_barrier
    v_mfma_f32_32x32x16_bf16 v[128:143], a[128:131], v[32:35], v[160:175]
    ds_read_b64_tr_b16 a[160:161], v17 offset:57344
    ds_read_b64_tr_b16 a[162:163], v17 offset:59392
    v_add_f32 v232, v232, v234
    v_add_f32 v233, v233, v235
    v_exp_f32 v224, v96
    v_mfma_f32_32x32x16_bf16 v[144:159], a[128:131], v[64:67], v[176:191]
    ds_read_b64_tr_b16 a[164:165], v17 offset:61440
    ds_read_b64_tr_b16 a[166:167], v17 offset:63488
    v_exp_f32 v225, v97
    v_exp_f32 v226, v98
    v_mfma_f32_32x32x16_bf16 v[128:143], a[132:135], v[36:39], v[128:143]
    ds_read_b64_tr_b16 a[168:169], v18 offset:57344
    v_exp_f32 v227, v99
    v_add_f32 v234, v224, v225
    v_cvt_pk_bf16_f32 v192, v224, v225
    v_mfma_f32_32x32x16_bf16 v[144:159], a[132:135], v[68:71], v[144:159]
    ds_read_b64_tr_b16 a[170:171], v18 offset:59392
    v_exp_f32 v228, v100
    v_add_f32 v234, v234, v226
    v_exp_f32 v229, v101
    v_mfma_f32_32x32x16_bf16 v[128:143], a[136:139], v[40:43], v[128:143]
    ds_read_b64_tr_b16 a[172:173], v18 offset:61440
    v_add_f32 v234, v234, v227
    v_cvt_pk_bf16_f32 v193, v226, v227
    v_exp_f32 v230, v102
    v_mfma_f32_32x32x16_bf16 v[144:159], a[136:139], v[72:75], v[144:159]
    ds_read_b64_tr_b16 a[174:175], v18 offset:63488
    v_add_f32 v234, v234, v228
    v_exp_f32 v231, v103
    v_mfma_f32_32x32x16_bf16 v[128:143], a[140:143], v[44:47], v[128:143]
    ds_read_b64_tr_b16 a[176:177], v19 offset:57344
    v_add_f32 v234, v234, v229
    v_cvt_pk_bf16_f32 v194, v228, v229
    v_exp_f32 v224, v104
    v_mfma_f32_32x32x16_bf16 v[144:159], a[140:143], v[76:79], v[144:159]
    ds_read_b64_tr_b16 a[178:179], v19 offset:59392
    v_add_f32 v234, v234, v230
    v_exp_f32 v225, v105
    v_add_f32 v234, v234, v231
    v_mfma_f32_32x32x16_bf16 v[128:143], a[144:147], v[48:51], v[128:143]
    ds_read_b64_tr_b16 a[180:181], v19 offset:61440
    v_cvt_pk_bf16_f32 v195, v230, v231
    v_exp_f32 v226, v106
    v_add_f32 v234, v234, v224
    v_mfma_f32_32x32x16_bf16 v[144:159], a[144:147], v[80:83], v[144:159]
    ds_read_b64_tr_b16 a[182:183], v19 offset:63488
    v_exp_f32 v227, v107
    v_add_f32 v234, v234, v225
    v_cvt_pk_bf16_f32 v196, v224, v225
    v_mfma_f32_32x32x16_bf16 v[128:143], a[148:151], v[52:55], v[128:143]
    ds_read_b64_tr_b16 a[184:185], v20 offset:57344
    v_exp_f32 v228, v108
    v_add_f32 v234, v234, v226
    v_exp_f32 v229, v109
    v_mfma_f32_32x32x16_bf16 v[144:159], a[148:151], v[84:87], v[144:159]
    ds_read_b64_tr_b16 a[186:187], v20 offset:59392
    v_add_f32 v234, v234, v227
    v_cvt_pk_bf16_f32 v197, v226, v227
    v_mfma_f32_32x32x16_bf16 v[128:143], a[152:155], v[56:59], v[128:143]
    ds_read_b64_tr_b16 a[188:189], v20 offset:61440
    v_exp_f32 v230, v110
    v_add_f32 v234, v234, v228
    v_exp_f32 v231, v111
    v_mfma_f32_32x32x16_bf16 v[144:159], a[152:155], v[88:91], v[144:159]
    ds_read_b64_tr_b16 a[190:191], v20 offset:63488
    v_add_f32 v234, v234, v229
    v_cvt_pk_bf16_f32 v198, v228, v229
    v_exp_f32 v224, v112
    v_mfma_f32_32x32x16_bf16 v[128:143], a[156:159], v[60:63], v[128:143]
    s_add_u32 m0, s92, 98304
    s_add_u32 s94, s93, 98304
    s_nop 0
    v_add_f32 v234, v234, v230
    v_mfma_f32_32x32x16_bf16 v[144:159], a[156:159], v[92:95], v[144:159]
    buffer_load_dwordx4 v29, s[68:71], s94 offen offset:0 lds
    v_exp_f32 v225, v113
    v_add_f32 v234, v234, v231
    s_waitcnt lgkmcnt(6)
    v_mfma_f32_32x32x16_bf16 a[0:15], a[160:163], v[208:211], a[0:15]
    ds_read_b128 a[128:131], v9 offset:16384
    v_cvt_pk_bf16_f32 v199, v230, v231
    v_exp_f32 v226, v114
    v_mfma_f32_32x32x16_bf16 a[16:31], a[160:163], v[216:219], a[16:31]
    ds_read_b128 a[132:135], v10 offset:16384
    v_exp_f32 v227, v115
    v_add_f32 v235, v224, v225
    v_cvt_pk_bf16_f32 v200, v224, v225
    v_mfma_f32_32x32x16_bf16 a[0:15], a[164:167], v[212:215], a[0:15]
    ds_read_b128 a[136:139], v11 offset:16384
    v_exp_f32 v228, v116
    v_add_f32 v235, v235, v226
    v_exp_f32 v229, v117
    v_mfma_f32_32x32x16_bf16 a[16:31], a[164:167], v[220:223], a[16:31]
    ds_read_b128 a[140:143], v12 offset:16384
    v_add_f32 v235, v235, v227
    v_cvt_pk_bf16_f32 v201, v226, v227
    v_exp_f32 v230, v118
    v_mfma_f32_32x32x16_bf16 a[32:47], a[168:171], v[208:211], a[32:47]
    ds_read_b128 a[144:147], v13 offset:16384
    v_add_f32 v235, v235, v228
    v_exp_f32 v231, v119
    v_add_f32 v235, v235, v229
    v_mfma_f32_32x32x16_bf16 a[48:63], a[168:171], v[216:219], a[48:63]
    ds_read_b128 a[148:151], v14 offset:16384
    v_cvt_pk_bf16_f32 v202, v228, v229
    v_exp_f32 v224, v120
    v_add_f32 v235, v235, v230
    v_mfma_f32_32x32x16_bf16 a[32:47], a[172:175], v[212:215], a[32:47]
    ds_read_b128 a[152:155], v15 offset:16384
    v_exp_f32 v225, v121
    v_add_f32 v235, v235, v231
    v_cvt_pk_bf16_f32 v203, v230, v231
    v_mfma_f32_32x32x16_bf16 a[48:63], a[172:175], v[220:223], a[48:63]
    ds_read_b128 a[156:159], v16 offset:16384
    v_exp_f32 v226, v122
    v_add_f32 v235, v235, v224
    v_exp_f32 v227, v123
    v_mfma_f32_32x32x16_bf16 a[64:79], a[176:179], v[208:211], a[64:79]
    buffer_load_dwordx4 v29, s[68:71], s94 offen offset:1024 lds
    v_add_f32 v235, v235, v225
    v_cvt_pk_bf16_f32 v204, v224, v225
    v_mfma_f32_32x32x16_bf16 a[80:95], a[176:179], v[216:219], a[80:95]
    buffer_load_dwordx4 v29, s[68:71], s94 offen offset:2048 lds
    v_exp_f32 v228, v124
    v_add_f32 v235, v235, v226
    s_waitcnt lgkmcnt(6)
    v_mfma_f32_32x32x16_bf16 a[64:79], a[180:183], v[212:215], a[64:79]
    buffer_load_dwordx4 v29, s[68:71], s94 offen offset:3072 lds
    v_exp_f32 v229, v125
    v_add_f32 v235, v235, v227
    v_mfma_f32_32x32x16_bf16 a[80:95], a[180:183], v[220:223], a[80:95]
    buffer_load_dword v31, v3, s[44:47], s101 offen offset:0
    v_cvt_pk_bf16_f32 v205, v226, v227
    v_exp_f32 v230, v126
    v_mfma_f32_32x32x16_bf16 a[96:111], a[184:187], v[208:211], a[96:111]
    buffer_load_dword v31, v3, s[52:55], s100 offen offset:0
    v_add_f32 v235, v235, v228
    v_exp_f32 v231, v127
    v_mfma_f32_32x32x16_bf16 a[112:127], a[184:187], v[216:219], a[112:127]
    s_add_u32 m0, s4, 4096
    s_nop 0
    buffer_load_dwordx4 v254, s[56:59], s14 offen offset:2048 lds
    v_add_f32 v235, v235, v229
    v_mfma_f32_32x32x16_bf16 a[96:111], a[188:191], v[212:215], a[96:111]
    buffer_load_dwordx4 v255, s[56:59], s14 offen offset:3072 lds
    v_cvt_pk_bf16_f32 v206, v228, v229
    v_add_f32 v235, v235, v230
    v_add_f32 v235, v235, v231
    v_mfma_f32_32x32x16_bf16 a[112:127], a[188:191], v[220:223], a[112:127]
    v_cvt_pk_bf16_f32 v207, v230, v231
    v_max_f32 v236, v234, v235
    v_cmp_nge_f32 vcc, s95, v236
    s_cbranch_vccnz recurrent_scan__sliding_block_cached__glu_gated_glu__prompt_kernel_rs8
recurrent_scan__sliding_block_cached__glu_gated_glu__prompt_kernel_rb8:
    s_getpc_b64 s[76:77]
recurrent_scan__sliding_block_cached__glu_gated_glu__prompt_kernel_pc2:
    s_sub_u32 s76, s76, recurrent_scan__sliding_block_cached__glu_gated_glu__prompt_kernel_pc2-recurrent_scan__sliding_block_cached__glu_gated_glu__prompt_kernel
    s_subb_u32 s77, s77, 0
    s_lshr_b32 s78, s2, 3
    s_lshl_b32 s78, s78, 11
    s_lshl_b32 s79, s3, 9
    s_add_u32 s78, s78, s79
    v_and_b32 v30, 7, v0
    v_mul_u32_u24 v30, 0x4080, v30
    v_and_b32 v30, 0x10180, v30
    v_add_u32 v30, s78, v30
    v_min_u32 v30, recurrent_scan__sliding_block_cached__glu_gated_glu__prompt_kernel_codeend-recurrent_scan__sliding_block_cached__glu_gated_glu__prompt_kernel-4, v30
    global_load_dword v31, v30, s[76:77]
    v_mfma_f32_32x32x16_bf16 v[96:111], a[128:131], v[32:35], v[160:175]
    ds_read_b64_tr_b16 a[160:161], v17 offset:0
    ds_read_b64_tr_b16 a[162:163], v17 offset:2048
    v_add_f32 v232, v232, v234
    v_add_f32 v233, v233, v235
    v_exp_f32 v224, v128
    v_mfma_f32_32x32x16_bf16 v[112:127], a[128:131], v[64:67], v[176:191]
    ds_read_b64_tr_b16 a[164:165], v17 offset:4096
    ds_read_b64_tr_b16 a[166:167], v17 offset:6144
    v_exp_f32 v225, v129
    v_exp_f32 v226, v130
    v_mfma_f32_32x32x16_bf16 v[96:111], a[132:135], v[36:39], v[96:111]
    ds_read_b64_tr_b16 a[168:169], v18 offset:0
    v_exp_f32 v227, v131
    v_mfma_f32_32x32x16_bf16 v[112:127], a[132:135], v[68:71], v[112:127]
    ds_read_b64_tr_b16 a[170:171], v18 offset:2048
    v_add_f32 v234, v224, v225
    v_cvt_pk_bf16_f32 v208, v224, v225
    v_exp_f32 v228, v132
    s_waitcnt lgkmcnt(6)
    v_mfma_f32_32x32x16_bf16 v[96:111], a[136:139], v[40:43], v[96:111]
    ds_read_b64_tr_b16 a[172:173], v18 offset:4096
    v_add_f32 v234, v234, v226
    v_exp_f32 v229, v133
    v_mfma_f32_32x32x16_bf16 v[112:127], a[136:139], v[72:75], v[112:127]
    ds_read_b64_tr_b16 a[174:175], v18 offset:6144
    v_add_f32 v234, v234, v227
    v_cvt_pk_bf16_f32 v209, v226, v227
    v_exp_f32 v230, v134
    v_mfma_f32_32x32x16_bf16 v[96:111], a[140:143], v[44:47], v[96:111]
    ds_read_b64_tr_b16 a[176:177], v19 offset:0
    v_add_f32 v234, v234, v228
    v_exp_f32 v231, v135
    v_mfma_f32_32x32x16_bf16 v[112:127], a[140:143], v[76:79], v[112:127]
    ds_read_b64_tr_b16 a[178:179], v19 offset:2048
    v_add_f32 v234, v234, v229
    v_cvt_pk_bf16_f32 v210, v228, v229
    v_exp_f32 v224, v136
    v_mfma_f32_32x32x16_bf16 v[96:111], a[144:147], v[48:51], v[96:111]
    ds_read_b64_tr_b16 a[180:181], v19 offset:4096
    v_add_f32 v234, v234, v230
    v_exp_f32 v225, v137
    v_mfma_f32_32x32x16_bf16 v[112:127], a[144:147], v[80:83], v[112:127]
    ds_read_b64_tr_b16 a[182:183], v19 offset:6144
    v_add_f32 v234, v234, v231
    v_cvt_pk_bf16_f32 v211, v230, v231
    v_exp_f32 v226, v138
    v_mfma_f32_32x32x16_bf16 v[96:111], a[148:151], v[52:55], v[96:111]
    ds_read_b64_tr_b16 a[184:185], v20 offset:0
    v_add_f32 v234, v234, v224
    v_exp_f32 v227, v139
    v_mfma_f32_32x32x16_bf16 v[112:127], a[148:151], v[84:87], v[112:127]
    ds_read_b64_tr_b16 a[186:187], v20 offset:2048
    v_add_f32 v234, v234, v225
    v_cvt_pk_bf16_f32 v212, v224, v225
    v_exp_f32 v228, v140
    v_mfma_f32_32x32x16_bf16 v[96:111], a[152:155], v[56:59], v[96:111]
    ds_read_b64_tr_b16 a[188:189], v20 offset:4096
    v_add_f32 v234, v234, v226
    v_exp_f32 v229, v141
    v_mfma_f32_32x32x16_bf16 v[112:127], a[152:155], v[88:91], v[112:127]
    ds_read_b64_tr_b16 a[190:191], v20 offset:6144
    v_add_f32 v234, v234, v227
    v_cvt_pk_bf16_f32 v213, v226, v227
    v_exp_f32 v230, v142
    v_mfma_f32_32x32x16_bf16 v[96:111], a[156:159], v[60:63], v[96:111]
    buffer_load_dword v31, v3, s[44:47], s101 offen offset:1024
    v_add_f32 v234, v234, v228
    v_exp_f32 v231, v143
    v_mfma_f32_32x32x16_bf16 v[112:127], a[156:159], v[92:95], v[112:127]
    buffer_load_dword v31, v3, s[52:55], s100 offen offset:1024
    v_add_f32 v234, v234, v229
    s_waitcnt lgkmcnt(6)
    v_mfma_f32_32x32x16_bf16 a[0:15], a[160:163], v[192:195], a[0:15]
    ds_read_b128 a[128:131], v9 offset:24576
    v_cvt_pk_bf16_f32 v214, v228, v229
    v_exp_f32 v224, v144
    v_mfma_f32_32x32x16_bf16 a[16:31], a[160:163], v[200:203], a[16:31]
    ds_read_b128 a[132:135], v10 offset:24576
    v_add_f32 v234, v234, v230
    v_exp_f32 v225, v145
    v_add_f32 v234, v234, v231
    v_mfma_f32_32x32x16_bf16 a[0:15], a[164:167], v[196:199], a[0:15]
    ds_read_b128 a[136:139], v11 offset:24576
    v_cvt_pk_bf16_f32 v215, v230, v231
    v_exp_f32 v226, v146
    v_mfma_f32_32x32x16_bf16 a[16:31], a[164:167], v[204:207], a[16:31]
    ds_read_b128 a[140:143], v12 offset:24576
    v_exp_f32 v227, v147
    v_add_f32 v235, v224, v225
    v_cvt_pk_bf16_f32 v216, v224, v225
    v_mfma_f32_32x32x16_bf16 a[32:47], a[168:171], v[192:195], a[32:47]
    ds_read_b128 a[144:147], v13 offset:24576
    v_exp_f32 v228, v148
    v_add_f32 v235, v235, v226
    v_mfma_f32_32x32x16_bf16 a[48:63], a[168:171], v[200:203], a[48:63]
    ds_read_b128 a[148:151], v14 offset:24576
    v_exp_f32 v229, v149
    v_add_f32 v235, v235, v227
    v_cvt_pk_bf16_f32 v217, v226, v227
    v_mfma_f32_32x32x16_bf16 a[32:47], a[172:175], v[196:199], a[32:47]
    ds_read_b128 a[152:155], v15 offset:24576
    v_exp_f32 v230, v150
    v_add_f32 v235, v235, v228
    v_mfma_f32_32x32x16_bf16 a[48:63], a[172:175], v[204:207], a[48:63]
    ds_read_b128 a[156:159], v16 offset:24576
    v_exp_f32 v231, v151
    v_add_f32 v235, v235, v229
    v_cvt_pk_bf16_f32 v218, v228, v229
    v_mfma_f32_32x32x16_bf16 a[64:79], a[176:179], v[192:195], a[64:79]
    v_exp_f32 v224, v152
    v_add_f32 v235, v235, v230
    v_exp_f32 v225, v153
    v_mfma_f32_32x32x16_bf16 a[80:95], a[176:179], v[200:203], a[80:95]
    v_add_f32 v235, v235, v231
    v_cvt_pk_bf16_f32 v219, v230, v231
    v_exp_f32 v226, v154
    s_waitcnt lgkmcnt(6)
    v_mfma_f32_32x32x16_bf16 a[64:79], a[180:183], v[196:199], a[64:79]
    v_add_f32 v235, v235, v224
    v_exp_f32 v227, v155
    v_add_f32 v235, v235, v225
    v_mfma_f32_32x32x16_bf16 a[80:95], a[180:183], v[204:207], a[80:95]
    v_cvt_pk_bf16_f32 v220, v224, v225
    v_exp_f32 v228, v156
    v_add_f32 v235, v235, v226
    v_mfma_f32_32x32x16_bf16 a[96:111], a[184:187], v[192:195], a[96:111]
    v_exp_f32 v229, v157
    v_add_f32 v235, v235, v227
    v_cvt_pk_bf16_f32 v221, v226, v227
    v_mfma_f32_32x32x16_bf16 a[112:127], a[184:187], v[200:203], a[112:127]
    v_exp_f32 v230, v158
    v_add_f32 v235, v235, v228
    v_exp_f32 v231, v159
    v_mfma_f32_32x32x16_bf16 a[96:111], a[188:191], v[196:199], a[96:111]
    v_add_f32 v235, v235, v229
    v_cvt_pk_bf16_f32 v222, v228, v229
    v_add_f32 v235, v235, v230
    v_add_f32 v235, v235, v231
    v_mfma_f32_32x32x16_bf16 a[112:127], a[188:191], v[204:207], a[112:127]
    v_cvt_pk_bf16_f32 v223, v230, v231
    v_max_f32 v236, v234, v235
    v_cmp_nge_f32 vcc, s95, v236
    s_cbranch_vccnz recurrent_scan__sliding_block_cached__glu_gated_glu__prompt_kernel_rs9
recurrent_scan__sliding_block_cached__glu_gated_glu__prompt_kernel_rb9:
    s_waitcnt vmcnt(19)
    s_waitcnt lgkmcnt(0)
    s_barrier
    v_mfma_f32_32x32x16_bf16 v[128:143], a[128:131], v[32:35], v[160:175]
    ds_read_b64_tr_b16 a[160:161], v17 offset:8192
    ds_read_b64_tr_b16 a[162:163], v17 offset:10240
    v_add_f32 v232, v232, v234
    v_add_f32 v233, v233, v235
    v_exp_f32 v224, v96
    v_mfma_f32_32x32x16_bf16 v[144:159], a[128:131], v[64:67], v[176:191]
    ds_read_b64_tr_b16 a[164:165], v17 offset:12288
    ds_read_b64_tr_b16 a[166:167], v17 offset:14336
    v_exp_f32 v225, v97
    v_exp_f32 v226, v98
    v_mfma_f32_32x32x16_bf16 v[128:143], a[132:135], v[36:39], v[128:143]
    ds_read_b64_tr_b16 a[168:169], v18 offset:8192
    v_exp_f32 v227, v99
    v_add_f32 v234, v224, v225
    v_mfma_f32_32x32x16_bf16 v[144:159], a[132:135], v[68:71], v[144:159]
    ds_read_b64_tr_b16 a[170:171], v18 offset:10240
    v_cvt_pk_bf16_f32 v192, v224, v225
    v_exp_f32 v228, v100
    v_add_f32 v234, v234, v226
    v_mfma_f32_32x32x16_bf16 v[128:143], a[136:139], v[40:43], v[128:143]
    ds_read_b64_tr_b16 a[172:173], v18 offset:12288
    v_exp_f32 v229, v101
    v_add_f32 v234, v234, v227
    v_cvt_pk_bf16_f32 v193, v226, v227
    v_mfma_f32_32x32x16_bf16 v[144:159], a[136:139], v[72:75], v[144:159]
    ds_read_b64_tr_b16 a[174:175], v18 offset:14336
    v_exp_f32 v230, v102
    v_add_f32 v234, v234, v228
    v_exp_f32 v231, v103
    v_mfma_f32_32x32x16_bf16 v[128:143], a[140:143], v[44:47], v[128:143]
    ds_read_b64_tr_b16 a[176:177], v19 offset:8192
    v_add_f32 v234, v234, v229
    v_cvt_pk_bf16_f32 v194, v228, v229
    v_mfma_f32_32x32x16_bf16 v[144:159], a[140:143], v[76:79], v[144:159]
    ds_read_b64_tr_b16 a[178:179], v19 offset:10240
    v_exp_f32 v224, v104
    v_add_f32 v234, v234, v230
    v_exp_f32 v225, v105
    v_mfma_f32_32x32x16_bf16 v[128:143], a[144:147], v[48:51], v[128:143]
    ds_read_b64_tr_b16 a[180:181], v19 offset:12288
    v_add_f32 v234, v234, v231
    v_cvt_pk_bf16_f32 v195, v230, v231
    v_exp_f32 v226, v106
    v_mfma_f32_32x32x16_bf16 v[144:159], a[144:147], v[80:83], v[144:159]
    ds_read_b64_tr_b16 a[182:183], v19 offset:14336
    v_add_f32 v234, v234, v224
    v_exp_f32 v227, v107
    v_mfma_f32_32x32x16_bf16 v[128:143], a[148:151], v[52:55], v[128:143]
    ds_read_b64_tr_b16 a[184:185], v20 offset:8192
    v_add_f32 v234, v234, v225
    v_cvt_pk_bf16_f32 v196, v224, v225
    v_exp_f32 v228, v108
    v_mfma_f32_32x32x16_bf16 v[144:159], a[148:151], v[84:87], v[144:159]
    ds_read_b64_tr_b16 a[186:187], v20 offset:10240
    v_add_f32 v234, v234, v226
    v_exp_f32 v229, v109
    v_mfma_f32_32x32x16_bf16 v[128:143], a[152:155], v[56:59], v[128:143]
    ds_read_b64_tr_b16 a[188:189], v20 offset:12288
    v_add_f32 v234, v234, v227
    v_cvt_pk_bf16_f32 v197, v226, v227
    v_exp_f32 v230, v110
    v_mfma_f32_32x32x16_bf16 v[144:159], a[152:155], v[88:91], v[144:159]
    ds_read_b64_tr_b16 a[190:191], v20 offset:14336
    v_add_f32 v234, v234, v228
    v_exp_f32 v231, v111
    v_add_f32 v234, v234, v229
    v_mfma_f32_32x32x16_bf16 v[128:143], a[156:159], v[60:63], v[128:143]
    s_add_u32 m0, s92, 114688
    s_add_u32 s94, s93, 114688
    s_nop 0
    v_cvt_pk_bf16_f32 v198, v228, v229
    v_mfma_f32_32x32x16_bf16 v[144:159], a[156:159], v[92:95], v[144:159]
    buffer_load_dwordx4 v29, s[68:71], s94 offen offset:0 lds
    v_exp_f32 v224, v112
    v_add_f32 v234, v234, v230
    s_waitcnt lgkmcnt(6)
    v_mfma_f32_32x32x16_bf16 a[0:15], a[160:163], v[208:211], a[0:15]
    ds_read_b128 a[128:131], v9 offset:32768
    v_exp_f32 v225, v113
    v_add_f32 v234, v234, v231
    v_mfma_f32_32x32x16_bf16 a[16:31], a[160:163], v[216:219], a[16:31]
    ds_read_b128 a[132:135], v10 offset:32768
    v_cvt_pk_bf16_f32 v199, v230, v231
    v_exp_f32 v226, v114
    v_mfma_f32_32x32x16_bf16 a[0:15], a[164:167], v[212:215], a[0:15]
    ds_read_b128 a[136:139], v11 offset:32768
    v_exp_f32 v227, v115
    v_add_f32 v235, v224, v225
    v_cvt_pk_bf16_f32 v200, v224, v225
    v_mfma_f32_32x32x16_bf16 a[16:31], a[164:167], v[220:223], a[16:31]
    ds_read_b128 a[140:143], v12 offset:32768
    v_exp_f32 v228, v116
    v_add_f32 v235, v235, v226
    v_exp_f32 v229, v117
    v_mfma_f32_32x32x16_bf16 a[32:47], a[168:171], v[208:211], a[32:47]
    ds_read_b128 a[144:147], v13 offset:32768
    v_add_f32 v235, v235, v227
    v_cvt_pk_bf16_f32 v201, v226, v227
    v_exp_f32 v230, v118
    v_mfma_f32_32x32x16_bf16 a[48:63], a[168:171], v[216:219], a[48:63]
    ds_read_b128 a[148:151], v14 offset:32768
    v_add_f32 v235, v235, v228
    v_exp_f32 v231, v119
    v_add_f32 v235, v235, v229
    v_mfma_f32_32x32x16_bf16 a[32:47], a[172:175], v[212:215], a[32:47]
    ds_read_b128 a[152:155], v15 offset:32768
    v_cvt_pk_bf16_f32 v202, v228, v229
    v_exp_f32 v224, v120
    v_add_f32 v235, v235, v230
    v_mfma_f32_32x32x16_bf16 a[48:63], a[172:175], v[220:223], a[48:63]
    ds_read_b128 a[156:159], v16 offset:32768
    v_exp_f32 v225, v121
    v_add_f32 v235, v235, v231
    v_cvt_pk_bf16_f32 v203, v230, v231
    v_mfma_f32_32x32x16_bf16 a[64:79], a[176:179], v[208:211], a[64:79]
    buffer_load_dwordx4 v29, s[68:71], s94 offen offset:1024 lds
    v_exp_f32 v226, v122
    v_mfma_f32_32x32x16_bf16 a[80:95], a[176:179], v[216:219], a[80:95]
    buffer_load_dwordx4 v29, s[68:71], s94 offen offset:2048 lds
    v_add_f32 v235, v235, v224
    v_exp_f32 v227, v123
    s_waitcnt lgkmcnt(6)
    v_mfma_f32_32x32x16_bf16 a[64:79], a[180:183], v[212:215], a[64:79]
    buffer_load_dwordx4 v29, s[68:71], s94 offen offset:3072 lds
    v_add_f32 v235, v235, v225
    v_cvt_pk_bf16_f32 v204, v224, v225
    v_mfma_f32_32x32x16_bf16 a[80:95], a[180:183], v[220:223], a[80:95]
    buffer_load_dword v31, v3, s[44:47], s101 offen offset:2048
    v_exp_f32 v228, v124
    v_add_f32 v235, v235, v226
    v_mfma_f32_32x32x16_bf16 a[96:111], a[184:187], v[208:211], a[96:111]
    buffer_load_dword v31, v3, s[52:55], s100 offen offset:2048
    v_exp_f32 v229, v125
    v_add_f32 v235, v235, v227
    v_mfma_f32_32x32x16_bf16 a[112:127], a[184:187], v[216:219], a[112:127]
    v_cvt_pk_bf16_f32 v205, v226, v227
    v_exp_f32 v230, v126
    v_add_f32 v235, v235, v228
    v_mfma_f32_32x32x16_bf16 a[96:111], a[188:191], v[212:215], a[96:111]
    v_exp_f32 v231, v127
    v_add_f32 v235, v235, v229
    v_cvt_pk_bf16_f32 v206, v228, v229
    v_add_f32 v235, v235, v230
    v_mfma_f32_32x32x16_bf16 a[112:127], a[188:191], v[220:223], a[112:127]
    v_add_f32 v235, v235, v231
    v_cvt_pk_bf16_f32 v207, v230, v231
    v_max_f32 v236, v234, v235
    v_cmp_nge_f32 vcc, s95, v236
    s_cbranch_vccnz recurrent_scan__sliding_block_cached__glu_gated_glu__prompt_kernel_rs10
recurrent_scan__sliding_block_cached__glu_gated_glu__prompt_kernel_rb10:
    s_waitcnt vmcnt(9)
    v_mfma_f32_32x32x16_bf16 v[96:111], a[128:131], v[32:35], v[160:175]
    ds_read_b64_tr_b16 a[160:161], v17 offset:16384
    ds_read_b64_tr_b16 a[162:163], v17 offset:18432
    v_add_f32 v232, v232, v234
    v_add_f32 v233, v233, v235
    v_exp_f32 v224, v128
    v_mfma_f32_32x32x16_bf16 v[112:127], a[128:131], v[64:67], v[176:191]
    ds_read_b64_tr_b16 a[164:165], v17 offset:20480
    ds_read_b64_tr_b16 a[166:167], v17 offset:22528
    v_exp_f32 v225, v129
    v_exp_f32 v226, v130
    v_mfma_f32_32x32x16_bf16 v[96:111], a[132:135], v[36:39], v[96:111]
    ds_read_b64_tr_b16 a[168:169], v18 offset:16384
    v_exp_f32 v227, v131
    v_add_f32 v234, v224, v225
    v_cvt_pk_bf16_f32 v208, v224, v225
    v_mfma_f32_32x32x16_bf16 v[112:127], a[132:135], v[68:71], v[112:127]
    ds_read_b64_tr_b16 a[170:171], v18 offset:18432
    v_exp_f32 v228, v132
    v_add_f32 v234, v234, v226
    v_exp_f32 v229, v133
    s_waitcnt lgkmcnt(6)
    v_mfma_f32_32x32x16_bf16 v[96:111], a[136:139], v[40:43], v[96:111]
    ds_read_b64_tr_b16 a[172:173], v18 offset:20480
    v_add_f32 v234, v234, v227
    v_cvt_pk_bf16_f32 v209, v226, v227
    v_exp_f32 v230, v134
    v_mfma_f32_32x32x16_bf16 v[112:127], a[136:139], v[72:75], v[112:127]
    ds_read_b64_tr_b16 a[174:175], v18 offset:22528
    v_add_f32 v234, v234, v228
    v_exp_f32 v231, v135
    v_add_f32 v234, v234, v229
    v_cvt_pk_bf16_f32 v210, v228, v229
    v_mfma_f32_32x32x16_bf16 v[96:111], a[140:143], v[44:47], v[96:111]
    ds_read_b64_tr_b16 a[176:177], v19 offset:16384
    v_exp_f32 v224, v136
    v_add_f32 v234, v234, v230
    v_exp_f32 v225, v137
    v_mfma_f32_32x32x16_bf16 v[112:127], a[140:143], v[76:79], v[112:127]
    ds_read_b64_tr_b16 a[178:179], v19 offset:18432
    v_add_f32 v234, v234, v231
    v_cvt_pk_bf16_f32 v211, v230, v231
    v_exp_f32 v226, v138
    v_add_f32 v234, v234, v224
    v_mfma_f32_32x32x16_bf16 v[96:111], a[144:147], v[48:51], v[96:111]
    ds_read_b64_tr_b16 a[180:181], v19 offset:20480
    v_exp_f32 v227, v139
    v_add_f32 v234, v234, v225
    v_cvt_pk_bf16_f32 v212, v224, v225
    v_mfma_f32_32x32x16_bf16 v[112:127], a[144:147], v[80:83], v[112:127]
    ds_read_b64_tr_b16 a[182:183], v19 offset:22528
    v_exp_f32 v228, v140
    v_add_f32 v234, v234, v226
    v_exp_f32 v229, v141
    v_mfma_f32_32x32x16_bf16 v[96:111], a[148:151], v[52:55], v[96:111]
    ds_read_b64_tr_b16 a[184:185], v20 offset:16384
    v_add_f32 v234, v234, v227
    v_cvt_pk_bf16_f32 v213, v226, v227
    v_exp_f32 v230, v142
    v_add_f32 v234, v234, v228
    v_mfma_f32_32x32x16_bf16 v[112:127], a[148:151], v[84:87], v[112:127]
    ds_read_b64_tr_b16 a[186:187], v20 offset:18432
    v_exp_f32 v231, v143
    v_add_f32 v234, v234, v229
    v_cvt_pk_bf16_f32 v214, v228, v229
    v_mfma_f32_32x32x16_bf16 v[96:111], a[152:155], v[56:59], v[96:111]
    ds_read_b64_tr_b16 a[188:189], v20 offset:20480
    v_exp_f32 v224, v144
    v_add_f32 v234, v234, v230
    v_exp_f32 v225, v145
    v_mfma_f32_32x32x16_bf16 v[112:127], a[152:155], v[88:91], v[112:127]
    ds_read_b64_tr_b16 a[190:191], v20 offset:22528
    v_add_f32 v234, v234, v231
    v_cvt_pk_bf16_f32 v215, v230, v231
    v_exp_f32 v226, v146
    v_mfma_f32_32x32x16_bf16 v[96:111], a[156:159], v[60:63], v[96:111]
    buffer_load_dword v31, v3, s[52:55], s100 offen offset:3072
    v_exp_f32 v227, v147
    v_add_f32 v235, v224, v225
    v_cvt_pk_bf16_f32 v216, v224, v225
    v_mfma_f32_32x32x16_bf16 v[112:127], a[156:159], v[92:95], v[112:127]
    v_and_b32 v1, 15, v0
    v_lshrrev_b32 v253, 5, v0
    v_xor_b32 v253, v253, v1
    v_exp_f32 v228, v148
    v_add_f32 v235, v235, v226
    s_waitcnt lgkmcnt(6)
    v_mfma_f32_32x32x16_bf16 a[0:15], a[160:163], v[192:195], a[0:15]
    ds_read_b128 a[128:131], v9 offset:40960
    v_exp_f32 v229, v149
    v_add_f32 v235, v235, v227
    v_cvt_pk_bf16_f32 v217, v226, v227
    v_mfma_f32_32x32x16_bf16 a[16:31], a[160:163], v[200:203], a[16:31]
    ds_read_b128 a[132:135], v10 offset:40960
    v_exp_f32 v230, v150
    v_add_f32 v235, v235, v228
    v_exp_f32 v231, v151
    v_mfma_f32_32x32x16_bf16 a[0:15], a[164:167], v[196:199], a[0:15]
    ds_read_b128 a[136:139], v11 offset:40960
    v_add_f32 v235, v235, v229
    v_cvt_pk_bf16_f32 v218, v228, v229
    v_exp_f32 v224, v152
    v_add_f32 v235, v235, v230
    v_mfma_f32_32x32x16_bf16 a[16:31], a[164:167], v[204:207], a[16:31]
    ds_read_b128 a[140:143], v12 offset:40960
    v_exp_f32 v225, v153
    v_add_f32 v235, v235, v231
    v_cvt_pk_bf16_f32 v219, v230, v231
    v_mfma_f32_32x32x16_bf16 a[32:47], a[168:171], v[192:195], a[32:47]
    ds_read_b128 a[144:147], v13 offset:40960
    v_exp_f32 v226, v154
    v_add_f32 v235, v235, v224
    v_exp_f32 v227, v155
    v_mfma_f32_32x32x16_bf16 a[48:63], a[168:171], v[200:203], a[48:63]
    ds_read_b128 a[148:151], v14 offset:40960
    v_add_f32 v235, v235, v225
    v_cvt_pk_bf16_f32 v220, v224, v225
    v_exp_f32 v228, v156
    v_mfma_f32_32x32x16_bf16 a[32:47], a[172:175], v[196:199], a[32:47]
    ds_read_b128 a[152:155], v15 offset:40960
    v_add_f32 v235, v235, v226
    v_exp_f32 v229, v157
    v_add_f32 v235, v235, v227
    v_cvt_pk_bf16_f32 v221, v226, v227
    v_mfma_f32_32x32x16_bf16 a[48:63], a[172:175], v[204:207], a[48:63]
    ds_read_b128 a[156:159], v16 offset:40960
    v_exp_f32 v230, v158
    v_add_f32 v235, v235, v228
    v_exp_f32 v231, v159
    v_mfma_f32_32x32x16_bf16 a[64:79], a[176:179], v[192:195], a[64:79]
    v_bfe_u32 v254, v0, 4, 1
    v_lshlrev_b32 v254, 3, v254
    v_lshl_add_u32 v254, v1, 8, v254
    v_add_f32 v235, v235, v229
    v_cvt_pk_bf16_f32 v222, v228, v229
    v_mfma_f32_32x32x16_bf16 a[80:95], a[176:179], v[200:203], a[80:95]
    v_add_u32 v254, s4, v254
    v_xor_b32 v30, 0, v253
    v_lshl_add_u32 v30, v30, 4, v254
    v_add_f32 v235, v235, v230
    v_add_f32 v235, v235, v231
    v_cvt_pk_bf16_f32 v223, v230, v231
    s_waitcnt lgkmcnt(6)
    v_mfma_f32_32x32x16_bf16 a[64:79], a[180:183], v[196:199], a[64:79]
    ds_read_b64 a[224:225], v30
    ds_read_b64 a[226:227], v30 offset:4096
    v_max_f32 v236, v234, v235
    v_cmp_nge_f32 vcc, s95, v236
    v_mfma_f32_32x32x16_bf16 a[80:95], a[180:183], v[204:207], a[80:95]
    v_xor_b32 v30, 2, v253
    v_lshl_add_u32 v30, v30, 4, v254
    ds_read_b64 a[228:229], v30
    v_mfma_f32_32x32x16_bf16 a[96:111], a[184:187], v[192:195], a[96:111]
    ds_read_b64 a[230:231], v30 offset:4096
    v_xor_b32 v30, 4, v253
    v_lshl_add_u32 v30, v30, 4, v254
    v_mfma_f32_32x32x16_bf16 a[112:127], a[184:187], v[200:203], a[112:127]
    ds_read_b64 a[232:233], v30
    ds_read_b64 a[234:235], v30 offset:4096
    v_xor_b32 v30, 6, v253
    v_mfma_f32_32x32x16_bf16 a[96:111], a[188:191], v[196:199], a[96:111]
    v_lshl_add_u32 v30, v30, 4, v254
    ds_read_b64 a[236:237], v30
    ds_read_b64 a[238:239], v30 offset:4096
    v_mfma_f32_32x32x16_bf16 a[112:127], a[188:191], v[204:207], a[112:127]
    v_xor_b32 v30, 8, v253
    v_lshl_add_u32 v30, v30, 4, v254
    ds_read_b64 a[240:241], v30
    ds_read_b64 a[242:243], v30 offset:4096
    v_xor_b32 v30, 10, v253
    v_lshl_add_u32 v30, v30, 4, v254
    ds_read_b64 a[244:245], v30
    ds_read_b64 a[246:247], v30 offset:4096
    v_xor_b32 v30, 12, v253
    v_lshl_add_u32 v30, v30, 4, v254
    ds_read_b64 a[248:249], v30
    ds_read_b64 a[250:251], v30 offset:4096
    v_xor_b32 v30, 14, v253
    v_lshl_add_u32 v30, v30, 4, v254
    ds_read_b64 a[252:253], v30
    ds_read_b64 a[254:255], v30 offset:4096
    s_cbranch_vccnz recurrent_scan__sliding_block_cached__glu_gated_glu__prompt_kernel_rs11
recurrent_scan__sliding_block_cached__glu_gated_glu__prompt_kernel_rb11:
    s_waitcnt lgkmcnt(0)
    s_barrier
    v_mfma_f32_32x32x16_bf16 v[128:143], a[128:131], v[32:35], v[160:175]
    ds_read_b64_tr_b16 a[160:161], v17 offset:24576
    ds_read_b64_tr_b16 a[162:163], v17 offset:26624
    v_add_f32 v232, v232, v234
    v_add_f32 v233, v233, v235
    v_exp_f32 v224, v96
    v_mfma_f32_32x32x16_bf16 v[144:159], a[128:131], v[64:67], v[176:191]
    ds_read_b64_tr_b16 a[164:165], v17 offset:28672
    ds_read_b64_tr_b16 a[166:167], v17 offset:30720
    v_exp_f32 v225, v97
    v_exp_f32 v226, v98
    v_mfma_f32_32x32x16_bf16 v[128:143], a[132:135], v[36:39], v[128:143]
    ds_read_b64_tr_b16 a[168:169], v18 offset:24576
    v_exp_f32 v227, v99
    v_add_f32 v234, v224, v225
    v_cvt_pk_bf16_f32 v192, v224, v225
    v_mfma_f32_32x32x16_bf16 v[144:159], a[132:135], v[68:71], v[144:159]
    ds_read_b64_tr_b16 a[170:171], v18 offset:26624
    v_exp_f32 v228, v100
    v_add_f32 v234, v234, v226
    v_exp_f32 v229, v101
    v_mfma_f32_32x32x16_bf16 v[128:143], a[136:139], v[40:43], v[128:143]
    ds_read_b64_tr_b16 a[172:173], v18 offset:28672
    v_add_f32 v234, v234, v227
    v_cvt_pk_bf16_f32 v193, v226, v227
    v_exp_f32 v230, v102
    v_mfma_f32_32x32x16_bf16 v[144:159], a[136:139], v[72:75], v[144:159]
    ds_read_b64_tr_b16 a[174:175], v18 offset:30720
    v_add_f32 v234, v234, v228
    v_exp_f32 v231, v103
    v_add_f32 v234, v234, v229
    v_mfma_f32_32x32x16_bf16 v[128:143], a[140:143], v[44:47], v[128:143]
    ds_read_b64_tr_b16 a[176:177], v19 offset:24576
    v_cvt_pk_bf16_f32 v194, v228, v229
    v_exp_f32 v224, v104
    v_add_f32 v234, v234, v230
    v_mfma_f32_32x32x16_bf16 v[144:159], a[140:143], v[76:79], v[144:159]
    ds_read_b64_tr_b16 a[178:179], v19 offset:26624
    v_exp_f32 v225, v105
    v_add_f32 v234, v234, v231
    v_cvt_pk_bf16_f32 v195, v230, v231
    v_mfma_f32_32x32x16_bf16 v[128:143], a[144:147], v[48:51], v[128:143]
    ds_read_b64_tr_b16 a[180:181], v19 offset:28672
    v_exp_f32 v226, v106
    v_add_f32 v234, v234, v224
    v_exp_f32 v227, v107
    v_mfma_f32_32x32x16_bf16 v[144:159], a[144:147], v[80:83], v[144:159]
    ds_read_b64_tr_b16 a[182:183], v19 offset:30720
    v_add_f32 v234, v234, v225
    v_cvt_pk_bf16_f32 v196, v224, v225
    v_exp_f32 v228, v108
    v_mfma_f32_32x32x16_bf16 v[128:143], a[148:151], v[52:55], v[128:143]
    ds_read_b64_tr_b16 a[184:185], v20 offset:24576
    v_add_f32 v234, v234, v226
    v_exp_f32 v229, v109
    v_mfma_f32_32x32x16_bf16 v[144:159], a[148:151], v[84:87], v[144:159]
    ds_read_b64_tr_b16 a[186:187], v20 offset:26624
    v_add_f32 v234, v234, v227
    v_cvt_pk_bf16_f32 v197, v226, v227
    v_exp_f32 v230, v110
    v_mfma_f32_32x32x16_bf16 v[128:143], a[152:155], v[56:59], v[128:143]
    ds_read_b64_tr_b16 a[188:189], v20 offset:28672
    v_add_f32 v234, v234, v228
    v_exp_f32 v231, v111
    v_add_f32 v234, v234, v229
    v_mfma_f32_32x32x16_bf16 v[144:159], a[152:155], v[88:91], v[144:159]
    ds_read_b64_tr_b16 a[190:191], v20 offset:30720
    v_cvt_pk_bf16_f32 v198, v228, v229
    v_exp_f32 v224, v112
    v_add_f32 v234, v234, v230
    v_mfma_f32_32x32x16_bf16 v[128:143], a[156:159], v[60:63], v[128:143]
    s_add_u32 m0, s10, 0
    s_lshl_b32 s12, s80, 6
    s_add_u32 s12, s12, s8
    v_exp_f32 v225, v113
    v_add_f32 v234, v234, v231
    v_mfma_f32_32x32x16_bf16 v[144:159], a[156:159], v[92:95], v[144:159]
    s_nop 0
    buffer_load_dwordx4 v246, s[44:47], s12 offen offset:0 lds
    v_cvt_pk_bf16_f32 v199, v230, v231
    s_waitcnt lgkmcnt(6)
    v_mfma_f32_32x32x16_bf16 a[0:15], a[160:163], v[208:211], a[0:15]
    ds_read_b128 a[128:131], v9 offset:49152
    v_exp_f32 v226, v114
    v_exp_f32 v227, v115
    v_mfma_f32_32x32x16_bf16 a[16:31], a[160:163], v[216:219], a[16:31]
    ds_read_b128 a[132:135], v10 offset:49152
    v_add_f32 v235, v224, v225
    v_cvt_pk_bf16_f32 v200, v224, v225
    v_exp_f32 v228, v116
    v_mfma_f32_32x32x16_bf16 a[0:15], a[164:167], v[212:215], a[0:15]
    ds_read_b128 a[136:139], v11 offset:49152
    v_add_f32 v235, v235, v226
    v_exp_f32 v229, v117
    v_add_f32 v235, v235, v227
    v_mfma_f32_32x32x16_bf16 a[16:31], a[164:167], v[220:223], a[16:31]
    ds_read_b128 a[140:143], v12 offset:49152
    v_cvt_pk_bf16_f32 v201, v226, v227
    v_exp_f32 v230, v118
    v_add_f32 v235, v235, v228
    v_mfma_f32_32x32x16_bf16 a[32:47], a[168:171], v[208:211], a[32:47]
    ds_read_b128 a[144:147], v13 offset:49152
    v_exp_f32 v231, v119
    v_add_f32 v235, v235, v229
    v_cvt_pk_bf16_f32 v202, v228, v229
    v_mfma_f32_32x32x16_bf16 a[48:63], a[168:171], v[216:219], a[48:63]
    ds_read_b128 a[148:151], v14 offset:49152
    v_exp_f32 v224, v120
    v_add_f32 v235, v235, v230
    v_exp_f32 v225, v121
    v_mfma_f32_32x32x16_bf16 a[32:47], a[172:175], v[212:215], a[32:47]
    ds_read_b128 a[152:155], v15 offset:49152
    v_add_f32 v235, v235, v231
    v_cvt_pk_bf16_f32 v203, v230, v231
    v_exp_f32 v226, v122
    v_mfma_f32_32x32x16_bf16 a[48:63], a[172:175], v[220:223], a[48:63]
    ds_read_b128 a[156:159], v16 offset:49152
    v_add_f32 v235, v235, v224
    v_exp_f32 v227, v123
    v_add_f32 v235, v235, v225
    v_mfma_f32_32x32x16_bf16 a[64:79], a[176:179], v[208:211], a[64:79]
    buffer_load_dwordx4 v247, s[44:47], s12 offen offset:1024 lds
    v_cvt_pk_bf16_f32 v204, v224, v225
    v_exp_f32 v228, v124
    v_mfma_f32_32x32x16_bf16 a[80:95], a[176:179], v[216:219], a[80:95]
    buffer_load_dwordx4 v248, s[44:47], s12 offen offset:2048 lds
    v_add_f32 v235, v235, v226
    v_exp_f32 v229, v125
    v_add_f32 v235, v235, v227
    s_waitcnt lgkmcnt(6)
    v_mfma_f32_32x32x16_bf16 a[64:79], a[180:183], v[212:215], a[64:79]
    buffer_load_dwordx4 v249, s[44:47], s12 offen offset:3072 lds
    v_cvt_pk_bf16_f32 v205, v226, v227
    v_mfma_f32_32x32x16_bf16 a[80:95], a[180:183], v[220:223], a[80:95]
    s_add_u32 m0, s10, 8192
    s_lshl_b32 s12, s81, 6
    s_add_u32 s12, s12, s8
    v_exp_f32 v230, v126
    v_add_f32 v235, v235, v228
    v_mfma_f32_32x32x16_bf16 a[96:111], a[184:187], v[208:211], a[96:111]
    s_nop 0
    buffer_load_dwordx4 v246, s[44:47], s12 offen offset:0 lds
    v_exp_f32 v231, v127
    v_add_f32 v235, v235, v229
    v_mfma_f32_32x32x16_bf16 a[112:127], a[184:187], v[216:219], a[112:127]
    buffer_load_dwordx4 v247, s[44:47], s12 offen offset:1024 lds
    v_cvt_pk_bf16_f32 v206, v228, v229
    v_add_f32 v235, v235, v230
    v_add_f32 v235, v235, v231
    v_mfma_f32_32x32x16_bf16 a[96:111], a[188:191], v[212:215], a[96:111]
    buffer_load_dwordx4 v248, s[44:47], s12 offen offset:2048 lds
    v_cvt_pk_bf16_f32 v207, v230, v231
    v_max_f32 v236, v234, v235
    v_cmp_nge_f32 vcc, s95, v236
    v_mfma_f32_32x32x16_bf16 a[112:127], a[188:191], v[220:223], a[112:127]
    buffer_load_dwordx4 v249, s[44:47], s12 offen offset:3072 lds
    buffer_load_dwordx2 v[22:23], v24, s[48:51], s91 offen sc0 sc1
    s_cbranch_vccnz recurrent_scan__sliding_block_cached__glu_gated_glu__prompt_kernel_rs12
recurrent_scan__sliding_block_cached__glu_gated_glu__prompt_kernel_rb12:
    v_mfma_f32_32x32x16_bf16 v[96:111], a[128:131], v[32:35], v[160:175]
    ds_read_b64_tr_b16 a[160:161], v17 offset:32768
    ds_read_b64_tr_b16 a[162:163], v17 offset:34816
    v_add_f32 v232, v232, v234
    v_add_f32 v233, v233, v235
    v_exp_f32 v224, v128
    v_mfma_f32_32x32x16_bf16 v[112:127], a[128:131], v[64:67], v[176:191]
    ds_read_b64_tr_b16 a[164:165], v17 offset:36864
    ds_read_b64_tr_b16 a[166:167], v17 offset:38912
    v_exp_f32 v225, v129
    v_exp_f32 v226, v130
    v_mfma_f32_32x32x16_bf16 v[96:111], a[132:135], v[36:39], v[96:111]
    ds_read_b64_tr_b16 a[168:169], v18 offset:32768
    v_exp_f32 v227, v131
    v_add_f32 v234, v224, v225
    v_cvt_pk_bf16_f32 v208, v224, v225
    v_mfma_f32_32x32x16_bf16 v[112:127], a[132:135], v[68:71], v[112:127]
    ds_read_b64_tr_b16 a[170:171], v18 offset:34816
    v_exp_f32 v228, v132
    v_add_f32 v234, v234, v226
    v_exp_f32 v229, v133
    s_waitcnt lgkmcnt(6)
    v_mfma_f32_32x32x16_bf16 v[96:111], a[136:139], v[40:43], v[96:111]
    ds_read_b64_tr_b16 a[172:173], v18 offset:36864
    v_add_f32 v234, v234, v227
    v_cvt_pk_bf16_f32 v209, v226, v227
    v_mfma_f32_32x32x16_bf16 v[112:127], a[136:139], v[72:75], v[112:127]
    ds_read_b64_tr_b16 a[174:175], v18 offset:38912
    v_exp_f32 v230, v134
    v_add_f32 v234, v234, v228
    v_exp_f32 v231, v135
    v_mfma_f32_32x32x16_bf16 v[96:111], a[140:143], v[44:47], v[96:111]
    ds_read_b64_tr_b16 a[176:177], v19 offset:32768
    v_add_f32 v234, v234, v229
    v_cvt_pk_bf16_f32 v210, v228, v229
    v_exp_f32 v224, v136
    v_mfma_f32_32x32x16_bf16 v[112:127], a[140:143], v[76:79], v[112:127]
    ds_read_b64_tr_b16 a[178:179], v19 offset:34816
    v_add_f32 v234, v234, v230
    v_exp_f32 v225, v137
    v_add_f32 v234, v234, v231
    v_mfma_f32_32x32x16_bf16 v[96:111], a[144:147], v[48:51], v[96:111]
    ds_read_b64_tr_b16 a[180:181], v19 offset:36864
    v_cvt_pk_bf16_f32 v211, v230, v231
    v_exp_f32 v226, v138
    v_add_f32 v234, v234, v224
    v_mfma_f32_32x32x16_bf16 v[112:127], a[144:147], v[80:83], v[112:127]
    ds_read_b64_tr_b16 a[182:183], v19 offset:38912
    v_exp_f32 v227, v139
    v_add_f32 v234, v234, v225
    v_cvt_pk_bf16_f32 v212, v224, v225
    v_mfma_f32_32x32x16_bf16 v[96:111], a[148:151], v[52:55], v[96:111]
    ds_read_b64_tr_b16 a[184:185], v20 offset:32768
    v_exp_f32 v228, v140
    v_add_f32 v234, v234, v226
    v_exp_f32 v229, v141
    v_mfma_f32_32x32x16_bf16 v[112:127], a[148:151], v[84:87], v[112:127]
    ds_read_b64_tr_b16 a[186:187], v20 offset:34816
    v_add_f32 v234, v234, v227
    v_cvt_pk_bf16_f32 v213, v226, v227
    v_exp_f32 v230, v142
    v_mfma_f32_32x32x16_bf16 v[96:111], a[152:155], v[56:59], v[96:111]
    ds_read_b64_tr_b16 a[188:189], v20 offset:36864
    v_add_f32 v234, v234, v228
    v_exp_f32 v231, v143
    v_add_f32 v234, v234, v229
    v_mfma_f32_32x32x16_bf16 v[112:127], a[152:155], v[88:91], v[112:127]
    ds_read_b64_tr_b16 a[190:191], v20 offset:38912
    v_cvt_pk_bf16_f32 v214, v228, v229
    v_exp_f32 v224, v144
    v_add_f32 v234, v234, v230
    v_mfma_f32_32x32x16_bf16 v[96:111], a[156:159], v[60:63], v[96:111]
    s_add_u32 m0, s10, 16384
    s_lshl_b32 s12, s82, 6
    s_add_u32 s12, s12, s8
    v_exp_f32 v225, v145
    v_mfma_f32_32x32x16_bf16 v[112:127], a[156:159], v[92:95], v[112:127]
    s_nop 0
    buffer_load_dwordx4 v246, s[44:47], s12 offen offset:0 lds
    v_add_f32 v234, v234, v231
    v_cvt_pk_bf16_f32 v215, v230, v231
    s_waitcnt lgkmcnt(6)
    v_mfma_f32_32x32x16_bf16 a[0:15], a[160:163], v[192:195], a[0:15]
    ds_read_b128 a[128:131], v9 offset:57344
    v_exp_f32 v226, v146
    v_exp_f32 v227, v147
    v_mfma_f32_32x32x16_bf16 a[16:31], a[160:163], v[200:203], a[16:31]
    ds_read_b128 a[132:135], v10 offset:57344
    v_add_f32 v235, v224, v225
    v_cvt_pk_bf16_f32 v216, v224, v225
    v_exp_f32 v228, v148
    v_mfma_f32_32x32x16_bf16 a[0:15], a[164:167], v[196:199], a[0:15]
    ds_read_b128 a[136:139], v11 offset:57344
    v_add_f32 v235, v235, v226
    v_exp_f32 v229, v149
    v_add_f32 v235, v235, v227
    v_mfma_f32_32x32x16_bf16 a[16:31], a[164:167], v[204:207], a[16:31]
    ds_read_b128 a[140:143], v12 offset:57344
    v_cvt_pk_bf16_f32 v217, v226, v227
    v_exp_f32 v230, v150
    v_add_f32 v235, v235, v228
    v_mfma_f32_32x32x16_bf16 a[32:47], a[168:171], v[192:195], a[32:47]
    ds_read_b128 a[144:147], v13 offset:57344
    v_exp_f32 v231, v151
    v_add_f32 v235, v235, v229
    v_cvt_pk_bf16_f32 v218, v228, v229
    v_mfma_f32_32x32x16_bf16 a[48:63], a[168:171], v[200:203], a[48:63]
    ds_read_b128 a[148:151], v14 offset:57344
    v_exp_f32 v224, v152
    v_add_f32 v235, v235, v230
    v_exp_f32 v225, v153
    v_mfma_f32_32x32x16_bf16 a[32:47], a[172:175], v[196:199], a[32:47]
    ds_read_b128 a[152:155], v15 offset:57344
    v_add_f32 v235, v235, v231
    v_cvt_pk_bf16_f32 v219, v230, v231
    v_exp_f32 v226, v154
    v_mfma_f32_32x32x16_bf16 a[48:63], a[172:175], v[204:207], a[48:63]
    ds_read_b128 a[156:159], v16 offset:57344
    v_add_f32 v235, v235, v224
    v_exp_f32 v227, v155
    v_mfma_f32_32x32x16_bf16 a[64:79], a[176:179], v[192:195], a[64:79]
    buffer_load_dwordx4 v247, s[44:47], s12 offen offset:1024 lds
    v_add_f32 v235, v235, v225
    v_cvt_pk_bf16_f32 v220, v224, v225
    v_mfma_f32_32x32x16_bf16 a[80:95], a[176:179], v[200:203], a[80:95]
    buffer_load_dwordx4 v248, s[44:47], s12 offen offset:2048 lds
    v_exp_f32 v228, v156
    v_add_f32 v235, v235, v226
    s_waitcnt lgkmcnt(6)
    v_mfma_f32_32x32x16_bf16 a[64:79], a[180:183], v[196:199], a[64:79]
    buffer_load_dwordx4 v249, s[44:47], s12 offen offset:3072 lds
    v_exp_f32 v229, v157
    v_add_f32 v235, v235, v227
    v_mfma_f32_32x32x16_bf16 a[80:95], a[180:183], v[204:207], a[80:95]
    s_add_u32 m0, s10, 24576
    s_lshl_b32 s12, s83, 6
    s_add_u32 s12, s12, s8
    v_cvt_pk_bf16_f32 v221, v226, v227
    v_mfma_f32_32x32x16_bf16 a[96:111], a[184:187], v[192:195], a[96:111]
    s_nop 0
    buffer_load_dwordx4 v246, s[44:47], s12 offen offset:0 lds
    v_exp_f32 v230, v158
    v_add_f32 v235, v235, v228
    v_mfma_f32_32x32x16_bf16 a[112:127], a[184:187], v[200:203], a[112:127]
    buffer_load_dwordx4 v247, s[44:47], s12 offen offset:1024 lds
    v_exp_f32 v231, v159
    v_add_f32 v235, v235, v229
    v_mfma_f32_32x32x16_bf16 a[96:111], a[188:191], v[196:199], a[96:111]
    buffer_load_dwordx4 v248, s[44:47], s12 offen offset:2048 lds
    v_cvt_pk_bf16_f32 v222, v228, v229
    v_add_f32 v235, v235, v230
    v_add_f32 v235, v235, v231
    v_mfma_f32_32x32x16_bf16 a[112:127], a[188:191], v[204:207], a[112:127]
    buffer_load_dwordx4 v249, s[44:47], s12 offen offset:3072 lds
    v_cvt_pk_bf16_f32 v223, v230, v231
    v_max_f32 v236, v234, v235
    v_cmp_nge_f32 vcc, s95, v236
    s_cbranch_vccnz recurrent_scan__sliding_block_cached__glu_gated_glu__prompt_kernel_rs13
recurrent_scan__sliding_block_cached__glu_gated_glu__prompt_kernel_rb13:
    s_waitcnt vmcnt(20)
    s_waitcnt lgkmcnt(0)
    s_barrier
    s_waitcnt vmcnt(8)
    v_cmp_ne_u64 vcc, s[98:99], v[22:23]
    s_cbranch_vccnz recurrent_scan__sliding_block_cached__glu_gated_glu__prompt_kernel_spinH
recurrent_scan__sliding_block_cached__glu_gated_glu__prompt_kernel_okH:
    v_mfma_f32_32x32x16_bf16 v[128:143], a[128:131], v[32:35], v[160:175]
    ds_read_b64_tr_b16 a[160:161], v17 offset:40960
    ds_read_b64_tr_b16 a[162:163], v17 offset:43008
    v_add_f32 v232, v232, v234
    v_add_f32 v233, v233, v235
    v_exp_f32 v224, v96
    v_mfma_f32_32x32x16_bf16 v[144:159], a[128:131], v[64:67], v[176:191]
    ds_read_b64_tr_b16 a[164:165], v17 offset:45056
    ds_read_b64_tr_b16 a[166:167], v17 offset:47104
    v_exp_f32 v225, v97
    v_exp_f32 v226, v98
    v_mfma_f32_32x32x16_bf16 v[128:143], a[132:135], v[36:39], v[128:143]
    ds_read_b64_tr_b16 a[168:169], v18 offset:40960
    v_exp_f32 v227, v99
    v_add_f32 v234, v224, v225
    v_cvt_pk_bf16_f32 v192, v224, v225
    v_mfma_f32_32x32x16_bf16 v[144:159], a[132:135], v[68:71], v[144:159]
    ds_read_b64_tr_b16 a[170:171], v18 offset:43008
    v_exp_f32 v228, v100
    v_add_f32 v234, v234, v226
    v_exp_f32 v229, v101
    v_mfma_f32_32x32x16_bf16 v[128:143], a[136:139], v[40:43], v[128:143]
    ds_read_b64_tr_b16 a[172:173], v18 offset:45056
    v_add_f32 v234, v234, v227
    v_cvt_pk_bf16_f32 v193, v226, v227
    v_exp_f32 v230, v102
    v_mfma_f32_32x32x16_bf16 v[144:159], a[136:139], v[72:75], v[144:159]
    ds_read_b64_tr_b16 a[174:175], v18 offset:47104
    v_add_f32 v234, v234, v228
    v_exp_f32 v231, v103
    v_add_f32 v234, v234, v229
    v_mfma_f32_32x32x16_bf16 v[128:143], a[140:143], v[44:47], v[128:143]
    ds_read_b64_tr_b16 a[176:177], v19 offset:40960
    v_cvt_pk_bf16_f32 v194, v228, v229
    v_exp_f32 v224, v104
    v_add_f32 v234, v234, v230
    v_mfma_f32_32x32x16_bf16 v[144:159], a[140:143], v[76:79], v[144:159]
    ds_read_b64_tr_b16 a[178:179], v19 offset:43008
    v_exp_f32 v225, v105
    v_add_f32 v234, v234, v231
    v_cvt_pk_bf16_f32 v195, v230, v231
    v_mfma_f32_32x32x16_bf16 v[128:143], a[144:147], v[48:51], v[128:143]
    ds_read_b64_tr_b16 a[180:181], v19 offset:45056
    v_exp_f32 v226, v106
    v_add_f32 v234, v234, v224
    v_exp_f32 v227, v107
    v_mfma_f32_32x32x16_bf16 v[144:159], a[144:147], v[80:83], v[144:159]
    ds_read_b64_tr_b16 a[182:183], v19 offset:47104
    v_add_f32 v234, v234, v225
    v_cvt_pk_bf16_f32 v196, v224, v225
    v_exp_f32 v228, v108
    v_mfma_f32_32x32x16_bf16 v[128:143], a[148:151], v[52:55], v[128:143]
    ds_read_b64_tr_b16 a[184:185], v20 offset:40960
    v_add_f32 v234, v234, v226
    v_exp_f32 v229, v109
    v_add_f32 v234, v234, v227
    v_mfma_f32_32x32x16_bf16 v[144:159], a[148:151], v[84:87], v[144:159]
    ds_read_b64_tr_b16 a[186:187], v20 offset:43008
    v_cvt_pk_bf16_f32 v197, v226, v227
    v_exp_f32 v230, v110
    v_add_f32 v234, v234, v228
    v_mfma_f32_32x32x16_bf16 v[128:143], a[152:155], v[56:59], v[128:143]
    ds_read_b64_tr_b16 a[188:189], v20 offset:45056
    v_exp_f32 v231, v111
    v_add_f32 v234, v234, v229
    v_cvt_pk_bf16_f32 v198, v228, v229
    v_mfma_f32_32x32x16_bf16 v[144:159], a[152:155], v[88:91], v[144:159]
    ds_read_b64_tr_b16 a[190:191], v20 offset:47104
    v_exp_f32 v224, v112
    v_add_f32 v234, v234, v230
    v_exp_f32 v225, v113
    v_mfma_f32_32x32x16_bf16 v[128:143], a[156:159], v[60:63], v[128:143]
    s_add_u32 s13, s80, s9
    s_nop 0
    buffer_load_dwordx4 a[192:195], v5, s[40:43], s13 offen sc0 sc1
    v_add_f32 v234, v234, v231
    v_mfma_f32_32x32x16_bf16 v[144:159], a[156:159], v[92:95], v[144:159]
    buffer_load_dwordx4 a[196:199], v6, s[40:43], s13 offen sc0 sc1
    v_cvt_pk_bf16_f32 v199, v230, v231
    v_exp_f32 v226, v114
    s_waitcnt lgkmcnt(6)
    v_mfma_f32_32x32x16_bf16 a[0:15], a[160:163], v[208:211], a[0:15]
    buffer_load_dwordx4 a[200:203], v7, s[40:43], s13 offen sc0 sc1
    v_exp_f32 v227, v115
    v_add_f32 v235, v224, v225
    v_mfma_f32_32x32x16_bf16 a[16:31], a[160:163], v[216:219], a[16:31]
    ds_read_b64_tr_b16 a[160:161], v17 offset:49152
    v_cvt_pk_bf16_f32 v200, v224, v225
    v_exp_f32 v228, v116
    v_add_f32 v235, v235, v226
    v_mfma_f32_32x32x16_bf16 a[0:15], a[164:167], v[212:215], a[0:15]
    ds_read_b64_tr_b16 a[162:163], v17 offset:51200
    v_exp_f32 v229, v117
    v_add_f32 v235, v235, v227
    v_cvt_pk_bf16_f32 v201, v226, v227
    v_mfma_f32_32x32x16_bf16 a[16:31], a[164:167], v[220:223], a[16:31]
    ds_read_b64_tr_b16 a[164:165], v17 offset:53248
    v_exp_f32 v230, v118
    v_add_f32 v235, v235, v228
    v_exp_f32 v231, v119
    v_mfma_f32_32x32x16_bf16 a[32:47], a[168:171], v[208:211], a[32:47]
    ds_read_b64_tr_b16 a[166:167], v17 offset:55296
    v_add_f32 v235, v235, v229
    v_cvt_pk_bf16_f32 v202, v228, v229
    v_exp_f32 v224, v120
    v_mfma_f32_32x32x16_bf16 a[48:63], a[168:171], v[216:219], a[48:63]
    ds_read_b64_tr_b16 a[168:169], v18 offset:49152
    v_add_f32 v235, v235, v230
    v_exp_f32 v225, v121
    v_add_f32 v235, v235, v231
    v_mfma_f32_32x32x16_bf16 a[32:47], a[172:175], v[212:215], a[32:47]
    ds_read_b64_tr_b16 a[170:171], v18 offset:51200
    v_cvt_pk_bf16_f32 v203, v230, v231
    v_exp_f32 v226, v122
    v_add_f32 v235, v235, v224
    v_mfma_f32_32x32x16_bf16 a[48:63], a[172:175], v[220:223], a[48:63]
    ds_read_b64_tr_b16 a[172:173], v18 offset:53248
    v_exp_f32 v227, v123
    v_add_f32 v235, v235, v225
    v_cvt_pk_bf16_f32 v204, v224, v225
    v_mfma_f32_32x32x16_bf16 a[64:79], a[176:179], v[208:211], a[64:79]
    ds_read_b64_tr_b16 a[174:175], v18 offset:55296
    v_exp_f32 v228, v124
    v_add_f32 v235, v235, v226
    v_exp_f32 v229, v125
    v_mfma_f32_32x32x16_bf16 a[80:95], a[176:179], v[216:219], a[80:95]
    ds_read_b64_tr_b16 a[176:177], v19 offset:49152
    v_add_f32 v235, v235, v227
    v_cvt_pk_bf16_f32 v205, v226, v227
    v_exp_f32 v230, v126
    s_waitcnt lgkmcnt(6)
    v_mfma_f32_32x32x16_bf16 a[64:79], a[180:183], v[212:215], a[64:79]
    ds_read_b64_tr_b16 a[178:179], v19 offset:51200
    v_add_f32 v235, v235, v228
    v_exp_f32 v231, v127
    v_add_f32 v235, v235, v229
    v_mfma_f32_32x32x16_bf16 a[80:95], a[180:183], v[220:223], a[80:95]
    ds_read_b64_tr_b16 a[180:181], v19 offset:53248
    v_cvt_pk_bf16_f32 v206, v228, v229
    v_add_f32 v235, v235, v230
    v_add_f32 v235, v235, v231
    v_cvt_pk_bf16_f32 v207, v230, v231
    v_mfma_f32_32x32x16_bf16 a[96:111], a[184:187], v[208:211], a[96:111]
    ds_read_b64_tr_b16 a[182:183], v19 offset:55296
    v_max_f32 v236, v234, v235
    v_cmp_nge_f32 vcc, s95, v236
    v_mfma_f32_32x32x16_bf16 a[112:127], a[184:187], v[216:219], a[112:127]
    ds_read_b64_tr_b16 a[184:185], v20 offset:49152
    v_mfma_f32_32x32x16_bf16 a[96:111], a[188:191], v[212:215], a[96:111]
    ds_read_b64_tr_b16 a[186:187], v20 offset:51200
    v_mfma_f32_32x32x16_bf16 a[112:127], a[188:191], v[220:223], a[112:127]
    ds_read_b64_tr_b16 a[188:189], v20 offset:53248
    ds_read_b64_tr_b16 a[190:191], v20 offset:55296
    buffer_load_dwordx4 a[204:207], v8, s[40:43], s13 offen sc0 sc1
    s_add_u32 s13, s81, s9
    s_nop 0
    buffer_load_dwordx4 a[208:211], v5, s[40:43], s13 offen sc0 sc1
    buffer_load_dwordx4 a[212:215], v6, s[40:43], s13 offen sc0 sc1
    buffer_load_dwordx4 a[216:219], v7, s[40:43], s13 offen sc0 sc1
    buffer_load_dwordx4 a[220:223], v8, s[40:43], s13 offen sc0 sc1
    s_cbranch_vccnz recurrent_scan__sliding_block_cached__glu_gated_glu__prompt_kernel_rs14
recurrent_scan__sliding_block_cached__glu_gated_glu__prompt_kernel_rb14:
    v_mfma_f32_32x32x16_bf16 a[0:15], a[160:163], v[192:195], a[0:15]
    v_add_f32 v232, v232, v234
    v_add_f32 v233, v233, v235
    v_exp_f32 v224, v128
    v_exp_f32 v225, v129
    v_exp_f32 v226, v130
    v_mfma_f32_32x32x16_bf16 a[16:31], a[160:163], v[200:203], a[16:31]
    ds_read_b64_tr_b16 a[160:161], v17 offset:57344
    v_exp_f32 v227, v131
    v_add_f32 v234, v224, v225
    v_cvt_pk_bf16_f32 v208, v224, v225
    v_exp_f32 v228, v132
    v_add_f32 v234, v234, v226
    s_waitcnt lgkmcnt(6)
    v_mfma_f32_32x32x16_bf16 a[0:15], a[164:167], v[196:199], a[0:15]
    ds_read_b64_tr_b16 a[162:163], v17 offset:59392
    v_exp_f32 v229, v133
    v_add_f32 v234, v234, v227
    v_cvt_pk_bf16_f32 v209, v226, v227
    v_exp_f32 v230, v134
    v_add_f32 v234, v234, v228
    v_mfma_f32_32x32x16_bf16 a[16:31], a[164:167], v[204:207], a[16:31]
    ds_read_b64_tr_b16 a[164:165], v17 offset:61440
    v_exp_f32 v231, v135
    v_add_f32 v234, v234, v229
    v_cvt_pk_bf16_f32 v210, v228, v229
    v_exp_f32 v224, v136
    v_add_f32 v234, v234, v230
    v_mfma_f32_32x32x16_bf16 a[32:47], a[168:171], v[192:195], a[32:47]
    ds_read_b64_tr_b16 a[166:167], v17 offset:63488
    v_exp_f32 v225, v137
    v_add_f32 v234, v234, v231
    v_cvt_pk_bf16_f32 v211, v230, v231
    v_exp_f32 v226, v138
    v_add_f32 v234, v234, v224
    v_mfma_f32_32x32x16_bf16 a[48:63], a[168:171], v[200:203], a[48:63]
    ds_read_b64_tr_b16 a[168:169], v18 offset:57344
    v_exp_f32 v227, v139
    v_add_f32 v234, v234, v225
    v_cvt_pk_bf16_f32 v212, v224, v225
    v_exp_f32 v228, v140
    v_add_f32 v234, v234, v226
    v_mfma_f32_32x32x16_bf16 a[32:47], a[172:175], v[196:199], a[32:47]
    ds_read_b64_tr_b16 a[170:171], v18 offset:59392
    v_exp_f32 v229, v141
    v_add_f32 v234, v234, v227
    v_cvt_pk_bf16_f32 v213, v226, v227
    v_exp_f32 v230, v142
    v_add_f32 v234, v234, v228
    v_mfma_f32_32x32x16_bf16 a[48:63], a[172:175], v[204:207], a[48:63]
    ds_read_b64_tr_b16 a[172:173], v18 offset:61440
    v_exp_f32 v231, v143
    v_add_f32 v234, v234, v229
    v_cvt_pk_bf16_f32 v214, v228, v229
    v_exp_f32 v224, v144
    v_add_f32 v234, v234, v230
    v_mfma_f32_32x32x16_bf16 a[64:79], a[176:179], v[192:195], a[64:79]
    ds_read_b64_tr_b16 a[174:175], v18 offset:63488
    v_exp_f32 v225, v145
    v_add_f32 v234, v234, v231
    v_cvt_pk_bf16_f32 v215, v230, v231
    v_exp_f32 v226, v146
    v_exp_f32 v227, v147
    v_mfma_f32_32x32x16_bf16 a[80:95], a[176:179], v[200:203], a[80:95]
    ds_read_b64_tr_b16 a[176:177], v19 offset:57344
    v_add_f32 v235, v224, v225
    v_cvt_pk_bf16_f32 v216, v224, v225
    v_exp_f32 v228, v148
    v_add_f32 v235, v235, v226
    v_exp_f32 v229, v149
    v_add_f32 v235, v235, v227
    s_waitcnt lgkmcnt(6)
    v_mfma_f32_32x32x16_bf16 a[64:79], a[180:183], v[196:199], a[64:79]
    ds_read_b64_tr_b16 a[178:179], v19 offset:59392
    v_cvt_pk_bf16_f32 v217, v226, v227
    v_exp_f32 v230, v150
    v_add_f32 v235, v235, v228
    v_exp_f32 v231, v151
    v_add_f32 v235, v235, v229
    v_mfma_f32_32x32x16_bf16 a[80:95], a[180:183], v[204:207], a[80:95]
    ds_read_b64_tr_b16 a[180:181], v19 offset:61440
    v_cvt_pk_bf16_f32 v218, v228, v229
    v_exp_f32 v224, v152
    v_add_f32 v235, v235, v230
    v_exp_f32 v225, v153
    v_add_f32 v235, v235, v231
    v_mfma_f32_32x32x16_bf16 a[96:111], a[184:187], v[192:195], a[96:111]
    ds_read_b64_tr_b16 a[182:183], v19 offset:63488
    v_cvt_pk_bf16_f32 v219, v230, v231
    v_exp_f32 v226, v154
    v_add_f32 v235, v235, v224
    v_exp_f32 v227, v155
    v_add_f32 v235, v235, v225
    v_mfma_f32_32x32x16_bf16 a[112:127], a[184:187], v[200:203], a[112:127]
    ds_read_b64_tr_b16 a[184:185], v20 offset:57344
    v_cvt_pk_bf16_f32 v220, v224, v225
    v_exp_f32 v228, v156
    v_add_f32 v235, v235, v226
    v_exp_f32 v229, v157
    v_add_f32 v235, v235, v227
    v_mfma_f32_32x32x16_bf16 a[96:111], a[188:191], v[196:199], a[96:111]
    ds_read_b64_tr_b16 a[186:187], v20 offset:59392
    v_cvt_pk_bf16_f32 v221, v226, v227
    v_exp_f32 v230, v158
    v_add_f32 v235, v235, v228
    v_exp_f32 v231, v159
    v_add_f32 v235, v235, v229
    v_mfma_f32_32x32x16_bf16 a[112:127], a[188:191], v[204:207], a[112:127]
    ds_read_b64_tr_b16 a[188:189], v20 offset:61440
    v_cvt_pk_bf16_f32 v222, v228, v229
    v_add_f32 v235, v235, v230
    v_add_f32 v235, v235, v231
    v_cvt_pk_bf16_f32 v223, v230, v231
    v_max_f32 v236, v234, v235
    v_cmp_nge_f32 vcc, s95, v236
    ds_read_b64_tr_b16 a[190:191], v20 offset:63488
    s_cbranch_vccnz recurrent_scan__sliding_block_cached__glu_gated_glu__prompt_kernel_rs15
recurrent_scan__sliding_block_cached__glu_gated_glu__prompt_kernel_rb15:
    s_waitcnt lgkmcnt(0)
    s_barrier
    v_mfma_f32_32x32x16_bf16 a[0:15], a[160:163], v[208:211], a[0:15]
    s_add_u32 m0, s11, 0
    s_lshl_b32 s12, s84, 6
    s_add_u32 s12, s12, s8
    v_add_f32 v232, v232, v234
    v_add_f32 v233, v233, v235
    s_lshl_b32 s6, s15, 17
    s_lshl_b32 s90, s5, 12
    v_mfma_f32_32x32x16_bf16 a[16:31], a[160:163], v[216:219], a[16:31]
    s_nop 0
    buffer_load_dwordx4 v246, s[44:47], s12 offen offset:0 lds
    s_add_u32 s6, s6, s90
    s_add_u32 s7, s6, 0x40000
    v_mov_b32 v236, v232
    v_mov_b32 v237, v233
    v_mfma_f32_32x32x16_bf16 a[0:15], a[164:167], v[212:215], a[0:15]
    buffer_load_dwordx4 v247, s[44:47], s12 offen offset:1024 lds
    v_mov_b32 v29, v21
    v_mov_b32 v253, v24
    v_permlane32_swap_b32 v236, v232
    v_permlane32_swap_b32 v237, v233
    v_add_f32 v236, v236, v232
    v_mfma_f32_32x32x16_bf16 a[16:31], a[164:167], v[220:223], a[16:31]
    buffer_load_dwordx4 v248, s[44:47], s12 offen offset:2048 lds
    v_add_f32 v237, v237, v233
    v_rcp_f32 v238, v236
    v_rcp_f32 v240, v237
    v_lshrrev_b32 v1, 4, v0
    v_mov_b32 v239, v238
    v_mfma_f32_32x32x16_bf16 a[32:47], a[168:171], v[208:211], a[32:47]
    buffer_load_dwordx4 v249, s[44:47], s12 offen offset:3072 lds
    v_mov_b32 v241, v240
    v_lshlrev_b32 v30, 10, v1
    v_and_b32 v1, 1, v1
    v_bfe_u32 v31, v0, 2, 2
    v_lshl_add_u32 v30, v31, 8, v30
    v_mfma_f32_32x32x16_bf16 a[48:63], a[168:171], v[216:219], a[48:63]
    s_add_u32 m0, s11, 8192
    s_lshl_b32 s12, s85, 6
    s_add_u32 s12, s12, s8
    v_lshl_or_b32 v31, v31, 1, v1
    v_and_b32 v1, 3, v0
    v_lshl_add_u32 v30, v1, 3, v30
    s_lshr_b32 s91, s3, 1
    v_mfma_f32_32x32x16_bf16 a[32:47], a[172:175], v[212:215], a[32:47]
    s_nop 0
    buffer_load_dwordx4 v246, s[44:47], s12 offen offset:0 lds
    s_lshl_b32 s90, s91, 17
    s_lshl_b32 s91, s91, 16
    s_add_u32 s91, s91, 0x8000
    v_xor_b32 v1, 0, v31
    v_mfma_f32_32x32x16_bf16 a[48:63], a[172:175], v[220:223], a[48:63]
    buffer_load_dwordx4 v247, s[44:47], s12 offen offset:1024 lds
    v_lshl_add_u32 v1, v1, 5, v30
    v_add_u32 v9, s90, v1
    v_add_u32 v17, s91, v1
    v_xor_b32 v1, 1, v31
    v_lshl_add_u32 v1, v1, 5, v30
    v_mfma_f32_32x32x16_bf16 a[64:79], a[176:179], v[208:211], a[64:79]
    buffer_load_dwordx4 v248, s[44:47], s12 offen offset:2048 lds
    v_add_u32 v10, s90, v1
    v_add_u32 v18, s91, v1
    v_xor_b32 v1, 2, v31
    v_lshl_add_u32 v1, v1, 5, v30
    v_add_u32 v11, s90, v1
    v_mfma_f32_32x32x16_bf16 a[80:95], a[176:179], v[216:219], a[80:95]
    buffer_load_dwordx4 v249, s[44:47], s12 offen offset:3072 lds
    v_add_u32 v19, s91, v1
    v_xor_b32 v1, 3, v31
    v_lshl_add_u32 v1, v1, 5, v30
    v_add_u32 v12, s90, v1
    v_add_u32 v20, s91, v1
    v_mfma_f32_32x32x16_bf16 a[64:79], a[180:183], v[212:215], a[64:79]
    s_add_u32 m0, s11, 16384
    s_lshl_b32 s12, s86, 6
    s_add_u32 s12, s12, s8
    v_xor_b32 v1, 4, v31
    v_lshl_add_u32 v1, v1, 5, v30
    v_add_u32 v13, s90, v1
    v_add_u32 v21, s91, v1
    v_mfma_f32_32x32x16_bf16 a[80:95], a[180:183], v[220:223], a[80:95]
    s_nop 0
    buffer_load_dwordx4 v246, s[44:47], s12 offen offset:0 lds
    v_xor_b32 v1, 5, v31
    v_lshl_add_u32 v1, v1, 5, v30
    v_add_u32 v14, s90, v1
    v_add_u32 v22, s91, v1
    v_mfma_f32_32x32x16_bf16 a[96:111], a[184:187], v[208:211], a[96:111]
    buffer_load_dwordx4 v247, s[44:47], s12 offen offset:1024 lds
    v_xor_b32 v1, 6, v31
    v_lshl_add_u32 v1, v1, 5, v30
    v_add_u32 v15, s90, v1
    v_add_u32 v23, s91, v1
    v_xor_b32 v1, 7, v31
    v_mfma_f32_32x32x16_bf16 a[112:127], a[184:187], v[216:219], a[112:127]
    buffer_load_dwordx4 v248, s[44:47], s12 offen offset:2048 lds
    v_lshl_add_u32 v1, v1, 5, v30
    v_add_u32 v16, s90, v1
    v_add_u32 v24, s91, v1
    v_mfma_f32_32x32x16_bf16 a[96:111], a[188:191], v[212:215], a[96:111]
    buffer_load_dwordx4 v249, s[44:47], s12 offen offset:3072 lds
    v_mfma_f32_32x32x16_bf16 a[112:127], a[188:191], v[220:223], a[112:127]
    s_add_u32 m0, s11, 24576
    s_lshl_b32 s12, s87, 6
    s_add_u32 s12, s12, s8
    s_nop 0
    buffer_load_dwordx4 v246, s[44:47], s12 offen offset:0 lds
    buffer_load_dwordx4 v247, s[44:47], s12 offen offset:1024 lds
    buffer_load_dwordx4 v248, s[44:47], s12 offen offset:2048 lds
    buffer_load_dwordx4 v249, s[44:47], s12 offen offset:3072 lds
    s_add_u32 s8, s8, 0x80000
    v_accvgpr_read_b32 v96, a0
    v_accvgpr_read_b32 v97, a1
    v_accvgpr_read_b32 v98, a2
    v_accvgpr_read_b32 v99, a3
    v_accvgpr_read_b32 v100, a4
    v_accvgpr_read_b32 v101, a5
    v_accvgpr_read_b32 v102, a6
    v_accvgpr_read_b32 v103, a7
    v_accvgpr_read_b32 v104, a8
    v_accvgpr_read_b32 v105, a9
    v_accvgpr_read_b32 v106, a10
    v_accvgpr_read_b32 v107, a11
    v_accvgpr_read_b32 v108, a12
    v_accvgpr_read_b32 v109, a13
    v_accvgpr_read_b32 v110, a14
    v_accvgpr_read_b32 v111, a15
    v_accvgpr_read_b32 v112, a16
    v_accvgpr_read_b32 v113, a17
    v_accvgpr_read_b32 v114, a18
    v_accvgpr_read_b32 v115, a19
    v_accvgpr_read_b32 v116, a20
    v_accvgpr_read_b32 v117, a21
    v_accvgpr_read_b32 v118, a22
    v_accvgpr_read_b32 v119, a23
    v_accvgpr_read_b32 v120, a24
    v_accvgpr_read_b32 v121, a25
    v_accvgpr_read_b32 v122, a26
    v_accvgpr_read_b32 v123, a27
    v_accvgpr_read_b32 v124, a28
    v_accvgpr_read_b32 v125, a29
    v_accvgpr_read_b32 v126, a30
    v_accvgpr_read_b32 v127, a31
    v_accvgpr_read_b32 v128, a32
    v_accvgpr_read_b32 v129, a33
    v_accvgpr_read_b32 v130, a34
    v_accvgpr_read_b32 v131, a35
    v_accvgpr_read_b32 v132, a36
    v_accvgpr_read_b32 v133, a37
    v_accvgpr_read_b32 v134, a38
    v_accvgpr_read_b32 v135, a39
    v_accvgpr_read_b32 v136, a40
    v_accvgpr_read_b32 v137, a41
    v_accvgpr_read_b32 v138, a42
    v_accvgpr_read_b32 v139, a43
    v_accvgpr_read_b32 v140, a44
    v_accvgpr_read_b32 v141, a45
    v_accvgpr_read_b32 v142, a46
    v_accvgpr_read_b32 v143, a47
    v_accvgpr_read_b32 v144, a48
    v_accvgpr_read_b32 v145, a49
    v_accvgpr_read_b32 v146, a50
    v_accvgpr_read_b32 v147, a51
    v_accvgpr_read_b32 v148, a52
    v_accvgpr_read_b32 v149, a53
    v_accvgpr_read_b32 v150, a54
    v_accvgpr_read_b32 v151, a55
    v_accvgpr_read_b32 v152, a56
    v_accvgpr_read_b32 v153, a57
    v_accvgpr_read_b32 v154, a58
    v_accvgpr_read_b32 v155, a59
    v_accvgpr_read_b32 v156, a60
    v_accvgpr_read_b32 v157, a61
    v_accvgpr_read_b32 v158, a62
    v_accvgpr_read_b32 v159, a63
    s_add_u32 s13, s82, s9
    buffer_load_dwordx4 a[0:3], v5, s[40:43], s13 offen sc0 sc1
    buffer_load_dwordx4 a[4:7], v6, s[40:43], s13 offen sc0 sc1
    buffer_load_dwordx4 a[8:11], v7, s[40:43], s13 offen sc0 sc1
    buffer_load_dwordx4 a[12:15], v8, s[40:43], s13 offen sc0 sc1
    s_add_u32 s13, s83, s9
    buffer_load_dwordx4 a[16:19], v5, s[40:43], s13 offen sc0 sc1
    buffer_load_dwordx4 a[20:23], v6, s[40:43], s13 offen sc0 sc1
    buffer_load_dwordx4 a[24:27], v7, s[40:43], s13 offen sc0 sc1
    buffer_load_dwordx4 a[28:31], v8, s[40:43], s13 offen sc0 sc1
    s_add_u32 s13, s84, s9
    buffer_load_dwordx4 a[32:35], v5, s[40:43], s13 offen sc0 sc1
    buffer_load_dwordx4 a[36:39], v6, s[40:43], s13 offen sc0 sc1
    buffer_load_dwordx4 a[40:43], v7, s[40:43], s13 offen sc0 sc1
    buffer_load_dwordx4 a[44:47], v8, s[40:43], s13 offen sc0 sc1
    s_add_u32 s13, s85, s9
    buffer_load_dwordx4 a[48:51], v5, s[40:43], s13 offen sc0 sc1
    buffer_load_dwordx4 a[52:55], v6, s[40:43], s13 offen sc0 sc1
    buffer_load_dwordx4 a[56:59], v7, s[40:43], s13 offen sc0 sc1
    buffer_load_dwordx4 a[60:63], v8, s[40:43], s13 offen sc0 sc1
    s_waitcnt vmcnt(40)
    s_barrier
    ds_read_b64_tr_b16 a[128:129], v9 offset:0
    ds_read_b64_tr_b16 a[130:131], v9 offset:4096
    ds_read_b64_tr_b16 a[160:161], v9 offset:8192
    ds_read_b64_tr_b16 a[162:163], v9 offset:12288
    ds_read_b64_tr_b16 a[132:133], v10 offset:0
    ds_read_b64_tr_b16 a[134:135], v10 offset:4096
    ds_read_b64_tr_b16 a[164:165], v10 offset:8192
    ds_read_b64_tr_b16 a[166:167], v10 offset:12288
    ds_read_b64_tr_b16 a[136:137], v11 offset:0
    ds_read_b64_tr_b16 a[138:139], v11 offset:4096
    ds_read_b64_tr_b16 a[168:169], v11 offset:8192
    ds_read_b64_tr_b16 a[170:171], v11 offset:12288
    ds_read_b64_tr_b16 a[140:141], v12 offset:0
    ds_read_b64_tr_b16 a[142:143], v12 offset:4096
    ds_read_b64_tr_b16 a[172:173], v12 offset:8192
    ds_read_b64_tr_b16 a[174:175], v12 offset:12288
    ds_read_b64_tr_b16 a[144:145], v13 offset:0
    ds_read_b64_tr_b16 a[146:147], v13 offset:4096
    ds_read_b64_tr_b16 a[176:177], v13 offset:8192
    ds_read_b64_tr_b16 a[178:179], v13 offset:12288
    ds_read_b64_tr_b16 a[148:149], v14 offset:0
    ds_read_b64_tr_b16 a[150:151], v14 offset:4096
    ds_read_b64_tr_b16 a[180:181], v14 offset:8192
    ds_read_b64_tr_b16 a[182:183], v14 offset:12288
    ds_read_b64_tr_b16 a[152:153], v15 offset:0
    ds_read_b64_tr_b16 a[154:155], v15 offset:4096
    ds_read_b64_tr_b16 a[184:185], v15 offset:8192
    ds_read_b64_tr_b16 a[186:187], v15 offset:12288
    ds_read_b64_tr_b16 a[156:157], v16 offset:0
    ds_read_b64_tr_b16 a[158:159], v16 offset:4096
    ds_read_b64_tr_b16 a[188:189], v16 offset:8192
    ds_read_b64_tr_b16 a[190:191], v16 offset:12288
    v_pk_mul_f32 v[96:97], v[96:97], v[238:239]
    v_pk_mul_f32 v[98:99], v[98:99], v[238:239]
    v_pk_mul_f32 v[100:101], v[100:101], v[238:239]
    v_pk_mul_f32 v[102:103], v[102:103], v[238:239]
    v_pk_mul_f32 v[104:105], v[104:105], v[238:239]
    v_pk_mul_f32 v[106:107], v[106:107], v[238:239]
    v_pk_mul_f32 v[108:109], v[108:109], v[238:239]
    v_pk_mul_f32 v[110:111], v[110:111], v[238:239]
    v_cvt_pk_bf16_f32 v160, v96, v97
    v_cvt_pk_bf16_f32 v161, v98, v99
    v_cvt_pk_bf16_f32 v162, v104, v105
    v_cvt_pk_bf16_f32 v163, v106, v107
    buffer_store_dwordx4 v[160:163], v29, s[60:63], s6 offen offset:0 sc0 sc1
    v_cvt_pk_bf16_f32 v164, v100, v101
    v_cvt_pk_bf16_f32 v165, v102, v103
    v_cvt_pk_bf16_f32 v166, v108, v109
    v_cvt_pk_bf16_f32 v167, v110, v111
    buffer_store_dwordx4 v[164:167], v29, s[60:63], s6 offen offset:512 sc0 sc1
    v_pk_mul_f32 v[112:113], v[112:113], v[240:241]
    v_pk_mul_f32 v[114:115], v[114:115], v[240:241]
    v_pk_mul_f32 v[116:117], v[116:117], v[240:241]
    v_pk_mul_f32 v[118:119], v[118:119], v[240:241]
    v_pk_mul_f32 v[120:121], v[120:121], v[240:241]
    v_pk_mul_f32 v[122:123], v[122:123], v[240:241]
    v_pk_mul_f32 v[124:125], v[124:125], v[240:241]
    v_pk_mul_f32 v[126:127], v[126:127], v[240:241]
    v_cvt_pk_bf16_f32 v168, v112, v113
    v_cvt_pk_bf16_f32 v169, v114, v115
    v_cvt_pk_bf16_f32 v170, v120, v121
    v_cvt_pk_bf16_f32 v171, v122, v123
    buffer_store_dwordx4 v[168:171], v29, s[60:63], s7 offen offset:0 sc0 sc1
    v_cvt_pk_bf16_f32 v172, v116, v117
    v_cvt_pk_bf16_f32 v173, v118, v119
    v_cvt_pk_bf16_f32 v174, v124, v125
    v_cvt_pk_bf16_f32 v175, v126, v127
    buffer_store_dwordx4 v[172:175], v29, s[60:63], s7 offen offset:512 sc0 sc1
    v_pk_mul_f32 v[128:129], v[128:129], v[238:239]
    v_pk_mul_f32 v[130:131], v[130:131], v[238:239]
    v_pk_mul_f32 v[132:133], v[132:133], v[238:239]
    v_pk_mul_f32 v[134:135], v[134:135], v[238:239]
    v_pk_mul_f32 v[136:137], v[136:137], v[238:239]
    v_pk_mul_f32 v[138:139], v[138:139], v[238:239]
    v_pk_mul_f32 v[140:141], v[140:141], v[238:239]
    v_pk_mul_f32 v[142:143], v[142:143], v[238:239]
    v_cvt_pk_bf16_f32 v176, v128, v129
    v_cvt_pk_bf16_f32 v177, v130, v131
    v_cvt_pk_bf16_f32 v178, v136, v137
    v_cvt_pk_bf16_f32 v179, v138, v139
    buffer_store_dwordx4 v[176:179], v29, s[60:63], s6 offen offset:1024 sc0 sc1
    v_cvt_pk_bf16_f32 v180, v132, v133
    v_cvt_pk_bf16_f32 v181, v134, v135
    v_cvt_pk_bf16_f32 v182, v140, v141
    v_cvt_pk_bf16_f32 v183, v142, v143
    buffer_store_dwordx4 v[180:183], v29, s[60:63], s6 offen offset:1536 sc0 sc1
    v_pk_mul_f32 v[144:145], v[144:145], v[240:241]
    v_pk_mul_f32 v[146:147], v[146:147], v[240:241]
    v_pk_mul_f32 v[148:149], v[148:149], v[240:241]
    v_pk_mul_f32 v[150:151], v[150:151], v[240:241]
    v_pk_mul_f32 v[152:153], v[152:153], v[240:241]
    v_pk_mul_f32 v[154:155], v[154:155], v[240:241]
    v_pk_mul_f32 v[156:157], v[156:157], v[240:241]
    v_pk_mul_f32 v[158:159], v[158:159], v[240:241]
    v_cvt_pk_bf16_f32 v184, v144, v145
    v_cvt_pk_bf16_f32 v185, v146, v147
    v_cvt_pk_bf16_f32 v186, v152, v153
    v_cvt_pk_bf16_f32 v187, v154, v155
    buffer_store_dwordx4 v[184:187], v29, s[60:63], s7 offen offset:1024 sc0 sc1
    v_cvt_pk_bf16_f32 v188, v148, v149
    v_cvt_pk_bf16_f32 v189, v150, v151
    v_cvt_pk_bf16_f32 v190, v156, v157
    v_cvt_pk_bf16_f32 v191, v158, v159
    buffer_store_dwordx4 v[188:191], v29, s[60:63], s7 offen offset:1536 sc0 sc1
    v_accvgpr_read_b32 v96, a64
    v_accvgpr_read_b32 v97, a65
    v_accvgpr_read_b32 v98, a66
    v_accvgpr_read_b32 v99, a67
    v_accvgpr_read_b32 v100, a68
    v_accvgpr_read_b32 v101, a69
    v_accvgpr_read_b32 v102, a70
    v_accvgpr_read_b32 v103, a71
    v_accvgpr_read_b32 v104, a72
    v_accvgpr_read_b32 v105, a73
    v_accvgpr_read_b32 v106, a74
    v_accvgpr_read_b32 v107, a75
    v_accvgpr_read_b32 v108, a76
    v_accvgpr_read_b32 v109, a77
    v_accvgpr_read_b32 v110, a78
    v_accvgpr_read_b32 v111, a79
    v_pk_mul_f32 v[96:97], v[96:97], v[238:239]
    v_pk_mul_f32 v[98:99], v[98:99], v[238:239]
    v_pk_mul_f32 v[100:101], v[100:101], v[238:239]
    v_pk_mul_f32 v[102:103], v[102:103], v[238:239]
    v_pk_mul_f32 v[104:105], v[104:105], v[238:239]
    v_pk_mul_f32 v[106:107], v[106:107], v[238:239]
    v_pk_mul_f32 v[108:109], v[108:109], v[238:239]
    v_pk_mul_f32 v[110:111], v[110:111], v[238:239]
    v_cvt_pk_bf16_f32 v192, v96, v97
    v_cvt_pk_bf16_f32 v193, v98, v99
    v_cvt_pk_bf16_f32 v194, v104, v105
    v_cvt_pk_bf16_f32 v195, v106, v107
    v_cvt_pk_bf16_f32 v196, v100, v101
    v_cvt_pk_bf16_f32 v197, v102, v103
    v_cvt_pk_bf16_f32 v198, v108, v109
    v_cvt_pk_bf16_f32 v199, v110, v111
    v_accvgpr_read_b32 v112, a80
    v_accvgpr_read_b32 v113, a81
    v_accvgpr_read_b32 v114, a82
    v_accvgpr_read_b32 v115, a83
    v_accvgpr_read_b32 v116, a84
    v_accvgpr_read_b32 v117, a85
    v_accvgpr_read_b32 v118, a86
    v_accvgpr_read_b32 v119, a87
    v_accvgpr_read_b32 v120, a88
    v_accvgpr_read_b32 v121, a89
    v_accvgpr_read_b32 v122, a90
    v_accvgpr_read_b32 v123, a91
    v_accvgpr_read_b32 v124, a92
    v_accvgpr_read_b32 v125, a93
    v_accvgpr_read_b32 v126, a94
    v_accvgpr_read_b32 v127, a95
    v_pk_mul_f32 v[112:113], v[112:113], v[240:241]
    v_pk_mul_f32 v[114:115], v[114:115], v[240:241]
    v_pk_mul_f32 v[116:117], v[116:117], v[240:241]
    v_pk_mul_f32 v[118:119], v[118:119], v[240:241]
    v_pk_mul_f32 v[120:121], v[120:121], v[240:241]
    v_pk_mul_f32 v[122:123], v[122:123], v[240:241]
    v_pk_mul_f32 v[124:125], v[124:125], v[240:241]
    v_pk_mul_f32 v[126:127], v[126:127], v[240:241]
    v_cvt_pk_bf16_f32 v200, v112, v113
    v_cvt_pk_bf16_f32 v201, v114, v115
    v_cvt_pk_bf16_f32 v202, v120, v121
    v_cvt_pk_bf16_f32 v203, v122, v123
    v_cvt_pk_bf16_f32 v204, v116, v117
    v_cvt_pk_bf16_f32 v205, v118, v119
    v_cvt_pk_bf16_f32 v206, v124, v125
    v_cvt_pk_bf16_f32 v207, v126, v127
    v_accvgpr_read_b32 v128, a96
    v_accvgpr_read_b32 v129, a97
    v_accvgpr_read_b32 v130, a98
    v_accvgpr_read_b32 v131, a99
    v_accvgpr_read_b32 v132, a100
    v_accvgpr_read_b32 v133, a101
    v_accvgpr_read_b32 v134, a102
    v_accvgpr_read_b32 v135, a103
    v_accvgpr_read_b32 v136, a104
    v_accvgpr_read_b32 v137, a105
    v_accvgpr_read_b32 v138, a106
    v_accvgpr_read_b32 v139, a107
    v_accvgpr_read_b32 v140, a108
    v_accvgpr_read_b32 v141, a109
    v_accvgpr_read_b32 v142, a110
    v_accvgpr_read_b32 v143, a111
    v_pk_mul_f32 v[128:129], v[128:129], v[238:239]
    v_pk_mul_f32 v[130:131], v[130:131], v[238:239]
    v_pk_mul_f32 v[132:133], v[132:133], v[238:239]
    v_pk_mul_f32 v[134:135], v[134:135], v[238:239]
    v_pk_mul_f32 v[136:137], v[136:137], v[238:239]
    v_pk_mul_f32 v[138:139], v[138:139], v[238:239]
    v_pk_mul_f32 v[140:141], v[140:141], v[238:239]
    v_pk_mul_f32 v[142:143], v[142:143], v[238:239]
    v_cvt_pk_bf16_f32 v208, v128, v129
    v_cvt_pk_bf16_f32 v209, v130, v131
    v_cvt_pk_bf16_f32 v210, v136, v137
    v_cvt_pk_bf16_f32 v211, v138, v139
    v_cvt_pk_bf16_f32 v212, v132, v133
    v_cvt_pk_bf16_f32 v213, v134, v135
    v_cvt_pk_bf16_f32 v214, v140, v141
    v_cvt_pk_bf16_f32 v215, v142, v143
    v_accvgpr_read_b32 v144, a112
    v_accvgpr_read_b32 v145, a113
    v_accvgpr_read_b32 v146, a114
    v_accvgpr_read_b32 v147, a115
    v_accvgpr_read_b32 v148, a116
    v_accvgpr_read_b32 v149, a117
    v_accvgpr_read_b32 v150, a118
    v_accvgpr_read_b32 v151, a119
    v_accvgpr_read_b32 v152, a120
    v_accvgpr_read_b32 v153, a121
    v_accvgpr_read_b32 v154, a122
    v_accvgpr_read_b32 v155, a123
    v_accvgpr_read_b32 v156, a124
    v_accvgpr_read_b32 v157, a125
    v_accvgpr_read_b32 v158, a126
    v_accvgpr_read_b32 v159, a127
    v_pk_mul_f32 v[144:145], v[144:145], v[240:241]
    v_pk_mul_f32 v[146:147], v[146:147], v[240:241]
    v_pk_mul_f32 v[148:149], v[148:149], v[240:241]
    v_pk_mul_f32 v[150:151], v[150:151], v[240:241]
    v_pk_mul_f32 v[152:153], v[152:153], v[240:241]
    v_pk_mul_f32 v[154:155], v[154:155], v[240:241]
    v_pk_mul_f32 v[156:157], v[156:157], v[240:241]
    v_pk_mul_f32 v[158:159], v[158:159], v[240:241]
    v_cvt_pk_bf16_f32 v216, v144, v145
    v_cvt_pk_bf16_f32 v217, v146, v147
    v_cvt_pk_bf16_f32 v218, v152, v153
    v_cvt_pk_bf16_f32 v219, v154, v155
    v_cvt_pk_bf16_f32 v220, v148, v149
    v_cvt_pk_bf16_f32 v221, v150, v151
    v_cvt_pk_bf16_f32 v222, v156, v157
    v_cvt_pk_bf16_f32 v223, v158, v159
    s_add_u32 s52, s38, 0x2200000
    s_addc_u32 s53, s39, 0
    s_and_b32 s53, s53, 0xffff
    s_mov_b32 s54, 0x1200000
    s_mov_b32 s55, 0x20000
    s_mov_b32 s64, s16
    s_and_b32 s65, s17, 0xffff
    s_mov_b32 s66, 0x400000
    s_mov_b32 s67, 0x20000
    s_mov_b32 s68, s34
    s_and_b32 s69, s35, 0xffff
    s_mov_b32 s70, 0x400000
    s_mov_b32 s71, 0x20000
    s_cmp_eq_u32 s72, 0
    s_cselect_b32 s90, 3, 2
    s_cselect_b32 s95, 2, 1
    s_mov_b32 s91, 0
    s_lshl_b32 s12, s73, 3
    s_add_u32 s12, s12, s74
    s_lshl_b32 s92, s12, 2
    s_add_u32 s92, s92, s3
    s_lshl_b32 s92, s92, 13
    s_lshl_b32 s93, s12, 7
    s_add_u32 s101, s93, 40960
    s_lshl_b32 s12, s3, 5
    s_add_u32 s93, s93, s12
    s_lshl_b32 s94, s73, 7
    s_and_b32 s12, s3, 1
    s_lshl_b32 s12, s12, 6
    s_add_u32 s94, s94, s12
    s_lshr_b32 s12, s3, 1
    s_lshl_b32 s12, s12, 5
    s_add_u32 s94, s94, s12
    s_lshl_b32 s94, s94, 11
    s_lshl_b32 s12, s74, 8
    s_add_u32 s94, s94, s12
    v_and_b32 v1, 15, v0
    v_lshlrev_b32 v1, 11, v1
    v_lshrrev_b32 v30, 4, v0
    v_lshl_add_u32 v25, v30, 3, v1
    v_add_u32 v26, 0x8000, v25
    v_lshl_add_u32 v27, v30, 4, v1
    v_add_u32 v28, 0x8000, v27
    s_lshl_b32 s12, s3, 14
    v_add_u32 v2, s12, v4
    s_xor_b32 s12, s12, 0x8000
    v_add_u32 v3, s12, v4
    s_lshl_b32 s12, s3, 13
    s_add_u32 s12, s12, 0x10000
    v_add_u32 v254, s12, v4
    s_xor_b32 s12, s12, 0x4000
    v_add_u32 v255, s12, v4
    s_waitcnt vmcnt(40)
    s_waitcnt lgkmcnt(8)
    v_mfma_f32_16x16x32_bf16 v[32:35], a[128:131], a[192:195], 0
    s_add_u32 s13, s86, s9
    v_mfma_f32_16x16x32_bf16 v[32:35], a[160:163], a[208:211], v[32:35]
    v_mfma_f32_16x16x32_bf16 v[36:39], a[128:131], a[196:199], 0
    v_mfma_f32_16x16x32_bf16 v[36:39], a[160:163], a[212:215], v[36:39]
    buffer_load_dwordx4 a[64:67], v5, s[40:43], s13 offen sc0 sc1
    v_mfma_f32_16x16x32_bf16 v[40:43], a[128:131], a[200:203], 0
    buffer_store_dwordx4 v[192:195], v29, s[60:63], s6 offen offset:2048 sc0 sc1
    v_mfma_f32_16x16x32_bf16 v[40:43], a[160:163], a[216:219], v[40:43]
    buffer_load_dwordx4 a[68:71], v6, s[40:43], s13 offen sc0 sc1
    v_mfma_f32_16x16x32_bf16 v[44:47], a[128:131], a[204:207], 0
    buffer_store_dwordx4 v[196:199], v29, s[60:63], s6 offen offset:2560 sc0 sc1
    v_mfma_f32_16x16x32_bf16 v[44:47], a[160:163], a[220:223], v[44:47]
    s_waitcnt lgkmcnt(0)
    s_barrier
    ds_read_b64_tr_b16 a[128:129], v9 offset:16384
    v_mfma_f32_16x16x32_bf16 v[48:51], a[132:135], a[192:195], 0
    ds_read_b64_tr_b16 a[130:131], v9 offset:20480
    v_mfma_f32_16x16x32_bf16 v[48:51], a[164:167], a[208:211], v[48:51]
    ds_read_b64_tr_b16 a[160:161], v9 offset:24576
    v_mfma_f32_16x16x32_bf16 v[52:55], a[132:135], a[196:199], 0
    ds_read_b64_tr_b16 a[162:163], v9 offset:28672
    v_mfma_f32_16x16x32_bf16 v[52:55], a[164:167], a[212:215], v[52:55]
    buffer_load_dwordx4 a[72:75], v7, s[40:43], s13 offen sc0 sc1
    v_mfma_f32_16x16x32_bf16 v[56:59], a[132:135], a[200:203], 0
    buffer_store_dwordx4 v[200:203], v29, s[60:63], s7 offen offset:2048 sc0 sc1
    v_mfma_f32_16x16x32_bf16 v[56:59], a[164:167], a[216:219], v[56:59]
    buffer_load_dwordx4 a[76:79], v8, s[40:43], s13 offen sc0 sc1
    v_mfma_f32_16x16x32_bf16 v[60:63], a[132:135], a[204:207], 0
    buffer_store_dwordx4 v[204:207], v29, s[60:63], s7 offen offset:2560 sc0 sc1
    v_mfma_f32_16x16x32_bf16 v[60:63], a[164:167], a[220:223], v[60:63]
    ds_read_b64_tr_b16 a[132:133], v10 offset:16384
    s_add_u32 s13, s87, s9
    v_mfma_f32_16x16x32_bf16 v[64:67], a[136:139], a[192:195], 0
    ds_read_b64_tr_b16 a[134:135], v10 offset:20480
    s_add_u32 m0, s10, 0
    v_mfma_f32_16x16x32_bf16 v[64:67], a[168:171], a[208:211], v[64:67]
    ds_read_b64_tr_b16 a[164:165], v10 offset:24576
    s_lshl_b32 s12, s80, 6
    v_mfma_f32_16x16x32_bf16 v[68:71], a[136:139], a[196:199], 0
    ds_read_b64_tr_b16 a[166:167], v10 offset:28672
    s_add_u32 s12, s12, s8
    v_mfma_f32_16x16x32_bf16 v[68:71], a[168:171], a[212:215], v[68:71]
    buffer_load_dwordx4 a[80:83], v5, s[40:43], s13 offen sc0 sc1
    v_mfma_f32_16x16x32_bf16 v[72:75], a[136:139], a[200:203], 0
    buffer_store_dwordx4 v[208:211], v29, s[60:63], s6 offen offset:3072 sc0 sc1
    v_mfma_f32_16x16x32_bf16 v[72:75], a[168:171], a[216:219], v[72:75]
    buffer_load_dwordx4 a[84:87], v6, s[40:43], s13 offen sc0 sc1
    v_mfma_f32_16x16x32_bf16 v[76:79], a[136:139], a[204:207], 0
    buffer_store_dwordx4 v[212:215], v29, s[60:63], s6 offen offset:3584 sc0 sc1
    v_mfma_f32_16x16x32_bf16 v[76:79], a[168:171], a[220:223], v[76:79]
    ds_read_b64_tr_b16 a[136:137], v11 offset:16384
    v_mfma_f32_16x16x32_bf16 v[80:83], a[140:143], a[192:195], 0
    ds_read_b64_tr_b16 a[138:139], v11 offset:20480
    v_mfma_f32_16x16x32_bf16 v[80:83], a[172:175], a[208:211], v[80:83]
    ds_read_b64_tr_b16 a[168:169], v11 offset:24576
    v_mfma_f32_16x16x32_bf16 v[84:87], a[140:143], a[196:199], 0
    ds_read_b64_tr_b16 a[170:171], v11 offset:28672
    v_mfma_f32_16x16x32_bf16 v[84:87], a[172:175], a[212:215], v[84:87]
    buffer_load_dwordx4 a[88:91], v7, s[40:43], s13 offen sc0 sc1
    v_mfma_f32_16x16x32_bf16 v[88:91], a[140:143], a[200:203], 0
    buffer_store_dwordx4 v[216:219], v29, s[60:63], s7 offen offset:3072 sc0 sc1
    v_mfma_f32_16x16x32_bf16 v[88:91], a[172:175], a[216:219], v[88:91]
    buffer_load_dwordx4 a[92:95], v8, s[40:43], s13 offen sc0 sc1
    v_mfma_f32_16x16x32_bf16 v[92:95], a[140:143], a[204:207], 0
    buffer_store_dwordx4 v[220:223], v29, s[60:63], s7 offen offset:3584 sc0 sc1
    v_mfma_f32_16x16x32_bf16 v[92:95], a[172:175], a[220:223], v[92:95]
    ds_read_b64_tr_b16 a[140:141], v12 offset:16384
    s_add_u32 s9, s9, 0x2000
    v_mfma_f32_16x16x32_bf16 v[96:99], a[144:147], a[192:195], 0
    ds_read_b64_tr_b16 a[142:143], v12 offset:20480
    v_mfma_f32_16x16x32_bf16 v[96:99], a[176:179], a[208:211], v[96:99]
    ds_read_b64_tr_b16 a[172:173], v12 offset:24576
    v_mfma_f32_16x16x32_bf16 v[100:103], a[144:147], a[196:199], 0
    ds_read_b64_tr_b16 a[174:175], v12 offset:28672
    v_mfma_f32_16x16x32_bf16 v[100:103], a[176:179], a[212:215], v[100:103]
    buffer_load_dwordx4 v246, s[44:47], s12 offen offset:0 lds
    v_mfma_f32_16x16x32_bf16 v[104:107], a[144:147], a[200:203], 0
    v_mfma_f32_16x16x32_bf16 v[104:107], a[176:179], a[216:219], v[104:107]
    buffer_load_dwordx4 v247, s[44:47], s12 offen offset:1024 lds
    v_mfma_f32_16x16x32_bf16 v[108:111], a[144:147], a[204:207], 0
    v_mfma_f32_16x16x32_bf16 v[108:111], a[176:179], a[220:223], v[108:111]
    ds_read_b64_tr_b16 a[144:145], v13 offset:16384
    v_mfma_f32_16x16x32_bf16 v[112:115], a[148:151], a[192:195], 0
    ds_read_b64_tr_b16 a[146:147], v13 offset:20480
    v_mfma_f32_16x16x32_bf16 v[112:115], a[180:183], a[208:211], v[112:115]
    ds_read_b64_tr_b16 a[176:177], v13 offset:24576
    v_mfma_f32_16x16x32_bf16 v[116:119], a[148:151], a[196:199], 0
    ds_read_b64_tr_b16 a[178:179], v13 offset:28672
    v_mfma_f32_16x16x32_bf16 v[116:119], a[180:183], a[212:215], v[116:119]
    buffer_load_dwordx4 v248, s[44:47], s12 offen offset:2048 lds
    v_mfma_f32_16x16x32_bf16 v[120:123], a[148:151], a[200:203], 0
    v_mfma_f32_16x16x32_bf16 v[120:123], a[180:183], a[216:219], v[120:123]
    buffer_load_dwordx4 v249, s[44:47], s12 offen offset:3072 lds
    v_mfma_f32_16x16x32_bf16 v[124:127], a[148:151], a[204:207], 0
    s_add_u32 m0, s10, 8192
    s_lshl_b32 s12, s81, 6
    v_mfma_f32_16x16x32_bf16 v[124:127], a[180:183], a[220:223], v[124:127]
    ds_read_b64_tr_b16 a[148:149], v14 offset:16384
    s_add_u32 s12, s12, s8
    v_mfma_f32_16x16x32_bf16 v[128:131], a[152:155], a[192:195], 0
    ds_read_b64_tr_b16 a[150:151], v14 offset:20480
    v_mfma_f32_16x16x32_bf16 v[128:131], a[184:187], a[208:211], v[128:131]
    ds_read_b64_tr_b16 a[180:181], v14 offset:24576
    v_mfma_f32_16x16x32_bf16 v[132:135], a[152:155], a[196:199], 0
    ds_read_b64_tr_b16 a[182:183], v14 offset:28672
    v_mfma_f32_16x16x32_bf16 v[132:135], a[184:187], a[212:215], v[132:135]
    buffer_load_dwordx4 v246, s[44:47], s12 offen offset:0 lds
    v_mfma_f32_16x16x32_bf16 v[136:139], a[152:155], a[200:203], 0
    v_mfma_f32_16x16x32_bf16 v[136:139], a[184:187], a[216:219], v[136:139]
    buffer_load_dwordx4 v247, s[44:47], s12 offen offset:1024 lds
    v_mfma_f32_16x16x32_bf16 v[140:143], a[152:155], a[204:207], 0
    v_mfma_f32_16x16x32_bf16 v[140:143], a[184:187], a[220:223], v[140:143]
    ds_read_b64_tr_b16 a[152:153], v15 offset:16384
    v_mfma_f32_16x16x32_bf16 v[144:147], a[156:159], a[192:195], 0
    ds_read_b64_tr_b16 a[154:155], v15 offset:20480
    v_mfma_f32_16x16x32_bf16 v[144:147], a[188:191], a[208:211], v[144:147]
    ds_read_b64_tr_b16 a[184:185], v15 offset:24576
    v_mfma_f32_16x16x32_bf16 v[148:151], a[156:159], a[196:199], 0
    ds_read_b64_tr_b16 a[186:187], v15 offset:28672
    v_mfma_f32_16x16x32_bf16 v[148:151], a[188:191], a[212:215], v[148:151]
    buffer_load_dwordx4 v248, s[44:47], s12 offen offset:2048 lds
    v_mfma_f32_16x16x32_bf16 v[152:155], a[156:159], a[200:203], 0
    v_mfma_f32_16x16x32_bf16 v[152:155], a[188:191], a[216:219], v[152:155]
    buffer_load_dwordx4 v249, s[44:47], s12 offen offset:3072 lds
    v_mfma_f32_16x16x32_bf16 v[156:159], a[156:159], a[204:207], 0
    v_mfma_f32_16x16x32_bf16 v[156:159], a[188:191], a[220:223], v[156:159]
    ds_read_b64_tr_b16 a[156:157], v16 offset:16384
    ds_read_b64_tr_b16 a[158:159], v16 offset:20480
    ds_read_b64_tr_b16 a[188:189], v16 offset:24576
    ds_read_b64_tr_b16 a[190:191], v16 offset:28672
    s_waitcnt vmcnt(40)
    s_waitcnt lgkmcnt(8)
    v_mfma_f32_16x16x32_bf16 v[32:35], a[128:131], a[0:3], v[32:35]
    s_add_u32 s13, s80, s9
    v_mfma_f32_16x16x32_bf16 v[32:35], a[160:163], a[16:19], v[32:35]
    v_mfma_f32_16x16x32_bf16 v[36:39], a[128:131], a[4:7], v[36:39]
    v_mfma_f32_16x16x32_bf16 v[36:39], a[160:163], a[20:23], v[36:39]
    buffer_load_dwordx4 a[192:195], v5, s[40:43], s13 offen sc0 sc1
    v_mfma_f32_16x16x32_bf16 v[40:43], a[128:131], a[8:11], v[40:43]
    v_mfma_f32_16x16x32_bf16 v[40:43], a[160:163], a[24:27], v[40:43]
    buffer_load_dwordx4 a[196:199], v6, s[40:43], s13 offen sc0 sc1
    v_mfma_f32_16x16x32_bf16 v[44:47], a[128:131], a[12:15], v[44:47]
    v_mfma_f32_16x16x32_bf16 v[44:47], a[160:163], a[28:31], v[44:47]
    s_waitcnt lgkmcnt(0)
    s_barrier
    ds_read_b64_tr_b16 a[128:129], v17 offset:0
    v_mfma_f32_16x16x32_bf16 v[48:51], a[132:135], a[0:3], v[48:51]
    ds_read_b64_tr_b16 a[130:131], v17 offset:4096
    v_mfma_f32_16x16x32_bf16 v[48:51], a[164:167], a[16:19], v[48:51]
    ds_read_b64_tr_b16 a[160:161], v17 offset:8192
    v_mfma_f32_16x16x32_bf16 v[52:55], a[132:135], a[4:7], v[52:55]
    ds_read_b64_tr_b16 a[162:163], v17 offset:12288
    v_mfma_f32_16x16x32_bf16 v[52:55], a[164:167], a[20:23], v[52:55]
    buffer_load_dwordx4 a[200:203], v7, s[40:43], s13 offen sc0 sc1
    v_mfma_f32_16x16x32_bf16 v[56:59], a[132:135], a[8:11], v[56:59]
    v_mfma_f32_16x16x32_bf16 v[56:59], a[164:167], a[24:27], v[56:59]
    buffer_load_dwordx4 a[204:207], v8, s[40:43], s13 offen sc0 sc1
    v_mfma_f32_16x16x32_bf16 v[60:63], a[132:135], a[12:15], v[60:63]
    s_add_u32 s13, s81, s9
    v_mfma_f32_16x16x32_bf16 v[60:63], a[164:167], a[28:31], v[60:63]
    ds_read_b64_tr_b16 a[132:133], v18 offset:0
    s_add_u32 m0, s10, 16384
    v_mfma_f32_16x16x32_bf16 v[64:67], a[136:139], a[0:3], v[64:67]
    ds_read_b64_tr_b16 a[134:135], v18 offset:4096
    s_lshl_b32 s12, s82, 6
    v_mfma_f32_16x16x32_bf16 v[64:67], a[168:171], a[16:19], v[64:67]
    ds_read_b64_tr_b16 a[164:165], v18 offset:8192
    s_add_u32 s12, s12, s8
    v_mfma_f32_16x16x32_bf16 v[68:71], a[136:139], a[4:7], v[68:71]
    ds_read_b64_tr_b16 a[166:167], v18 offset:12288
    v_mfma_f32_16x16x32_bf16 v[68:71], a[168:171], a[20:23], v[68:71]
    buffer_load_dwordx4 a[208:211], v5, s[40:43], s13 offen sc0 sc1
    v_mfma_f32_16x16x32_bf16 v[72:75], a[136:139], a[8:11], v[72:75]
    v_mfma_f32_16x16x32_bf16 v[72:75], a[168:171], a[24:27], v[72:75]
    buffer_load_dwordx4 a[212:215], v6, s[40:43], s13 offen sc0 sc1
    v_mfma_f32_16x16x32_bf16 v[76:79], a[136:139], a[12:15], v[76:79]
    v_mfma_f32_16x16x32_bf16 v[76:79], a[168:171], a[28:31], v[76:79]
    ds_read_b64_tr_b16 a[136:137], v19 offset:0
    v_mfma_f32_16x16x32_bf16 v[80:83], a[140:143], a[0:3], v[80:83]
    ds_read_b64_tr_b16 a[138:139], v19 offset:4096
    v_mfma_f32_16x16x32_bf16 v[80:83], a[172:175], a[16:19], v[80:83]
    ds_read_b64_tr_b16 a[168:169], v19 offset:8192
    v_mfma_f32_16x16x32_bf16 v[84:87], a[140:143], a[4:7], v[84:87]
    ds_read_b64_tr_b16 a[170:171], v19 offset:12288
    v_mfma_f32_16x16x32_bf16 v[84:87], a[172:175], a[20:23], v[84:87]
    buffer_load_dwordx4 a[216:219], v7, s[40:43], s13 offen sc0 sc1
    v_mfma_f32_16x16x32_bf16 v[88:91], a[140:143], a[8:11], v[88:91]
    v_mfma_f32_16x16x32_bf16 v[88:91], a[172:175], a[24:27], v[88:91]
    buffer_load_dwordx4 a[220:223], v8, s[40:43], s13 offen sc0 sc1
    v_mfma_f32_16x16x32_bf16 v[92:95], a[140:143], a[12:15], v[92:95]
    v_mfma_f32_16x16x32_bf16 v[92:95], a[172:175], a[28:31], v[92:95]
    ds_read_b64_tr_b16 a[140:141], v20 offset:0
    v_mfma_f32_16x16x32_bf16 v[96:99], a[144:147], a[0:3], v[96:99]
    ds_read_b64_tr_b16 a[142:143], v20 offset:4096
    v_mfma_f32_16x16x32_bf16 v[96:99], a[176:179], a[16:19], v[96:99]
    ds_read_b64_tr_b16 a[172:173], v20 offset:8192
    v_mfma_f32_16x16x32_bf16 v[100:103], a[144:147], a[4:7], v[100:103]
    ds_read_b64_tr_b16 a[174:175], v20 offset:12288
    v_mfma_f32_16x16x32_bf16 v[100:103], a[176:179], a[20:23], v[100:103]
    buffer_load_dwordx4 v246, s[44:47], s12 offen offset:0 lds
    v_mfma_f32_16x16x32_bf16 v[104:107], a[144:147], a[8:11], v[104:107]
    v_mfma_f32_16x16x32_bf16 v[104:107], a[176:179], a[24:27], v[104:107]
    buffer_load_dwordx4 v247, s[44:47], s12 offen offset:1024 lds
    v_mfma_f32_16x16x32_bf16 v[108:111], a[144:147], a[12:15], v[108:111]
    v_mfma_f32_16x16x32_bf16 v[108:111], a[176:179], a[28:31], v[108:111]
    ds_read_b64_tr_b16 a[144:145], v21 offset:0
    v_mfma_f32_16x16x32_bf16 v[112:115], a[148:151], a[0:3], v[112:115]
    ds_read_b64_tr_b16 a[146:147], v21 offset:4096
    v_mfma_f32_16x16x32_bf16 v[112:115], a[180:183], a[16:19], v[112:115]
    ds_read_b64_tr_b16 a[176:177], v21 offset:8192
    v_mfma_f32_16x16x32_bf16 v[116:119], a[148:151], a[4:7], v[116:119]
    ds_read_b64_tr_b16 a[178:179], v21 offset:12288
    v_mfma_f32_16x16x32_bf16 v[116:119], a[180:183], a[20:23], v[116:119]
    buffer_load_dwordx4 v248, s[44:47], s12 offen offset:2048 lds
    v_mfma_f32_16x16x32_bf16 v[120:123], a[148:151], a[8:11], v[120:123]
    v_mfma_f32_16x16x32_bf16 v[120:123], a[180:183], a[24:27], v[120:123]
    buffer_load_dwordx4 v249, s[44:47], s12 offen offset:3072 lds
    v_mfma_f32_16x16x32_bf16 v[124:127], a[148:151], a[12:15], v[124:127]
    s_add_u32 m0, s10, 24576
    s_lshl_b32 s12, s83, 6
    v_mfma_f32_16x16x32_bf16 v[124:127], a[180:183], a[28:31], v[124:127]
    ds_read_b64_tr_b16 a[148:149], v22 offset:0
    s_add_u32 s12, s12, s8
    v_mfma_f32_16x16x32_bf16 v[128:131], a[152:155], a[0:3], v[128:131]
    ds_read_b64_tr_b16 a[150:151], v22 offset:4096
    v_mfma_f32_16x16x32_bf16 v[128:131], a[184:187], a[16:19], v[128:131]
    ds_read_b64_tr_b16 a[180:181], v22 offset:8192
    v_mfma_f32_16x16x32_bf16 v[132:135], a[152:155], a[4:7], v[132:135]
    ds_read_b64_tr_b16 a[182:183], v22 offset:12288
    v_mfma_f32_16x16x32_bf16 v[132:135], a[184:187], a[20:23], v[132:135]
    buffer_load_dwordx4 v246, s[44:47], s12 offen offset:0 lds
    v_mfma_f32_16x16x32_bf16 v[136:139], a[152:155], a[8:11], v[136:139]
    v_mfma_f32_16x16x32_bf16 v[136:139], a[184:187], a[24:27], v[136:139]
    buffer_load_dwordx4 v247, s[44:47], s12 offen offset:1024 lds
    v_mfma_f32_16x16x32_bf16 v[140:143], a[152:155], a[12:15], v[140:143]
    v_mfma_f32_16x16x32_bf16 v[140:143], a[184:187], a[28:31], v[140:143]
    ds_read_b64_tr_b16 a[152:153], v23 offset:0
    v_mfma_f32_16x16x32_bf16 v[144:147], a[156:159], a[0:3], v[144:147]
    ds_read_b64_tr_b16 a[154:155], v23 offset:4096
    v_mfma_f32_16x16x32_bf16 v[144:147], a[188:191], a[16:19], v[144:147]
    ds_read_b64_tr_b16 a[184:185], v23 offset:8192
    v_mfma_f32_16x16x32_bf16 v[148:151], a[156:159], a[4:7], v[148:151]
    ds_read_b64_tr_b16 a[186:187], v23 offset:12288
    v_mfma_f32_16x16x32_bf16 v[148:151], a[188:191], a[20:23], v[148:151]
    buffer_load_dwordx4 v248, s[44:47], s12 offen offset:2048 lds
    v_mfma_f32_16x16x32_bf16 v[152:155], a[156:159], a[8:11], v[152:155]
    v_mfma_f32_16x16x32_bf16 v[152:155], a[188:191], a[24:27], v[152:155]
    buffer_load_dwordx4 v249, s[44:47], s12 offen offset:3072 lds
    v_mfma_f32_16x16x32_bf16 v[156:159], a[156:159], a[12:15], v[156:159]
    v_mfma_f32_16x16x32_bf16 v[156:159], a[188:191], a[28:31], v[156:159]
    ds_read_b64_tr_b16 a[156:157], v24 offset:0
    ds_read_b64_tr_b16 a[158:159], v24 offset:4096
    ds_read_b64_tr_b16 a[188:189], v24 offset:8192
    ds_read_b64_tr_b16 a[190:191], v24 offset:12288
    s_waitcnt vmcnt(48)
    s_waitcnt lgkmcnt(8)
    v_mfma_f32_16x16x32_bf16 v[32:35], a[128:131], a[32:35], v[32:35]
    s_add_u32 s13, s82, s9
    v_mfma_f32_16x16x32_bf16 v[32:35], a[160:163], a[48:51], v[32:35]
    v_mfma_f32_16x16x32_bf16 v[36:39], a[128:131], a[36:39], v[36:39]
    v_mfma_f32_16x16x32_bf16 v[36:39], a[160:163], a[52:55], v[36:39]
    buffer_load_dwordx4 a[0:3], v5, s[40:43], s13 offen sc0 sc1
    v_mfma_f32_16x16x32_bf16 v[40:43], a[128:131], a[40:43], v[40:43]
    v_mfma_f32_16x16x32_bf16 v[40:43], a[160:163], a[56:59], v[40:43]
    buffer_load_dwordx4 a[4:7], v6, s[40:43], s13 offen sc0 sc1
    v_mfma_f32_16x16x32_bf16 v[44:47], a[128:131], a[44:47], v[44:47]
    v_mfma_f32_16x16x32_bf16 v[44:47], a[160:163], a[60:63], v[44:47]
    s_waitcnt vmcnt(26)
    s_waitcnt lgkmcnt(0)
    s_barrier
    s_cmp_lg_u32 s3, 0
    s_cbranch_scc1 recurrent_scan__sliding_block_cached__glu_gated_glu__prompt_kernel_fl1
    s_mov_b64 exec, 1
    buffer_store_dwordx2 v[250:251], v252, s[48:51], s89 offen sc0 sc1
    s_mov_b64 exec, -1
recurrent_scan__sliding_block_cached__glu_gated_glu__prompt_kernel_fl1:
    ds_read_b64_tr_b16 a[128:129], v17 offset:16384
    v_mfma_f32_16x16x32_bf16 v[48:51], a[132:135], a[32:35], v[48:51]
    ds_read_b64_tr_b16 a[130:131], v17 offset:20480
    v_mfma_f32_16x16x32_bf16 v[48:51], a[164:167], a[48:51], v[48:51]
    ds_read_b64_tr_b16 a[160:161], v17 offset:24576
    v_mfma_f32_16x16x32_bf16 v[52:55], a[132:135], a[36:39], v[52:55]
    ds_read_b64_tr_b16 a[162:163], v17 offset:28672
    v_mfma_f32_16x16x32_bf16 v[52:55], a[164:167], a[52:55], v[52:55]
    buffer_load_dwordx4 a[8:11], v7, s[40:43], s13 offen sc0 sc1
    v_mfma_f32_16x16x32_bf16 v[56:59], a[132:135], a[40:43], v[56:59]
    v_mfma_f32_16x16x32_bf16 v[56:59], a[164:167], a[56:59], v[56:59]
    buffer_load_dwordx4 a[12:15], v8, s[40:43], s13 offen sc0 sc1
    v_mfma_f32_16x16x32_bf16 v[60:63], a[132:135], a[44:47], v[60:63]
    s_add_u32 s13, s83, s9
    v_mfma_f32_16x16x32_bf16 v[60:63], a[164:167], a[60:63], v[60:63]
    ds_read_b64_tr_b16 a[132:133], v18 offset:16384
    s_add_u32 m0, s11, 0
    v_mfma_f32_16x16x32_bf16 v[64:67], a[136:139], a[32:35], v[64:67]
    ds_read_b64_tr_b16 a[134:135], v18 offset:20480
    s_lshl_b32 s12, s84, 6
    v_mfma_f32_16x16x32_bf16 v[64:67], a[168:171], a[48:51], v[64:67]
    ds_read_b64_tr_b16 a[164:165], v18 offset:24576
    s_add_u32 s12, s12, s8
    v_mfma_f32_16x16x32_bf16 v[68:71], a[136:139], a[36:39], v[68:71]
    ds_read_b64_tr_b16 a[166:167], v18 offset:28672
    v_mfma_f32_16x16x32_bf16 v[68:71], a[168:171], a[52:55], v[68:71]
    buffer_load_dwordx4 a[16:19], v5, s[40:43], s13 offen sc0 sc1
    v_mfma_f32_16x16x32_bf16 v[72:75], a[136:139], a[40:43], v[72:75]
    v_mfma_f32_16x16x32_bf16 v[72:75], a[168:171], a[56:59], v[72:75]
    buffer_load_dwordx4 a[20:23], v6, s[40:43], s13 offen sc0 sc1
    v_mfma_f32_16x16x32_bf16 v[76:79], a[136:139], a[44:47], v[76:79]
    v_mfma_f32_16x16x32_bf16 v[76:79], a[168:171], a[60:63], v[76:79]
    ds_read_b64_tr_b16 a[136:137], v19 offset:16384
    v_mfma_f32_16x16x32_bf16 v[80:83], a[140:143], a[32:35], v[80:83]
    ds_read_b64_tr_b16 a[138:139], v19 offset:20480
    v_mfma_f32_16x16x32_bf16 v[80:83], a[172:175], a[48:51], v[80:83]
    ds_read_b64_tr_b16 a[168:169], v19 offset:24576
    v_mfma_f32_16x16x32_bf16 v[84:87], a[140:143], a[36:39], v[84:87]
    ds_read_b64_tr_b16 a[170:171], v19 offset:28672
    v_mfma_f32_16x16x32_bf16 v[84:87], a[172:175], a[52:55], v[84:87]
    buffer_load_dwordx4 a[24:27], v7, s[40:43], s13 offen sc0 sc1
    v_mfma_f32_16x16x32_bf16 v[88:91], a[140:143], a[40:43], v[88:91]
    v_mfma_f32_16x16x32_bf16 v[88:91], a[172:175], a[56:59], v[88:91]
    buffer_load_dwordx4 a[28:31], v8, s[40:43], s13 offen sc0 sc1
    v_mfma_f32_16x16x32_bf16 v[92:95], a[140:143], a[44:47], v[92:95]
    v_mfma_f32_16x16x32_bf16 v[92:95], a[172:175], a[60:63], v[92:95]
    ds_read_b64_tr_b16 a[140:141], v20 offset:16384
    v_mfma_f32_16x16x32_bf16 v[96:99], a[144:147], a[32:35], v[96:99]
    ds_read_b64_tr_b16 a[142:143], v20 offset:20480
    v_mfma_f32_16x16x32_bf16 v[96:99], a[176:179], a[48:51], v[96:99]
    ds_read_b64_tr_b16 a[172:173], v20 offset:24576
    v_mfma_f32_16x16x32_bf16 v[100:103], a[144:147], a[36:39], v[100:103]
    ds_read_b64_tr_b16 a[174:175], v20 offset:28672
    v_mfma_f32_16x16x32_bf16 v[100:103], a[176:179], a[52:55], v[100:103]
    buffer_load_dwordx4 v246, s[44:47], s12 offen offset:0 lds
    v_mfma_f32_16x16x32_bf16 v[104:107], a[144:147], a[40:43], v[104:107]
    v_mfma_f32_16x16x32_bf16 v[104:107], a[176:179], a[56:59], v[104:107]
    buffer_load_dwordx4 v247, s[44:47], s12 offen offset:1024 lds
    v_mfma_f32_16x16x32_bf16 v[108:111], a[144:147], a[44:47], v[108:111]
    v_mfma_f32_16x16x32_bf16 v[108:111], a[176:179], a[60:63], v[108:111]
    ds_read_b64_tr_b16 a[144:145], v21 offset:16384
    v_mfma_f32_16x16x32_bf16 v[112:115], a[148:151], a[32:35], v[112:115]
    ds_read_b64_tr_b16 a[146:147], v21 offset:20480
    v_mfma_f32_16x16x32_bf16 v[112:115], a[180:183], a[48:51], v[112:115]
    ds_read_b64_tr_b16 a[176:177], v21 offset:24576
    v_mfma_f32_16x16x32_bf16 v[116:119], a[148:151], a[36:39], v[116:119]
    ds_read_b64_tr_b16 a[178:179], v21 offset:28672
    v_mfma_f32_16x16x32_bf16 v[116:119], a[180:183], a[52:55], v[116:119]
    buffer_load_dwordx4 v248, s[44:47], s12 offen offset:2048 lds
    v_mfma_f32_16x16x32_bf16 v[120:123], a[148:151], a[40:43], v[120:123]
    v_mfma_f32_16x16x32_bf16 v[120:123], a[180:183], a[56:59], v[120:123]
    buffer_load_dwordx4 v249, s[44:47], s12 offen offset:3072 lds
    v_mfma_f32_16x16x32_bf16 v[124:127], a[148:151], a[44:47], v[124:127]
    s_add_u32 m0, s11, 8192
    s_lshl_b32 s12, s85, 6
    v_mfma_f32_16x16x32_bf16 v[124:127], a[180:183], a[60:63], v[124:127]
    ds_read_b64_tr_b16 a[148:149], v22 offset:16384
    s_add_u32 s12, s12, s8
    v_mfma_f32_16x16x32_bf16 v[128:131], a[152:155], a[32:35], v[128:131]
    ds_read_b64_tr_b16 a[150:151], v22 offset:20480
    v_mfma_f32_16x16x32_bf16 v[128:131], a[184:187], a[48:51], v[128:131]
    ds_read_b64_tr_b16 a[180:181], v22 offset:24576
    v_mfma_f32_16x16x32_bf16 v[132:135], a[152:155], a[36:39], v[132:135]
    ds_read_b64_tr_b16 a[182:183], v22 offset:28672
    v_mfma_f32_16x16x32_bf16 v[132:135], a[184:187], a[52:55], v[132:135]
    buffer_load_dwordx4 v246, s[44:47], s12 offen offset:0 lds
    v_mfma_f32_16x16x32_bf16 v[136:139], a[152:155], a[40:43], v[136:139]
    v_mfma_f32_16x16x32_bf16 v[136:139], a[184:187], a[56:59], v[136:139]
    buffer_load_dwordx4 v247, s[44:47], s12 offen offset:1024 lds
    v_mfma_f32_16x16x32_bf16 v[140:143], a[152:155], a[44:47], v[140:143]
    v_mfma_f32_16x16x32_bf16 v[140:143], a[184:187], a[60:63], v[140:143]
    ds_read_b64_tr_b16 a[152:153], v23 offset:16384
    v_mfma_f32_16x16x32_bf16 v[144:147], a[156:159], a[32:35], v[144:147]
    ds_read_b64_tr_b16 a[154:155], v23 offset:20480
    v_mfma_f32_16x16x32_bf16 v[144:147], a[188:191], a[48:51], v[144:147]
    ds_read_b64_tr_b16 a[184:185], v23 offset:24576
    v_mfma_f32_16x16x32_bf16 v[148:151], a[156:159], a[36:39], v[148:151]
    ds_read_b64_tr_b16 a[186:187], v23 offset:28672
    v_mfma_f32_16x16x32_bf16 v[148:151], a[188:191], a[52:55], v[148:151]
    buffer_load_dwordx4 v248, s[44:47], s12 offen offset:2048 lds
    v_mfma_f32_16x16x32_bf16 v[152:155], a[156:159], a[40:43], v[152:155]
    v_mfma_f32_16x16x32_bf16 v[152:155], a[188:191], a[56:59], v[152:155]
    buffer_load_dwordx4 v249, s[44:47], s12 offen offset:3072 lds
    v_mfma_f32_16x16x32_bf16 v[156:159], a[156:159], a[44:47], v[156:159]
    v_mfma_f32_16x16x32_bf16 v[156:159], a[188:191], a[60:63], v[156:159]
    ds_read_b64_tr_b16 a[156:157], v24 offset:16384
    ds_read_b64_tr_b16 a[158:159], v24 offset:20480
    ds_read_b64_tr_b16 a[188:189], v24 offset:24576
    ds_read_b64_tr_b16 a[190:191], v24 offset:28672
    s_waitcnt lgkmcnt(8)
    v_mfma_f32_16x16x32_bf16 v[32:35], a[128:131], a[64:67], v[32:35]
    s_add_u32 s13, s84, s9
    v_mfma_f32_16x16x32_bf16 v[32:35], a[160:163], a[80:83], v[32:35]
    v_mfma_f32_16x16x32_bf16 v[36:39], a[128:131], a[68:71], v[36:39]
    v_mfma_f32_16x16x32_bf16 v[36:39], a[160:163], a[84:87], v[36:39]
    buffer_load_dwordx4 a[32:35], v5, s[40:43], s13 offen sc0 sc1
    v_mfma_f32_16x16x32_bf16 v[40:43], a[128:131], a[72:75], v[40:43]
    v_mfma_f32_16x16x32_bf16 v[40:43], a[160:163], a[88:91], v[40:43]
    buffer_load_dwordx4 a[36:39], v6, s[40:43], s13 offen sc0 sc1
    v_mfma_f32_16x16x32_bf16 v[44:47], a[128:131], a[76:79], v[44:47]
    v_mfma_f32_16x16x32_bf16 v[44:47], a[160:163], a[92:95], v[44:47]
    s_waitcnt vmcnt(34)
    s_waitcnt lgkmcnt(0)
    s_barrier
    ds_read_b64_tr_b16 a[128:129], v9 offset:0
    v_mfma_f32_16x16x32_bf16 v[48:51], a[132:135], a[64:67], v[48:51]
    ds_read_b64_tr_b16 a[130:131], v9 offset:4096
    v_mfma_f32_16x16x32_bf16 v[48:51], a[164:167], a[80:83], v[48:51]
    ds_read_b64_tr_b16 a[160:161], v9 offset:8192
    v_mfma_f32_16x16x32_bf16 v[52:55], a[132:135], a[68:71], v[52:55]
    ds_read_b64_tr_b16 a[162:163], v9 offset:12288
    v_mfma_f32_16x16x32_bf16 v[52:55], a[164:167], a[84:87], v[52:55]
    buffer_load_dwordx4 a[40:43], v7, s[40:43], s13 offen sc0 sc1
    v_mfma_f32_16x16x32_bf16 v[56:59], a[132:135], a[72:75], v[56:59]
    v_mfma_f32_16x16x32_bf16 v[56:59], a[164:167], a[88:91], v[56:59]
    buffer_load_dwordx4 a[44:47], v8, s[40:43], s13 offen sc0 sc1
    v_mfma_f32_16x16x32_bf16 v[60:63], a[132:135], a[76:79], v[60:63]
    s_add_u32 s13, s85, s9
    v_mfma_f32_16x16x32_bf16 v[60:63], a[164:167], a[92:95], v[60:63]
    ds_read_b64_tr_b16 a[132:133], v10 offset:0
    s_add_u32 m0, s11, 16384
    v_mfma_f32_16x16x32_bf16 v[64:67], a[136:139], a[64:67], v[64:67]
    ds_read_b64_tr_b16 a[134:135], v10 offset:4096
    s_lshl_b32 s12, s86, 6
    v_mfma_f32_16x16x32_bf16 v[64:67], a[168:171], a[80:83], v[64:67]
    ds_read_b64_tr_b16 a[164:165], v10 offset:8192
    s_add_u32 s12, s12, s8
    v_mfma_f32_16x16x32_bf16 v[68:71], a[136:139], a[68:71], v[68:71]
    ds_read_b64_tr_b16 a[166:167], v10 offset:12288
    v_mfma_f32_16x16x32_bf16 v[68:71], a[168:171], a[84:87], v[68:71]
    buffer_load_dwordx4 a[48:51], v5, s[40:43], s13 offen sc0 sc1
    v_mfma_f32_16x16x32_bf16 v[72:75], a[136:139], a[72:75], v[72:75]
    v_mfma_f32_16x16x32_bf16 v[72:75], a[168:171], a[88:91], v[72:75]
    buffer_load_dwordx4 a[52:55], v6, s[40:43], s13 offen sc0 sc1
    v_mfma_f32_16x16x32_bf16 v[76:79], a[136:139], a[76:79], v[76:79]
    v_mfma_f32_16x16x32_bf16 v[76:79], a[168:171], a[92:95], v[76:79]
    ds_read_b64_tr_b16 a[136:137], v11 offset:0
    v_mfma_f32_16x16x32_bf16 v[80:83], a[140:143], a[64:67], v[80:83]
    ds_read_b64_tr_b16 a[138:139], v11 offset:4096
    v_mfma_f32_16x16x32_bf16 v[80:83], a[172:175], a[80:83], v[80:83]
    ds_read_b64_tr_b16 a[168:169], v11 offset:8192
    v_mfma_f32_16x16x32_bf16 v[84:87], a[140:143], a[68:71], v[84:87]
    ds_read_b64_tr_b16 a[170:171], v11 offset:12288
    v_mfma_f32_16x16x32_bf16 v[84:87], a[172:175], a[84:87], v[84:87]
    buffer_load_dwordx4 a[56:59], v7, s[40:43], s13 offen sc0 sc1
    v_mfma_f32_16x16x32_bf16 v[88:91], a[140:143], a[72:75], v[88:91]
    v_mfma_f32_16x16x32_bf16 v[88:91], a[172:175], a[88:91], v[88:91]
    buffer_load_dwordx4 a[60:63], v8, s[40:43], s13 offen sc0 sc1
    v_mfma_f32_16x16x32_bf16 v[92:95], a[140:143], a[76:79], v[92:95]
    v_mfma_f32_16x16x32_bf16 v[92:95], a[172:175], a[92:95], v[92:95]
    ds_read_b64_tr_b16 a[140:141], v12 offset:0
    v_mfma_f32_16x16x32_bf16 v[96:99], a[144:147], a[64:67], v[96:99]
    ds_read_b64_tr_b16 a[142:143], v12 offset:4096
    v_mfma_f32_16x16x32_bf16 v[96:99], a[176:179], a[80:83], v[96:99]
    ds_read_b64_tr_b16 a[172:173], v12 offset:8192
    v_mfma_f32_16x16x32_bf16 v[100:103], a[144:147], a[68:71], v[100:103]
    ds_read_b64_tr_b16 a[174:175], v12 offset:12288
    v_mfma_f32_16x16x32_bf16 v[100:103], a[176:179], a[84:87], v[100:103]
    buffer_load_dwordx4 v246, s[44:47], s12 offen offset:0 lds
    v_mfma_f32_16x16x32_bf16 v[104:107], a[144:147], a[72:75], v[104:107]
    v_mfma_f32_16x16x32_bf16 v[104:107], a[176:179], a[88:91], v[104:107]
    buffer_load_dwordx4 v247, s[44:47], s12 offen offset:1024 lds
    v_mfma_f32_16x16x32_bf16 v[108:111], a[144:147], a[76:79], v[108:111]
    v_mfma_f32_16x16x32_bf16 v[108:111], a[176:179], a[92:95], v[108:111]
    ds_read_b64_tr_b16 a[144:145], v13 offset:0
    v_mfma_f32_16x16x32_bf16 v[112:115], a[148:151], a[64:67], v[112:115]
    ds_read_b64_tr_b16 a[146:147], v13 offset:4096
    v_mfma_f32_16x16x32_bf16 v[112:115], a[180:183], a[80:83], v[112:115]
    ds_read_b64_tr_b16 a[176:177], v13 offset:8192
    v_mfma_f32_16x16x32_bf16 v[116:119], a[148:151], a[68:71], v[116:119]
    ds_read_b64_tr_b16 a[178:179], v13 offset:12288
    v_mfma_f32_16x16x32_bf16 v[116:119], a[180:183], a[84:87], v[116:119]
    buffer_load_dwordx4 v248, s[44:47], s12 offen offset:2048 lds
    v_mfma_f32_16x16x32_bf16 v[120:123], a[148:151], a[72:75], v[120:123]
    v_mfma_f32_16x16x32_bf16 v[120:123], a[180:183], a[88:91], v[120:123]
    buffer_load_dwordx4 v249, s[44:47], s12 offen offset:3072 lds
    v_mfma_f32_16x16x32_bf16 v[124:127], a[148:151], a[76:79], v[124:127]
    s_add_u32 m0, s11, 24576
    s_lshl_b32 s12, s87, 6
    v_mfma_f32_16x16x32_bf16 v[124:127], a[180:183], a[92:95], v[124:127]
    ds_read_b64_tr_b16 a[148:149], v14 offset:0
    s_add_u32 s12, s12, s8
    v_mfma_f32_16x16x32_bf16 v[128:131], a[152:155], a[64:67], v[128:131]
    ds_read_b64_tr_b16 a[150:151], v14 offset:4096
    v_mfma_f32_16x16x32_bf16 v[128:131], a[184:187], a[80:83], v[128:131]
    ds_read_b64_tr_b16 a[180:181], v14 offset:8192
    v_mfma_f32_16x16x32_bf16 v[132:135], a[152:155], a[68:71], v[132:135]
    ds_read_b64_tr_b16 a[182:183], v14 offset:12288
    v_mfma_f32_16x16x32_bf16 v[132:135], a[184:187], a[84:87], v[132:135]
    buffer_load_dwordx4 v246, s[44:47], s12 offen offset:0 lds
    v_mfma_f32_16x16x32_bf16 v[136:139], a[152:155], a[72:75], v[136:139]
    v_mfma_f32_16x16x32_bf16 v[136:139], a[184:187], a[88:91], v[136:139]
    buffer_load_dwordx4 v247, s[44:47], s12 offen offset:1024 lds
    v_mfma_f32_16x16x32_bf16 v[140:143], a[152:155], a[76:79], v[140:143]
    v_mfma_f32_16x16x32_bf16 v[140:143], a[184:187], a[92:95], v[140:143]
    ds_read_b64_tr_b16 a[152:153], v15 offset:0
    v_mfma_f32_16x16x32_bf16 v[144:147], a[156:159], a[64:67], v[144:147]
    ds_read_b64_tr_b16 a[154:155], v15 offset:4096
    v_mfma_f32_16x16x32_bf16 v[144:147], a[188:191], a[80:83], v[144:147]
    ds_read_b64_tr_b16 a[184:185], v15 offset:8192
    v_mfma_f32_16x16x32_bf16 v[148:151], a[156:159], a[68:71], v[148:151]
    ds_read_b64_tr_b16 a[186:187], v15 offset:12288
    v_mfma_f32_16x16x32_bf16 v[148:151], a[188:191], a[84:87], v[148:151]
    buffer_load_dwordx4 v248, s[44:47], s12 offen offset:2048 lds
    v_mfma_f32_16x16x32_bf16 v[152:155], a[156:159], a[72:75], v[152:155]
    v_mfma_f32_16x16x32_bf16 v[152:155], a[188:191], a[88:91], v[152:155]
    buffer_load_dwordx4 v249, s[44:47], s12 offen offset:3072 lds
    v_mfma_f32_16x16x32_bf16 v[156:159], a[156:159], a[76:79], v[156:159]
    s_add_u32 s8, s8, 0x80000
    v_mfma_f32_16x16x32_bf16 v[156:159], a[188:191], a[92:95], v[156:159]
    ds_read_b64_tr_b16 a[156:157], v16 offset:0
    ds_read_b64_tr_b16 a[158:159], v16 offset:4096
    ds_read_b64_tr_b16 a[188:189], v16 offset:8192
    ds_read_b64_tr_b16 a[190:191], v16 offset:12288
.p2align 6
recurrent_scan__sliding_block_cached__glu_gated_glu__prompt_kernel_floop:
    s_cmp_lg_u32 s95, 0
    s_cbranch_scc1 recurrent_scan__sliding_block_cached__glu_gated_glu__prompt_kernel_nosw1
    s_mov_b32 s44, s24
    s_and_b32 s45, s25, 0xffff
    s_mov_b32 s46, 0x800000
    s_mov_b32 s47, 0x20000
    s_mov_b32 s8, s75
recurrent_scan__sliding_block_cached__glu_gated_glu__prompt_kernel_nosw1:
    s_waitcnt vmcnt(40)
    s_waitcnt lgkmcnt(8)
    v_mfma_f32_16x16x32_bf16 v[32:35], a[128:131], a[192:195], v[32:35]
    s_add_u32 s13, s86, s9
    v_mfma_f32_16x16x32_bf16 v[32:35], a[160:163], a[208:211], v[32:35]
    v_mfma_f32_16x16x32_bf16 v[36:39], a[128:131], a[196:199], v[36:39]
    v_mfma_f32_16x16x32_bf16 v[36:39], a[160:163], a[212:215], v[36:39]
    buffer_load_dwordx4 a[64:67], v5, s[40:43], s13 offen sc0 sc1
    v_mfma_f32_16x16x32_bf16 v[40:43], a[128:131], a[200:203], v[40:43]
    v_mfma_f32_16x16x32_bf16 v[40:43], a[160:163], a[216:219], v[40:43]
    buffer_load_dwordx4 a[68:71], v6, s[40:43], s13 offen sc0 sc1
    v_mfma_f32_16x16x32_bf16 v[44:47], a[128:131], a[204:207], v[44:47]
    v_mfma_f32_16x16x32_bf16 v[44:47], a[160:163], a[220:223], v[44:47]
    s_waitcnt vmcnt(34)
    s_waitcnt lgkmcnt(0)
    s_barrier
    ds_read_b64_tr_b16 a[128:129], v9 offset:16384
    v_mfma_f32_16x16x32_bf16 v[48:51], a[132:135], a[192:195], v[48:51]
    ds_read_b64_tr_b16 a[130:131], v9 offset:20480
    v_mfma_f32_16x16x32_bf16 v[48:51], a[164:167], a[208:211], v[48:51]
    ds_read_b64_tr_b16 a[160:161], v9 offset:24576
    v_mfma_f32_16x16x32_bf16 v[52:55], a[132:135], a[196:199], v[52:55]
    ds_read_b64_tr_b16 a[162:163], v9 offset:28672
    v_mfma_f32_16x16x32_bf16 v[52:55], a[164:167], a[212:215], v[52:55]
    buffer_load_dwordx4 a[72:75], v7, s[40:43], s13 offen sc0 sc1
    v_mfma_f32_16x16x32_bf16 v[56:59], a[132:135], a[200:203], v[56:59]
    v_mfma_f32_16x16x32_bf16 v[56:59], a[164:167], a[216:219], v[56:59]
    buffer_load_dwordx4 a[76:79], v8, s[40:43], s13 offen sc0 sc1
    v_mfma_f32_16x16x32_bf16 v[60:63], a[132:135], a[204:207], v[60:63]
    s_add_u32 s13, s87, s9
    v_mfma_f32_16x16x32_bf16 v[60:63], a[164:167], a[220:223], v[60:63]
    ds_read_b64_tr_b16 a[132:133], v10 offset:16384
    s_add_u32 m0, s10, 0
    v_mfma_f32_16x16x32_bf16 v[64:67], a[136:139], a[192:195], v[64:67]
    ds_read_b64_tr_b16 a[134:135], v10 offset:20480
    s_lshl_b32 s12, s80, 6
    v_mfma_f32_16x16x32_bf16 v[64:67], a[168:171], a[208:211], v[64:67]
    ds_read_b64_tr_b16 a[164:165], v10 offset:24576
    s_add_u32 s12, s12, s8
    v_mfma_f32_16x16x32_bf16 v[68:71], a[136:139], a[196:199], v[68:71]
    ds_read_b64_tr_b16 a[166:167], v10 offset:28672
    v_mfma_f32_16x16x32_bf16 v[68:71], a[168:171], a[212:215], v[68:71]
    buffer_load_dwordx4 a[80:83], v5, s[40:43], s13 offen sc0 sc1
    v_mfma_f32_16x16x32_bf16 v[72:75], a[136:139], a[200:203], v[72:75]
    v_mfma_f32_16x16x32_bf16 v[72:75], a[168:171], a[216:219], v[72:75]
    buffer_load_dwordx4 a[84:87], v6, s[40:43], s13 offen sc0 sc1
    v_mfma_f32_16x16x32_bf16 v[76:79], a[136:139], a[204:207], v[76:79]
    v_mfma_f32_16x16x32_bf16 v[76:79], a[168:171], a[220:223], v[76:79]
    ds_read_b64_tr_b16 a[136:137], v11 offset:16384
    v_mfma_f32_16x16x32_bf16 v[80:83], a[140:143], a[192:195], v[80:83]
    ds_read_b64_tr_b16 a[138:139], v11 offset:20480
    v_mfma_f32_16x16x32_bf16 v[80:83], a[172:175], a[208:211], v[80:83]
    ds_read_b64_tr_b16 a[168:169], v11 offset:24576
    v_mfma_f32_16x16x32_bf16 v[84:87], a[140:143], a[196:199], v[84:87]
    ds_read_b64_tr_b16 a[170:171], v11 offset:28672
    v_mfma_f32_16x16x32_bf16 v[84:87], a[172:175], a[212:215], v[84:87]
    buffer_load_dwordx4 a[88:91], v7, s[40:43], s13 offen sc0 sc1
    v_mfma_f32_16x16x32_bf16 v[88:91], a[140:143], a[200:203], v[88:91]
    v_mfma_f32_16x16x32_bf16 v[88:91], a[172:175], a[216:219], v[88:91]
    buffer_load_dwordx4 a[92:95], v8, s[40:43], s13 offen sc0 sc1
    v_mfma_f32_16x16x32_bf16 v[92:95], a[140:143], a[204:207], v[92:95]
    s_add_u32 s9, s9, 0x2000
    v_mfma_f32_16x16x32_bf16 v[92:95], a[172:175], a[220:223], v[92:95]
    ds_read_b64_tr_b16 a[140:141], v12 offset:16384
    v_mfma_f32_16x16x32_bf16 v[96:99], a[144:147], a[192:195], v[96:99]
    ds_read_b64_tr_b16 a[142:143], v12 offset:20480
    v_mfma_f32_16x16x32_bf16 v[96:99], a[176:179], a[208:211], v[96:99]
    ds_read_b64_tr_b16 a[172:173], v12 offset:24576
    v_mfma_f32_16x16x32_bf16 v[100:103], a[144:147], a[196:199], v[100:103]
    ds_read_b64_tr_b16 a[174:175], v12 offset:28672
    v_mfma_f32_16x16x32_bf16 v[100:103], a[176:179], a[212:215], v[100:103]
    buffer_load_dwordx4 v246, s[44:47], s12 offen offset:0 lds
    v_mfma_f32_16x16x32_bf16 v[104:107], a[144:147], a[200:203], v[104:107]
    v_mfma_f32_16x16x32_bf16 v[104:107], a[176:179], a[216:219], v[104:107]
    buffer_load_dwordx4 v247, s[44:47], s12 offen offset:1024 lds
    v_mfma_f32_16x16x32_bf16 v[108:111], a[144:147], a[204:207], v[108:111]
    v_mfma_f32_16x16x32_bf16 v[108:111], a[176:179], a[220:223], v[108:111]
    ds_read_b64_tr_b16 a[144:145], v13 offset:16384
    v_mfma_f32_16x16x32_bf16 v[112:115], a[148:151], a[192:195], v[112:115]
    ds_read_b64_tr_b16 a[146:147], v13 offset:20480
    v_mfma_f32_16x16x32_bf16 v[112:115], a[180:183], a[208:211], v[112:115]
    ds_read_b64_tr_b16 a[176:177], v13 offset:24576
    v_mfma_f32_16x16x32_bf16 v[116:119], a[148:151], a[196:199], v[116:119]
    ds_read_b64_tr_b16 a[178:179], v13 offset:28672
    v_mfma_f32_16x16x32_bf16 v[116:119], a[180:183], a[212:215], v[116:119]
    buffer_load_dwordx4 v248, s[44:47], s12 offen offset:2048 lds
    v_mfma_f32_16x16x32_bf16 v[120:123], a[148:151], a[200:203], v[120:123]
    v_mfma_f32_16x16x32_bf16 v[120:123], a[180:183], a[216:219], v[120:123]
    buffer_load_dwordx4 v249, s[44:47], s12 offen offset:3072 lds
    v_mfma_f32_16x16x32_bf16 v[124:127], a[148:151], a[204:207], v[124:127]
    s_add_u32 m0, s10, 8192
    s_lshl_b32 s12, s81, 6
    v_mfma_f32_16x16x32_bf16 v[124:127], a[180:183], a[220:223], v[124:127]
    ds_read_b64_tr_b16 a[148:149], v14 offset:16384
    s_add_u32 s12, s12, s8
    v_mfma_f32_16x16x32_bf16 v[128:131], a[152:155], a[192:195], v[128:131]
    ds_read_b64_tr_b16 a[150:151], v14 offset:20480
    v_mfma_f32_16x16x32_bf16 v[128:131], a[184:187], a[208:211], v[128:131]
    ds_read_b64_tr_b16 a[180:181], v14 offset:24576
    v_mfma_f32_16x16x32_bf16 v[132:135], a[152:155], a[196:199], v[132:135]
    ds_read_b64_tr_b16 a[182:183], v14 offset:28672
    v_mfma_f32_16x16x32_bf16 v[132:135], a[184:187], a[212:215], v[132:135]
    buffer_load_dwordx4 v246, s[44:47], s12 offen offset:0 lds
    v_mfma_f32_16x16x32_bf16 v[136:139], a[152:155], a[200:203], v[136:139]
    v_mfma_f32_16x16x32_bf16 v[136:139], a[184:187], a[216:219], v[136:139]
    buffer_load_dwordx4 v247, s[44:47], s12 offen offset:1024 lds
    v_mfma_f32_16x16x32_bf16 v[140:143], a[152:155], a[204:207], v[140:143]
    v_mfma_f32_16x16x32_bf16 v[140:143], a[184:187], a[220:223], v[140:143]
    ds_read_b64_tr_b16 a[152:153], v15 offset:16384
    v_mfma_f32_16x16x32_bf16 v[144:147], a[156:159], a[192:195], v[144:147]
    ds_read_b64_tr_b16 a[154:155], v15 offset:20480
    v_mfma_f32_16x16x32_bf16 v[144:147], a[188:191], a[208:211], v[144:147]
    ds_read_b64_tr_b16 a[184:185], v15 offset:24576
    v_mfma_f32_16x16x32_bf16 v[148:151], a[156:159], a[196:199], v[148:151]
    ds_read_b64_tr_b16 a[186:187], v15 offset:28672
    v_mfma_f32_16x16x32_bf16 v[148:151], a[188:191], a[212:215], v[148:151]
    buffer_load_dwordx4 v248, s[44:47], s12 offen offset:2048 lds
    v_mfma_f32_16x16x32_bf16 v[152:155], a[156:159], a[200:203], v[152:155]
    v_mfma_f32_16x16x32_bf16 v[152:155], a[188:191], a[216:219], v[152:155]
    buffer_load_dwordx4 v249, s[44:47], s12 offen offset:3072 lds
    v_mfma_f32_16x16x32_bf16 v[156:159], a[156:159], a[204:207], v[156:159]
    v_mfma_f32_16x16x32_bf16 v[156:159], a[188:191], a[220:223], v[156:159]
    ds_read_b64_tr_b16 a[156:157], v16 offset:16384
    ds_read_b64_tr_b16 a[158:159], v16 offset:20480
    ds_read_b64_tr_b16 a[188:189], v16 offset:24576
    ds_read_b64_tr_b16 a[190:191], v16 offset:28672
    s_cmp_lg_u32 s95, 0
    s_cbranch_scc1 recurrent_scan__sliding_block_cached__glu_gated_glu__prompt_kernel_nosw
    v_cmp_ne_u64 vcc, s[98:99], v[30:31]
    s_cbranch_vccnz recurrent_scan__sliding_block_cached__glu_gated_glu__prompt_kernel_spinO
recurrent_scan__sliding_block_cached__glu_gated_glu__prompt_kernel_okO:
    s_add_u32 s40, s38, 0x1200000
    s_addc_u32 s41, s39, 0
    s_and_b32 s41, s41, 0xffff
    s_mov_b32 s42, 0x1000000
    s_mov_b32 s43, 0x20000
    s_mov_b32 s9, s96
    s_mov_b32 s97, s101
    v_mov_b32 v253, 0
    v_mov_b32 v5, v242
    v_mov_b32 v6, v243
    v_mov_b32 v7, v244
    v_mov_b32 v8, v245
recurrent_scan__sliding_block_cached__glu_gated_glu__prompt_kernel_nosw:
    s_waitcnt vmcnt(40)
    s_waitcnt lgkmcnt(8)
    v_mfma_f32_16x16x32_bf16 v[32:35], a[128:131], a[0:3], v[32:35]
    s_add_u32 s13, s80, s9
    v_mfma_f32_16x16x32_bf16 v[32:35], a[160:163], a[16:19], v[32:35]
    v_mfma_f32_16x16x32_bf16 v[36:39], a[128:131], a[4:7], v[36:39]
    v_mfma_f32_16x16x32_bf16 v[36:39], a[160:163], a[20:23], v[36:39]
    buffer_load_dwordx4 a[192:195], v5, s[40:43], s13 offen sc0 sc1
    v_mfma_f32_16x16x32_bf16 v[40:43], a[128:131], a[8:11], v[40:43]
    buffer_load_dwordx2 v[30:31], v253, s[48:51], s97 offen sc0 sc1
    v_mfma_f32_16x16x32_bf16 v[40:43], a[160:163], a[24:27], v[40:43]
    buffer_load_dwordx4 a[196:199], v6, s[40:43], s13 offen sc0 sc1
    v_mfma_f32_16x16x32_bf16 v[44:47], a[128:131], a[12:15], v[44:47]
    v_mfma_f32_16x16x32_bf16 v[44:47], a[160:163], a[28:31], v[44:47]
    s_waitcnt vmcnt(35)
    s_waitcnt lgkmcnt(0)
    s_barrier
    ds_read_b64_tr_b16 a[128:129], v17 offset:0
    v_mfma_f32_16x16x32_bf16 v[48:51], a[132:135], a[0:3], v[48:51]
    ds_read_b64_tr_b16 a[130:131], v17 offset:4096
    v_mfma_f32_16x16x32_bf16 v[48:51], a[164:167], a[16:19], v[48:51]
    ds_read_b64_tr_b16 a[160:161], v17 offset:8192
    v_mfma_f32_16x16x32_bf16 v[52:55], a[132:135], a[4:7], v[52:55]
    ds_read_b64_tr_b16 a[162:163], v17 offset:12288
    v_mfma_f32_16x16x32_bf16 v[52:55], a[164:167], a[20:23], v[52:55]
    buffer_load_dwordx4 a[200:203], v7, s[40:43], s13 offen sc0 sc1
    v_mfma_f32_16x16x32_bf16 v[56:59], a[132:135], a[8:11], v[56:59]
    v_mfma_f32_16x16x32_bf16 v[56:59], a[164:167], a[24:27], v[56:59]
    buffer_load_dwordx4 a[204:207], v8, s[40:43], s13 offen sc0 sc1
    v_mfma_f32_16x16x32_bf16 v[60:63], a[132:135], a[12:15], v[60:63]
    s_add_u32 s13, s81, s9
    v_mfma_f32_16x16x32_bf16 v[60:63], a[164:167], a[28:31], v[60:63]
    ds_read_b64_tr_b16 a[132:133], v18 offset:0
    s_add_u32 m0, s10, 16384
    v_mfma_f32_16x16x32_bf16 v[64:67], a[136:139], a[0:3], v[64:67]
    ds_read_b64_tr_b16 a[134:135], v18 offset:4096
    s_lshl_b32 s12, s82, 6
    v_mfma_f32_16x16x32_bf16 v[64:67], a[168:171], a[16:19], v[64:67]
    ds_read_b64_tr_b16 a[164:165], v18 offset:8192
    s_add_u32 s12, s12, s8
    v_mfma_f32_16x16x32_bf16 v[68:71], a[136:139], a[4:7], v[68:71]
    ds_read_b64_tr_b16 a[166:167], v18 offset:12288
    v_mfma_f32_16x16x32_bf16 v[68:71], a[168:171], a[20:23], v[68:71]
    buffer_load_dwordx4 a[208:211], v5, s[40:43], s13 offen sc0 sc1
    v_mfma_f32_16x16x32_bf16 v[72:75], a[136:139], a[8:11], v[72:75]
    v_mfma_f32_16x16x32_bf16 v[72:75], a[168:171], a[24:27], v[72:75]
    buffer_load_dwordx4 a[212:215], v6, s[40:43], s13 offen sc0 sc1
    v_mfma_f32_16x16x32_bf16 v[76:79], a[136:139], a[12:15], v[76:79]
    v_mfma_f32_16x16x32_bf16 v[76:79], a[168:171], a[28:31], v[76:79]
    ds_read_b64_tr_b16 a[136:137], v19 offset:0
    v_mfma_f32_16x16x32_bf16 v[80:83], a[140:143], a[0:3], v[80:83]
    ds_read_b64_tr_b16 a[138:139], v19 offset:4096
    v_mfma_f32_16x16x32_bf16 v[80:83], a[172:175], a[16:19], v[80:83]
    ds_read_b64_tr_b16 a[168:169], v19 offset:8192
    v_mfma_f32_16x16x32_bf16 v[84:87], a[140:143], a[4:7], v[84:87]
    ds_read_b64_tr_b16 a[170:171], v19 offset:12288
    v_mfma_f32_16x16x32_bf16 v[84:87], a[172:175], a[20:23], v[84:87]
    buffer_load_dwordx4 a[216:219], v7, s[40:43], s13 offen sc0 sc1
    v_mfma_f32_16x16x32_bf16 v[88:91], a[140:143], a[8:11], v[88:91]
    v_mfma_f32_16x16x32_bf16 v[88:91], a[172:175], a[24:27], v[88:91]
    buffer_load_dwordx4 a[220:223], v8, s[40:43], s13 offen sc0 sc1
    v_mfma_f32_16x16x32_bf16 v[92:95], a[140:143], a[12:15], v[92:95]
    v_mfma_f32_16x16x32_bf16 v[92:95], a[172:175], a[28:31], v[92:95]
    ds_read_b64_tr_b16 a[140:141], v20 offset:0
    v_mfma_f32_16x16x32_bf16 v[96:99], a[144:147], a[0:3], v[96:99]
    ds_read_b64_tr_b16 a[142:143], v20 offset:4096
    v_mfma_f32_16x16x32_bf16 v[96:99], a[176:179], a[16:19], v[96:99]
    ds_read_b64_tr_b16 a[172:173], v20 offset:8192
    v_mfma_f32_16x16x32_bf16 v[100:103], a[144:147], a[4:7], v[100:103]
    ds_read_b64_tr_b16 a[174:175], v20 offset:12288
    v_mfma_f32_16x16x32_bf16 v[100:103], a[176:179], a[20:23], v[100:103]
    buffer_load_dwordx4 v246, s[44:47], s12 offen offset:0 lds
    v_mfma_f32_16x16x32_bf16 v[104:107], a[144:147], a[8:11], v[104:107]
    v_mfma_f32_16x16x32_bf16 v[104:107], a[176:179], a[24:27], v[104:107]
    buffer_load_dwordx4 v247, s[44:47], s12 offen offset:1024 lds
    v_mfma_f32_16x16x32_bf16 v[108:111], a[144:147], a[12:15], v[108:111]
    v_mfma_f32_16x16x32_bf16 v[108:111], a[176:179], a[28:31], v[108:111]
    ds_read_b64_tr_b16 a[144:145], v21 offset:0
    v_mfma_f32_16x16x32_bf16 v[112:115], a[148:151], a[0:3], v[112:115]
    ds_read_b64_tr_b16 a[146:147], v21 offset:4096
    v_mfma_f32_16x16x32_bf16 v[112:115], a[180:183], a[16:19], v[112:115]
    ds_read_b64_tr_b16 a[176:177], v21 offset:8192
    v_mfma_f32_16x16x32_bf16 v[116:119], a[148:151], a[4:7], v[116:119]
    ds_read_b64_tr_b16 a[178:179], v21 offset:12288
    v_mfma_f32_16x16x32_bf16 v[116:119], a[180:183], a[20:23], v[116:119]
    buffer_load_dwordx4 v248, s[44:47], s12 offen offset:2048 lds
    v_mfma_f32_16x16x32_bf16 v[120:123], a[148:151], a[8:11], v[120:123]
    v_mfma_f32_16x16x32_bf16 v[120:123], a[180:183], a[24:27], v[120:123]
    buffer_load_dwordx4 v249, s[44:47], s12 offen offset:3072 lds
    v_mfma_f32_16x16x32_bf16 v[124:127], a[148:151], a[12:15], v[124:127]
    s_add_u32 m0, s10, 24576
    s_lshl_b32 s12, s83, 6
    v_mfma_f32_16x16x32_bf16 v[124:127], a[180:183], a[28:31], v[124:127]
    ds_read_b64_tr_b16 a[148:149], v22 offset:0
    s_add_u32 s12, s12, s8
    v_mfma_f32_16x16x32_bf16 v[128:131], a[152:155], a[0:3], v[128:131]
    ds_read_b64_tr_b16 a[150:151], v22 offset:4096
    v_mfma_f32_16x16x32_bf16 v[128:131], a[184:187], a[16:19], v[128:131]
    ds_read_b64_tr_b16 a[180:181], v22 offset:8192
    v_mfma_f32_16x16x32_bf16 v[132:135], a[152:155], a[4:7], v[132:135]
    ds_read_b64_tr_b16 a[182:183], v22 offset:12288
    v_mfma_f32_16x16x32_bf16 v[132:135], a[184:187], a[20:23], v[132:135]
    buffer_load_dwordx4 v246, s[44:47], s12 offen offset:0 lds
    v_mfma_f32_16x16x32_bf16 v[136:139], a[152:155], a[8:11], v[136:139]
    v_mfma_f32_16x16x32_bf16 v[136:139], a[184:187], a[24:27], v[136:139]
    buffer_load_dwordx4 v247, s[44:47], s12 offen offset:1024 lds
    v_mfma_f32_16x16x32_bf16 v[140:143], a[152:155], a[12:15], v[140:143]
    v_mfma_f32_16x16x32_bf16 v[140:143], a[184:187], a[28:31], v[140:143]
    ds_read_b64_tr_b16 a[152:153], v23 offset:0
    v_mfma_f32_16x16x32_bf16 v[144:147], a[156:159], a[0:3], v[144:147]
    ds_read_b64_tr_b16 a[154:155], v23 offset:4096
    v_mfma_f32_16x16x32_bf16 v[144:147], a[188:191], a[16:19], v[144:147]
    ds_read_b64_tr_b16 a[184:185], v23 offset:8192
    v_mfma_f32_16x16x32_bf16 v[148:151], a[156:159], a[4:7], v[148:151]
    ds_read_b64_tr_b16 a[186:187], v23 offset:12288
    v_mfma_f32_16x16x32_bf16 v[148:151], a[188:191], a[20:23], v[148:151]
    buffer_load_dwordx4 v248, s[44:47], s12 offen offset:2048 lds
    v_mfma_f32_16x16x32_bf16 v[152:155], a[156:159], a[8:11], v[152:155]
    v_mfma_f32_16x16x32_bf16 v[152:155], a[188:191], a[24:27], v[152:155]
    buffer_load_dwordx4 v249, s[44:47], s12 offen offset:3072 lds
    v_mfma_f32_16x16x32_bf16 v[156:159], a[156:159], a[12:15], v[156:159]
    v_mfma_f32_16x16x32_bf16 v[156:159], a[188:191], a[28:31], v[156:159]
    ds_read_b64_tr_b16 a[156:157], v24 offset:0
    ds_read_b64_tr_b16 a[158:159], v24 offset:4096
    ds_read_b64_tr_b16 a[188:189], v24 offset:8192
    ds_read_b64_tr_b16 a[190:191], v24 offset:12288
    s_waitcnt vmcnt(41)
    s_waitcnt lgkmcnt(8)
    v_mfma_f32_16x16x32_bf16 v[32:35], a[128:131], a[32:35], v[32:35]
    s_add_u32 s13, s82, s9
    v_mfma_f32_16x16x32_bf16 v[32:35], a[160:163], a[48:51], v[32:35]
    v_mfma_f32_16x16x32_bf16 v[36:39], a[128:131], a[36:39], v[36:39]
    v_mfma_f32_16x16x32_bf16 v[36:39], a[160:163], a[52:55], v[36:39]
    buffer_load_dwordx4 a[0:3], v5, s[40:43], s13 offen sc0 sc1
    v_mfma_f32_16x16x32_bf16 v[40:43], a[128:131], a[40:43], v[40:43]
    v_mfma_f32_16x16x32_bf16 v[40:43], a[160:163], a[56:59], v[40:43]
    buffer_load_dwordx4 a[4:7], v6, s[40:43], s13 offen sc0 sc1
    v_mfma_f32_16x16x32_bf16 v[44:47], a[128:131], a[44:47], v[44:47]
    v_mfma_f32_16x16x32_bf16 v[44:47], a[160:163], a[60:63], v[44:47]
    s_waitcnt vmcnt(35)
    s_waitcnt lgkmcnt(0)
    s_barrier
    ds_read_b64_tr_b16 a[128:129], v17 offset:16384
    v_mfma_f32_16x16x32_bf16 v[48:51], a[132:135], a[32:35], v[48:51]
    ds_read_b64_tr_b16 a[130:131], v17 offset:20480
    v_mfma_f32_16x16x32_bf16 v[48:51], a[164:167], a[48:51], v[48:51]
    ds_read_b64_tr_b16 a[160:161], v17 offset:24576
    v_mfma_f32_16x16x32_bf16 v[52:55], a[132:135], a[36:39], v[52:55]
    ds_read_b64_tr_b16 a[162:163], v17 offset:28672
    v_mfma_f32_16x16x32_bf16 v[52:55], a[164:167], a[52:55], v[52:55]
    buffer_load_dwordx4 a[8:11], v7, s[40:43], s13 offen sc0 sc1
    v_mfma_f32_16x16x32_bf16 v[56:59], a[132:135], a[40:43], v[56:59]
    v_mfma_f32_16x16x32_bf16 v[56:59], a[164:167], a[56:59], v[56:59]
    buffer_load_dwordx4 a[12:15], v8, s[40:43], s13 offen sc0 sc1
    v_mfma_f32_16x16x32_bf16 v[60:63], a[132:135], a[44:47], v[60:63]
    s_add_u32 s13, s83, s9
    v_mfma_f32_16x16x32_bf16 v[60:63], a[164:167], a[60:63], v[60:63]
    ds_read_b64_tr_b16 a[132:133], v18 offset:16384
    s_add_u32 m0, s11, 0
    v_mfma_f32_16x16x32_bf16 v[64:67], a[136:139], a[32:35], v[64:67]
    ds_read_b64_tr_b16 a[134:135], v18 offset:20480
    s_lshl_b32 s12, s84, 6
    v_mfma_f32_16x16x32_bf16 v[64:67], a[168:171], a[48:51], v[64:67]
    ds_read_b64_tr_b16 a[164:165], v18 offset:24576
    s_add_u32 s12, s12, s8
    v_mfma_f32_16x16x32_bf16 v[68:71], a[136:139], a[36:39], v[68:71]
    ds_read_b64_tr_b16 a[166:167], v18 offset:28672
    v_mfma_f32_16x16x32_bf16 v[68:71], a[168:171], a[52:55], v[68:71]
    buffer_load_dwordx4 a[16:19], v5, s[40:43], s13 offen sc0 sc1
    v_mfma_f32_16x16x32_bf16 v[72:75], a[136:139], a[40:43], v[72:75]
    v_mfma_f32_16x16x32_bf16 v[72:75], a[168:171], a[56:59], v[72:75]
    buffer_load_dwordx4 a[20:23], v6, s[40:43], s13 offen sc0 sc1
    v_mfma_f32_16x16x32_bf16 v[76:79], a[136:139], a[44:47], v[76:79]
    v_mfma_f32_16x16x32_bf16 v[76:79], a[168:171], a[60:63], v[76:79]
    ds_read_b64_tr_b16 a[136:137], v19 offset:16384
    v_mfma_f32_16x16x32_bf16 v[80:83], a[140:143], a[32:35], v[80:83]
    ds_read_b64_tr_b16 a[138:139], v19 offset:20480
    v_mfma_f32_16x16x32_bf16 v[80:83], a[172:175], a[48:51], v[80:83]
    ds_read_b64_tr_b16 a[168:169], v19 offset:24576
    v_mfma_f32_16x16x32_bf16 v[84:87], a[140:143], a[36:39], v[84:87]
    ds_read_b64_tr_b16 a[170:171], v19 offset:28672
    v_mfma_f32_16x16x32_bf16 v[84:87], a[172:175], a[52:55], v[84:87]
    buffer_load_dwordx4 a[24:27], v7, s[40:43], s13 offen sc0 sc1
    v_mfma_f32_16x16x32_bf16 v[88:91], a[140:143], a[40:43], v[88:91]
    v_mfma_f32_16x16x32_bf16 v[88:91], a[172:175], a[56:59], v[88:91]
    buffer_load_dwordx4 a[28:31], v8, s[40:43], s13 offen sc0 sc1
    v_mfma_f32_16x16x32_bf16 v[92:95], a[140:143], a[44:47], v[92:95]
    v_mfma_f32_16x16x32_bf16 v[92:95], a[172:175], a[60:63], v[92:95]
    ds_read_b64_tr_b16 a[140:141], v20 offset:16384
    v_mfma_f32_16x16x32_bf16 v[96:99], a[144:147], a[32:35], v[96:99]
    ds_read_b64_tr_b16 a[142:143], v20 offset:20480
    v_mfma_f32_16x16x32_bf16 v[96:99], a[176:179], a[48:51], v[96:99]
    ds_read_b64_tr_b16 a[172:173], v20 offset:24576
    v_mfma_f32_16x16x32_bf16 v[100:103], a[144:147], a[36:39], v[100:103]
    ds_read_b64_tr_b16 a[174:175], v20 offset:28672
    v_mfma_f32_16x16x32_bf16 v[100:103], a[176:179], a[52:55], v[100:103]
    buffer_load_dwordx4 v246, s[44:47], s12 offen offset:0 lds
    v_mfma_f32_16x16x32_bf16 v[104:107], a[144:147], a[40:43], v[104:107]
    v_mfma_f32_16x16x32_bf16 v[104:107], a[176:179], a[56:59], v[104:107]
    buffer_load_dwordx4 v247, s[44:47], s12 offen offset:1024 lds
    v_mfma_f32_16x16x32_bf16 v[108:111], a[144:147], a[44:47], v[108:111]
    v_mfma_f32_16x16x32_bf16 v[108:111], a[176:179], a[60:63], v[108:111]
    ds_read_b64_tr_b16 a[144:145], v21 offset:16384
    v_mfma_f32_16x16x32_bf16 v[112:115], a[148:151], a[32:35], v[112:115]
    ds_read_b64_tr_b16 a[146:147], v21 offset:20480
    v_mfma_f32_16x16x32_bf16 v[112:115], a[180:183], a[48:51], v[112:115]
    ds_read_b64_tr_b16 a[176:177], v21 offset:24576
    v_mfma_f32_16x16x32_bf16 v[116:119], a[148:151], a[36:39], v[116:119]
    ds_read_b64_tr_b16 a[178:179], v21 offset:28672
    v_mfma_f32_16x16x32_bf16 v[116:119], a[180:183], a[52:55], v[116:119]
    buffer_load_dwordx4 v248, s[44:47], s12 offen offset:2048 lds
    v_mfma_f32_16x16x32_bf16 v[120:123], a[148:151], a[40:43], v[120:123]
    v_mfma_f32_16x16x32_bf16 v[120:123], a[180:183], a[56:59], v[120:123]
    buffer_load_dwordx4 v249, s[44:47], s12 offen offset:3072 lds
    v_mfma_f32_16x16x32_bf16 v[124:127], a[148:151], a[44:47], v[124:127]
    s_add_u32 m0, s11, 8192
    s_lshl_b32 s12, s85, 6
    v_mfma_f32_16x16x32_bf16 v[124:127], a[180:183], a[60:63], v[124:127]
    ds_read_b64_tr_b16 a[148:149], v22 offset:16384
    s_add_u32 s12, s12, s8
    v_mfma_f32_16x16x32_bf16 v[128:131], a[152:155], a[32:35], v[128:131]
    ds_read_b64_tr_b16 a[150:151], v22 offset:20480
    v_mfma_f32_16x16x32_bf16 v[128:131], a[184:187], a[48:51], v[128:131]
    ds_read_b64_tr_b16 a[180:181], v22 offset:24576
    v_mfma_f32_16x16x32_bf16 v[132:135], a[152:155], a[36:39], v[132:135]
    ds_read_b64_tr_b16 a[182:183], v22 offset:28672
    v_mfma_f32_16x16x32_bf16 v[132:135], a[184:187], a[52:55], v[132:135]
    buffer_load_dwordx4 v246, s[44:47], s12 offen offset:0 lds
    v_mfma_f32_16x16x32_bf16 v[136:139], a[152:155], a[40:43], v[136:139]
    v_mfma_f32_16x16x32_bf16 v[136:139], a[184:187], a[56:59], v[136:139]
    buffer_load_dwordx4 v247, s[44:47], s12 offen offset:1024 lds
    v_mfma_f32_16x16x32_bf16 v[140:143], a[152:155], a[44:47], v[140:143]
    v_mfma_f32_16x16x32_bf16 v[140:143], a[184:187], a[60:63], v[140:143]
    ds_read_b64_tr_b16 a[152:153], v23 offset:16384
    v_mfma_f32_16x16x32_bf16 v[144:147], a[156:159], a[32:35], v[144:147]
    ds_read_b64_tr_b16 a[154:155], v23 offset:20480
    v_mfma_f32_16x16x32_bf16 v[144:147], a[188:191], a[48:51], v[144:147]
    ds_read_b64_tr_b16 a[184:185], v23 offset:24576
    v_mfma_f32_16x16x32_bf16 v[148:151], a[156:159], a[36:39], v[148:151]
    ds_read_b64_tr_b16 a[186:187], v23 offset:28672
    v_mfma_f32_16x16x32_bf16 v[148:151], a[188:191], a[52:55], v[148:151]
    buffer_load_dwordx4 v248, s[44:47], s12 offen offset:2048 lds
    v_mfma_f32_16x16x32_bf16 v[152:155], a[156:159], a[40:43], v[152:155]
    v_mfma_f32_16x16x32_bf16 v[152:155], a[188:191], a[56:59], v[152:155]
    buffer_load_dwordx4 v249, s[44:47], s12 offen offset:3072 lds
    v_mfma_f32_16x16x32_bf16 v[156:159], a[156:159], a[44:47], v[156:159]
    v_mfma_f32_16x16x32_bf16 v[156:159], a[188:191], a[60:63], v[156:159]
    ds_read_b64_tr_b16 a[156:157], v24 offset:16384
    ds_read_b64_tr_b16 a[158:159], v24 offset:20480
    ds_read_b64_tr_b16 a[188:189], v24 offset:24576
    ds_read_b64_tr_b16 a[190:191], v24 offset:28672
    s_waitcnt vmcnt(41)
    s_waitcnt lgkmcnt(8)
    v_mfma_f32_16x16x32_bf16 v[32:35], a[128:131], a[64:67], v[32:35]
    s_add_u32 s13, s84, s9
    v_mfma_f32_16x16x32_bf16 v[32:35], a[160:163], a[80:83], v[32:35]
    v_mfma_f32_16x16x32_bf16 v[36:39], a[128:131], a[68:71], v[36:39]
    v_mfma_f32_16x16x32_bf16 v[36:39], a[160:163], a[84:87], v[36:39]
    buffer_load_dwordx4 a[32:35], v5, s[40:43], s13 offen sc0 sc1
    v_mfma_f32_16x16x32_bf16 v[40:43], a[128:131], a[72:75], v[40:43]
    v_mfma_f32_16x16x32_bf16 v[40:43], a[160:163], a[88:91], v[40:43]
    buffer_load_dwordx4 a[36:39], v6, s[40:43], s13 offen sc0 sc1
    v_mfma_f32_16x16x32_bf16 v[44:47], a[128:131], a[76:79], v[44:47]
    v_mfma_f32_16x16x32_bf16 v[44:47], a[160:163], a[92:95], v[44:47]
    s_waitcnt vmcnt(35)
    s_waitcnt lgkmcnt(0)
    s_barrier
    ds_read_b64_tr_b16 a[128:129], v9 offset:0
    v_mfma_f32_16x16x32_bf16 v[48:51], a[132:135], a[64:67], v[48:51]
    ds_read_b64_tr_b16 a[130:131], v9 offset:4096
    v_mfma_f32_16x16x32_bf16 v[48:51], a[164:167], a[80:83], v[48:51]
    ds_read_b64_tr_b16 a[160:161], v9 offset:8192
    v_mfma_f32_16x16x32_bf16 v[52:55], a[132:135], a[68:71], v[52:55]
    ds_read_b64_tr_b16 a[162:163], v9 offset:12288
    v_mfma_f32_16x16x32_bf16 v[52:55], a[164:167], a[84:87], v[52:55]
    buffer_load_dwordx4 a[40:43], v7, s[40:43], s13 offen sc0 sc1
    v_mfma_f32_16x16x32_bf16 v[56:59], a[132:135], a[72:75], v[56:59]
    v_mfma_f32_16x16x32_bf16 v[56:59], a[164:167], a[88:91], v[56:59]
    buffer_load_dwordx4 a[44:47], v8, s[40:43], s13 offen sc0 sc1
    v_mfma_f32_16x16x32_bf16 v[60:63], a[132:135], a[76:79], v[60:63]
    s_add_u32 s13, s85, s9
    v_mfma_f32_16x16x32_bf16 v[60:63], a[164:167], a[92:95], v[60:63]
    ds_read_b64_tr_b16 a[132:133], v10 offset:0
    s_add_u32 m0, s11, 16384
    v_mfma_f32_16x16x32_bf16 v[64:67], a[136:139], a[64:67], v[64:67]
    ds_read_b64_tr_b16 a[134:135], v10 offset:4096
    s_lshl_b32 s12, s86, 6
    v_mfma_f32_16x16x32_bf16 v[64:67], a[168:171], a[80:83], v[64:67]
    ds_read_b64_tr_b16 a[164:165], v10 offset:8192
    s_add_u32 s12, s12, s8
    v_mfma_f32_16x16x32_bf16 v[68:71], a[136:139], a[68:71], v[68:71]
    ds_read_b64_tr_b16 a[166:167], v10 offset:12288
    v_mfma_f32_16x16x32_bf16 v[68:71], a[168:171], a[84:87], v[68:71]
    buffer_load_dwordx4 a[48:51], v5, s[40:43], s13 offen sc0 sc1
    v_mfma_f32_16x16x32_bf16 v[72:75], a[136:139], a[72:75], v[72:75]
    v_mfma_f32_16x16x32_bf16 v[72:75], a[168:171], a[88:91], v[72:75]
    buffer_load_dwordx4 a[52:55], v6, s[40:43], s13 offen sc0 sc1
    v_mfma_f32_16x16x32_bf16 v[76:79], a[136:139], a[76:79], v[76:79]
    v_mfma_f32_16x16x32_bf16 v[76:79], a[168:171], a[92:95], v[76:79]
    ds_read_b64_tr_b16 a[136:137], v11 offset:0
    v_mfma_f32_16x16x32_bf16 v[80:83], a[140:143], a[64:67], v[80:83]
    ds_read_b64_tr_b16 a[138:139], v11 offset:4096
    v_mfma_f32_16x16x32_bf16 v[80:83], a[172:175], a[80:83], v[80:83]
    ds_read_b64_tr_b16 a[168:169], v11 offset:8192
    v_mfma_f32_16x16x32_bf16 v[84:87], a[140:143], a[68:71], v[84:87]
    ds_read_b64_tr_b16 a[170:171], v11 offset:12288
    v_mfma_f32_16x16x32_bf16 v[84:87], a[172:175], a[84:87], v[84:87]
    buffer_load_dwordx4 a[56:59], v7, s[40:43], s13 offen sc0 sc1
    v_mfma_f32_16x16x32_bf16 v[88:91], a[140:143], a[72:75], v[88:91]
    v_mfma_f32_16x16x32_bf16 v[88:91], a[172:175], a[88:91], v[88:91]
    buffer_load_dwordx4 a[60:63], v8, s[40:43], s13 offen sc0 sc1
    v_mfma_f32_16x16x32_bf16 v[92:95], a[140:143], a[76:79], v[92:95]
    v_mfma_f32_16x16x32_bf16 v[92:95], a[172:175], a[92:95], v[92:95]
    ds_read_b64_tr_b16 a[140:141], v12 offset:0
    v_mfma_f32_16x16x32_bf16 v[96:99], a[144:147], a[64:67], v[96:99]
    ds_read_b64_tr_b16 a[142:143], v12 offset:4096
    v_mfma_f32_16x16x32_bf16 v[96:99], a[176:179], a[80:83], v[96:99]
    ds_read_b64_tr_b16 a[172:173], v12 offset:8192
    v_mfma_f32_16x16x32_bf16 v[100:103], a[144:147], a[68:71], v[100:103]
    ds_read_b64_tr_b16 a[174:175], v12 offset:12288
    v_mfma_f32_16x16x32_bf16 v[100:103], a[176:179], a[84:87], v[100:103]
    buffer_load_dwordx4 v246, s[44:47], s12 offen offset:0 lds
    v_mfma_f32_16x16x32_bf16 v[104:107], a[144:147], a[72:75], v[104:107]
    v_mfma_f32_16x16x32_bf16 v[104:107], a[176:179], a[88:91], v[104:107]
    buffer_load_dwordx4 v247, s[44:47], s12 offen offset:1024 lds
    v_mfma_f32_16x16x32_bf16 v[108:111], a[144:147], a[76:79], v[108:111]
    v_mfma_f32_16x16x32_bf16 v[108:111], a[176:179], a[92:95], v[108:111]
    ds_read_b64_tr_b16 a[144:145], v13 offset:0
    v_mfma_f32_16x16x32_bf16 v[112:115], a[148:151], a[64:67], v[112:115]
    ds_read_b64_tr_b16 a[146:147], v13 offset:4096
    v_mfma_f32_16x16x32_bf16 v[112:115], a[180:183], a[80:83], v[112:115]
    ds_read_b64_tr_b16 a[176:177], v13 offset:8192
    v_mfma_f32_16x16x32_bf16 v[116:119], a[148:151], a[68:71], v[116:119]
    ds_read_b64_tr_b16 a[178:179], v13 offset:12288
    v_mfma_f32_16x16x32_bf16 v[116:119], a[180:183], a[84:87], v[116:119]
    buffer_load_dwordx4 v248, s[44:47], s12 offen offset:2048 lds
    v_mfma_f32_16x16x32_bf16 v[120:123], a[148:151], a[72:75], v[120:123]
    v_mfma_f32_16x16x32_bf16 v[120:123], a[180:183], a[88:91], v[120:123]
    buffer_load_dwordx4 v249, s[44:47], s12 offen offset:3072 lds
    v_mfma_f32_16x16x32_bf16 v[124:127], a[148:151], a[76:79], v[124:127]
    s_add_u32 m0, s11, 24576
    s_lshl_b32 s12, s87, 6
    v_mfma_f32_16x16x32_bf16 v[124:127], a[180:183], a[92:95], v[124:127]
    ds_read_b64_tr_b16 a[148:149], v14 offset:0
    s_add_u32 s12, s12, s8
    v_mfma_f32_16x16x32_bf16 v[128:131], a[152:155], a[64:67], v[128:131]
    ds_read_b64_tr_b16 a[150:151], v14 offset:4096
    v_mfma_f32_16x16x32_bf16 v[128:131], a[184:187], a[80:83], v[128:131]
    ds_read_b64_tr_b16 a[180:181], v14 offset:8192
    v_mfma_f32_16x16x32_bf16 v[132:135], a[152:155], a[68:71], v[132:135]
    ds_read_b64_tr_b16 a[182:183], v14 offset:12288
    v_mfma_f32_16x16x32_bf16 v[132:135], a[184:187], a[84:87], v[132:135]
    buffer_load_dwordx4 v246, s[44:47], s12 offen offset:0 lds
    v_mfma_f32_16x16x32_bf16 v[136:139], a[152:155], a[72:75], v[136:139]
    v_mfma_f32_16x16x32_bf16 v[136:139], a[184:187], a[88:91], v[136:139]
    buffer_load_dwordx4 v247, s[44:47], s12 offen offset:1024 lds
    v_mfma_f32_16x16x32_bf16 v[140:143], a[152:155], a[76:79], v[140:143]
    v_mfma_f32_16x16x32_bf16 v[140:143], a[184:187], a[92:95], v[140:143]
    ds_read_b64_tr_b16 a[152:153], v15 offset:0
    v_mfma_f32_16x16x32_bf16 v[144:147], a[156:159], a[64:67], v[144:147]
    ds_read_b64_tr_b16 a[154:155], v15 offset:4096
    v_mfma_f32_16x16x32_bf16 v[144:147], a[188:191], a[80:83], v[144:147]
    ds_read_b64_tr_b16 a[184:185], v15 offset:8192
    v_mfma_f32_16x16x32_bf16 v[148:151], a[156:159], a[68:71], v[148:151]
    ds_read_b64_tr_b16 a[186:187], v15 offset:12288
    v_mfma_f32_16x16x32_bf16 v[148:151], a[188:191], a[84:87], v[148:151]
    buffer_load_dwordx4 v248, s[44:47], s12 offen offset:2048 lds
    v_mfma_f32_16x16x32_bf16 v[152:155], a[156:159], a[72:75], v[152:155]
    v_mfma_f32_16x16x32_bf16 v[152:155], a[188:191], a[88:91], v[152:155]
    buffer_load_dwordx4 v249, s[44:47], s12 offen offset:3072 lds
    v_mfma_f32_16x16x32_bf16 v[156:159], a[156:159], a[76:79], v[156:159]
    s_add_u32 s8, s8, 0x80000
    v_mfma_f32_16x16x32_bf16 v[156:159], a[188:191], a[92:95], v[156:159]
    ds_read_b64_tr_b16 a[156:157], v16 offset:0
    ds_read_b64_tr_b16 a[158:159], v16 offset:4096
    ds_read_b64_tr_b16 a[188:189], v16 offset:8192
    ds_read_b64_tr_b16 a[190:191], v16 offset:12288
    s_sub_u32 s95, s95, 1
    s_sub_u32 s90, s90, 1
    s_cmp_lg_u32 s90, 0
    s_cbranch_scc1 recurrent_scan__sliding_block_cached__glu_gated_glu__prompt_kernel_floop
    s_cmp_lg_u32 s91, 0
    s_cbranch_scc1 recurrent_scan__sliding_block_cached__glu_gated_glu__prompt_kernel_flast
    s_nop 2
    v_cvt_pk_bf16_f32 v160, v40, v41
    v_cvt_pk_bf16_f32 v161, v42, v43
    v_cvt_pk_bf16_f32 v162, v56, v57
    v_cvt_pk_bf16_f32 v163, v58, v59
    ds_write_b128 v254, v[160:163] offset:0
    v_cvt_pk_bf16_f32 v176, v72, v73
    v_cvt_pk_bf16_f32 v177, v74, v75
    v_cvt_pk_bf16_f32 v178, v88, v89
    v_cvt_pk_bf16_f32 v179, v90, v91
    ds_write_b128 v254, v[176:179] offset:1024
    v_cvt_pk_bf16_f32 v192, v104, v105
    v_cvt_pk_bf16_f32 v193, v106, v107
    v_cvt_pk_bf16_f32 v194, v120, v121
    v_cvt_pk_bf16_f32 v195, v122, v123
    ds_write_b128 v254, v[192:195] offset:2048
    v_cvt_pk_bf16_f32 v208, v136, v137
    v_cvt_pk_bf16_f32 v209, v138, v139
    v_cvt_pk_bf16_f32 v210, v152, v153
    v_cvt_pk_bf16_f32 v211, v154, v155
    ds_write_b128 v254, v[208:211] offset:3072
    v_cvt_pk_bf16_f32 v164, v44, v45
    v_cvt_pk_bf16_f32 v165, v46, v47
    v_cvt_pk_bf16_f32 v166, v60, v61
    v_cvt_pk_bf16_f32 v167, v62, v63
    ds_write_b128 v254, v[164:167] offset:4096
    v_cvt_pk_bf16_f32 v180, v76, v77
    v_cvt_pk_bf16_f32 v181, v78, v79
    v_cvt_pk_bf16_f32 v182, v92, v93
    v_cvt_pk_bf16_f32 v183, v94, v95
    ds_write_b128 v254, v[180:183] offset:5120
    v_cvt_pk_bf16_f32 v196, v108, v109
    v_cvt_pk_bf16_f32 v197, v110, v111
    v_cvt_pk_bf16_f32 v198, v124, v125
    v_cvt_pk_bf16_f32 v199, v126, v127
    ds_write_b128 v254, v[196:199] offset:6144
    v_cvt_pk_bf16_f32 v212, v140, v141
    v_cvt_pk_bf16_f32 v213, v142, v143
    v_cvt_pk_bf16_f32 v214, v156, v157
    v_cvt_pk_bf16_f32 v215, v158, v159
    ds_write_b128 v254, v[212:215] offset:7168
    s_waitcnt lgkmcnt(0)
    s_barrier
    ds_read_b128 v[40:43], v255 offset:0
    ds_read_b128 v[72:75], v255 offset:1024
    ds_read_b128 v[104:107], v255 offset:2048
    ds_read_b128 v[136:139], v255 offset:3072
    ds_read_b128 v[44:47], v255 offset:4096
    ds_read_b128 v[76:79], v255 offset:5120
    ds_read_b128 v[108:111], v255 offset:6144
    ds_read_b128 v[140:143], v255 offset:7168
    s_waitcnt lgkmcnt(7)
    v_lshlrev_b32 v160, 16, v40
    v_and_b32 v161, 0xffff0000, v40
    v_lshlrev_b32 v162, 16, v41
    v_and_b32 v163, 0xffff0000, v41
    v_pk_add_f32 v[160:161], v[160:161], v[32:33]
    v_pk_add_f32 v[162:163], v[162:163], v[34:35]
    v_lshlrev_b32 v168, 16, v42
    v_and_b32 v169, 0xffff0000, v42
    v_lshlrev_b32 v170, 16, v43
    v_and_b32 v171, 0xffff0000, v43
    v_pk_add_f32 v[168:169], v[168:169], v[48:49]
    v_pk_add_f32 v[170:171], v[170:171], v[50:51]
    s_waitcnt lgkmcnt(6)
    v_lshlrev_b32 v176, 16, v72
    v_and_b32 v177, 0xffff0000, v72
    v_lshlrev_b32 v178, 16, v73
    v_and_b32 v179, 0xffff0000, v73
    v_pk_add_f32 v[176:177], v[176:177], v[64:65]
    v_pk_add_f32 v[178:179], v[178:179], v[66:67]
    v_lshlrev_b32 v184, 16, v74
    v_and_b32 v185, 0xffff0000, v74
    v_lshlrev_b32 v186, 16, v75
    v_and_b32 v187, 0xffff0000, v75
    v_pk_add_f32 v[184:185], v[184:185], v[80:81]
    v_pk_add_f32 v[186:187], v[186:187], v[82:83]
    s_waitcnt lgkmcnt(5)
    v_lshlrev_b32 v192, 16, v104
    v_and_b32 v193, 0xffff0000, v104
    v_lshlrev_b32 v194, 16, v105
    v_and_b32 v195, 0xffff0000, v105
    v_pk_add_f32 v[192:193], v[192:193], v[96:97]
    v_pk_add_f32 v[194:195], v[194:195], v[98:99]
    v_lshlrev_b32 v200, 16, v106
    v_and_b32 v201, 0xffff0000, v106
    v_lshlrev_b32 v202, 16, v107
    v_and_b32 v203, 0xffff0000, v107
    v_pk_add_f32 v[200:201], v[200:201], v[112:113]
    v_pk_add_f32 v[202:203], v[202:203], v[114:115]
    s_waitcnt lgkmcnt(4)
    v_lshlrev_b32 v208, 16, v136
    v_and_b32 v209, 0xffff0000, v136
    v_lshlrev_b32 v210, 16, v137
    v_and_b32 v211, 0xffff0000, v137
    v_pk_add_f32 v[208:209], v[208:209], v[128:129]
    v_pk_add_f32 v[210:211], v[210:211], v[130:131]
    v_lshlrev_b32 v216, 16, v138
    v_and_b32 v217, 0xffff0000, v138
    v_lshlrev_b32 v218, 16, v139
    v_and_b32 v219, 0xffff0000, v139
    v_pk_add_f32 v[216:217], v[216:217], v[144:145]
    v_pk_add_f32 v[218:219], v[218:219], v[146:147]
    s_waitcnt lgkmcnt(3)
    v_lshlrev_b32 v164, 16, v44
    v_and_b32 v165, 0xffff0000, v44
    v_lshlrev_b32 v166, 16, v45
    v_and_b32 v167, 0xffff0000, v45
    v_pk_add_f32 v[164:165], v[164:165], v[36:37]
    v_pk_add_f32 v[166:167], v[166:167], v[38:39]
    v_lshlrev_b32 v172, 16, v46
    v_and_b32 v173, 0xffff0000, v46
    v_lshlrev_b32 v174, 16, v47
    v_and_b32 v175, 0xffff0000, v47
    v_pk_add_f32 v[172:173], v[172:173], v[52:53]
    v_pk_add_f32 v[174:175], v[174:175], v[54:55]
    s_waitcnt lgkmcnt(2)
    v_lshlrev_b32 v180, 16, v76
    v_and_b32 v181, 0xffff0000, v76
    v_lshlrev_b32 v182, 16, v77
    v_and_b32 v183, 0xffff0000, v77
    v_pk_add_f32 v[180:181], v[180:181], v[68:69]
    v_pk_add_f32 v[182:183], v[182:183], v[70:71]
    v_lshlrev_b32 v188, 16, v78
    v_and_b32 v189, 0xffff0000, v78
    v_lshlrev_b32 v190, 16, v79
    v_and_b32 v191, 0xffff0000, v79
    v_pk_add_f32 v[188:189], v[188:189], v[84:85]
    v_pk_add_f32 v[190:191], v[190:191], v[86:87]
    s_waitcnt lgkmcnt(1)
    v_lshlrev_b32 v196, 16, v108
    v_and_b32 v197, 0xffff0000, v108
    v_lshlrev_b32 v198, 16, v109
    v_and_b32 v199, 0xffff0000, v109
    v_pk_add_f32 v[196:197], v[196:197], v[100:101]
    v_pk_add_f32 v[198:199], v[198:199], v[102:103]
    v_lshlrev_b32 v204, 16, v110
    v_and_b32 v205, 0xffff0000, v110
    v_lshlrev_b32 v206, 16, v111
    v_and_b32 v207, 0xffff0000, v111
    v_pk_add_f32 v[204:205], v[204:205], v[116:117]
    v_pk_add_f32 v[206:207], v[206:207], v[118:119]
    s_waitcnt lgkmcnt(0)
    v_lshlrev_b32 v212, 16, v140
    v_and_b32 v213, 0xffff0000, v140
    v_lshlrev_b32 v214, 16, v141
    v_and_b32 v215, 0xffff0000, v141
    v_pk_add_f32 v[212:213], v[212:213], v[132:133]
    v_pk_add_f32 v[214:215], v[214:215], v[134:135]
    v_lshlrev_b32 v220, 16, v142
    v_and_b32 v221, 0xffff0000, v142
    v_lshlrev_b32 v222, 16, v143
    v_and_b32 v223, 0xffff0000, v143
    v_pk_add_f32 v[220:221], v[220:221], v[148:149]
    v_pk_add_f32 v[222:223], v[222:223], v[150:151]
    s_cmp_eq_u32 s72, 0
    s_cbranch_scc1 recurrent_scan__sliding_block_cached__glu_gated_glu__prompt_kernel_firstC
    s_add_u32 s6, s92, 4096
    v_cvt_pk_bf16_f32 v224, v160, v161
    v_cvt_pk_bf16_f32 v225, v162, v163
    v_cvt_pk_bf16_f32 v226, v168, v169
    v_cvt_pk_bf16_f32 v227, v170, v171
    buffer_store_dwordx4 v[224:227], v4, s[52:55], s92 offen offset:0 sc0 sc1
    v_cvt_pk_bf16_f32 v228, v176, v177
    v_cvt_pk_bf16_f32 v229, v178, v179
    v_cvt_pk_bf16_f32 v230, v184, v185
    v_cvt_pk_bf16_f32 v231, v186, v187
    buffer_store_dwordx4 v[228:231], v4, s[52:55], s92 offen offset:1024 sc0 sc1
    v_cvt_pk_bf16_f32 v224, v192, v193
    v_cvt_pk_bf16_f32 v225, v194, v195
    v_cvt_pk_bf16_f32 v226, v200, v201
    v_cvt_pk_bf16_f32 v227, v202, v203
    buffer_store_dwordx4 v[224:227], v4, s[52:55], s92 offen offset:2048 sc0 sc1
    v_cvt_pk_bf16_f32 v228, v208, v209
    v_cvt_pk_bf16_f32 v229, v210, v211
    v_cvt_pk_bf16_f32 v230, v216, v217
    v_cvt_pk_bf16_f32 v231, v218, v219
    buffer_store_dwordx4 v[228:231], v4, s[52:55], s92 offen offset:3072 sc0 sc1
    v_cvt_pk_bf16_f32 v232, v164, v165
    v_cvt_pk_bf16_f32 v233, v166, v167
    v_cvt_pk_bf16_f32 v234, v172, v173
    v_cvt_pk_bf16_f32 v235, v174, v175
    buffer_store_dwordx4 v[232:235], v4, s[52:55], s6 offen offset:0 sc0 sc1
    v_cvt_pk_bf16_f32 v236, v180, v181
    v_cvt_pk_bf16_f32 v237, v182, v183
    v_cvt_pk_bf16_f32 v238, v188, v189
    v_cvt_pk_bf16_f32 v239, v190, v191
    buffer_store_dwordx4 v[236:239], v4, s[52:55], s6 offen offset:1024 sc0 sc1
    v_cvt_pk_bf16_f32 v232, v196, v197
    v_cvt_pk_bf16_f32 v233, v198, v199
    v_cvt_pk_bf16_f32 v234, v204, v205
    v_cvt_pk_bf16_f32 v235, v206, v207
    buffer_store_dwordx4 v[232:235], v4, s[52:55], s6 offen offset:2048 sc0 sc1
    v_cvt_pk_bf16_f32 v236, v212, v213
    v_cvt_pk_bf16_f32 v237, v214, v215
    v_cvt_pk_bf16_f32 v238, v220, v221
    v_cvt_pk_bf16_f32 v239, v222, v223
    buffer_store_dwordx4 v[236:239], v4, s[52:55], s6 offen offset:3072 sc0 sc1
recurrent_scan__sliding_block_cached__glu_gated_glu__prompt_kernel_firstC:
    s_waitcnt vmcnt(40)
    s_waitcnt lgkmcnt(8)
    v_mfma_f32_16x16x32_bf16 v[32:35], a[128:131], a[192:195], 0
    s_add_u32 s13, s86, s9
    v_mfma_f32_16x16x32_bf16 v[32:35], a[160:163], a[208:211], v[32:35]
    v_mfma_f32_16x16x32_bf16 v[36:39], a[128:131], a[196:199], 0
    v_mfma_f32_16x16x32_bf16 v[36:39], a[160:163], a[212:215], v[36:39]
    buffer_load_dwordx4 a[64:67], v5, s[40:43], s13 offen sc0 sc1
    v_mfma_f32_16x16x32_bf16 v[40:43], a[128:131], a[200:203], 0
    v_mfma_f32_16x16x32_bf16 v[40:43], a[160:163], a[216:219], v[40:43]
    buffer_load_dwordx4 a[68:71], v6, s[40:43], s13 offen sc0 sc1
    v_mfma_f32_16x16x32_bf16 v[44:47], a[128:131], a[204:207], 0
    v_mfma_f32_16x16x32_bf16 v[44:47], a[160:163], a[220:223], v[44:47]
    s_waitcnt vmcnt(34)
    s_waitcnt lgkmcnt(0)
    s_barrier
    ds_read_b64_tr_b16 a[128:129], v9 offset:16384
    v_mfma_f32_16x16x32_bf16 v[48:51], a[132:135], a[192:195], 0
    ds_read_b64_tr_b16 a[130:131], v9 offset:20480
    v_mfma_f32_16x16x32_bf16 v[48:51], a[164:167], a[208:211], v[48:51]
    ds_read_b64_tr_b16 a[160:161], v9 offset:24576
    v_mfma_f32_16x16x32_bf16 v[52:55], a[132:135], a[196:199], 0
    ds_read_b64_tr_b16 a[162:163], v9 offset:28672
    v_mfma_f32_16x16x32_bf16 v[52:55], a[164:167], a[212:215], v[52:55]
    buffer_load_dwordx4 a[72:75], v7, s[40:43], s13 offen sc0 sc1
    v_mfma_f32_16x16x32_bf16 v[56:59], a[132:135], a[200:203], 0
    v_mfma_f32_16x16x32_bf16 v[56:59], a[164:167], a[216:219], v[56:59]
    buffer_load_dwordx4 a[76:79], v8, s[40:43], s13 offen sc0 sc1
    v_mfma_f32_16x16x32_bf16 v[60:63], a[132:135], a[204:207], 0
    s_add_u32 s13, s87, s9
    v_mfma_f32_16x16x32_bf16 v[60:63], a[164:167], a[220:223], v[60:63]
    ds_read_b64_tr_b16 a[132:133], v10 offset:16384
    s_add_u32 m0, s10, 0
    v_mfma_f32_16x16x32_bf16 v[64:67], a[136:139], a[192:195], 0
    ds_read_b64_tr_b16 a[134:135], v10 offset:20480
    s_lshl_b32 s12, s80, 6
    v_mfma_f32_16x16x32_bf16 v[64:67], a[168:171], a[208:211], v[64:67]
    ds_read_b64_tr_b16 a[164:165], v10 offset:24576
    s_add_u32 s12, s12, s8
    v_mfma_f32_16x16x32_bf16 v[68:71], a[136:139], a[196:199], 0
    ds_read_b64_tr_b16 a[166:167], v10 offset:28672
    v_mfma_f32_16x16x32_bf16 v[68:71], a[168:171], a[212:215], v[68:71]
    buffer_load_dwordx4 a[80:83], v5, s[40:43], s13 offen sc0 sc1
    v_mfma_f32_16x16x32_bf16 v[72:75], a[136:139], a[200:203], 0
    v_mfma_f32_16x16x32_bf16 v[72:75], a[168:171], a[216:219], v[72:75]
    buffer_load_dwordx4 a[84:87], v6, s[40:43], s13 offen sc0 sc1
    v_mfma_f32_16x16x32_bf16 v[76:79], a[136:139], a[204:207], 0
    v_mfma_f32_16x16x32_bf16 v[76:79], a[168:171], a[220:223], v[76:79]
    ds_read_b64_tr_b16 a[136:137], v11 offset:16384
    v_mfma_f32_16x16x32_bf16 v[80:83], a[140:143], a[192:195], 0
    ds_read_b64_tr_b16 a[138:139], v11 offset:20480
    v_mfma_f32_16x16x32_bf16 v[80:83], a[172:175], a[208:211], v[80:83]
    ds_read_b64_tr_b16 a[168:169], v11 offset:24576
    v_mfma_f32_16x16x32_bf16 v[84:87], a[140:143], a[196:199], 0
    ds_read_b64_tr_b16 a[170:171], v11 offset:28672
    v_mfma_f32_16x16x32_bf16 v[84:87], a[172:175], a[212:215], v[84:87]
    buffer_load_dwordx4 a[88:91], v7, s[40:43], s13 offen sc0 sc1
    v_mfma_f32_16x16x32_bf16 v[88:91], a[140:143], a[200:203], 0
    v_mfma_f32_16x16x32_bf16 v[88:91], a[172:175], a[216:219], v[88:91]
    buffer_load_dwordx4 a[92:95], v8, s[40:43], s13 offen sc0 sc1
    v_mfma_f32_16x16x32_bf16 v[92:95], a[140:143], a[204:207], 0
    s_add_u32 s9, s9, 0x2000
    v_mfma_f32_16x16x32_bf16 v[92:95], a[172:175], a[220:223], v[92:95]
    ds_read_b64_tr_b16 a[140:141], v12 offset:16384
    v_mfma_f32_16x16x32_bf16 v[96:99], a[144:147], a[192:195], 0
    ds_read_b64_tr_b16 a[142:143], v12 offset:20480
    v_mfma_f32_16x16x32_bf16 v[96:99], a[176:179], a[208:211], v[96:99]
    ds_read_b64_tr_b16 a[172:173], v12 offset:24576
    v_mfma_f32_16x16x32_bf16 v[100:103], a[144:147], a[196:199], 0
    ds_read_b64_tr_b16 a[174:175], v12 offset:28672
    v_mfma_f32_16x16x32_bf16 v[100:103], a[176:179], a[212:215], v[100:103]
    buffer_load_dwordx4 v246, s[44:47], s12 offen offset:0 lds
    v_mfma_f32_16x16x32_bf16 v[104:107], a[144:147], a[200:203], 0
    v_mfma_f32_16x16x32_bf16 v[104:107], a[176:179], a[216:219], v[104:107]
    buffer_load_dwordx4 v247, s[44:47], s12 offen offset:1024 lds
    v_mfma_f32_16x16x32_bf16 v[108:111], a[144:147], a[204:207], 0
    v_mfma_f32_16x16x32_bf16 v[108:111], a[176:179], a[220:223], v[108:111]
    ds_read_b64_tr_b16 a[144:145], v13 offset:16384
    v_mfma_f32_16x16x32_bf16 v[112:115], a[148:151], a[192:195], 0
    ds_read_b64_tr_b16 a[146:147], v13 offset:20480
    v_mfma_f32_16x16x32_bf16 v[112:115], a[180:183], a[208:211], v[112:115]
    ds_read_b64_tr_b16 a[176:177], v13 offset:24576
    v_mfma_f32_16x16x32_bf16 v[116:119], a[148:151], a[196:199], 0
    ds_read_b64_tr_b16 a[178:179], v13 offset:28672
    v_mfma_f32_16x16x32_bf16 v[116:119], a[180:183], a[212:215], v[116:119]
    buffer_load_dwordx4 v248, s[44:47], s12 offen offset:2048 lds
    v_mfma_f32_16x16x32_bf16 v[120:123], a[148:151], a[200:203], 0
    v_mfma_f32_16x16x32_bf16 v[120:123], a[180:183], a[216:219], v[120:123]
    buffer_load_dwordx4 v249, s[44:47], s12 offen offset:3072 lds
    v_mfma_f32_16x16x32_bf16 v[124:127], a[148:151], a[204:207], 0
    s_add_u32 m0, s10, 8192
    s_lshl_b32 s12, s81, 6
    v_mfma_f32_16x16x32_bf16 v[124:127], a[180:183], a[220:223], v[124:127]
    ds_read_b64_tr_b16 a[148:149], v14 offset:16384
    s_add_u32 s12, s12, s8
    v_mfma_f32_16x16x32_bf16 v[128:131], a[152:155], a[192:195], 0
    ds_read_b64_tr_b16 a[150:151], v14 offset:20480
    v_mfma_f32_16x16x32_bf16 v[128:131], a[184:187], a[208:211], v[128:131]
    ds_read_b64_tr_b16 a[180:181], v14 offset:24576
    v_mfma_f32_16x16x32_bf16 v[132:135], a[152:155], a[196:199], 0
    ds_read_b64_tr_b16 a[182:183], v14 offset:28672
    v_mfma_f32_16x16x32_bf16 v[132:135], a[184:187], a[212:215], v[132:135]
    buffer_load_dwordx4 v246, s[44:47], s12 offen offset:0 lds
    v_mfma_f32_16x16x32_bf16 v[136:139], a[152:155], a[200:203], 0
    v_mfma_f32_16x16x32_bf16 v[136:139], a[184:187], a[216:219], v[136:139]
    buffer_load_dwordx4 v247, s[44:47], s12 offen offset:1024 lds
    v_mfma_f32_16x16x32_bf16 v[140:143], a[152:155], a[204:207], 0
    v_mfma_f32_16x16x32_bf16 v[140:143], a[184:187], a[220:223], v[140:143]
    ds_read_b64_tr_b16 a[152:153], v15 offset:16384
    v_mfma_f32_16x16x32_bf16 v[144:147], a[156:159], a[192:195], 0
    ds_read_b64_tr_b16 a[154:155], v15 offset:20480
    v_mfma_f32_16x16x32_bf16 v[144:147], a[188:191], a[208:211], v[144:147]
    ds_read_b64_tr_b16 a[184:185], v15 offset:24576
    v_mfma_f32_16x16x32_bf16 v[148:151], a[156:159], a[196:199], 0
    ds_read_b64_tr_b16 a[186:187], v15 offset:28672
    v_mfma_f32_16x16x32_bf16 v[148:151], a[188:191], a[212:215], v[148:151]
    buffer_load_dwordx4 v248, s[44:47], s12 offen offset:2048 lds
    v_mfma_f32_16x16x32_bf16 v[152:155], a[156:159], a[200:203], 0
    v_mfma_f32_16x16x32_bf16 v[152:155], a[188:191], a[216:219], v[152:155]
    buffer_load_dwordx4 v249, s[44:47], s12 offen offset:3072 lds
    v_mfma_f32_16x16x32_bf16 v[156:159], a[156:159], a[204:207], 0
    v_mfma_f32_16x16x32_bf16 v[156:159], a[188:191], a[220:223], v[156:159]
    ds_read_b64_tr_b16 a[156:157], v16 offset:16384
    ds_read_b64_tr_b16 a[158:159], v16 offset:20480
    ds_read_b64_tr_b16 a[188:189], v16 offset:24576
    ds_read_b64_tr_b16 a[190:191], v16 offset:28672
    s_waitcnt vmcnt(40)
    s_waitcnt lgkmcnt(8)
    v_mfma_f32_16x16x32_bf16 v[32:35], a[128:131], a[0:3], v[32:35]
    s_add_u32 s13, s80, s9
    v_mfma_f32_16x16x32_bf16 v[32:35], a[160:163], a[16:19], v[32:35]
    v_mfma_f32_16x16x32_bf16 v[36:39], a[128:131], a[4:7], v[36:39]
    v_mfma_f32_16x16x32_bf16 v[36:39], a[160:163], a[20:23], v[36:39]
    buffer_load_dwordx4 a[192:195], v5, s[40:43], s13 offen sc0 sc1
    v_mfma_f32_16x16x32_bf16 v[40:43], a[128:131], a[8:11], v[40:43]
    v_mfma_f32_16x16x32_bf16 v[40:43], a[160:163], a[24:27], v[40:43]
    buffer_load_dwordx4 a[196:199], v6, s[40:43], s13 offen sc0 sc1
    v_mfma_f32_16x16x32_bf16 v[44:47], a[128:131], a[12:15], v[44:47]
    v_mfma_f32_16x16x32_bf16 v[44:47], a[160:163], a[28:31], v[44:47]
    s_waitcnt vmcnt(18)
    s_waitcnt lgkmcnt(0)
    s_barrier
    s_xor_b32 s6, s72, 1
    s_or_b32 s6, s6, s3
    s_cmp_lg_u32 s6, 0
    s_cbranch_scc1 recurrent_scan__sliding_block_cached__glu_gated_glu__prompt_kernel_pf
    s_mov_b64 exec, 1
    buffer_store_dwordx2 v[250:251], v252, s[48:51], s101 offen sc0 sc1
    s_mov_b64 exec, -1
recurrent_scan__sliding_block_cached__glu_gated_glu__prompt_kernel_pf:
    ds_read_b64_tr_b16 a[128:129], v17 offset:0
    v_mfma_f32_16x16x32_bf16 v[48:51], a[132:135], a[0:3], v[48:51]
    ds_read_b64_tr_b16 a[130:131], v17 offset:4096
    v_mfma_f32_16x16x32_bf16 v[48:51], a[164:167], a[16:19], v[48:51]
    ds_read_b64_tr_b16 a[160:161], v17 offset:8192
    v_mfma_f32_16x16x32_bf16 v[52:55], a[132:135], a[4:7], v[52:55]
    ds_read_b64_tr_b16 a[162:163], v17 offset:12288
    v_mfma_f32_16x16x32_bf16 v[52:55], a[164:167], a[20:23], v[52:55]
    buffer_load_dwordx4 a[200:203], v7, s[40:43], s13 offen sc0 sc1
    v_mfma_f32_16x16x32_bf16 v[56:59], a[132:135], a[8:11], v[56:59]
    v_mfma_f32_16x16x32_bf16 v[56:59], a[164:167], a[24:27], v[56:59]
    buffer_load_dwordx4 a[204:207], v8, s[40:43], s13 offen sc0 sc1
    v_mfma_f32_16x16x32_bf16 v[60:63], a[132:135], a[12:15], v[60:63]
    s_add_u32 s13, s81, s9
    v_mfma_f32_16x16x32_bf16 v[60:63], a[164:167], a[28:31], v[60:63]
    ds_read_b64_tr_b16 a[132:133], v18 offset:0
    s_add_u32 m0, s10, 16384
    v_mfma_f32_16x16x32_bf16 v[64:67], a[136:139], a[0:3], v[64:67]
    ds_read_b64_tr_b16 a[134:135], v18 offset:4096
    s_lshl_b32 s12, s82, 6
    v_mfma_f32_16x16x32_bf16 v[64:67], a[168:171], a[16:19], v[64:67]
    ds_read_b64_tr_b16 a[164:165], v18 offset:8192
    s_add_u32 s12, s12, s8
    v_mfma_f32_16x16x32_bf16 v[68:71], a[136:139], a[4:7], v[68:71]
    ds_read_b64_tr_b16 a[166:167], v18 offset:12288
    v_mfma_f32_16x16x32_bf16 v[68:71], a[168:171], a[20:23], v[68:71]
    buffer_load_dwordx4 a[208:211], v5, s[40:43], s13 offen sc0 sc1
    v_mfma_f32_16x16x32_bf16 v[72:75], a[136:139], a[8:11], v[72:75]
    v_mfma_f32_16x16x32_bf16 v[72:75], a[168:171], a[24:27], v[72:75]
    buffer_load_dwordx4 a[212:215], v6, s[40:43], s13 offen sc0 sc1
    v_mfma_f32_16x16x32_bf16 v[76:79], a[136:139], a[12:15], v[76:79]
    v_mfma_f32_16x16x32_bf16 v[76:79], a[168:171], a[28:31], v[76:79]
    ds_read_b64_tr_b16 a[136:137], v19 offset:0
    v_mfma_f32_16x16x32_bf16 v[80:83], a[140:143], a[0:3], v[80:83]
    ds_read_b64_tr_b16 a[138:139], v19 offset:4096
    v_mfma_f32_16x16x32_bf16 v[80:83], a[172:175], a[16:19], v[80:83]
    ds_read_b64_tr_b16 a[168:169], v19 offset:8192
    v_mfma_f32_16x16x32_bf16 v[84:87], a[140:143], a[4:7], v[84:87]
    ds_read_b64_tr_b16 a[170:171], v19 offset:12288
    v_mfma_f32_16x16x32_bf16 v[84:87], a[172:175], a[20:23], v[84:87]
    buffer_load_dwordx4 a[216:219], v7, s[40:43], s13 offen sc0 sc1
    v_mfma_f32_16x16x32_bf16 v[88:91], a[140:143], a[8:11], v[88:91]
    v_mfma_f32_16x16x32_bf16 v[88:91], a[172:175], a[24:27], v[88:91]
    buffer_load_dwordx4 a[220:223], v8, s[40:43], s13 offen sc0 sc1
    v_mfma_f32_16x16x32_bf16 v[92:95], a[140:143], a[12:15], v[92:95]
    v_mfma_f32_16x16x32_bf16 v[92:95], a[172:175], a[28:31], v[92:95]
    ds_read_b64_tr_b16 a[140:141], v20 offset:0
    v_mfma_f32_16x16x32_bf16 v[96:99], a[144:147], a[0:3], v[96:99]
    ds_read_b64_tr_b16 a[142:143], v20 offset:4096
    v_mfma_f32_16x16x32_bf16 v[96:99], a[176:179], a[16:19], v[96:99]
    ds_read_b64_tr_b16 a[172:173], v20 offset:8192
    v_mfma_f32_16x16x32_bf16 v[100:103], a[144:147], a[4:7], v[100:103]
    ds_read_b64_tr_b16 a[174:175], v20 offset:12288
    v_mfma_f32_16x16x32_bf16 v[100:103], a[176:179], a[20:23], v[100:103]
    buffer_load_dwordx4 v246, s[44:47], s12 offen offset:0 lds
    v_mfma_f32_16x16x32_bf16 v[104:107], a[144:147], a[8:11], v[104:107]
    v_mfma_f32_16x16x32_bf16 v[104:107], a[176:179], a[24:27], v[104:107]
    buffer_load_dwordx4 v247, s[44:47], s12 offen offset:1024 lds
    v_mfma_f32_16x16x32_bf16 v[108:111], a[144:147], a[12:15], v[108:111]
    v_mfma_f32_16x16x32_bf16 v[108:111], a[176:179], a[28:31], v[108:111]
    ds_read_b64_tr_b16 a[144:145], v21 offset:0
    v_mfma_f32_16x16x32_bf16 v[112:115], a[148:151], a[0:3], v[112:115]
    ds_read_b64_tr_b16 a[146:147], v21 offset:4096
    v_mfma_f32_16x16x32_bf16 v[112:115], a[180:183], a[16:19], v[112:115]
    ds_read_b64_tr_b16 a[176:177], v21 offset:8192
    v_mfma_f32_16x16x32_bf16 v[116:119], a[148:151], a[4:7], v[116:119]
    ds_read_b64_tr_b16 a[178:179], v21 offset:12288
    v_mfma_f32_16x16x32_bf16 v[116:119], a[180:183], a[20:23], v[116:119]
    buffer_load_dwordx4 v248, s[44:47], s12 offen offset:2048 lds
    v_mfma_f32_16x16x32_bf16 v[120:123], a[148:151], a[8:11], v[120:123]
    v_mfma_f32_16x16x32_bf16 v[120:123], a[180:183], a[24:27], v[120:123]
    buffer_load_dwordx4 v249, s[44:47], s12 offen offset:3072 lds
    v_mfma_f32_16x16x32_bf16 v[124:127], a[148:151], a[12:15], v[124:127]
    s_add_u32 m0, s10, 24576
    s_lshl_b32 s12, s83, 6
    v_mfma_f32_16x16x32_bf16 v[124:127], a[180:183], a[28:31], v[124:127]
    ds_read_b64_tr_b16 a[148:149], v22 offset:0
    s_add_u32 s12, s12, s8
    v_mfma_f32_16x16x32_bf16 v[128:131], a[152:155], a[0:3], v[128:131]
    ds_read_b64_tr_b16 a[150:151], v22 offset:4096
    v_mfma_f32_16x16x32_bf16 v[128:131], a[184:187], a[16:19], v[128:131]
    ds_read_b64_tr_b16 a[180:181], v22 offset:8192
    v_mfma_f32_16x16x32_bf16 v[132:135], a[152:155], a[4:7], v[132:135]
    ds_read_b64_tr_b16 a[182:183], v22 offset:12288
    v_mfma_f32_16x16x32_bf16 v[132:135], a[184:187], a[20:23], v[132:135]
    buffer_load_dwordx4 v246, s[44:47], s12 offen offset:0 lds
    v_mfma_f32_16x16x32_bf16 v[136:139], a[152:155], a[8:11], v[136:139]
    v_mfma_f32_16x16x32_bf16 v[136:139], a[184:187], a[24:27], v[136:139]
    buffer_load_dwordx4 v247, s[44:47], s12 offen offset:1024 lds
    v_mfma_f32_16x16x32_bf16 v[140:143], a[152:155], a[12:15], v[140:143]
    v_mfma_f32_16x16x32_bf16 v[140:143], a[184:187], a[28:31], v[140:143]
    ds_read_b64_tr_b16 a[152:153], v23 offset:0
    v_mfma_f32_16x16x32_bf16 v[144:147], a[156:159], a[0:3], v[144:147]
    ds_read_b64_tr_b16 a[154:155], v23 offset:4096
    v_mfma_f32_16x16x32_bf16 v[144:147], a[188:191], a[16:19], v[144:147]
    ds_read_b64_tr_b16 a[184:185], v23 offset:8192
    v_mfma_f32_16x16x32_bf16 v[148:151], a[156:159], a[4:7], v[148:151]
    ds_read_b64_tr_b16 a[186:187], v23 offset:12288
    v_mfma_f32_16x16x32_bf16 v[148:151], a[188:191], a[20:23], v[148:151]
    buffer_load_dwordx4 v248, s[44:47], s12 offen offset:2048 lds
    v_mfma_f32_16x16x32_bf16 v[152:155], a[156:159], a[8:11], v[152:155]
    v_mfma_f32_16x16x32_bf16 v[152:155], a[188:191], a[24:27], v[152:155]
    buffer_load_dwordx4 v249, s[44:47], s12 offen offset:3072 lds
    v_mfma_f32_16x16x32_bf16 v[156:159], a[156:159], a[12:15], v[156:159]
    v_mfma_f32_16x16x32_bf16 v[156:159], a[188:191], a[28:31], v[156:159]
    ds_read_b64_tr_b16 a[156:157], v24 offset:0
    ds_read_b64_tr_b16 a[158:159], v24 offset:4096
    ds_read_b64_tr_b16 a[188:189], v24 offset:8192
    ds_read_b64_tr_b16 a[190:191], v24 offset:12288
    s_waitcnt lgkmcnt(8)
    v_mfma_f32_16x16x32_bf16 v[32:35], a[128:131], a[32:35], v[32:35]
    s_add_u32 s13, s82, s9
    v_mfma_f32_16x16x32_bf16 v[32:35], a[160:163], a[48:51], v[32:35]
    v_mfma_f32_16x16x32_bf16 v[36:39], a[128:131], a[36:39], v[36:39]
    v_mfma_f32_16x16x32_bf16 v[36:39], a[160:163], a[52:55], v[36:39]
    buffer_load_dwordx4 a[0:3], v5, s[40:43], s13 offen sc0 sc1
    v_mfma_f32_16x16x32_bf16 v[40:43], a[128:131], a[40:43], v[40:43]
    buffer_load_dwordx2 v[30:31], v253, s[48:51], s97 offen sc0 sc1
    v_mfma_f32_16x16x32_bf16 v[40:43], a[160:163], a[56:59], v[40:43]
    buffer_load_dwordx4 a[4:7], v6, s[40:43], s13 offen sc0 sc1
    v_mfma_f32_16x16x32_bf16 v[44:47], a[128:131], a[44:47], v[44:47]
    v_mfma_f32_16x16x32_bf16 v[44:47], a[160:163], a[60:63], v[44:47]
    s_waitcnt lgkmcnt(0)
    s_barrier
    ds_read_b64_tr_b16 a[128:129], v17 offset:16384
    v_mfma_f32_16x16x32_bf16 v[48:51], a[132:135], a[32:35], v[48:51]
    ds_read_b64_tr_b16 a[130:131], v17 offset:20480
    v_mfma_f32_16x16x32_bf16 v[48:51], a[164:167], a[48:51], v[48:51]
    ds_read_b64_tr_b16 a[160:161], v17 offset:24576
    v_mfma_f32_16x16x32_bf16 v[52:55], a[132:135], a[36:39], v[52:55]
    ds_read_b64_tr_b16 a[162:163], v17 offset:28672
    v_mfma_f32_16x16x32_bf16 v[52:55], a[164:167], a[52:55], v[52:55]
    buffer_load_dwordx4 a[8:11], v7, s[40:43], s13 offen sc0 sc1
    v_mfma_f32_16x16x32_bf16 v[56:59], a[132:135], a[40:43], v[56:59]
    v_mfma_f32_16x16x32_bf16 v[56:59], a[164:167], a[56:59], v[56:59]
    buffer_load_dwordx4 a[12:15], v8, s[40:43], s13 offen sc0 sc1
    v_mfma_f32_16x16x32_bf16 v[60:63], a[132:135], a[44:47], v[60:63]
    s_add_u32 s13, s83, s9
    v_mfma_f32_16x16x32_bf16 v[60:63], a[164:167], a[60:63], v[60:63]
    ds_read_b64_tr_b16 a[132:133], v18 offset:16384
    s_add_u32 m0, s11, 0
    v_mfma_f32_16x16x32_bf16 v[64:67], a[136:139], a[32:35], v[64:67]
    ds_read_b64_tr_b16 a[134:135], v18 offset:20480
    s_lshl_b32 s12, s84, 6
    v_mfma_f32_16x16x32_bf16 v[64:67], a[168:171], a[48:51], v[64:67]
    ds_read_b64_tr_b16 a[164:165], v18 offset:24576
    s_add_u32 s12, s12, s8
    v_mfma_f32_16x16x32_bf16 v[68:71], a[136:139], a[36:39], v[68:71]
    ds_read_b64_tr_b16 a[166:167], v18 offset:28672
    v_mfma_f32_16x16x32_bf16 v[68:71], a[168:171], a[52:55], v[68:71]
    buffer_load_dwordx4 a[16:19], v5, s[40:43], s13 offen sc0 sc1
    v_mfma_f32_16x16x32_bf16 v[72:75], a[136:139], a[40:43], v[72:75]
    v_mfma_f32_16x16x32_bf16 v[72:75], a[168:171], a[56:59], v[72:75]
    buffer_load_dwordx4 a[20:23], v6, s[40:43], s13 offen sc0 sc1
    v_mfma_f32_16x16x32_bf16 v[76:79], a[136:139], a[44:47], v[76:79]
    v_mfma_f32_16x16x32_bf16 v[76:79], a[168:171], a[60:63], v[76:79]
    ds_read_b64_tr_b16 a[136:137], v19 offset:16384
    v_mfma_f32_16x16x32_bf16 v[80:83], a[140:143], a[32:35], v[80:83]
    ds_read_b64_tr_b16 a[138:139], v19 offset:20480
    v_mfma_f32_16x16x32_bf16 v[80:83], a[172:175], a[48:51], v[80:83]
    ds_read_b64_tr_b16 a[168:169], v19 offset:24576
    v_mfma_f32_16x16x32_bf16 v[84:87], a[140:143], a[36:39], v[84:87]
    ds_read_b64_tr_b16 a[170:171], v19 offset:28672
    v_mfma_f32_16x16x32_bf16 v[84:87], a[172:175], a[52:55], v[84:87]
    buffer_load_dwordx4 a[24:27], v7, s[40:43], s13 offen sc0 sc1
    v_mfma_f32_16x16x32_bf16 v[88:91], a[140:143], a[40:43], v[88:91]
    v_mfma_f32_16x16x32_bf16 v[88:91], a[172:175], a[56:59], v[88:91]
    buffer_load_dwordx4 a[28:31], v8, s[40:43], s13 offen sc0 sc1
    v_mfma_f32_16x16x32_bf16 v[92:95], a[140:143], a[44:47], v[92:95]
    v_mfma_f32_16x16x32_bf16 v[92:95], a[172:175], a[60:63], v[92:95]
    ds_read_b64_tr_b16 a[140:141], v20 offset:16384
    v_mfma_f32_16x16x32_bf16 v[96:99], a[144:147], a[32:35], v[96:99]
    ds_read_b64_tr_b16 a[142:143], v20 offset:20480
    v_mfma_f32_16x16x32_bf16 v[96:99], a[176:179], a[48:51], v[96:99]
    ds_read_b64_tr_b16 a[172:173], v20 offset:24576
    v_mfma_f32_16x16x32_bf16 v[100:103], a[144:147], a[36:39], v[100:103]
    ds_read_b64_tr_b16 a[174:175], v20 offset:28672
    v_mfma_f32_16x16x32_bf16 v[100:103], a[176:179], a[52:55], v[100:103]
    buffer_load_dwordx4 v246, s[44:47], s12 offen offset:0 lds
    v_mfma_f32_16x16x32_bf16 v[104:107], a[144:147], a[40:43], v[104:107]
    v_mfma_f32_16x16x32_bf16 v[104:107], a[176:179], a[56:59], v[104:107]
    buffer_load_dwordx4 v247, s[44:47], s12 offen offset:1024 lds
    v_mfma_f32_16x16x32_bf16 v[108:111], a[144:147], a[44:47], v[108:111]
    v_mfma_f32_16x16x32_bf16 v[108:111], a[176:179], a[60:63], v[108:111]
    ds_read_b64_tr_b16 a[144:145], v21 offset:16384
    v_mfma_f32_16x16x32_bf16 v[112:115], a[148:151], a[32:35], v[112:115]
    ds_read_b64_tr_b16 a[146:147], v21 offset:20480
    v_mfma_f32_16x16x32_bf16 v[112:115], a[180:183], a[48:51], v[112:115]
    ds_read_b64_tr_b16 a[176:177], v21 offset:24576
    v_mfma_f32_16x16x32_bf16 v[116:119], a[148:151], a[36:39], v[116:119]
    ds_read_b64_tr_b16 a[178:179], v21 offset:28672
    v_mfma_f32_16x16x32_bf16 v[116:119], a[180:183], a[52:55], v[116:119]
    buffer_load_dwordx4 v248, s[44:47], s12 offen offset:2048 lds
    v_mfma_f32_16x16x32_bf16 v[120:123], a[148:151], a[40:43], v[120:123]
    v_mfma_f32_16x16x32_bf16 v[120:123], a[180:183], a[56:59], v[120:123]
    buffer_load_dwordx4 v249, s[44:47], s12 offen offset:3072 lds
    v_mfma_f32_16x16x32_bf16 v[124:127], a[148:151], a[44:47], v[124:127]
    s_add_u32 m0, s11, 8192
    s_lshl_b32 s12, s85, 6
    v_mfma_f32_16x16x32_bf16 v[124:127], a[180:183], a[60:63], v[124:127]
    ds_read_b64_tr_b16 a[148:149], v22 offset:16384
    s_add_u32 s12, s12, s8
    v_mfma_f32_16x16x32_bf16 v[128:131], a[152:155], a[32:35], v[128:131]
    ds_read_b64_tr_b16 a[150:151], v22 offset:20480
    v_mfma_f32_16x16x32_bf16 v[128:131], a[184:187], a[48:51], v[128:131]
    ds_read_b64_tr_b16 a[180:181], v22 offset:24576
    v_mfma_f32_16x16x32_bf16 v[132:135], a[152:155], a[36:39], v[132:135]
    ds_read_b64_tr_b16 a[182:183], v22 offset:28672
    v_mfma_f32_16x16x32_bf16 v[132:135], a[184:187], a[52:55], v[132:135]
    buffer_load_dwordx4 v246, s[44:47], s12 offen offset:0 lds
    v_mfma_f32_16x16x32_bf16 v[136:139], a[152:155], a[40:43], v[136:139]
    v_mfma_f32_16x16x32_bf16 v[136:139], a[184:187], a[56:59], v[136:139]
    buffer_load_dwordx4 v247, s[44:47], s12 offen offset:1024 lds
    v_mfma_f32_16x16x32_bf16 v[140:143], a[152:155], a[44:47], v[140:143]
    v_mfma_f32_16x16x32_bf16 v[140:143], a[184:187], a[60:63], v[140:143]
    ds_read_b64_tr_b16 a[152:153], v23 offset:16384
    v_mfma_f32_16x16x32_bf16 v[144:147], a[156:159], a[32:35], v[144:147]
    ds_read_b64_tr_b16 a[154:155], v23 offset:20480
    v_mfma_f32_16x16x32_bf16 v[144:147], a[188:191], a[48:51], v[144:147]
    ds_read_b64_tr_b16 a[184:185], v23 offset:24576
    v_mfma_f32_16x16x32_bf16 v[148:151], a[156:159], a[36:39], v[148:151]
    ds_read_b64_tr_b16 a[186:187], v23 offset:28672
    v_mfma_f32_16x16x32_bf16 v[148:151], a[188:191], a[52:55], v[148:151]
    buffer_load_dwordx4 v248, s[44:47], s12 offen offset:2048 lds
    v_mfma_f32_16x16x32_bf16 v[152:155], a[156:159], a[40:43], v[152:155]
    v_mfma_f32_16x16x32_bf16 v[152:155], a[188:191], a[56:59], v[152:155]
    buffer_load_dwordx4 v249, s[44:47], s12 offen offset:3072 lds
    v_mfma_f32_16x16x32_bf16 v[156:159], a[156:159], a[44:47], v[156:159]
    v_mfma_f32_16x16x32_bf16 v[156:159], a[188:191], a[60:63], v[156:159]
    ds_read_b64_tr_b16 a[156:157], v24 offset:16384
    ds_read_b64_tr_b16 a[158:159], v24 offset:20480
    ds_read_b64_tr_b16 a[188:189], v24 offset:24576
    ds_read_b64_tr_b16 a[190:191], v24 offset:28672
    s_waitcnt vmcnt(41)
    s_waitcnt lgkmcnt(8)
    v_mfma_f32_16x16x32_bf16 v[32:35], a[128:131], a[64:67], v[32:35]
    s_add_u32 s13, s84, s9
    v_mfma_f32_16x16x32_bf16 v[32:35], a[160:163], a[80:83], v[32:35]
    v_mfma_f32_16x16x32_bf16 v[36:39], a[128:131], a[68:71], v[36:39]
    v_mfma_f32_16x16x32_bf16 v[36:39], a[160:163], a[84:87], v[36:39]
    buffer_load_dwordx4 a[32:35], v5, s[40:43], s13 offen sc0 sc1
    v_mfma_f32_16x16x32_bf16 v[40:43], a[128:131], a[72:75], v[40:43]
    v_mfma_f32_16x16x32_bf16 v[40:43], a[160:163], a[88:91], v[40:43]
    buffer_load_dwordx4 a[36:39], v6, s[40:43], s13 offen sc0 sc1
    v_mfma_f32_16x16x32_bf16 v[44:47], a[128:131], a[76:79], v[44:47]
    v_mfma_f32_16x16x32_bf16 v[44:47], a[160:163], a[92:95], v[44:47]
    s_waitcnt vmcnt(35)
    s_waitcnt lgkmcnt(0)
    s_barrier
    ds_read_b64_tr_b16 a[128:129], v9 offset:0
    v_mfma_f32_16x16x32_bf16 v[48:51], a[132:135], a[64:67], v[48:51]
    ds_read_b64_tr_b16 a[130:131], v9 offset:4096
    v_mfma_f32_16x16x32_bf16 v[48:51], a[164:167], a[80:83], v[48:51]
    ds_read_b64_tr_b16 a[160:161], v9 offset:8192
    v_mfma_f32_16x16x32_bf16 v[52:55], a[132:135], a[68:71], v[52:55]
    ds_read_b64_tr_b16 a[162:163], v9 offset:12288
    v_mfma_f32_16x16x32_bf16 v[52:55], a[164:167], a[84:87], v[52:55]
    buffer_load_dwordx4 a[40:43], v7, s[40:43], s13 offen sc0 sc1
    v_mfma_f32_16x16x32_bf16 v[56:59], a[132:135], a[72:75], v[56:59]
    v_mfma_f32_16x16x32_bf16 v[56:59], a[164:167], a[88:91], v[56:59]
    buffer_load_dwordx4 a[44:47], v8, s[40:43], s13 offen sc0 sc1
    v_mfma_f32_16x16x32_bf16 v[60:63], a[132:135], a[76:79], v[60:63]
    s_add_u32 s13, s85, s9
    v_mfma_f32_16x16x32_bf16 v[60:63], a[164:167], a[92:95], v[60:63]
    ds_read_b64_tr_b16 a[132:133], v10 offset:0
    s_add_u32 m0, s11, 16384
    v_mfma_f32_16x16x32_bf16 v[64:67], a[136:139], a[64:67], v[64:67]
    ds_read_b64_tr_b16 a[134:135], v10 offset:4096
    s_lshl_b32 s12, s86, 6
    v_mfma_f32_16x16x32_bf16 v[64:67], a[168:171], a[80:83], v[64:67]
    ds_read_b64_tr_b16 a[164:165], v10 offset:8192
    s_add_u32 s12, s12, s8
    v_mfma_f32_16x16x32_bf16 v[68:71], a[136:139], a[68:71], v[68:71]
    ds_read_b64_tr_b16 a[166:167], v10 offset:12288
    v_mfma_f32_16x16x32_bf16 v[68:71], a[168:171], a[84:87], v[68:71]
    buffer_load_dwordx4 a[48:51], v5, s[40:43], s13 offen sc0 sc1
    v_mfma_f32_16x16x32_bf16 v[72:75], a[136:139], a[72:75], v[72:75]
    v_mfma_f32_16x16x32_bf16 v[72:75], a[168:171], a[88:91], v[72:75]
    buffer_load_dwordx4 a[52:55], v6, s[40:43], s13 offen sc0 sc1
    v_mfma_f32_16x16x32_bf16 v[76:79], a[136:139], a[76:79], v[76:79]
    v_mfma_f32_16x16x32_bf16 v[76:79], a[168:171], a[92:95], v[76:79]
    ds_read_b64_tr_b16 a[136:137], v11 offset:0
    v_mfma_f32_16x16x32_bf16 v[80:83], a[140:143], a[64:67], v[80:83]
    ds_read_b64_tr_b16 a[138:139], v11 offset:4096
    v_mfma_f32_16x16x32_bf16 v[80:83], a[172:175], a[80:83], v[80:83]
    ds_read_b64_tr_b16 a[168:169], v11 offset:8192
    v_mfma_f32_16x16x32_bf16 v[84:87], a[140:143], a[68:71], v[84:87]
    ds_read_b64_tr_b16 a[170:171], v11 offset:12288
    v_mfma_f32_16x16x32_bf16 v[84:87], a[172:175], a[84:87], v[84:87]
    buffer_load_dwordx4 a[56:59], v7, s[40:43], s13 offen sc0 sc1
    v_mfma_f32_16x16x32_bf16 v[88:91], a[140:143], a[72:75], v[88:91]
    v_mfma_f32_16x16x32_bf16 v[88:91], a[172:175], a[88:91], v[88:91]
    buffer_load_dwordx4 a[60:63], v8, s[40:43], s13 offen sc0 sc1
    v_mfma_f32_16x16x32_bf16 v[92:95], a[140:143], a[76:79], v[92:95]
    v_mfma_f32_16x16x32_bf16 v[92:95], a[172:175], a[92:95], v[92:95]
    ds_read_b64_tr_b16 a[140:141], v12 offset:0
    v_mfma_f32_16x16x32_bf16 v[96:99], a[144:147], a[64:67], v[96:99]
    ds_read_b64_tr_b16 a[142:143], v12 offset:4096
    v_mfma_f32_16x16x32_bf16 v[96:99], a[176:179], a[80:83], v[96:99]
    ds_read_b64_tr_b16 a[172:173], v12 offset:8192
    v_mfma_f32_16x16x32_bf16 v[100:103], a[144:147], a[68:71], v[100:103]
    ds_read_b64_tr_b16 a[174:175], v12 offset:12288
    v_mfma_f32_16x16x32_bf16 v[100:103], a[176:179], a[84:87], v[100:103]
    buffer_load_dwordx4 v246, s[44:47], s12 offen offset:0 lds
    v_mfma_f32_16x16x32_bf16 v[104:107], a[144:147], a[72:75], v[104:107]
    v_mfma_f32_16x16x32_bf16 v[104:107], a[176:179], a[88:91], v[104:107]
    buffer_load_dwordx4 v247, s[44:47], s12 offen offset:1024 lds
    v_mfma_f32_16x16x32_bf16 v[108:111], a[144:147], a[76:79], v[108:111]
    v_mfma_f32_16x16x32_bf16 v[108:111], a[176:179], a[92:95], v[108:111]
    ds_read_b64_tr_b16 a[144:145], v13 offset:0
    v_mfma_f32_16x16x32_bf16 v[112:115], a[148:151], a[64:67], v[112:115]
    ds_read_b64_tr_b16 a[146:147], v13 offset:4096
    v_mfma_f32_16x16x32_bf16 v[112:115], a[180:183], a[80:83], v[112:115]
    ds_read_b64_tr_b16 a[176:177], v13 offset:8192
    v_mfma_f32_16x16x32_bf16 v[116:119], a[148:151], a[68:71], v[116:119]
    ds_read_b64_tr_b16 a[178:179], v13 offset:12288
    v_mfma_f32_16x16x32_bf16 v[116:119], a[180:183], a[84:87], v[116:119]
    buffer_load_dwordx4 v248, s[44:47], s12 offen offset:2048 lds
    v_mfma_f32_16x16x32_bf16 v[120:123], a[148:151], a[72:75], v[120:123]
    v_mfma_f32_16x16x32_bf16 v[120:123], a[180:183], a[88:91], v[120:123]
    buffer_load_dwordx4 v249, s[44:47], s12 offen offset:3072 lds
    v_mfma_f32_16x16x32_bf16 v[124:127], a[148:151], a[76:79], v[124:127]
    s_add_u32 m0, s11, 24576
    s_lshl_b32 s12, s87, 6
    v_mfma_f32_16x16x32_bf16 v[124:127], a[180:183], a[92:95], v[124:127]
    ds_read_b64_tr_b16 a[148:149], v14 offset:0
    s_add_u32 s12, s12, s8
    v_mfma_f32_16x16x32_bf16 v[128:131], a[152:155], a[64:67], v[128:131]
    ds_read_b64_tr_b16 a[150:151], v14 offset:4096
    v_mfma_f32_16x16x32_bf16 v[128:131], a[184:187], a[80:83], v[128:131]
    ds_read_b64_tr_b16 a[180:181], v14 offset:8192
    v_mfma_f32_16x16x32_bf16 v[132:135], a[152:155], a[68:71], v[132:135]
    ds_read_b64_tr_b16 a[182:183], v14 offset:12288
    v_mfma_f32_16x16x32_bf16 v[132:135], a[184:187], a[84:87], v[132:135]
    buffer_load_dwordx4 v246, s[44:47], s12 offen offset:0 lds
    v_mfma_f32_16x16x32_bf16 v[136:139], a[152:155], a[72:75], v[136:139]
    v_mfma_f32_16x16x32_bf16 v[136:139], a[184:187], a[88:91], v[136:139]
    buffer_load_dwordx4 v247, s[44:47], s12 offen offset:1024 lds
    v_mfma_f32_16x16x32_bf16 v[140:143], a[152:155], a[76:79], v[140:143]
    v_mfma_f32_16x16x32_bf16 v[140:143], a[184:187], a[92:95], v[140:143]
    ds_read_b64_tr_b16 a[152:153], v15 offset:0
    v_mfma_f32_16x16x32_bf16 v[144:147], a[156:159], a[64:67], v[144:147]
    ds_read_b64_tr_b16 a[154:155], v15 offset:4096
    v_mfma_f32_16x16x32_bf16 v[144:147], a[188:191], a[80:83], v[144:147]
    ds_read_b64_tr_b16 a[184:185], v15 offset:8192
    v_mfma_f32_16x16x32_bf16 v[148:151], a[156:159], a[68:71], v[148:151]
    ds_read_b64_tr_b16 a[186:187], v15 offset:12288
    v_mfma_f32_16x16x32_bf16 v[148:151], a[188:191], a[84:87], v[148:151]
    buffer_load_dwordx4 v248, s[44:47], s12 offen offset:2048 lds
    v_mfma_f32_16x16x32_bf16 v[152:155], a[156:159], a[72:75], v[152:155]
    v_mfma_f32_16x16x32_bf16 v[152:155], a[188:191], a[88:91], v[152:155]
    buffer_load_dwordx4 v249, s[44:47], s12 offen offset:3072 lds
    v_mfma_f32_16x16x32_bf16 v[156:159], a[156:159], a[76:79], v[156:159]
    s_add_u32 s8, s8, 0x80000
    v_mfma_f32_16x16x32_bf16 v[156:159], a[188:191], a[92:95], v[156:159]
    ds_read_b64_tr_b16 a[156:157], v16 offset:0
    ds_read_b64_tr_b16 a[158:159], v16 offset:4096
    ds_read_b64_tr_b16 a[188:189], v16 offset:8192
    ds_read_b64_tr_b16 a[190:191], v16 offset:12288
    s_mov_b32 s91, 1
    s_mov_b32 s90, 2
    s_cmp_lg_u32 s72, 0
    s_cbranch_scc1 recurrent_scan__sliding_block_cached__glu_gated_glu__prompt_kernel_floop
    s_waitcnt vmcnt(31)
    v_cmp_ne_u64 vcc, s[98:99], v[30:31]
    s_cbranch_vccnz recurrent_scan__sliding_block_cached__glu_gated_glu__prompt_kernel_spinP
recurrent_scan__sliding_block_cached__glu_gated_glu__prompt_kernel_okP:
    s_add_u32 s6, s92, 4096
    buffer_load_dwordx4 v[224:227], v4, s[52:55], s92 offen offset:0 sc0 sc1
    buffer_load_dwordx4 a[96:99], v4, s[52:55], s6 offen offset:0 sc0 sc1
    buffer_load_dwordx4 v[228:231], v4, s[52:55], s92 offen offset:1024 sc0 sc1
    buffer_load_dwordx4 a[100:103], v4, s[52:55], s6 offen offset:1024 sc0 sc1
    buffer_load_dwordx4 v[232:235], v4, s[52:55], s92 offen offset:2048 sc0 sc1
    buffer_load_dwordx4 a[104:107], v4, s[52:55], s6 offen offset:2048 sc0 sc1
    buffer_load_dwordx4 v[236:239], v4, s[52:55], s92 offen offset:3072 sc0 sc1
    buffer_load_dwordx4 a[108:111], v4, s[52:55], s6 offen offset:3072 sc0 sc1
    s_mov_b32 s90, 2
    s_branch recurrent_scan__sliding_block_cached__glu_gated_glu__prompt_kernel_floop
recurrent_scan__sliding_block_cached__glu_gated_glu__prompt_kernel_flast:
    s_mov_b32 s6, 0xbfb8aa3b
    s_mov_b32 s7, 0xbfb8aa3b
    s_cmp_lg_u32 s72, 0
    s_cbranch_scc1 recurrent_scan__sliding_block_cached__glu_gated_glu__prompt_kernel_flast2
    v_lshlrev_b32 v240, 16, v224
    v_and_b32 v241, 0xffff0000, v224
    v_lshlrev_b32 v242, 16, v225
    v_and_b32 v243, 0xffff0000, v225
    v_pk_add_f32 v[160:161], v[160:161], v[240:241]
    v_pk_add_f32 v[162:163], v[162:163], v[242:243]
    v_pk_mul_f32 v[240:241], v[160:161], s[6:7]
    v_pk_mul_f32 v[242:243], v[162:163], s[6:7]
    v_exp_f32 v240, v240
    v_exp_f32 v241, v241
    v_exp_f32 v242, v242
    v_exp_f32 v243, v243
    v_pk_add_f32 v[240:241], v[240:241], 1.0 op_sel_hi:[1,0]
    v_pk_add_f32 v[242:243], v[242:243], 1.0 op_sel_hi:[1,0]
    v_rcp_f32 v240, v240
    v_rcp_f32 v241, v241
    v_rcp_f32 v242, v242
    v_rcp_f32 v243, v243
    v_pk_mul_f32 v[160:161], v[160:161], v[240:241]
    v_pk_mul_f32 v[162:163], v[162:163], v[242:243]
    v_lshlrev_b32 v240, 16, v226
    v_and_b32 v241, 0xffff0000, v226
    v_lshlrev_b32 v242, 16, v227
    v_and_b32 v243, 0xffff0000, v227
    v_pk_add_f32 v[168:169], v[168:169], v[240:241]
    v_pk_add_f32 v[170:171], v[170:171], v[242:243]
    v_pk_mul_f32 v[240:241], v[168:169], s[6:7]
    v_pk_mul_f32 v[242:243], v[170:171], s[6:7]
    v_exp_f32 v240, v240
    v_exp_f32 v241, v241
    v_exp_f32 v242, v242
    v_exp_f32 v243, v243
    v_pk_add_f32 v[240:241], v[240:241], 1.0 op_sel_hi:[1,0]
    v_pk_add_f32 v[242:243], v[242:243], 1.0 op_sel_hi:[1,0]
    v_rcp_f32 v240, v240
    v_rcp_f32 v241, v241
    v_rcp_f32 v242, v242
    v_rcp_f32 v243, v243
    v_pk_mul_f32 v[168:169], v[168:169], v[240:241]
    v_pk_mul_f32 v[170:171], v[170:171], v[242:243]
    v_lshlrev_b32 v240, 16, v228
    v_and_b32 v241, 0xffff0000, v228
    v_lshlrev_b32 v242, 16, v229
    v_and_b32 v243, 0xffff0000, v229
    v_pk_add_f32 v[176:177], v[176:177], v[240:241]
    v_pk_add_f32 v[178:179], v[178:179], v[242:243]
    v_pk_mul_f32 v[240:241], v[176:177], s[6:7]
    v_pk_mul_f32 v[242:243], v[178:179], s[6:7]
    v_exp_f32 v240, v240
    v_exp_f32 v241, v241
    v_exp_f32 v242, v242
    v_exp_f32 v243, v243
    v_pk_add_f32 v[240:241], v[240:241], 1.0 op_sel_hi:[1,0]
    v_pk_add_f32 v[242:243], v[242:243], 1.0 op_sel_hi:[1,0]
    v_rcp_f32 v240, v240
    v_rcp_f32 v241, v241
    v_rcp_f32 v242, v242
    v_rcp_f32 v243, v243
    v_pk_mul_f32 v[176:177], v[176:177], v[240:241]
    v_pk_mul_f32 v[178:179], v[178:179], v[242:243]
    v_lshlrev_b32 v240, 16, v230
    v_and_b32 v241, 0xffff0000, v230
    v_lshlrev_b32 v242, 16, v231
    v_and_b32 v243, 0xffff0000, v231
    v_pk_add_f32 v[184:185], v[184:185], v[240:241]
    v_pk_add_f32 v[186:187], v[186:187], v[242:243]
    v_pk_mul_f32 v[240:241], v[184:185], s[6:7]
    v_pk_mul_f32 v[242:243], v[186:187], s[6:7]
    v_exp_f32 v240, v240
    v_exp_f32 v241, v241
    v_exp_f32 v242, v242
    v_exp_f32 v243, v243
    v_pk_add_f32 v[240:241], v[240:241], 1.0 op_sel_hi:[1,0]
    v_pk_add_f32 v[242:243], v[242:243], 1.0 op_sel_hi:[1,0]
    v_rcp_f32 v240, v240
    v_rcp_f32 v241, v241
    v_rcp_f32 v242, v242
    v_rcp_f32 v243, v243
    v_pk_mul_f32 v[184:185], v[184:185], v[240:241]
    v_pk_mul_f32 v[186:187], v[186:187], v[242:243]
    v_lshlrev_b32 v240, 16, v232
    v_and_b32 v241, 0xffff0000, v232
    v_lshlrev_b32 v242, 16, v233
    v_and_b32 v243, 0xffff0000, v233
    v_pk_add_f32 v[192:193], v[192:193], v[240:241]
    v_pk_add_f32 v[194:195], v[194:195], v[242:243]
    v_pk_mul_f32 v[240:241], v[192:193], s[6:7]
    v_pk_mul_f32 v[242:243], v[194:195], s[6:7]
    v_exp_f32 v240, v240
    v_exp_f32 v241, v241
    v_exp_f32 v242, v242
    v_exp_f32 v243, v243
    v_pk_add_f32 v[240:241], v[240:241], 1.0 op_sel_hi:[1,0]
    v_pk_add_f32 v[242:243], v[242:243], 1.0 op_sel_hi:[1,0]
    v_rcp_f32 v240, v240
    v_rcp_f32 v241, v241
    v_rcp_f32 v242, v242
    v_rcp_f32 v243, v243
    v_pk_mul_f32 v[192:193], v[192:193], v[240:241]
    v_pk_mul_f32 v[194:195], v[194:195], v[242:243]
    v_lshlrev_b32 v240, 16, v234
    v_and_b32 v241, 0xffff0000, v234
    v_lshlrev_b32 v242, 16, v235
    v_and_b32 v243, 0xffff0000, v235
    v_pk_add_f32 v[200:201], v[200:201], v[240:241]
    v_pk_add_f32 v[202:203], v[202:203], v[242:243]
    v_pk_mul_f32 v[240:241], v[200:201], s[6:7]
    v_pk_mul_f32 v[242:243], v[202:203], s[6:7]
    v_exp_f32 v240, v240
    v_exp_f32 v241, v241
    v_exp_f32 v242, v242
    v_exp_f32 v243, v243
    v_pk_add_f32 v[240:241], v[240:241], 1.0 op_sel_hi:[1,0]
    v_pk_add_f32 v[242:243], v[242:243], 1.0 op_sel_hi:[1,0]
    v_rcp_f32 v240, v240
    v_rcp_f32 v241, v241
    v_rcp_f32 v242, v242
    v_rcp_f32 v243, v243
    v_pk_mul_f32 v[200:201], v[200:201], v[240:241]
    v_pk_mul_f32 v[202:203], v[202:203], v[242:243]
    v_lshlrev_b32 v240, 16, v236
    v_and_b32 v241, 0xffff0000, v236
    v_lshlrev_b32 v242, 16, v237
    v_and_b32 v243, 0xffff0000, v237
    v_pk_add_f32 v[208:209], v[208:209], v[240:241]
    v_pk_add_f32 v[210:211], v[210:211], v[242:243]
    v_pk_mul_f32 v[240:241], v[208:209], s[6:7]
    v_pk_mul_f32 v[242:243], v[210:211], s[6:7]
    v_exp_f32 v240, v240
    v_exp_f32 v241, v241
    v_exp_f32 v242, v242
    v_exp_f32 v243, v243
    v_pk_add_f32 v[240:241], v[240:241], 1.0 op_sel_hi:[1,0]
    v_pk_add_f32 v[242:243], v[242:243], 1.0 op_sel_hi:[1,0]
    v_rcp_f32 v240, v240
    v_rcp_f32 v241, v241
    v_rcp_f32 v242, v242
    v_rcp_f32 v243, v243
    v_pk_mul_f32 v[208:209], v[208:209], v[240:241]
    v_pk_mul_f32 v[210:211], v[210:211], v[242:243]
    v_lshlrev_b32 v240, 16, v238
    v_and_b32 v241, 0xffff0000, v238
    v_lshlrev_b32 v242, 16, v239
    v_and_b32 v243, 0xffff0000, v239
    v_pk_add_f32 v[216:217], v[216:217], v[240:241]
    v_pk_add_f32 v[218:219], v[218:219], v[242:243]
    v_pk_mul_f32 v[240:241], v[216:217], s[6:7]
    v_pk_mul_f32 v[242:243], v[218:219], s[6:7]
    v_exp_f32 v240, v240
    v_exp_f32 v241, v241
    v_exp_f32 v242, v242
    v_exp_f32 v243, v243
    v_pk_add_f32 v[240:241], v[240:241], 1.0 op_sel_hi:[1,0]
    v_pk_add_f32 v[242:243], v[242:243], 1.0 op_sel_hi:[1,0]
    v_rcp_f32 v240, v240
    v_rcp_f32 v241, v241
    v_rcp_f32 v242, v242
    v_rcp_f32 v243, v243
    v_pk_mul_f32 v[216:217], v[216:217], v[240:241]
    v_pk_mul_f32 v[218:219], v[218:219], v[242:243]
recurrent_scan__sliding_block_cached__glu_gated_glu__prompt_kernel_flast2:
    s_waitcnt vmcnt(40)
    s_waitcnt lgkmcnt(8)
    v_mfma_f32_16x16x32_bf16 v[32:35], a[128:131], a[192:195], v[32:35]
    s_add_u32 s13, s86, s9
    v_accvgpr_read_b32 v225, a96
    v_mfma_f32_16x16x32_bf16 v[32:35], a[160:163], a[208:211], v[32:35]
    v_accvgpr_read_b32 v227, a97
    v_lshlrev_b32 v224, 16, v225
    v_mfma_f32_16x16x32_bf16 v[36:39], a[128:131], a[196:199], v[36:39]
    v_and_b32 v225, 0xffff0000, v225
    v_lshlrev_b32 v226, 16, v227
    v_mfma_f32_16x16x32_bf16 v[36:39], a[160:163], a[212:215], v[36:39]
    buffer_load_dwordx4 a[64:67], v5, s[40:43], s13 offen sc0 sc1
    v_mfma_f32_16x16x32_bf16 v[40:43], a[128:131], a[200:203], v[40:43]
    v_and_b32 v227, 0xffff0000, v227
    v_add_f32 v164, v164, v224
    v_mfma_f32_16x16x32_bf16 v[40:43], a[160:163], a[216:219], v[40:43]
    buffer_load_dwordx4 a[68:71], v6, s[40:43], s13 offen sc0 sc1
    v_mfma_f32_16x16x32_bf16 v[44:47], a[128:131], a[204:207], v[44:47]
    v_add_f32 v165, v165, v225
    v_add_f32 v166, v166, v226
    v_mfma_f32_16x16x32_bf16 v[44:47], a[160:163], a[220:223], v[44:47]
    s_waitcnt vmcnt(34)
    s_waitcnt lgkmcnt(0)
    s_barrier
    ds_read_b64_tr_b16 a[128:129], v9 offset:16384
    v_add_f32 v167, v167, v227
    v_mfma_f32_16x16x32_bf16 v[48:51], a[132:135], a[192:195], v[48:51]
    ds_read_b64_tr_b16 a[130:131], v9 offset:20480
    v_mul_f32 v224, s7, v164
    v_mfma_f32_16x16x32_bf16 v[48:51], a[164:167], a[208:211], v[48:51]
    ds_read_b64_tr_b16 a[160:161], v9 offset:24576
    v_mul_f32 v225, s7, v165
    v_mfma_f32_16x16x32_bf16 v[52:55], a[132:135], a[196:199], v[52:55]
    ds_read_b64_tr_b16 a[162:163], v9 offset:28672
    v_mul_f32 v226, s7, v166
    v_mfma_f32_16x16x32_bf16 v[52:55], a[164:167], a[212:215], v[52:55]
    buffer_load_dwordx4 a[72:75], v7, s[40:43], s13 offen sc0 sc1
    v_mfma_f32_16x16x32_bf16 v[56:59], a[132:135], a[200:203], v[56:59]
    v_mul_f32 v227, s7, v167
    v_mfma_f32_16x16x32_bf16 v[56:59], a[164:167], a[216:219], v[56:59]
    buffer_load_dwordx4 a[76:79], v8, s[40:43], s13 offen sc0 sc1
    v_mfma_f32_16x16x32_bf16 v[60:63], a[132:135], a[204:207], v[60:63]
    s_add_u32 s13, s87, s9
    v_mfma_f32_16x16x32_bf16 v[60:63], a[164:167], a[220:223], v[60:63]
    ds_read_b64_tr_b16 a[132:133], v10 offset:16384
    v_mfma_f32_16x16x32_bf16 v[64:67], a[136:139], a[192:195], v[64:67]
    ds_read_b64_tr_b16 a[134:135], v10 offset:20480
    v_mfma_f32_16x16x32_bf16 v[64:67], a[168:171], a[208:211], v[64:67]
    ds_read_b64_tr_b16 a[164:165], v10 offset:24576
    v_mfma_f32_16x16x32_bf16 v[68:71], a[136:139], a[196:199], v[68:71]
    ds_read_b64_tr_b16 a[166:167], v10 offset:28672
    v_mfma_f32_16x16x32_bf16 v[68:71], a[168:171], a[212:215], v[68:71]
    buffer_load_dwordx4 a[80:83], v5, s[40:43], s13 offen sc0 sc1
    v_mfma_f32_16x16x32_bf16 v[72:75], a[136:139], a[200:203], v[72:75]
    v_exp_f32 v224, v224
    v_mfma_f32_16x16x32_bf16 v[72:75], a[168:171], a[216:219], v[72:75]
    buffer_load_dwordx4 a[84:87], v6, s[40:43], s13 offen sc0 sc1
    v_mfma_f32_16x16x32_bf16 v[76:79], a[136:139], a[204:207], v[76:79]
    v_exp_f32 v225, v225
    v_mfma_f32_16x16x32_bf16 v[76:79], a[168:171], a[220:223], v[76:79]
    ds_read_b64_tr_b16 a[136:137], v11 offset:16384
    v_mfma_f32_16x16x32_bf16 v[80:83], a[140:143], a[192:195], v[80:83]
    ds_read_b64_tr_b16 a[138:139], v11 offset:20480
    v_mfma_f32_16x16x32_bf16 v[80:83], a[172:175], a[208:211], v[80:83]
    ds_read_b64_tr_b16 a[168:169], v11 offset:24576
    v_mfma_f32_16x16x32_bf16 v[84:87], a[140:143], a[196:199], v[84:87]
    ds_read_b64_tr_b16 a[170:171], v11 offset:28672
    v_mfma_f32_16x16x32_bf16 v[84:87], a[172:175], a[212:215], v[84:87]
    buffer_load_dwordx4 a[88:91], v7, s[40:43], s13 offen sc0 sc1
    v_mfma_f32_16x16x32_bf16 v[88:91], a[140:143], a[200:203], v[88:91]
    v_exp_f32 v226, v226
    v_mfma_f32_16x16x32_bf16 v[88:91], a[172:175], a[216:219], v[88:91]
    buffer_load_dwordx4 a[92:95], v8, s[40:43], s13 offen sc0 sc1
    v_mfma_f32_16x16x32_bf16 v[92:95], a[140:143], a[204:207], v[92:95]
    s_add_u32 s9, s9, 0x2000
    v_mfma_f32_16x16x32_bf16 v[92:95], a[172:175], a[220:223], v[92:95]
    ds_read_b64_tr_b16 a[140:141], v12 offset:16384
    v_mfma_f32_16x16x32_bf16 v[96:99], a[144:147], a[192:195], v[96:99]
    ds_read_b64_tr_b16 a[142:143], v12 offset:20480
    v_mfma_f32_16x16x32_bf16 v[96:99], a[176:179], a[208:211], v[96:99]
    ds_read_b64_tr_b16 a[172:173], v12 offset:24576
    v_mfma_f32_16x16x32_bf16 v[100:103], a[144:147], a[196:199], v[100:103]
    ds_read_b64_tr_b16 a[174:175], v12 offset:28672
    v_mfma_f32_16x16x32_bf16 v[100:103], a[176:179], a[212:215], v[100:103]
    v_exp_f32 v227, v227
    v_mfma_f32_16x16x32_bf16 v[104:107], a[144:147], a[200:203], v[104:107]
    v_add_f32 v224, 1.0, v224
    v_add_f32 v225, 1.0, v225
    v_mfma_f32_16x16x32_bf16 v[104:107], a[176:179], a[216:219], v[104:107]
    v_add_f32 v226, 1.0, v226
    v_add_f32 v227, 1.0, v227
    v_mfma_f32_16x16x32_bf16 v[108:111], a[144:147], a[204:207], v[108:111]
    v_rcp_f32 v224, v224
    v_mfma_f32_16x16x32_bf16 v[108:111], a[176:179], a[220:223], v[108:111]
    ds_read_b64_tr_b16 a[144:145], v13 offset:16384
    v_mfma_f32_16x16x32_bf16 v[112:115], a[148:151], a[192:195], v[112:115]
    ds_read_b64_tr_b16 a[146:147], v13 offset:20480
    v_mfma_f32_16x16x32_bf16 v[112:115], a[180:183], a[208:211], v[112:115]
    ds_read_b64_tr_b16 a[176:177], v13 offset:24576
    v_mfma_f32_16x16x32_bf16 v[116:119], a[148:151], a[196:199], v[116:119]
    ds_read_b64_tr_b16 a[178:179], v13 offset:28672
    v_mfma_f32_16x16x32_bf16 v[116:119], a[180:183], a[212:215], v[116:119]
    v_rcp_f32 v225, v225
    v_mfma_f32_16x16x32_bf16 v[120:123], a[148:151], a[200:203], v[120:123]
    v_rcp_f32 v226, v226
    v_mfma_f32_16x16x32_bf16 v[120:123], a[180:183], a[216:219], v[120:123]
    v_rcp_f32 v227, v227
    v_mfma_f32_16x16x32_bf16 v[124:127], a[148:151], a[204:207], v[124:127]
    v_mul_f32 v164, v164, v224
    v_mul_f32 v165, v165, v225
    v_mfma_f32_16x16x32_bf16 v[124:127], a[180:183], a[220:223], v[124:127]
    ds_read_b64_tr_b16 a[148:149], v14 offset:16384
    v_mul_f32 v166, v166, v226
    v_mfma_f32_16x16x32_bf16 v[128:131], a[152:155], a[192:195], v[128:131]
    ds_read_b64_tr_b16 a[150:151], v14 offset:20480
    v_mul_f32 v167, v167, v227
    v_mfma_f32_16x16x32_bf16 v[128:131], a[184:187], a[208:211], v[128:131]
    ds_read_b64_tr_b16 a[180:181], v14 offset:24576
    v_accvgpr_read_b32 v229, a98
    v_mfma_f32_16x16x32_bf16 v[132:135], a[152:155], a[196:199], v[132:135]
    ds_read_b64_tr_b16 a[182:183], v14 offset:28672
    v_accvgpr_read_b32 v231, a99
    v_mfma_f32_16x16x32_bf16 v[132:135], a[184:187], a[212:215], v[132:135]
    v_lshlrev_b32 v228, 16, v229
    v_and_b32 v229, 0xffff0000, v229
    v_mfma_f32_16x16x32_bf16 v[136:139], a[152:155], a[200:203], v[136:139]
    v_lshlrev_b32 v230, 16, v231
    v_and_b32 v231, 0xffff0000, v231
    v_mfma_f32_16x16x32_bf16 v[136:139], a[184:187], a[216:219], v[136:139]
    v_add_f32 v172, v172, v228
    v_add_f32 v173, v173, v229
    v_mfma_f32_16x16x32_bf16 v[140:143], a[152:155], a[204:207], v[140:143]
    v_add_f32 v174, v174, v230
    v_add_f32 v175, v175, v231
    v_mfma_f32_16x16x32_bf16 v[140:143], a[184:187], a[220:223], v[140:143]
    ds_read_b64_tr_b16 a[152:153], v15 offset:16384
    v_mul_f32 v228, s7, v172
    v_mfma_f32_16x16x32_bf16 v[144:147], a[156:159], a[192:195], v[144:147]
    ds_read_b64_tr_b16 a[154:155], v15 offset:20480
    v_mul_f32 v229, s7, v173
    v_mfma_f32_16x16x32_bf16 v[144:147], a[188:191], a[208:211], v[144:147]
    ds_read_b64_tr_b16 a[184:185], v15 offset:24576
    v_mul_f32 v230, s7, v174
    v_mfma_f32_16x16x32_bf16 v[148:151], a[156:159], a[196:199], v[148:151]
    ds_read_b64_tr_b16 a[186:187], v15 offset:28672
    v_mul_f32 v231, s7, v175
    v_mfma_f32_16x16x32_bf16 v[148:151], a[188:191], a[212:215], v[148:151]
    v_exp_f32 v228, v228
    v_mfma_f32_16x16x32_bf16 v[152:155], a[156:159], a[200:203], v[152:155]
    v_exp_f32 v229, v229
    v_mfma_f32_16x16x32_bf16 v[152:155], a[188:191], a[216:219], v[152:155]
    v_exp_f32 v230, v230
    v_mfma_f32_16x16x32_bf16 v[156:159], a[156:159], a[204:207], v[156:159]
    v_exp_f32 v231, v231
    v_mfma_f32_16x16x32_bf16 v[156:159], a[188:191], a[220:223], v[156:159]
    ds_read_b64_tr_b16 a[156:157], v16 offset:16384
    v_add_f32 v228, 1.0, v228
    ds_read_b64_tr_b16 a[158:159], v16 offset:20480
    ds_read_b64_tr_b16 a[188:189], v16 offset:24576
    ds_read_b64_tr_b16 a[190:191], v16 offset:28672
    s_waitcnt vmcnt(32)
    s_waitcnt lgkmcnt(8)
    v_mfma_f32_16x16x32_bf16 v[32:35], a[128:131], a[0:3], v[32:35]
    v_add_f32 v229, 1.0, v229
    v_add_f32 v230, 1.0, v230
    v_mfma_f32_16x16x32_bf16 v[32:35], a[160:163], a[16:19], v[32:35]
    v_add_f32 v231, 1.0, v231
    v_mfma_f32_16x16x32_bf16 v[36:39], a[128:131], a[4:7], v[36:39]
    v_rcp_f32 v228, v228
    v_mfma_f32_16x16x32_bf16 v[36:39], a[160:163], a[20:23], v[36:39]
    v_rcp_f32 v229, v229
    v_mfma_f32_16x16x32_bf16 v[40:43], a[128:131], a[8:11], v[40:43]
    v_rcp_f32 v230, v230
    v_mfma_f32_16x16x32_bf16 v[40:43], a[160:163], a[24:27], v[40:43]
    v_rcp_f32 v231, v231
    v_mfma_f32_16x16x32_bf16 v[44:47], a[128:131], a[12:15], v[44:47]
    v_mul_f32 v172, v172, v228
    v_mul_f32 v173, v173, v229
    v_mfma_f32_16x16x32_bf16 v[44:47], a[160:163], a[28:31], v[44:47]
    s_waitcnt vmcnt(24)
    s_waitcnt lgkmcnt(0)
    s_barrier
    ds_read_b64_tr_b16 a[128:129], v17 offset:0
    v_mul_f32 v174, v174, v230
    v_mfma_f32_16x16x32_bf16 v[48:51], a[132:135], a[0:3], v[48:51]
    ds_read_b64_tr_b16 a[130:131], v17 offset:4096
    v_mul_f32 v175, v175, v231
    v_mfma_f32_16x16x32_bf16 v[48:51], a[164:167], a[16:19], v[48:51]
    ds_read_b64_tr_b16 a[160:161], v17 offset:8192
    v_accvgpr_read_b32 v225, a100
    v_mfma_f32_16x16x32_bf16 v[52:55], a[132:135], a[4:7], v[52:55]
    ds_read_b64_tr_b16 a[162:163], v17 offset:12288
    v_accvgpr_read_b32 v227, a101
    v_mfma_f32_16x16x32_bf16 v[52:55], a[164:167], a[20:23], v[52:55]
    v_lshlrev_b32 v224, 16, v225
    v_and_b32 v225, 0xffff0000, v225
    v_mfma_f32_16x16x32_bf16 v[56:59], a[132:135], a[8:11], v[56:59]
    v_lshlrev_b32 v226, 16, v227
    v_and_b32 v227, 0xffff0000, v227
    v_mfma_f32_16x16x32_bf16 v[56:59], a[164:167], a[24:27], v[56:59]
    v_add_f32 v180, v180, v224
    v_add_f32 v181, v181, v225
    v_mfma_f32_16x16x32_bf16 v[60:63], a[132:135], a[12:15], v[60:63]
    v_add_f32 v182, v182, v226
    v_add_f32 v183, v183, v227
    v_mfma_f32_16x16x32_bf16 v[60:63], a[164:167], a[28:31], v[60:63]
    ds_read_b64_tr_b16 a[132:133], v18 offset:0
    v_mul_f32 v224, s7, v180
    v_mfma_f32_16x16x32_bf16 v[64:67], a[136:139], a[0:3], v[64:67]
    ds_read_b64_tr_b16 a[134:135], v18 offset:4096
    v_mul_f32 v225, s7, v181
    v_mfma_f32_16x16x32_bf16 v[64:67], a[168:171], a[16:19], v[64:67]
    ds_read_b64_tr_b16 a[164:165], v18 offset:8192
    v_mul_f32 v226, s7, v182
    v_mfma_f32_16x16x32_bf16 v[68:71], a[136:139], a[4:7], v[68:71]
    ds_read_b64_tr_b16 a[166:167], v18 offset:12288
    v_mul_f32 v227, s7, v183
    v_mfma_f32_16x16x32_bf16 v[68:71], a[168:171], a[20:23], v[68:71]
    v_exp_f32 v224, v224
    v_mfma_f32_16x16x32_bf16 v[72:75], a[136:139], a[8:11], v[72:75]
    v_exp_f32 v225, v225
    v_mfma_f32_16x16x32_bf16 v[72:75], a[168:171], a[24:27], v[72:75]
    v_exp_f32 v226, v226
    v_mfma_f32_16x16x32_bf16 v[76:79], a[136:139], a[12:15], v[76:79]
    v_exp_f32 v227, v227
    v_mfma_f32_16x16x32_bf16 v[76:79], a[168:171], a[28:31], v[76:79]
    ds_read_b64_tr_b16 a[136:137], v19 offset:0
    v_add_f32 v224, 1.0, v224
    v_mfma_f32_16x16x32_bf16 v[80:83], a[140:143], a[0:3], v[80:83]
    ds_read_b64_tr_b16 a[138:139], v19 offset:4096
    v_add_f32 v225, 1.0, v225
    v_mfma_f32_16x16x32_bf16 v[80:83], a[172:175], a[16:19], v[80:83]
    ds_read_b64_tr_b16 a[168:169], v19 offset:8192
    v_add_f32 v226, 1.0, v226
    v_mfma_f32_16x16x32_bf16 v[84:87], a[140:143], a[4:7], v[84:87]
    ds_read_b64_tr_b16 a[170:171], v19 offset:12288
    v_add_f32 v227, 1.0, v227
    v_mfma_f32_16x16x32_bf16 v[84:87], a[172:175], a[20:23], v[84:87]
    v_rcp_f32 v224, v224
    v_mfma_f32_16x16x32_bf16 v[88:91], a[140:143], a[8:11], v[88:91]
    v_rcp_f32 v225, v225
    v_mfma_f32_16x16x32_bf16 v[88:91], a[172:175], a[24:27], v[88:91]
    v_rcp_f32 v226, v226
    v_mfma_f32_16x16x32_bf16 v[92:95], a[140:143], a[12:15], v[92:95]
    v_rcp_f32 v227, v227
    v_mfma_f32_16x16x32_bf16 v[92:95], a[172:175], a[28:31], v[92:95]
    ds_read_b64_tr_b16 a[140:141], v20 offset:0
    v_mul_f32 v180, v180, v224
    v_mfma_f32_16x16x32_bf16 v[96:99], a[144:147], a[0:3], v[96:99]
    ds_read_b64_tr_b16 a[142:143], v20 offset:4096
    v_mul_f32 v181, v181, v225
    v_mfma_f32_16x16x32_bf16 v[96:99], a[176:179], a[16:19], v[96:99]
    ds_read_b64_tr_b16 a[172:173], v20 offset:8192
    v_mul_f32 v182, v182, v226
    v_mfma_f32_16x16x32_bf16 v[100:103], a[144:147], a[4:7], v[100:103]
    ds_read_b64_tr_b16 a[174:175], v20 offset:12288
    v_mul_f32 v183, v183, v227
    v_mfma_f32_16x16x32_bf16 v[100:103], a[176:179], a[20:23], v[100:103]
    v_accvgpr_read_b32 v229, a102
    v_accvgpr_read_b32 v231, a103
    v_mfma_f32_16x16x32_bf16 v[104:107], a[144:147], a[8:11], v[104:107]
    v_lshlrev_b32 v228, 16, v229
    v_and_b32 v229, 0xffff0000, v229
    v_mfma_f32_16x16x32_bf16 v[104:107], a[176:179], a[24:27], v[104:107]
    v_lshlrev_b32 v230, 16, v231
    v_and_b32 v231, 0xffff0000, v231
    v_mfma_f32_16x16x32_bf16 v[108:111], a[144:147], a[12:15], v[108:111]
    v_add_f32 v188, v188, v228
    v_add_f32 v189, v189, v229
    v_mfma_f32_16x16x32_bf16 v[108:111], a[176:179], a[28:31], v[108:111]
    ds_read_b64_tr_b16 a[144:145], v21 offset:0
    v_add_f32 v190, v190, v230
    v_mfma_f32_16x16x32_bf16 v[112:115], a[148:151], a[0:3], v[112:115]
    ds_read_b64_tr_b16 a[146:147], v21 offset:4096
    v_add_f32 v191, v191, v231
    v_mfma_f32_16x16x32_bf16 v[112:115], a[180:183], a[16:19], v[112:115]
    ds_read_b64_tr_b16 a[176:177], v21 offset:8192
    v_mul_f32 v228, s7, v188
    v_mfma_f32_16x16x32_bf16 v[116:119], a[148:151], a[4:7], v[116:119]
    ds_read_b64_tr_b16 a[178:179], v21 offset:12288
    v_mul_f32 v229, s7, v189
    v_mfma_f32_16x16x32_bf16 v[116:119], a[180:183], a[20:23], v[116:119]
    v_mul_f32 v230, s7, v190
    v_mul_f32 v231, s7, v191
    v_mfma_f32_16x16x32_bf16 v[120:123], a[148:151], a[8:11], v[120:123]
    v_exp_f32 v228, v228
    v_mfma_f32_16x16x32_bf16 v[120:123], a[180:183], a[24:27], v[120:123]
    v_exp_f32 v229, v229
    v_mfma_f32_16x16x32_bf16 v[124:127], a[148:151], a[12:15], v[124:127]
    v_exp_f32 v230, v230
    v_mfma_f32_16x16x32_bf16 v[124:127], a[180:183], a[28:31], v[124:127]
    ds_read_b64_tr_b16 a[148:149], v22 offset:0
    v_mfma_f32_16x16x32_bf16 v[128:131], a[152:155], a[0:3], v[128:131]
    ds_read_b64_tr_b16 a[150:151], v22 offset:4096
    v_mfma_f32_16x16x32_bf16 v[128:131], a[184:187], a[16:19], v[128:131]
    ds_read_b64_tr_b16 a[180:181], v22 offset:8192
    v_mfma_f32_16x16x32_bf16 v[132:135], a[152:155], a[4:7], v[132:135]
    ds_read_b64_tr_b16 a[182:183], v22 offset:12288
    v_mfma_f32_16x16x32_bf16 v[132:135], a[184:187], a[20:23], v[132:135]
    v_exp_f32 v231, v231
    v_mfma_f32_16x16x32_bf16 v[136:139], a[152:155], a[8:11], v[136:139]
    v_add_f32 v228, 1.0, v228
    v_add_f32 v229, 1.0, v229
    v_mfma_f32_16x16x32_bf16 v[136:139], a[184:187], a[24:27], v[136:139]
    v_add_f32 v230, 1.0, v230
    v_add_f32 v231, 1.0, v231
    v_mfma_f32_16x16x32_bf16 v[140:143], a[152:155], a[12:15], v[140:143]
    v_rcp_f32 v228, v228
    v_mfma_f32_16x16x32_bf16 v[140:143], a[184:187], a[28:31], v[140:143]
    ds_read_b64_tr_b16 a[152:153], v23 offset:0
    v_mfma_f32_16x16x32_bf16 v[144:147], a[156:159], a[0:3], v[144:147]
    ds_read_b64_tr_b16 a[154:155], v23 offset:4096
    v_mfma_f32_16x16x32_bf16 v[144:147], a[188:191], a[16:19], v[144:147]
    ds_read_b64_tr_b16 a[184:185], v23 offset:8192
    v_mfma_f32_16x16x32_bf16 v[148:151], a[156:159], a[4:7], v[148:151]
    ds_read_b64_tr_b16 a[186:187], v23 offset:12288
    v_mfma_f32_16x16x32_bf16 v[148:151], a[188:191], a[20:23], v[148:151]
    v_rcp_f32 v229, v229
    v_mfma_f32_16x16x32_bf16 v[152:155], a[156:159], a[8:11], v[152:155]
    v_rcp_f32 v230, v230
    v_mfma_f32_16x16x32_bf16 v[152:155], a[188:191], a[24:27], v[152:155]
    v_rcp_f32 v231, v231
    v_mfma_f32_16x16x32_bf16 v[156:159], a[156:159], a[12:15], v[156:159]
    v_mul_f32 v188, v188, v228
    v_mul_f32 v189, v189, v229
    v_mfma_f32_16x16x32_bf16 v[156:159], a[188:191], a[28:31], v[156:159]
    ds_read_b64_tr_b16 a[156:157], v24 offset:0
    v_mul_f32 v190, v190, v230
    ds_read_b64_tr_b16 a[158:159], v24 offset:4096
    ds_read_b64_tr_b16 a[188:189], v24 offset:8192
    ds_read_b64_tr_b16 a[190:191], v24 offset:12288
    s_waitcnt vmcnt(16)
    s_waitcnt lgkmcnt(8)
    v_mfma_f32_16x16x32_bf16 v[32:35], a[128:131], a[32:35], v[32:35]
    v_mov_b32 v29, 0
    v_mul_f32 v191, v191, v231
    v_mfma_f32_16x16x32_bf16 v[32:35], a[160:163], a[48:51], v[32:35]
    v_accvgpr_read_b32 v225, a104
    v_accvgpr_read_b32 v227, a105
    v_mfma_f32_16x16x32_bf16 v[36:39], a[128:131], a[36:39], v[36:39]
    v_lshlrev_b32 v224, 16, v225
    v_and_b32 v225, 0xffff0000, v225
    v_mfma_f32_16x16x32_bf16 v[36:39], a[160:163], a[52:55], v[36:39]
    v_lshlrev_b32 v226, 16, v227
    v_and_b32 v227, 0xffff0000, v227
    v_mfma_f32_16x16x32_bf16 v[40:43], a[128:131], a[40:43], v[40:43]
    buffer_load_dwordx2 v[30:31], v29, s[48:51], s93 offen sc0 sc1
    v_mfma_f32_16x16x32_bf16 v[40:43], a[160:163], a[56:59], v[40:43]
    v_add_f32 v196, v196, v224
    v_add_f32 v197, v197, v225
    v_mfma_f32_16x16x32_bf16 v[44:47], a[128:131], a[44:47], v[44:47]
    v_add_f32 v198, v198, v226
    v_add_f32 v199, v199, v227
    v_mfma_f32_16x16x32_bf16 v[44:47], a[160:163], a[60:63], v[44:47]
    s_waitcnt vmcnt(9)
    s_waitcnt lgkmcnt(0)
    s_barrier
    ds_read_b64_tr_b16 a[128:129], v17 offset:16384
    v_mul_f32 v224, s7, v196
    v_mfma_f32_16x16x32_bf16 v[48:51], a[132:135], a[32:35], v[48:51]
    ds_read_b64_tr_b16 a[130:131], v17 offset:20480
    v_mul_f32 v225, s7, v197
    v_mfma_f32_16x16x32_bf16 v[48:51], a[164:167], a[48:51], v[48:51]
    ds_read_b64_tr_b16 a[160:161], v17 offset:24576
    v_mul_f32 v226, s7, v198
    v_mfma_f32_16x16x32_bf16 v[52:55], a[132:135], a[36:39], v[52:55]
    ds_read_b64_tr_b16 a[162:163], v17 offset:28672
    v_mul_f32 v227, s7, v199
    v_mfma_f32_16x16x32_bf16 v[52:55], a[164:167], a[52:55], v[52:55]
    v_exp_f32 v224, v224
    v_mfma_f32_16x16x32_bf16 v[56:59], a[132:135], a[40:43], v[56:59]
    v_exp_f32 v225, v225
    v_mfma_f32_16x16x32_bf16 v[56:59], a[164:167], a[56:59], v[56:59]
    v_exp_f32 v226, v226
    v_mfma_f32_16x16x32_bf16 v[60:63], a[132:135], a[44:47], v[60:63]
    v_exp_f32 v227, v227
    v_mfma_f32_16x16x32_bf16 v[60:63], a[164:167], a[60:63], v[60:63]
    ds_read_b64_tr_b16 a[132:133], v18 offset:16384
    v_add_f32 v224, 1.0, v224
    v_mfma_f32_16x16x32_bf16 v[64:67], a[136:139], a[32:35], v[64:67]
    ds_read_b64_tr_b16 a[134:135], v18 offset:20480
    v_add_f32 v225, 1.0, v225
    v_mfma_f32_16x16x32_bf16 v[64:67], a[168:171], a[48:51], v[64:67]
    ds_read_b64_tr_b16 a[164:165], v18 offset:24576
    v_add_f32 v226, 1.0, v226
    v_mfma_f32_16x16x32_bf16 v[68:71], a[136:139], a[36:39], v[68:71]
    ds_read_b64_tr_b16 a[166:167], v18 offset:28672
    v_add_f32 v227, 1.0, v227
    v_mfma_f32_16x16x32_bf16 v[68:71], a[168:171], a[52:55], v[68:71]
    v_rcp_f32 v224, v224
    v_mfma_f32_16x16x32_bf16 v[72:75], a[136:139], a[40:43], v[72:75]
    v_rcp_f32 v225, v225
    v_mfma_f32_16x16x32_bf16 v[72:75], a[168:171], a[56:59], v[72:75]
    v_rcp_f32 v226, v226
    v_mfma_f32_16x16x32_bf16 v[76:79], a[136:139], a[44:47], v[76:79]
    v_rcp_f32 v227, v227
    v_mfma_f32_16x16x32_bf16 v[76:79], a[168:171], a[60:63], v[76:79]
    ds_read_b64_tr_b16 a[136:137], v19 offset:16384
    v_mul_f32 v196, v196, v224
    v_mfma_f32_16x16x32_bf16 v[80:83], a[140:143], a[32:35], v[80:83]
    ds_read_b64_tr_b16 a[138:139], v19 offset:20480
    v_mul_f32 v197, v197, v225
    v_mfma_f32_16x16x32_bf16 v[80:83], a[172:175], a[48:51], v[80:83]
    ds_read_b64_tr_b16 a[168:169], v19 offset:24576
    v_mul_f32 v198, v198, v226
    v_mfma_f32_16x16x32_bf16 v[84:87], a[140:143], a[36:39], v[84:87]
    ds_read_b64_tr_b16 a[170:171], v19 offset:28672
    v_mul_f32 v199, v199, v227
    v_mfma_f32_16x16x32_bf16 v[84:87], a[172:175], a[52:55], v[84:87]
    v_accvgpr_read_b32 v229, a106
    v_accvgpr_read_b32 v231, a107
    v_mfma_f32_16x16x32_bf16 v[88:91], a[140:143], a[40:43], v[88:91]
    v_lshlrev_b32 v228, 16, v229
    v_and_b32 v229, 0xffff0000, v229
    v_mfma_f32_16x16x32_bf16 v[88:91], a[172:175], a[56:59], v[88:91]
    v_lshlrev_b32 v230, 16, v231
    v_and_b32 v231, 0xffff0000, v231
    v_mfma_f32_16x16x32_bf16 v[92:95], a[140:143], a[44:47], v[92:95]
    v_add_f32 v204, v204, v228
    v_add_f32 v205, v205, v229
    v_mfma_f32_16x16x32_bf16 v[92:95], a[172:175], a[60:63], v[92:95]
    ds_read_b64_tr_b16 a[140:141], v20 offset:16384
    v_add_f32 v206, v206, v230
    v_mfma_f32_16x16x32_bf16 v[96:99], a[144:147], a[32:35], v[96:99]
    ds_read_b64_tr_b16 a[142:143], v20 offset:20480
    v_add_f32 v207, v207, v231
    v_mfma_f32_16x16x32_bf16 v[96:99], a[176:179], a[48:51], v[96:99]
    ds_read_b64_tr_b16 a[172:173], v20 offset:24576
    v_mul_f32 v228, s7, v204
    v_mfma_f32_16x16x32_bf16 v[100:103], a[144:147], a[36:39], v[100:103]
    ds_read_b64_tr_b16 a[174:175], v20 offset:28672
    v_mul_f32 v229, s7, v205
    v_mfma_f32_16x16x32_bf16 v[100:103], a[176:179], a[52:55], v[100:103]
    v_mul_f32 v230, s7, v206
    v_mul_f32 v231, s7, v207
    v_mfma_f32_16x16x32_bf16 v[104:107], a[144:147], a[40:43], v[104:107]
    v_exp_f32 v228, v228
    v_mfma_f32_16x16x32_bf16 v[104:107], a[176:179], a[56:59], v[104:107]
    v_exp_f32 v229, v229
    v_mfma_f32_16x16x32_bf16 v[108:111], a[144:147], a[44:47], v[108:111]
    v_exp_f32 v230, v230
    v_mfma_f32_16x16x32_bf16 v[108:111], a[176:179], a[60:63], v[108:111]
    ds_read_b64_tr_b16 a[144:145], v21 offset:16384
    v_mfma_f32_16x16x32_bf16 v[112:115], a[148:151], a[32:35], v[112:115]
    ds_read_b64_tr_b16 a[146:147], v21 offset:20480
    v_mfma_f32_16x16x32_bf16 v[112:115], a[180:183], a[48:51], v[112:115]
    ds_read_b64_tr_b16 a[176:177], v21 offset:24576
    v_mfma_f32_16x16x32_bf16 v[116:119], a[148:151], a[36:39], v[116:119]
    ds_read_b64_tr_b16 a[178:179], v21 offset:28672
    v_mfma_f32_16x16x32_bf16 v[116:119], a[180:183], a[52:55], v[116:119]
    v_exp_f32 v231, v231
    v_mfma_f32_16x16x32_bf16 v[120:123], a[148:151], a[40:43], v[120:123]
    v_add_f32 v228, 1.0, v228
    v_add_f32 v229, 1.0, v229
    v_mfma_f32_16x16x32_bf16 v[120:123], a[180:183], a[56:59], v[120:123]
    v_add_f32 v230, 1.0, v230
    v_add_f32 v231, 1.0, v231
    v_mfma_f32_16x16x32_bf16 v[124:127], a[148:151], a[44:47], v[124:127]
    v_rcp_f32 v228, v228
    v_mfma_f32_16x16x32_bf16 v[124:127], a[180:183], a[60:63], v[124:127]
    ds_read_b64_tr_b16 a[148:149], v22 offset:16384
    v_mfma_f32_16x16x32_bf16 v[128:131], a[152:155], a[32:35], v[128:131]
    ds_read_b64_tr_b16 a[150:151], v22 offset:20480
    v_mfma_f32_16x16x32_bf16 v[128:131], a[184:187], a[48:51], v[128:131]
    ds_read_b64_tr_b16 a[180:181], v22 offset:24576
    v_mfma_f32_16x16x32_bf16 v[132:135], a[152:155], a[36:39], v[132:135]
    ds_read_b64_tr_b16 a[182:183], v22 offset:28672
    v_mfma_f32_16x16x32_bf16 v[132:135], a[184:187], a[52:55], v[132:135]
    v_rcp_f32 v229, v229
    v_mfma_f32_16x16x32_bf16 v[136:139], a[152:155], a[40:43], v[136:139]
    v_rcp_f32 v230, v230
    v_mfma_f32_16x16x32_bf16 v[136:139], a[184:187], a[56:59], v[136:139]
    v_rcp_f32 v231, v231
    v_mfma_f32_16x16x32_bf16 v[140:143], a[152:155], a[44:47], v[140:143]
    v_mul_f32 v204, v204, v228
    v_mul_f32 v205, v205, v229
    v_mfma_f32_16x16x32_bf16 v[140:143], a[184:187], a[60:63], v[140:143]
    ds_read_b64_tr_b16 a[152:153], v23 offset:16384
    v_mul_f32 v206, v206, v230
    v_mfma_f32_16x16x32_bf16 v[144:147], a[156:159], a[32:35], v[144:147]
    ds_read_b64_tr_b16 a[154:155], v23 offset:20480
    v_mul_f32 v207, v207, v231
    v_mfma_f32_16x16x32_bf16 v[144:147], a[188:191], a[48:51], v[144:147]
    ds_read_b64_tr_b16 a[184:185], v23 offset:24576
    v_accvgpr_read_b32 v225, a108
    v_mfma_f32_16x16x32_bf16 v[148:151], a[156:159], a[36:39], v[148:151]
    ds_read_b64_tr_b16 a[186:187], v23 offset:28672
    v_accvgpr_read_b32 v227, a109
    v_mfma_f32_16x16x32_bf16 v[148:151], a[188:191], a[52:55], v[148:151]
    v_lshlrev_b32 v224, 16, v225
    v_and_b32 v225, 0xffff0000, v225
    v_mfma_f32_16x16x32_bf16 v[152:155], a[156:159], a[40:43], v[152:155]
    v_lshlrev_b32 v226, 16, v227
    v_and_b32 v227, 0xffff0000, v227
    v_mfma_f32_16x16x32_bf16 v[152:155], a[188:191], a[56:59], v[152:155]
    v_add_f32 v212, v212, v224
    v_add_f32 v213, v213, v225
    v_mfma_f32_16x16x32_bf16 v[156:159], a[156:159], a[44:47], v[156:159]
    v_add_f32 v214, v214, v226
    v_add_f32 v215, v215, v227
    v_mfma_f32_16x16x32_bf16 v[156:159], a[188:191], a[60:63], v[156:159]
    ds_read_b64_tr_b16 a[156:157], v24 offset:16384
    v_mul_f32 v224, s7, v212
    ds_read_b64_tr_b16 a[158:159], v24 offset:20480
    ds_read_b64_tr_b16 a[188:189], v24 offset:24576
    ds_read_b64_tr_b16 a[190:191], v24 offset:28672
    s_waitcnt vmcnt(1)
    s_waitcnt lgkmcnt(8)
    v_mfma_f32_16x16x32_bf16 v[32:35], a[128:131], a[64:67], v[32:35]
    v_mul_f32 v225, s7, v213
    v_mul_f32 v226, s7, v214
    v_mfma_f32_16x16x32_bf16 v[32:35], a[160:163], a[80:83], v[32:35]
    v_mul_f32 v227, s7, v215
    v_mfma_f32_16x16x32_bf16 v[36:39], a[128:131], a[68:71], v[36:39]
    v_exp_f32 v224, v224
    v_mfma_f32_16x16x32_bf16 v[36:39], a[160:163], a[84:87], v[36:39]
    v_exp_f32 v225, v225
    v_mfma_f32_16x16x32_bf16 v[40:43], a[128:131], a[72:75], v[40:43]
    v_exp_f32 v226, v226
    v_mfma_f32_16x16x32_bf16 v[40:43], a[160:163], a[88:91], v[40:43]
    v_exp_f32 v227, v227
    v_mfma_f32_16x16x32_bf16 v[44:47], a[128:131], a[76:79], v[44:47]
    v_add_f32 v224, 1.0, v224
    v_add_f32 v225, 1.0, v225
    v_mfma_f32_16x16x32_bf16 v[44:47], a[160:163], a[92:95], v[44:47]
    s_waitcnt lgkmcnt(0)
    s_barrier
    v_add_f32 v226, 1.0, v226
    v_add_f32 v227, 1.0, v227
    v_mfma_f32_16x16x32_bf16 v[48:51], a[132:135], a[64:67], v[48:51]
    v_rcp_f32 v224, v224
    v_mfma_f32_16x16x32_bf16 v[48:51], a[164:167], a[80:83], v[48:51]
    v_rcp_f32 v225, v225
    v_mfma_f32_16x16x32_bf16 v[52:55], a[132:135], a[68:71], v[52:55]
    v_rcp_f32 v226, v226
    v_mfma_f32_16x16x32_bf16 v[52:55], a[164:167], a[84:87], v[52:55]
    v_rcp_f32 v227, v227
    v_mfma_f32_16x16x32_bf16 v[56:59], a[132:135], a[72:75], v[56:59]
    v_mul_f32 v212, v212, v224
    v_mul_f32 v213, v213, v225
    v_mfma_f32_16x16x32_bf16 v[56:59], a[164:167], a[88:91], v[56:59]
    v_mul_f32 v214, v214, v226
    v_mul_f32 v215, v215, v227
    v_mfma_f32_16x16x32_bf16 v[60:63], a[132:135], a[76:79], v[60:63]
    v_accvgpr_read_b32 v229, a110
    v_accvgpr_read_b32 v231, a111
    v_mfma_f32_16x16x32_bf16 v[60:63], a[164:167], a[92:95], v[60:63]
    v_lshlrev_b32 v228, 16, v229
    v_and_b32 v229, 0xffff0000, v229
    v_mfma_f32_16x16x32_bf16 v[64:67], a[136:139], a[64:67], v[64:67]
    v_lshlrev_b32 v230, 16, v231
    v_and_b32 v231, 0xffff0000, v231
    v_mfma_f32_16x16x32_bf16 v[64:67], a[168:171], a[80:83], v[64:67]
    v_add_f32 v220, v220, v228
    v_add_f32 v221, v221, v229
    v_mfma_f32_16x16x32_bf16 v[68:71], a[136:139], a[68:71], v[68:71]
    v_add_f32 v222, v222, v230
    v_add_f32 v223, v223, v231
    v_mfma_f32_16x16x32_bf16 v[68:71], a[168:171], a[84:87], v[68:71]
    v_mul_f32 v228, s7, v220
    v_mul_f32 v229, s7, v221
    v_mfma_f32_16x16x32_bf16 v[72:75], a[136:139], a[72:75], v[72:75]
    ds_write_b128 v2, v[40:43] offset:0
    v_mfma_f32_16x16x32_bf16 v[72:75], a[168:171], a[88:91], v[72:75]
    v_mul_f32 v230, s7, v222
    v_mul_f32 v231, s7, v223
    v_mfma_f32_16x16x32_bf16 v[76:79], a[136:139], a[76:79], v[76:79]
    ds_write_b128 v2, v[44:47] offset:1024
    v_mfma_f32_16x16x32_bf16 v[76:79], a[168:171], a[92:95], v[76:79]
    v_exp_f32 v228, v228
    v_mfma_f32_16x16x32_bf16 v[80:83], a[140:143], a[64:67], v[80:83]
    v_exp_f32 v229, v229
    v_mfma_f32_16x16x32_bf16 v[80:83], a[172:175], a[80:83], v[80:83]
    v_exp_f32 v230, v230
    v_mfma_f32_16x16x32_bf16 v[84:87], a[140:143], a[68:71], v[84:87]
    v_exp_f32 v231, v231
    v_mfma_f32_16x16x32_bf16 v[84:87], a[172:175], a[84:87], v[84:87]
    v_add_f32 v228, 1.0, v228
    v_add_f32 v229, 1.0, v229
    v_mfma_f32_16x16x32_bf16 v[88:91], a[140:143], a[72:75], v[88:91]
    ds_write_b128 v2, v[56:59] offset:2048
    v_mfma_f32_16x16x32_bf16 v[88:91], a[172:175], a[88:91], v[88:91]
    v_add_f32 v230, 1.0, v230
    v_add_f32 v231, 1.0, v231
    v_mfma_f32_16x16x32_bf16 v[92:95], a[140:143], a[76:79], v[92:95]
    ds_write_b128 v2, v[60:63] offset:3072
    v_mfma_f32_16x16x32_bf16 v[92:95], a[172:175], a[92:95], v[92:95]
    v_rcp_f32 v228, v228
    v_mfma_f32_16x16x32_bf16 v[96:99], a[144:147], a[64:67], v[96:99]
    v_rcp_f32 v229, v229
    v_mfma_f32_16x16x32_bf16 v[96:99], a[176:179], a[80:83], v[96:99]
    v_rcp_f32 v230, v230
    v_mfma_f32_16x16x32_bf16 v[100:103], a[144:147], a[68:71], v[100:103]
    v_rcp_f32 v231, v231
    v_mfma_f32_16x16x32_bf16 v[100:103], a[176:179], a[84:87], v[100:103]
    v_mul_f32 v220, v220, v228
    v_mul_f32 v221, v221, v229
    v_mfma_f32_16x16x32_bf16 v[104:107], a[144:147], a[72:75], v[104:107]
    ds_write_b128 v2, v[72:75] offset:4096
    v_mfma_f32_16x16x32_bf16 v[104:107], a[176:179], a[88:91], v[104:107]
    v_mul_f32 v222, v222, v230
    v_mul_f32 v223, v223, v231
    v_mfma_f32_16x16x32_bf16 v[108:111], a[144:147], a[76:79], v[108:111]
    ds_write_b128 v2, v[76:79] offset:5120
    v_mfma_f32_16x16x32_bf16 v[108:111], a[176:179], a[92:95], v[108:111]
    v_mfma_f32_16x16x32_bf16 v[112:115], a[148:151], a[64:67], v[112:115]
    v_mfma_f32_16x16x32_bf16 v[112:115], a[180:183], a[80:83], v[112:115]
    v_mfma_f32_16x16x32_bf16 v[116:119], a[148:151], a[68:71], v[116:119]
    v_mfma_f32_16x16x32_bf16 v[116:119], a[180:183], a[84:87], v[116:119]
    v_mfma_f32_16x16x32_bf16 v[120:123], a[148:151], a[72:75], v[120:123]
    ds_write_b128 v2, v[88:91] offset:6144
    v_mfma_f32_16x16x32_bf16 v[120:123], a[180:183], a[88:91], v[120:123]
    v_mfma_f32_16x16x32_bf16 v[124:127], a[148:151], a[76:79], v[124:127]
    ds_write_b128 v2, v[92:95] offset:7168
    v_mfma_f32_16x16x32_bf16 v[124:127], a[180:183], a[92:95], v[124:127]
    v_mfma_f32_16x16x32_bf16 v[128:131], a[152:155], a[64:67], v[128:131]
    v_mfma_f32_16x16x32_bf16 v[128:131], a[184:187], a[80:83], v[128:131]
    v_mfma_f32_16x16x32_bf16 v[132:135], a[152:155], a[68:71], v[132:135]
    v_mfma_f32_16x16x32_bf16 v[132:135], a[184:187], a[84:87], v[132:135]
    v_mfma_f32_16x16x32_bf16 v[136:139], a[152:155], a[72:75], v[136:139]
    ds_write_b128 v2, v[104:107] offset:8192
    v_mfma_f32_16x16x32_bf16 v[136:139], a[184:187], a[88:91], v[136:139]
    v_mfma_f32_16x16x32_bf16 v[140:143], a[152:155], a[76:79], v[140:143]
    ds_write_b128 v2, v[108:111] offset:9216
    v_mfma_f32_16x16x32_bf16 v[140:143], a[184:187], a[92:95], v[140:143]
    v_mfma_f32_16x16x32_bf16 v[144:147], a[156:159], a[64:67], v[144:147]
    v_mfma_f32_16x16x32_bf16 v[144:147], a[188:191], a[80:83], v[144:147]
    v_mfma_f32_16x16x32_bf16 v[148:151], a[156:159], a[68:71], v[148:151]
    v_mfma_f32_16x16x32_bf16 v[148:151], a[188:191], a[84:87], v[148:151]
    v_mfma_f32_16x16x32_bf16 v[152:155], a[156:159], a[72:75], v[152:155]
    ds_write_b128 v2, v[120:123] offset:10240
    v_mfma_f32_16x16x32_bf16 v[152:155], a[188:191], a[88:91], v[152:155]
    v_mfma_f32_16x16x32_bf16 v[156:159], a[156:159], a[76:79], v[156:159]
    ds_write_b128 v2, v[124:127] offset:11264
    v_mfma_f32_16x16x32_bf16 v[156:159], a[188:191], a[92:95], v[156:159]
    v_mov_b32 v22, s98
    v_mov_b32 v23, s99
    s_add_u32 s6, s92, 6291456
    s_add_u32 s7, s92, 6295552
    s_cmp_lg_u32 s72, 0
    s_cbranch_scc1 recurrent_scan__sliding_block_cached__glu_gated_glu__prompt_kernel_xch
    s_waitcnt vmcnt(0)
    v_cmp_ne_u64 vcc, s[98:99], v[30:31]
    s_cbranch_vccnz recurrent_scan__sliding_block_cached__glu_gated_glu__prompt_kernel_xch
    s_mov_b32 s91, 2
    buffer_load_dwordx4 v[224:227], v4, s[52:55], s6 offen offset:0 sc0 sc1
    buffer_load_dwordx4 v[228:231], v4, s[52:55], s6 offen offset:1024 sc0 sc1
    buffer_load_dwordx4 v[232:235], v4, s[52:55], s6 offen offset:2048 sc0 sc1
    buffer_load_dwordx4 v[236:239], v4, s[52:55], s6 offen offset:3072 sc0 sc1
    buffer_load_dwordx4 v[240:243], v4, s[52:55], s7 offen offset:0 sc0 sc1
    buffer_load_dwordx4 v[244:247], v4, s[52:55], s7 offen offset:1024 sc0 sc1
    buffer_load_dwordx4 v[248:251], v4, s[52:55], s7 offen offset:2048 sc0 sc1
    buffer_load_dwordx4 v[252:255], v4, s[52:55], s7 offen offset:3072 sc0 sc1
recurrent_scan__sliding_block_cached__glu_gated_glu__prompt_kernel_xch:
    s_nop 2
    ds_write_b128 v2, v[136:139] offset:12288
    ds_write_b128 v2, v[140:143] offset:13312
    ds_write_b128 v2, v[152:155] offset:14336
    ds_write_b128 v2, v[156:159] offset:15360
    s_waitcnt lgkmcnt(0)
    s_barrier
    ds_read_b128 v[40:43], v3 offset:0
    ds_read_b128 v[56:59], v3 offset:2048
    ds_read_b128 v[72:75], v3 offset:4096
    ds_read_b128 v[88:91], v3 offset:6144
    ds_read_b128 v[104:107], v3 offset:8192
    ds_read_b128 v[120:123], v3 offset:10240
    ds_read_b128 v[136:139], v3 offset:12288
    ds_read_b128 v[152:155], v3 offset:14336
    ds_read_b128 v[44:47], v3 offset:1024
    ds_read_b128 v[60:63], v3 offset:3072
    ds_read_b128 v[76:79], v3 offset:5120
    ds_read_b128 v[92:95], v3 offset:7168
    ds_read_b128 v[108:111], v3 offset:9216
    ds_read_b128 v[124:127], v3 offset:11264
    ds_read_b128 v[140:143], v3 offset:13312
    ds_read_b128 v[156:159], v3 offset:15360
    s_cmp_eq_u32 s72, 0
    s_cbranch_scc1 recurrent_scan__sliding_block_cached__glu_gated_glu__prompt_kernel_sepi
    s_waitcnt lgkmcnt(15)
    v_pk_add_f32 v[32:33], v[32:33], v[40:41]
    v_pk_add_f32 v[34:35], v[34:35], v[42:43]
    v_cvt_pk_bf16_f32 v160, v32, v33
    v_cvt_pk_bf16_f32 v161, v34, v35
    s_waitcnt lgkmcnt(14)
    v_pk_add_f32 v[48:49], v[48:49], v[56:57]
    v_pk_add_f32 v[50:51], v[50:51], v[58:59]
    v_cvt_pk_bf16_f32 v162, v48, v49
    v_cvt_pk_bf16_f32 v163, v50, v51
    buffer_store_dwordx4 v[160:163], v4, s[52:55], s6 offen offset:0 sc0 sc1
    s_waitcnt lgkmcnt(13)
    v_pk_add_f32 v[64:65], v[64:65], v[72:73]
    v_pk_add_f32 v[66:67], v[66:67], v[74:75]
    v_cvt_pk_bf16_f32 v164, v64, v65
    v_cvt_pk_bf16_f32 v165, v66, v67
    s_waitcnt lgkmcnt(12)
    v_pk_add_f32 v[80:81], v[80:81], v[88:89]
    v_pk_add_f32 v[82:83], v[82:83], v[90:91]
    v_cvt_pk_bf16_f32 v166, v80, v81
    v_cvt_pk_bf16_f32 v167, v82, v83
    buffer_store_dwordx4 v[164:167], v4, s[52:55], s6 offen offset:1024 sc0 sc1
    s_waitcnt lgkmcnt(11)
    v_pk_add_f32 v[96:97], v[96:97], v[104:105]
    v_pk_add_f32 v[98:99], v[98:99], v[106:107]
    v_cvt_pk_bf16_f32 v168, v96, v97
    v_cvt_pk_bf16_f32 v169, v98, v99
    s_waitcnt lgkmcnt(10)
    v_pk_add_f32 v[112:113], v[112:113], v[120:121]
    v_pk_add_f32 v[114:115], v[114:115], v[122:123]
    v_cvt_pk_bf16_f32 v170, v112, v113
    v_cvt_pk_bf16_f32 v171, v114, v115
    buffer_store_dwordx4 v[168:171], v4, s[52:55], s6 offen offset:2048 sc0 sc1
    s_waitcnt lgkmcnt(9)
    v_pk_add_f32 v[128:129], v[128:129], v[136:137]
    v_pk_add_f32 v[130:131], v[130:131], v[138:139]
    v_cvt_pk_bf16_f32 v172, v128, v129
    v_cvt_pk_bf16_f32 v173, v130, v131
    s_waitcnt lgkmcnt(8)
    v_pk_add_f32 v[144:145], v[144:145], v[152:153]
    v_pk_add_f32 v[146:147], v[146:147], v[154:155]
    v_cvt_pk_bf16_f32 v174, v144, v145
    v_cvt_pk_bf16_f32 v175, v146, v147
    buffer_store_dwordx4 v[172:175], v4, s[52:55], s6 offen offset:3072 sc0 sc1
    s_waitcnt lgkmcnt(7)
    v_pk_add_f32 v[36:37], v[36:37], v[44:45]
    v_pk_add_f32 v[38:39], v[38:39], v[46:47]
    v_cvt_pk_bf16_f32 v176, v36, v37
    v_cvt_pk_bf16_f32 v177, v38, v39
    s_waitcnt lgkmcnt(6)
    v_pk_add_f32 v[52:53], v[52:53], v[60:61]
    v_pk_add_f32 v[54:55], v[54:55], v[62:63]
    v_cvt_pk_bf16_f32 v178, v52, v53
    v_cvt_pk_bf16_f32 v179, v54, v55
    buffer_store_dwordx4 v[176:179], v4, s[52:55], s7 offen offset:0 sc0 sc1
    s_waitcnt lgkmcnt(5)
    v_pk_add_f32 v[68:69], v[68:69], v[76:77]
    v_pk_add_f32 v[70:71], v[70:71], v[78:79]
    v_cvt_pk_bf16_f32 v180, v68, v69
    v_cvt_pk_bf16_f32 v181, v70, v71
    s_waitcnt lgkmcnt(4)
    v_pk_add_f32 v[84:85], v[84:85], v[92:93]
    v_pk_add_f32 v[86:87], v[86:87], v[94:95]
    v_cvt_pk_bf16_f32 v182, v84, v85
    v_cvt_pk_bf16_f32 v183, v86, v87
    buffer_store_dwordx4 v[180:183], v4, s[52:55], s7 offen offset:1024 sc0 sc1
    s_waitcnt lgkmcnt(3)
    v_pk_add_f32 v[100:101], v[100:101], v[108:109]
    v_pk_add_f32 v[102:103], v[102:103], v[110:111]
    v_cvt_pk_bf16_f32 v184, v100, v101
    v_cvt_pk_bf16_f32 v185, v102, v103
    s_waitcnt lgkmcnt(2)
    v_pk_add_f32 v[116:117], v[116:117], v[124:125]
    v_pk_add_f32 v[118:119], v[118:119], v[126:127]
    v_cvt_pk_bf16_f32 v186, v116, v117
    v_cvt_pk_bf16_f32 v187, v118, v119
    buffer_store_dwordx4 v[184:187], v4, s[52:55], s7 offen offset:2048 sc0 sc1
    s_waitcnt lgkmcnt(1)
    v_pk_add_f32 v[132:133], v[132:133], v[140:141]
    v_pk_add_f32 v[134:135], v[134:135], v[142:143]
    v_cvt_pk_bf16_f32 v188, v132, v133
    v_cvt_pk_bf16_f32 v189, v134, v135
    s_waitcnt lgkmcnt(0)
    v_pk_add_f32 v[148:149], v[148:149], v[156:157]
    v_pk_add_f32 v[150:151], v[150:151], v[158:159]
    v_cvt_pk_bf16_f32 v190, v148, v149
    v_cvt_pk_bf16_f32 v191, v150, v151
    buffer_store_dwordx4 v[188:191], v4, s[52:55], s7 offen offset:3072 sc0 sc1
    s_waitcnt vmcnt(0)
    s_mov_b64 exec, 1
    buffer_store_dwordx2 v[22:23], v29, s[48:51], s93 offen sc0 sc1
    s_mov_b64 exec, -1
    s_branch recurrent_scan__sliding_block_cached__glu_gated_glu__prompt_kernel_fin
recurrent_scan__sliding_block_cached__glu_gated_glu__prompt_kernel_sepi:
    s_waitcnt lgkmcnt(0)
    v_accvgpr_read_b32 v9, a224
    v_accvgpr_read_b32 v11, a225
    v_pk_add_f32 v[32:33], v[32:33], v[40:41]
    v_pk_add_f32 v[34:35], v[34:35], v[42:43]
    v_lshlrev_b32 v8, 16, v9
    v_and_b32 v9, 0xffff0000, v9
    v_lshlrev_b32 v10, 16, v11
    v_and_b32 v11, 0xffff0000, v11
    v_pk_fma_f32 v[32:33], v[32:33], v[160:161], v[8:9]
    v_pk_fma_f32 v[34:35], v[34:35], v[162:163], v[10:11]
    v_accvgpr_read_b32 v13, a228
    v_accvgpr_read_b32 v15, a229
    v_pk_add_f32 v[48:49], v[48:49], v[56:57]
    v_pk_add_f32 v[50:51], v[50:51], v[58:59]
    v_lshlrev_b32 v12, 16, v13
    v_and_b32 v13, 0xffff0000, v13
    v_lshlrev_b32 v14, 16, v15
    v_and_b32 v15, 0xffff0000, v15
    v_pk_fma_f32 v[48:49], v[48:49], v[168:169], v[12:13]
    v_pk_fma_f32 v[50:51], v[50:51], v[170:171], v[14:15]
    v_accvgpr_read_b32 v9, a232
    v_accvgpr_read_b32 v11, a233
    v_pk_add_f32 v[64:65], v[64:65], v[72:73]
    v_pk_add_f32 v[66:67], v[66:67], v[74:75]
    v_lshlrev_b32 v8, 16, v9
    v_and_b32 v9, 0xffff0000, v9
    v_lshlrev_b32 v10, 16, v11
    v_and_b32 v11, 0xffff0000, v11
    v_pk_fma_f32 v[64:65], v[64:65], v[176:177], v[8:9]
    v_pk_fma_f32 v[66:67], v[66:67], v[178:179], v[10:11]
    v_accvgpr_read_b32 v13, a236
    v_accvgpr_read_b32 v15, a237
    v_pk_add_f32 v[80:81], v[80:81], v[88:89]
    v_pk_add_f32 v[82:83], v[82:83], v[90:91]
    v_lshlrev_b32 v12, 16, v13
    v_and_b32 v13, 0xffff0000, v13
    v_lshlrev_b32 v14, 16, v15
    v_and_b32 v15, 0xffff0000, v15
    v_pk_fma_f32 v[80:81], v[80:81], v[184:185], v[12:13]
    v_pk_fma_f32 v[82:83], v[82:83], v[186:187], v[14:15]
    v_accvgpr_read_b32 v9, a240
    v_accvgpr_read_b32 v11, a241
    v_pk_add_f32 v[96:97], v[96:97], v[104:105]
    v_pk_add_f32 v[98:99], v[98:99], v[106:107]
    v_lshlrev_b32 v8, 16, v9
    v_and_b32 v9, 0xffff0000, v9
    v_lshlrev_b32 v10, 16, v11
    v_and_b32 v11, 0xffff0000, v11
    v_pk_fma_f32 v[96:97], v[96:97], v[192:193], v[8:9]
    v_pk_fma_f32 v[98:99], v[98:99], v[194:195], v[10:11]
    v_accvgpr_read_b32 v13, a244
    v_accvgpr_read_b32 v15, a245
    v_pk_add_f32 v[112:113], v[112:113], v[120:121]
    v_pk_add_f32 v[114:115], v[114:115], v[122:123]
    v_lshlrev_b32 v12, 16, v13
    v_and_b32 v13, 0xffff0000, v13
    v_lshlrev_b32 v14, 16, v15
    v_and_b32 v15, 0xffff0000, v15
    v_pk_fma_f32 v[112:113], v[112:113], v[200:201], v[12:13]
    v_pk_fma_f32 v[114:115], v[114:115], v[202:203], v[14:15]
    v_accvgpr_read_b32 v9, a248
    v_accvgpr_read_b32 v11, a249
    v_pk_add_f32 v[128:129], v[128:129], v[136:137]
    v_pk_add_f32 v[130:131], v[130:131], v[138:139]
    v_lshlrev_b32 v8, 16, v9
    v_and_b32 v9, 0xffff0000, v9
    v_lshlrev_b32 v10, 16, v11
    v_and_b32 v11, 0xffff0000, v11
    v_pk_fma_f32 v[128:129], v[128:129], v[208:209], v[8:9]
    v_pk_fma_f32 v[130:131], v[130:131], v[210:211], v[10:11]
    v_accvgpr_read_b32 v13, a252
    v_accvgpr_read_b32 v15, a253
    v_pk_add_f32 v[144:145], v[144:145], v[152:153]
    v_pk_add_f32 v[146:147], v[146:147], v[154:155]
    v_lshlrev_b32 v12, 16, v13
    v_and_b32 v13, 0xffff0000, v13
    v_lshlrev_b32 v14, 16, v15
    v_and_b32 v15, 0xffff0000, v15
    v_pk_fma_f32 v[144:145], v[144:145], v[216:217], v[12:13]
    v_pk_fma_f32 v[146:147], v[146:147], v[218:219], v[14:15]
    v_accvgpr_read_b32 v9, a226
    v_accvgpr_read_b32 v11, a227
    v_pk_add_f32 v[36:37], v[36:37], v[44:45]
    v_pk_add_f32 v[38:39], v[38:39], v[46:47]
    v_lshlrev_b32 v8, 16, v9
    v_and_b32 v9, 0xffff0000, v9
    v_lshlrev_b32 v10, 16, v11
    v_and_b32 v11, 0xffff0000, v11
    v_pk_fma_f32 v[36:37], v[36:37], v[164:165], v[8:9]
    v_pk_fma_f32 v[38:39], v[38:39], v[166:167], v[10:11]
    v_accvgpr_read_b32 v13, a230
    v_accvgpr_read_b32 v15, a231
    v_pk_add_f32 v[52:53], v[52:53], v[60:61]
    v_pk_add_f32 v[54:55], v[54:55], v[62:63]
    v_lshlrev_b32 v12, 16, v13
    v_and_b32 v13, 0xffff0000, v13
    v_lshlrev_b32 v14, 16, v15
    v_and_b32 v15, 0xffff0000, v15
    v_pk_fma_f32 v[52:53], v[52:53], v[172:173], v[12:13]
    v_pk_fma_f32 v[54:55], v[54:55], v[174:175], v[14:15]
    v_accvgpr_read_b32 v9, a234
    v_accvgpr_read_b32 v11, a235
    v_pk_add_f32 v[68:69], v[68:69], v[76:77]
    v_pk_add_f32 v[70:71], v[70:71], v[78:79]
    v_lshlrev_b32 v8, 16, v9
    v_and_b32 v9, 0xffff0000, v9
    v_lshlrev_b32 v10, 16, v11
    v_and_b32 v11, 0xffff0000, v11
    v_pk_fma_f32 v[68:69], v[68:69], v[180:181], v[8:9]
    v_pk_fma_f32 v[70:71], v[70:71], v[182:183], v[10:11]
    v_accvgpr_read_b32 v13, a238
    v_accvgpr_read_b32 v15, a239
    v_pk_add_f32 v[84:85], v[84:85], v[92:93]
    v_pk_add_f32 v[86:87], v[86:87], v[94:95]
    v_lshlrev_b32 v12, 16, v13
    v_and_b32 v13, 0xffff0000, v13
    v_lshlrev_b32 v14, 16, v15
    v_and_b32 v15, 0xffff0000, v15
    v_pk_fma_f32 v[84:85], v[84:85], v[188:189], v[12:13]
    v_pk_fma_f32 v[86:87], v[86:87], v[190:191], v[14:15]
    v_accvgpr_read_b32 v9, a242
    v_accvgpr_read_b32 v11, a243
    v_pk_add_f32 v[100:101], v[100:101], v[108:109]
    v_pk_add_f32 v[102:103], v[102:103], v[110:111]
    v_lshlrev_b32 v8, 16, v9
    v_and_b32 v9, 0xffff0000, v9
    v_lshlrev_b32 v10, 16, v11
    v_and_b32 v11, 0xffff0000, v11
    v_pk_fma_f32 v[100:101], v[100:101], v[196:197], v[8:9]
    v_pk_fma_f32 v[102:103], v[102:103], v[198:199], v[10:11]
    v_accvgpr_read_b32 v13, a246
    v_accvgpr_read_b32 v15, a247
    v_pk_add_f32 v[116:117], v[116:117], v[124:125]
    v_pk_add_f32 v[118:119], v[118:119], v[126:127]
    v_lshlrev_b32 v12, 16, v13
    v_and_b32 v13, 0xffff0000, v13
    v_lshlrev_b32 v14, 16, v15
    v_and_b32 v15, 0xffff0000, v15
    v_pk_fma_f32 v[116:117], v[116:117], v[204:205], v[12:13]
    v_pk_fma_f32 v[118:119], v[118:119], v[206:207], v[14:15]
    v_accvgpr_read_b32 v9, a250
    v_accvgpr_read_b32 v11, a251
    v_pk_add_f32 v[132:133], v[132:133], v[140:141]
    v_pk_add_f32 v[134:135], v[134:135], v[142:143]
    v_lshlrev_b32 v8, 16, v9
    v_and_b32 v9, 0xffff0000, v9
    v_lshlrev_b32 v10, 16, v11
    v_and_b32 v11, 0xffff0000, v11
    v_pk_fma_f32 v[132:133], v[132:133], v[212:213], v[8:9]
    v_pk_fma_f32 v[134:135], v[134:135], v[214:215], v[10:11]
    v_accvgpr_read_b32 v13, a254
    v_accvgpr_read_b32 v15, a255
    v_pk_add_f32 v[148:149], v[148:149], v[156:157]
    v_pk_add_f32 v[150:151], v[150:151], v[158:159]
    v_lshlrev_b32 v12, 16, v13
    v_and_b32 v13, 0xffff0000, v13
    v_lshlrev_b32 v14, 16, v15
    v_and_b32 v15, 0xffff0000, v15
    v_pk_fma_f32 v[148:149], v[148:149], v[220:221], v[12:13]
    v_pk_fma_f32 v[150:151], v[150:151], v[222:223], v[14:15]
    s_cmp_eq_u32 s91, 2
    s_cbranch_scc1 recurrent_scan__sliding_block_cached__glu_gated_glu__prompt_kernel_have
    s_mov_b32 s12, 0x10000
recurrent_scan__sliding_block_cached__glu_gated_glu__prompt_kernel_poll:
    buffer_load_dwordx2 v[30:31], v29, s[48:51], s93 offen sc0 sc1
    s_waitcnt vmcnt(0)
    s_sub_u32 s12, s12, 1
    s_cbranch_scc1 recurrent_scan__sliding_block_cached__glu_gated_glu__prompt_kernel_got
    v_cmp_ne_u64 vcc, s[98:99], v[30:31]
    s_cbranch_vccz recurrent_scan__sliding_block_cached__glu_gated_glu__prompt_kernel_got
    s_sleep 1
    s_branch recurrent_scan__sliding_block_cached__glu_gated_glu__prompt_kernel_poll
recurrent_scan__sliding_block_cached__glu_gated_glu__prompt_kernel_got:
    buffer_load_dwordx4 v[224:227], v4, s[52:55], s6 offen offset:0 sc0 sc1
    buffer_load_dwordx4 v[228:231], v4, s[52:55], s6 offen offset:1024 sc0 sc1
    buffer_load_dwordx4 v[232:235], v4, s[52:55], s6 offen offset:2048 sc0 sc1
    buffer_load_dwordx4 v[236:239], v4, s[52:55], s6 offen offset:3072 sc0 sc1
    buffer_load_dwordx4 v[240:243], v4, s[52:55], s7 offen offset:0 sc0 sc1
    buffer_load_dwordx4 v[244:247], v4, s[52:55], s7 offen offset:1024 sc0 sc1
    buffer_load_dwordx4 v[248:251], v4, s[52:55], s7 offen offset:2048 sc0 sc1
    buffer_load_dwordx4 v[252:255], v4, s[52:55], s7 offen offset:3072 sc0 sc1
recurrent_scan__sliding_block_cached__glu_gated_glu__prompt_kernel_have:
    s_waitcnt vmcnt(7)
    v_lshlrev_b32 v8, 16, v224
    v_and_b32 v9, 0xffff0000, v224
    v_lshlrev_b32 v10, 16, v225
    v_and_b32 v11, 0xffff0000, v225
    v_pk_fma_f32 v[32:33], v[8:9], v[160:161], v[32:33]
    v_pk_fma_f32 v[34:35], v[10:11], v[162:163], v[34:35]
    v_cvt_pk_bf16_f32 v224, v32, v33
    v_cvt_pk_bf16_f32 v225, v34, v35
    v_lshlrev_b32 v12, 16, v226
    v_and_b32 v13, 0xffff0000, v226
    v_lshlrev_b32 v14, 16, v227
    v_and_b32 v15, 0xffff0000, v227
    v_pk_fma_f32 v[48:49], v[12:13], v[168:169], v[48:49]
    v_pk_fma_f32 v[50:51], v[14:15], v[170:171], v[50:51]
    v_cvt_pk_bf16_f32 v226, v48, v49
    v_cvt_pk_bf16_f32 v227, v50, v51
    s_nop 1
    v_permlane32_swap_b32 v224, v226
    v_permlane32_swap_b32 v225, v227
    s_nop 0
    v_permlane16_swap_b32 v224, v226
    v_permlane16_swap_b32 v225, v227
    buffer_store_dwordx4 v[224:227], v27, s[68:71], s94 offen offset:0
    s_waitcnt vmcnt(7)
    v_lshlrev_b32 v8, 16, v228
    v_and_b32 v9, 0xffff0000, v228
    v_lshlrev_b32 v10, 16, v229
    v_and_b32 v11, 0xffff0000, v229
    v_pk_fma_f32 v[64:65], v[8:9], v[176:177], v[64:65]
    v_pk_fma_f32 v[66:67], v[10:11], v[178:179], v[66:67]
    v_cvt_pk_bf16_f32 v228, v64, v65
    v_cvt_pk_bf16_f32 v229, v66, v67
    v_lshlrev_b32 v12, 16, v230
    v_and_b32 v13, 0xffff0000, v230
    v_lshlrev_b32 v14, 16, v231
    v_and_b32 v15, 0xffff0000, v231
    v_pk_fma_f32 v[80:81], v[12:13], v[184:185], v[80:81]
    v_pk_fma_f32 v[82:83], v[14:15], v[186:187], v[82:83]
    v_cvt_pk_bf16_f32 v230, v80, v81
    v_cvt_pk_bf16_f32 v231, v82, v83
    s_nop 1
    v_permlane32_swap_b32 v228, v230
    v_permlane32_swap_b32 v229, v231
    s_nop 0
    v_permlane16_swap_b32 v228, v230
    v_permlane16_swap_b32 v229, v231
    buffer_store_dwordx4 v[228:231], v27, s[68:71], s94 offen offset:64
    s_waitcnt vmcnt(7)
    v_lshlrev_b32 v8, 16, v232
    v_and_b32 v9, 0xffff0000, v232
    v_lshlrev_b32 v10, 16, v233
    v_and_b32 v11, 0xffff0000, v233
    v_pk_fma_f32 v[96:97], v[8:9], v[192:193], v[96:97]
    v_pk_fma_f32 v[98:99], v[10:11], v[194:195], v[98:99]
    v_cvt_pk_bf16_f32 v232, v96, v97
    v_cvt_pk_bf16_f32 v233, v98, v99
    v_lshlrev_b32 v12, 16, v234
    v_and_b32 v13, 0xffff0000, v234
    v_lshlrev_b32 v14, 16, v235
    v_and_b32 v15, 0xffff0000, v235
    v_pk_fma_f32 v[112:113], v[12:13], v[200:201], v[112:113]
    v_pk_fma_f32 v[114:115], v[14:15], v[202:203], v[114:115]
    v_cvt_pk_bf16_f32 v234, v112, v113
    v_cvt_pk_bf16_f32 v235, v114, v115
    s_nop 1
    v_permlane32_swap_b32 v232, v234
    v_permlane32_swap_b32 v233, v235
    s_nop 0
    v_permlane16_swap_b32 v232, v234
    v_permlane16_swap_b32 v233, v235
    buffer_store_dwordx4 v[232:235], v27, s[68:71], s94 offen offset:128
    s_waitcnt vmcnt(7)
    v_lshlrev_b32 v8, 16, v236
    v_and_b32 v9, 0xffff0000, v236
    v_lshlrev_b32 v10, 16, v237
    v_and_b32 v11, 0xffff0000, v237
    v_pk_fma_f32 v[128:129], v[8:9], v[208:209], v[128:129]
    v_pk_fma_f32 v[130:131], v[10:11], v[210:211], v[130:131]
    v_cvt_pk_bf16_f32 v236, v128, v129
    v_cvt_pk_bf16_f32 v237, v130, v131
    v_lshlrev_b32 v12, 16, v238
    v_and_b32 v13, 0xffff0000, v238
    v_lshlrev_b32 v14, 16, v239
    v_and_b32 v15, 0xffff0000, v239
    v_pk_fma_f32 v[144:145], v[12:13], v[216:217], v[144:145]
    v_pk_fma_f32 v[146:147], v[14:15], v[218:219], v[146:147]
    v_cvt_pk_bf16_f32 v238, v144, v145
    v_cvt_pk_bf16_f32 v239, v146, v147
    s_nop 1
    v_permlane32_swap_b32 v236, v238
    v_permlane32_swap_b32 v237, v239
    s_nop 0
    v_permlane16_swap_b32 v236, v238
    v_permlane16_swap_b32 v237, v239
    buffer_store_dwordx4 v[236:239], v27, s[68:71], s94 offen offset:192
    s_waitcnt vmcnt(7)
    v_lshlrev_b32 v8, 16, v240
    v_and_b32 v9, 0xffff0000, v240
    v_lshlrev_b32 v10, 16, v241
    v_and_b32 v11, 0xffff0000, v241
    v_pk_fma_f32 v[36:37], v[8:9], v[164:165], v[36:37]
    v_pk_fma_f32 v[38:39], v[10:11], v[166:167], v[38:39]
    v_cvt_pk_bf16_f32 v240, v36, v37
    v_cvt_pk_bf16_f32 v241, v38, v39
    v_lshlrev_b32 v12, 16, v242
    v_and_b32 v13, 0xffff0000, v242
    v_lshlrev_b32 v14, 16, v243
    v_and_b32 v15, 0xffff0000, v243
    v_pk_fma_f32 v[52:53], v[12:13], v[172:173], v[52:53]
    v_pk_fma_f32 v[54:55], v[14:15], v[174:175], v[54:55]
    v_cvt_pk_bf16_f32 v242, v52, v53
    v_cvt_pk_bf16_f32 v243, v54, v55
    s_nop 1
    v_permlane32_swap_b32 v240, v242
    v_permlane32_swap_b32 v241, v243
    s_nop 0
    v_permlane16_swap_b32 v240, v242
    v_permlane16_swap_b32 v241, v243
    buffer_store_dwordx4 v[240:243], v28, s[68:71], s94 offen offset:0
    s_waitcnt vmcnt(7)
    v_lshlrev_b32 v8, 16, v244
    v_and_b32 v9, 0xffff0000, v244
    v_lshlrev_b32 v10, 16, v245
    v_and_b32 v11, 0xffff0000, v245
    v_pk_fma_f32 v[68:69], v[8:9], v[180:181], v[68:69]
    v_pk_fma_f32 v[70:71], v[10:11], v[182:183], v[70:71]
    v_cvt_pk_bf16_f32 v244, v68, v69
    v_cvt_pk_bf16_f32 v245, v70, v71
    v_lshlrev_b32 v12, 16, v246
    v_and_b32 v13, 0xffff0000, v246
    v_lshlrev_b32 v14, 16, v247
    v_and_b32 v15, 0xffff0000, v247
    v_pk_fma_f32 v[84:85], v[12:13], v[188:189], v[84:85]
    v_pk_fma_f32 v[86:87], v[14:15], v[190:191], v[86:87]
    v_cvt_pk_bf16_f32 v246, v84, v85
    v_cvt_pk_bf16_f32 v247, v86, v87
    s_nop 1
    v_permlane32_swap_b32 v244, v246
    v_permlane32_swap_b32 v245, v247
    s_nop 0
    v_permlane16_swap_b32 v244, v246
    v_permlane16_swap_b32 v245, v247
    buffer_store_dwordx4 v[244:247], v28, s[68:71], s94 offen offset:64
    s_waitcnt vmcnt(7)
    v_lshlrev_b32 v8, 16, v248
    v_and_b32 v9, 0xffff0000, v248
    v_lshlrev_b32 v10, 16, v249
    v_and_b32 v11, 0xffff0000, v249
    v_pk_fma_f32 v[100:101], v[8:9], v[196:197], v[100:101]
    v_pk_fma_f32 v[102:103], v[10:11], v[198:199], v[102:103]
    v_cvt_pk_bf16_f32 v248, v100, v101
    v_cvt_pk_bf16_f32 v249, v102, v103
    v_lshlrev_b32 v12, 16, v250
    v_and_b32 v13, 0xffff0000, v250
    v_lshlrev_b32 v14, 16, v251
    v_and_b32 v15, 0xffff0000, v251
    v_pk_fma_f32 v[116:117], v[12:13], v[204:205], v[116:117]
    v_pk_fma_f32 v[118:119], v[14:15], v[206:207], v[118:119]
    v_cvt_pk_bf16_f32 v250, v116, v117
    v_cvt_pk_bf16_f32 v251, v118, v119
    s_nop 1
    v_permlane32_swap_b32 v248, v250
    v_permlane32_swap_b32 v249, v251
    s_nop 0
    v_permlane16_swap_b32 v248, v250
    v_permlane16_swap_b32 v249, v251
    buffer_store_dwordx4 v[248:251], v28, s[68:71], s94 offen offset:128
    s_waitcnt vmcnt(7)
    v_lshlrev_b32 v8, 16, v252
    v_and_b32 v9, 0xffff0000, v252
    v_lshlrev_b32 v10, 16, v253
    v_and_b32 v11, 0xffff0000, v253
    v_pk_fma_f32 v[132:133], v[8:9], v[212:213], v[132:133]
    v_pk_fma_f32 v[134:135], v[10:11], v[214:215], v[134:135]
    v_cvt_pk_bf16_f32 v252, v132, v133
    v_cvt_pk_bf16_f32 v253, v134, v135
    v_lshlrev_b32 v12, 16, v254
    v_and_b32 v13, 0xffff0000, v254
    v_lshlrev_b32 v14, 16, v255
    v_and_b32 v15, 0xffff0000, v255
    v_pk_fma_f32 v[148:149], v[12:13], v[220:221], v[148:149]
    v_pk_fma_f32 v[150:151], v[14:15], v[222:223], v[150:151]
    v_cvt_pk_bf16_f32 v254, v148, v149
    v_cvt_pk_bf16_f32 v255, v150, v151
    s_nop 1
    v_permlane32_swap_b32 v252, v254
    v_permlane32_swap_b32 v253, v255
    s_nop 0
    v_permlane16_swap_b32 v252, v254
    v_permlane16_swap_b32 v253, v255
    buffer_store_dwordx4 v[252:255], v28, s[68:71], s94 offen offset:192
recurrent_scan__sliding_block_cached__glu_gated_glu__prompt_kernel_fin:
recurrent_scan__sliding_block_cached__glu_gated_glu__prompt_kernel_end:
    s_endpgm
recurrent_scan__sliding_block_cached__glu_gated_glu__prompt_kernel_spinH:
    s_mov_b32 s12, 0x10000
recurrent_scan__sliding_block_cached__glu_gated_glu__prompt_kernel_spinlH:
    s_sleep 2
    buffer_load_dwordx2 v[22:23], v24, s[48:51], s91 offen sc0 sc1
    s_waitcnt vmcnt(0)
    s_sub_u32 s12, s12, 1
    s_cbranch_scc1 recurrent_scan__sliding_block_cached__glu_gated_glu__prompt_kernel_okH
    v_cmp_ne_u64 vcc, s[98:99], v[22:23]
    s_cbranch_vccnz recurrent_scan__sliding_block_cached__glu_gated_glu__prompt_kernel_spinlH
    s_branch recurrent_scan__sliding_block_cached__glu_gated_glu__prompt_kernel_okH
recurrent_scan__sliding_block_cached__glu_gated_glu__prompt_kernel_spinO:
    s_mov_b32 s12, 0x10000
recurrent_scan__sliding_block_cached__glu_gated_glu__prompt_kernel_spinlO:
    s_sleep 2
    buffer_load_dwordx2 v[30:31], v253, s[48:51], s97 offen sc0 sc1
    s_waitcnt vmcnt(0)
    s_sub_u32 s12, s12, 1
    s_cbranch_scc1 recurrent_scan__sliding_block_cached__glu_gated_glu__prompt_kernel_okO
    v_cmp_ne_u64 vcc, s[98:99], v[30:31]
    s_cbranch_vccnz recurrent_scan__sliding_block_cached__glu_gated_glu__prompt_kernel_spinlO
    s_branch recurrent_scan__sliding_block_cached__glu_gated_glu__prompt_kernel_okO
recurrent_scan__sliding_block_cached__glu_gated_glu__prompt_kernel_spinP:
    s_mov_b32 s12, 0x10000
recurrent_scan__sliding_block_cached__glu_gated_glu__prompt_kernel_spinlP:
    s_sleep 2
    buffer_load_dwordx2 v[30:31], v252, s[48:51], s101 offen sc0 sc1
    s_waitcnt vmcnt(0)
    s_sub_u32 s12, s12, 1
    s_cbranch_scc1 recurrent_scan__sliding_block_cached__glu_gated_glu__prompt_kernel_okP
    v_cmp_ne_u64 vcc, s[98:99], v[30:31]
    s_cbranch_vccnz recurrent_scan__sliding_block_cached__glu_gated_glu__prompt_kernel_spinlP
    s_branch recurrent_scan__sliding_block_cached__glu_gated_glu__prompt_kernel_okP
recurrent_scan__sliding_block_cached__glu_gated_glu__prompt_kernel_rs0:
    s_call_b64 s[6:7], recurrent_scan__sliding_block_cached__glu_gated_glu__prompt_kernel_rare0
    s_branch recurrent_scan__sliding_block_cached__glu_gated_glu__prompt_kernel_rb0
recurrent_scan__sliding_block_cached__glu_gated_glu__prompt_kernel_rs1:
    s_call_b64 s[6:7], recurrent_scan__sliding_block_cached__glu_gated_glu__prompt_kernel_rare1
    s_branch recurrent_scan__sliding_block_cached__glu_gated_glu__prompt_kernel_rb1
recurrent_scan__sliding_block_cached__glu_gated_glu__prompt_kernel_rs2:
    s_call_b64 s[6:7], recurrent_scan__sliding_block_cached__glu_gated_glu__prompt_kernel_rare0
    s_branch recurrent_scan__sliding_block_cached__glu_gated_glu__prompt_kernel_rb2
recurrent_scan__sliding_block_cached__glu_gated_glu__prompt_kernel_rs3:
    s_call_b64 s[6:7], recurrent_scan__sliding_block_cached__glu_gated_glu__prompt_kernel_rare1
    s_branch recurrent_scan__sliding_block_cached__glu_gated_glu__prompt_kernel_rb3
recurrent_scan__sliding_block_cached__glu_gated_glu__prompt_kernel_rs4:
    s_call_b64 s[6:7], recurrent_scan__sliding_block_cached__glu_gated_glu__prompt_kernel_rare0
    s_branch recurrent_scan__sliding_block_cached__glu_gated_glu__prompt_kernel_rb4
recurrent_scan__sliding_block_cached__glu_gated_glu__prompt_kernel_rs5:
    s_call_b64 s[6:7], recurrent_scan__sliding_block_cached__glu_gated_glu__prompt_kernel_rare1
    s_branch recurrent_scan__sliding_block_cached__glu_gated_glu__prompt_kernel_rb5
recurrent_scan__sliding_block_cached__glu_gated_glu__prompt_kernel_rs6:
    s_call_b64 s[6:7], recurrent_scan__sliding_block_cached__glu_gated_glu__prompt_kernel_rare0
    s_branch recurrent_scan__sliding_block_cached__glu_gated_glu__prompt_kernel_rb6
recurrent_scan__sliding_block_cached__glu_gated_glu__prompt_kernel_rs7:
    s_call_b64 s[6:7], recurrent_scan__sliding_block_cached__glu_gated_glu__prompt_kernel_rare1
    s_branch recurrent_scan__sliding_block_cached__glu_gated_glu__prompt_kernel_rb7
recurrent_scan__sliding_block_cached__glu_gated_glu__prompt_kernel_rs8:
    s_call_b64 s[6:7], recurrent_scan__sliding_block_cached__glu_gated_glu__prompt_kernel_rare0
    s_branch recurrent_scan__sliding_block_cached__glu_gated_glu__prompt_kernel_rb8
recurrent_scan__sliding_block_cached__glu_gated_glu__prompt_kernel_rs9:
    s_call_b64 s[6:7], recurrent_scan__sliding_block_cached__glu_gated_glu__prompt_kernel_rare1
    s_branch recurrent_scan__sliding_block_cached__glu_gated_glu__prompt_kernel_rb9
recurrent_scan__sliding_block_cached__glu_gated_glu__prompt_kernel_rs10:
    s_call_b64 s[6:7], recurrent_scan__sliding_block_cached__glu_gated_glu__prompt_kernel_rare0
    s_branch recurrent_scan__sliding_block_cached__glu_gated_glu__prompt_kernel_rb10
recurrent_scan__sliding_block_cached__glu_gated_glu__prompt_kernel_rs11:
    s_call_b64 s[6:7], recurrent_scan__sliding_block_cached__glu_gated_glu__prompt_kernel_rare1
    s_branch recurrent_scan__sliding_block_cached__glu_gated_glu__prompt_kernel_rb11
recurrent_scan__sliding_block_cached__glu_gated_glu__prompt_kernel_rs12:
    s_call_b64 s[6:7], recurrent_scan__sliding_block_cached__glu_gated_glu__prompt_kernel_rare0
    s_branch recurrent_scan__sliding_block_cached__glu_gated_glu__prompt_kernel_rb12
recurrent_scan__sliding_block_cached__glu_gated_glu__prompt_kernel_rs13:
    s_call_b64 s[6:7], recurrent_scan__sliding_block_cached__glu_gated_glu__prompt_kernel_rare1
    s_branch recurrent_scan__sliding_block_cached__glu_gated_glu__prompt_kernel_rb13
recurrent_scan__sliding_block_cached__glu_gated_glu__prompt_kernel_rs14:
    s_call_b64 s[6:7], recurrent_scan__sliding_block_cached__glu_gated_glu__prompt_kernel_rare0
    s_branch recurrent_scan__sliding_block_cached__glu_gated_glu__prompt_kernel_rb14
recurrent_scan__sliding_block_cached__glu_gated_glu__prompt_kernel_rs15:
    s_call_b64 s[6:7], recurrent_scan__sliding_block_cached__glu_gated_glu__prompt_kernel_rare1
    s_branch recurrent_scan__sliding_block_cached__glu_gated_glu__prompt_kernel_rb15
recurrent_scan__sliding_block_cached__glu_gated_glu__prompt_kernel_rare0:
    s_nop 15
    s_nop 15
    v_max3_f32 v236, v96, v97, v98
    v_max3_f32 v236, v236, v99, v100
    v_max3_f32 v236, v236, v101, v102
    v_max3_f32 v236, v236, v103, v104
    v_max3_f32 v236, v236, v105, v106
    v_max3_f32 v236, v236, v107, v108
    v_max3_f32 v236, v236, v109, v110
    v_max_f32 v236, v236, v111
    v_mov_b32 v238, v236
    s_nop 1
    v_permlane32_swap_b32 v238, v236
    v_max_f32 v236, v236, v238
    v_max_f32 v236, 0, v236
    v_exp_f32 v237, -v236
    v_sub_f32 v160, v160, v236
    v_sub_f32 v161, v161, v236
    v_sub_f32 v162, v162, v236
    v_sub_f32 v163, v163, v236
    v_sub_f32 v164, v164, v236
    v_sub_f32 v165, v165, v236
    v_sub_f32 v166, v166, v236
    v_sub_f32 v167, v167, v236
    v_sub_f32 v168, v168, v236
    v_sub_f32 v169, v169, v236
    v_sub_f32 v170, v170, v236
    v_sub_f32 v171, v171, v236
    v_sub_f32 v172, v172, v236
    v_sub_f32 v173, v173, v236
    v_sub_f32 v174, v174, v236
    v_sub_f32 v175, v175, v236
    v_sub_f32 v96, v96, v236
    v_sub_f32 v97, v97, v236
    v_sub_f32 v98, v98, v236
    v_sub_f32 v99, v99, v236
    v_sub_f32 v100, v100, v236
    v_sub_f32 v101, v101, v236
    v_sub_f32 v102, v102, v236
    v_sub_f32 v103, v103, v236
    v_sub_f32 v104, v104, v236
    v_sub_f32 v105, v105, v236
    v_sub_f32 v106, v106, v236
    v_sub_f32 v107, v107, v236
    v_sub_f32 v108, v108, v236
    v_sub_f32 v109, v109, v236
    v_sub_f32 v110, v110, v236
    v_sub_f32 v111, v111, v236
    v_sub_f32 v128, v128, v236
    v_sub_f32 v129, v129, v236
    v_sub_f32 v130, v130, v236
    v_sub_f32 v131, v131, v236
    v_sub_f32 v132, v132, v236
    v_sub_f32 v133, v133, v236
    v_sub_f32 v134, v134, v236
    v_sub_f32 v135, v135, v236
    v_sub_f32 v136, v136, v236
    v_sub_f32 v137, v137, v236
    v_sub_f32 v138, v138, v236
    v_sub_f32 v139, v139, v236
    v_sub_f32 v140, v140, v236
    v_sub_f32 v141, v141, v236
    v_sub_f32 v142, v142, v236
    v_sub_f32 v143, v143, v236
    v_mul_f32 v232, v232, v237
    v_accvgpr_read_b32 v238, a0
    v_mul_f32 v238, v238, v237
    v_accvgpr_write_b32 a0, v238
    v_accvgpr_read_b32 v238, a1
    v_mul_f32 v238, v238, v237
    v_accvgpr_write_b32 a1, v238
    v_accvgpr_read_b32 v238, a2
    v_mul_f32 v238, v238, v237
    v_accvgpr_write_b32 a2, v238
    v_accvgpr_read_b32 v238, a3
    v_mul_f32 v238, v238, v237
    v_accvgpr_write_b32 a3, v238
    v_accvgpr_read_b32 v238, a4
    v_mul_f32 v238, v238, v237
    v_accvgpr_write_b32 a4, v238
    v_accvgpr_read_b32 v238, a5
    v_mul_f32 v238, v238, v237
    v_accvgpr_write_b32 a5, v238
    v_accvgpr_read_b32 v238, a6
    v_mul_f32 v238, v238, v237
    v_accvgpr_write_b32 a6, v238
    v_accvgpr_read_b32 v238, a7
    v_mul_f32 v238, v238, v237
    v_accvgpr_write_b32 a7, v238
    v_accvgpr_read_b32 v238, a8
    v_mul_f32 v238, v238, v237
    v_accvgpr_write_b32 a8, v238
    v_accvgpr_read_b32 v238, a9
    v_mul_f32 v238, v238, v237
    v_accvgpr_write_b32 a9, v238
    v_accvgpr_read_b32 v238, a10
    v_mul_f32 v238, v238, v237
    v_accvgpr_write_b32 a10, v238
    v_accvgpr_read_b32 v238, a11
    v_mul_f32 v238, v238, v237
    v_accvgpr_write_b32 a11, v238
    v_accvgpr_read_b32 v238, a12
    v_mul_f32 v238, v238, v237
    v_accvgpr_write_b32 a12, v238
    v_accvgpr_read_b32 v238, a13
    v_mul_f32 v238, v238, v237
    v_accvgpr_write_b32 a13, v238
    v_accvgpr_read_b32 v238, a14
    v_mul_f32 v238, v238, v237
    v_accvgpr_write_b32 a14, v238
    v_accvgpr_read_b32 v238, a15
    v_mul_f32 v238, v238, v237
    v_accvgpr_write_b32 a15, v238
    v_accvgpr_read_b32 v238, a32
    v_mul_f32 v238, v238, v237
    v_accvgpr_write_b32 a32, v238
    v_accvgpr_read_b32 v238, a33
    v_mul_f32 v238, v238, v237
    v_accvgpr_write_b32 a33, v238
    v_accvgpr_read_b32 v238, a34
    v_mul_f32 v238, v238, v237
    v_accvgpr_write_b32 a34, v238
    v_accvgpr_read_b32 v238, a35
    v_mul_f32 v238, v238, v237
    v_accvgpr_write_b32 a35, v238
    v_accvgpr_read_b32 v238, a36
    v_mul_f32 v238, v238, v237
    v_accvgpr_write_b32 a36, v238
    v_accvgpr_read_b32 v238, a37
    v_mul_f32 v238, v238, v237
    v_accvgpr_write_b32 a37, v238
    v_accvgpr_read_b32 v238, a38
    v_mul_f32 v238, v238, v237
    v_accvgpr_write_b32 a38, v238
    v_accvgpr_read_b32 v238, a39
    v_mul_f32 v238, v238, v237
    v_accvgpr_write_b32 a39, v238
    v_accvgpr_read_b32 v238, a40
    v_mul_f32 v238, v238, v237
    v_accvgpr_write_b32 a40, v238
    v_accvgpr_read_b32 v238, a41
    v_mul_f32 v238, v238, v237
    v_accvgpr_write_b32 a41, v238
    v_accvgpr_read_b32 v238, a42
    v_mul_f32 v238, v238, v237
    v_accvgpr_write_b32 a42, v238
    v_accvgpr_read_b32 v238, a43
    v_mul_f32 v238, v238, v237
    v_accvgpr_write_b32 a43, v238
    v_accvgpr_read_b32 v238, a44
    v_mul_f32 v238, v238, v237
    v_accvgpr_write_b32 a44, v238
    v_accvgpr_read_b32 v238, a45
    v_mul_f32 v238, v238, v237
    v_accvgpr_write_b32 a45, v238
    v_accvgpr_read_b32 v238, a46
    v_mul_f32 v238, v238, v237
    v_accvgpr_write_b32 a46, v238
    v_accvgpr_read_b32 v238, a47
    v_mul_f32 v238, v238, v237
    v_accvgpr_write_b32 a47, v238
    v_accvgpr_read_b32 v238, a64
    v_mul_f32 v238, v238, v237
    v_accvgpr_write_b32 a64, v238
    v_accvgpr_read_b32 v238, a65
    v_mul_f32 v238, v238, v237
    v_accvgpr_write_b32 a65, v238
    v_accvgpr_read_b32 v238, a66
    v_mul_f32 v238, v238, v237
    v_accvgpr_write_b32 a66, v238
    v_accvgpr_read_b32 v238, a67
    v_mul_f32 v238, v238, v237
    v_accvgpr_write_b32 a67, v238
    v_accvgpr_read_b32 v238, a68
    v_mul_f32 v238, v238, v237
    v_accvgpr_write_b32 a68, v238
    v_accvgpr_read_b32 v238, a69
    v_mul_f32 v238, v238, v237
    v_accvgpr_write_b32 a69, v238
    v_accvgpr_read_b32 v238, a70
    v_mul_f32 v238, v238, v237
    v_accvgpr_write_b32 a70, v238
    v_accvgpr_read_b32 v238, a71
    v_mul_f32 v238, v238, v237
    v_accvgpr_write_b32 a71, v238
    v_accvgpr_read_b32 v238, a72
    v_mul_f32 v238, v238, v237
    v_accvgpr_write_b32 a72, v238
    v_accvgpr_read_b32 v238, a73
    v_mul_f32 v238, v238, v237
    v_accvgpr_write_b32 a73, v238
    v_accvgpr_read_b32 v238, a74
    v_mul_f32 v238, v238, v237
    v_accvgpr_write_b32 a74, v238
    v_accvgpr_read_b32 v238, a75
    v_mul_f32 v238, v238, v237
    v_accvgpr_write_b32 a75, v238
    v_accvgpr_read_b32 v238, a76
    v_mul_f32 v238, v238, v237
    v_accvgpr_write_b32 a76, v238
    v_accvgpr_read_b32 v238, a77
    v_mul_f32 v238, v238, v237
    v_accvgpr_write_b32 a77, v238
    v_accvgpr_read_b32 v238, a78
    v_mul_f32 v238, v238, v237
    v_accvgpr_write_b32 a78, v238
    v_accvgpr_read_b32 v238, a79
    v_mul_f32 v238, v238, v237
    v_accvgpr_write_b32 a79, v238
    v_accvgpr_read_b32 v238, a96
    v_mul_f32 v238, v238, v237
    v_accvgpr_write_b32 a96, v238
    v_accvgpr_read_b32 v238, a97
    v_mul_f32 v238, v238, v237
    v_accvgpr_write_b32 a97, v238
    v_accvgpr_read_b32 v238, a98
    v_mul_f32 v238, v238, v237
    v_accvgpr_write_b32 a98, v238
    v_accvgpr_read_b32 v238, a99
    v_mul_f32 v238, v238, v237
    v_accvgpr_write_b32 a99, v238
    v_accvgpr_read_b32 v238, a100
    v_mul_f32 v238, v238, v237
    v_accvgpr_write_b32 a100, v238
    v_accvgpr_read_b32 v238, a101
    v_mul_f32 v238, v238, v237
    v_accvgpr_write_b32 a101, v238
    v_accvgpr_read_b32 v238, a102
    v_mul_f32 v238, v238, v237
    v_accvgpr_write_b32 a102, v238
    v_accvgpr_read_b32 v238, a103
    v_mul_f32 v238, v238, v237
    v_accvgpr_write_b32 a103, v238
    v_accvgpr_read_b32 v238, a104
    v_mul_f32 v238, v238, v237
    v_accvgpr_write_b32 a104, v238
    v_accvgpr_read_b32 v238, a105
    v_mul_f32 v238, v238, v237
    v_accvgpr_write_b32 a105, v238
    v_accvgpr_read_b32 v238, a106
    v_mul_f32 v238, v238, v237
    v_accvgpr_write_b32 a106, v238
    v_accvgpr_read_b32 v238, a107
    v_mul_f32 v238, v238, v237
    v_accvgpr_write_b32 a107, v238
    v_accvgpr_read_b32 v238, a108
    v_mul_f32 v238, v238, v237
    v_accvgpr_write_b32 a108, v238
    v_accvgpr_read_b32 v238, a109
    v_mul_f32 v238, v238, v237
    v_accvgpr_write_b32 a109, v238
    v_accvgpr_read_b32 v238, a110
    v_mul_f32 v238, v238, v237
    v_accvgpr_write_b32 a110, v238
    v_accvgpr_read_b32 v238, a111
    v_mul_f32 v238, v238, v237
    v_accvgpr_write_b32 a111, v238
    v_exp_f32 v224, v96
    v_exp_f32 v225, v97
    s_nop 0
    v_cvt_pk_bf16_f32 v192, v224, v225
    v_add_f32 v224, v224, v225
    v_mov_b32 v234, v224
    v_exp_f32 v224, v98
    v_exp_f32 v225, v99
    s_nop 0
    v_cvt_pk_bf16_f32 v193, v224, v225
    v_add_f32 v224, v224, v225
    v_add_f32 v234, v234, v224
    v_exp_f32 v224, v100
    v_exp_f32 v225, v101
    s_nop 0
    v_cvt_pk_bf16_f32 v194, v224, v225
    v_add_f32 v224, v224, v225
    v_add_f32 v234, v234, v224
    v_exp_f32 v224, v102
    v_exp_f32 v225, v103
    s_nop 0
    v_cvt_pk_bf16_f32 v195, v224, v225
    v_add_f32 v224, v224, v225
    v_add_f32 v234, v234, v224
    v_exp_f32 v224, v104
    v_exp_f32 v225, v105
    s_nop 0
    v_cvt_pk_bf16_f32 v196, v224, v225
    v_add_f32 v224, v224, v225
    v_add_f32 v234, v234, v224
    v_exp_f32 v224, v106
    v_exp_f32 v225, v107
    s_nop 0
    v_cvt_pk_bf16_f32 v197, v224, v225
    v_add_f32 v224, v224, v225
    v_add_f32 v234, v234, v224
    v_exp_f32 v224, v108
    v_exp_f32 v225, v109
    s_nop 0
    v_cvt_pk_bf16_f32 v198, v224, v225
    v_add_f32 v224, v224, v225
    v_add_f32 v234, v234, v224
    v_exp_f32 v224, v110
    v_exp_f32 v225, v111
    s_nop 0
    v_cvt_pk_bf16_f32 v199, v224, v225
    v_add_f32 v224, v224, v225
    v_add_f32 v234, v234, v224
    v_max3_f32 v236, v112, v113, v114
    v_max3_f32 v236, v236, v115, v116
    v_max3_f32 v236, v236, v117, v118
    v_max3_f32 v236, v236, v119, v120
    v_max3_f32 v236, v236, v121, v122
    v_max3_f32 v236, v236, v123, v124
    v_max3_f32 v236, v236, v125, v126
    v_max_f32 v236, v236, v127
    v_mov_b32 v238, v236
    s_nop 1
    v_permlane32_swap_b32 v238, v236
    v_max_f32 v236, v236, v238
    v_max_f32 v236, 0, v236
    v_exp_f32 v237, -v236
    v_sub_f32 v176, v176, v236
    v_sub_f32 v177, v177, v236
    v_sub_f32 v178, v178, v236
    v_sub_f32 v179, v179, v236
    v_sub_f32 v180, v180, v236
    v_sub_f32 v181, v181, v236
    v_sub_f32 v182, v182, v236
    v_sub_f32 v183, v183, v236
    v_sub_f32 v184, v184, v236
    v_sub_f32 v185, v185, v236
    v_sub_f32 v186, v186, v236
    v_sub_f32 v187, v187, v236
    v_sub_f32 v188, v188, v236
    v_sub_f32 v189, v189, v236
    v_sub_f32 v190, v190, v236
    v_sub_f32 v191, v191, v236
    v_sub_f32 v112, v112, v236
    v_sub_f32 v113, v113, v236
    v_sub_f32 v114, v114, v236
    v_sub_f32 v115, v115, v236
    v_sub_f32 v116, v116, v236
    v_sub_f32 v117, v117, v236
    v_sub_f32 v118, v118, v236
    v_sub_f32 v119, v119, v236
    v_sub_f32 v120, v120, v236
    v_sub_f32 v121, v121, v236
    v_sub_f32 v122, v122, v236
    v_sub_f32 v123, v123, v236
    v_sub_f32 v124, v124, v236
    v_sub_f32 v125, v125, v236
    v_sub_f32 v126, v126, v236
    v_sub_f32 v127, v127, v236
    v_sub_f32 v144, v144, v236
    v_sub_f32 v145, v145, v236
    v_sub_f32 v146, v146, v236
    v_sub_f32 v147, v147, v236
    v_sub_f32 v148, v148, v236
    v_sub_f32 v149, v149, v236
    v_sub_f32 v150, v150, v236
    v_sub_f32 v151, v151, v236
    v_sub_f32 v152, v152, v236
    v_sub_f32 v153, v153, v236
    v_sub_f32 v154, v154, v236
    v_sub_f32 v155, v155, v236
    v_sub_f32 v156, v156, v236
    v_sub_f32 v157, v157, v236
    v_sub_f32 v158, v158, v236
    v_sub_f32 v159, v159, v236
    v_mul_f32 v233, v233, v237
    v_accvgpr_read_b32 v238, a16
    v_mul_f32 v238, v238, v237
    v_accvgpr_write_b32 a16, v238
    v_accvgpr_read_b32 v238, a17
    v_mul_f32 v238, v238, v237
    v_accvgpr_write_b32 a17, v238
    v_accvgpr_read_b32 v238, a18
    v_mul_f32 v238, v238, v237
    v_accvgpr_write_b32 a18, v238
    v_accvgpr_read_b32 v238, a19
    v_mul_f32 v238, v238, v237
    v_accvgpr_write_b32 a19, v238
    v_accvgpr_read_b32 v238, a20
    v_mul_f32 v238, v238, v237
    v_accvgpr_write_b32 a20, v238
    v_accvgpr_read_b32 v238, a21
    v_mul_f32 v238, v238, v237
    v_accvgpr_write_b32 a21, v238
    v_accvgpr_read_b32 v238, a22
    v_mul_f32 v238, v238, v237
    v_accvgpr_write_b32 a22, v238
    v_accvgpr_read_b32 v238, a23
    v_mul_f32 v238, v238, v237
    v_accvgpr_write_b32 a23, v238
    v_accvgpr_read_b32 v238, a24
    v_mul_f32 v238, v238, v237
    v_accvgpr_write_b32 a24, v238
    v_accvgpr_read_b32 v238, a25
    v_mul_f32 v238, v238, v237
    v_accvgpr_write_b32 a25, v238
    v_accvgpr_read_b32 v238, a26
    v_mul_f32 v238, v238, v237
    v_accvgpr_write_b32 a26, v238
    v_accvgpr_read_b32 v238, a27
    v_mul_f32 v238, v238, v237
    v_accvgpr_write_b32 a27, v238
    v_accvgpr_read_b32 v238, a28
    v_mul_f32 v238, v238, v237
    v_accvgpr_write_b32 a28, v238
    v_accvgpr_read_b32 v238, a29
    v_mul_f32 v238, v238, v237
    v_accvgpr_write_b32 a29, v238
    v_accvgpr_read_b32 v238, a30
    v_mul_f32 v238, v238, v237
    v_accvgpr_write_b32 a30, v238
    v_accvgpr_read_b32 v238, a31
    v_mul_f32 v238, v238, v237
    v_accvgpr_write_b32 a31, v238
    v_accvgpr_read_b32 v238, a48
    v_mul_f32 v238, v238, v237
    v_accvgpr_write_b32 a48, v238
    v_accvgpr_read_b32 v238, a49
    v_mul_f32 v238, v238, v237
    v_accvgpr_write_b32 a49, v238
    v_accvgpr_read_b32 v238, a50
    v_mul_f32 v238, v238, v237
    v_accvgpr_write_b32 a50, v238
    v_accvgpr_read_b32 v238, a51
    v_mul_f32 v238, v238, v237
    v_accvgpr_write_b32 a51, v238
    v_accvgpr_read_b32 v238, a52
    v_mul_f32 v238, v238, v237
    v_accvgpr_write_b32 a52, v238
    v_accvgpr_read_b32 v238, a53
    v_mul_f32 v238, v238, v237
    v_accvgpr_write_b32 a53, v238
    v_accvgpr_read_b32 v238, a54
    v_mul_f32 v238, v238, v237
    v_accvgpr_write_b32 a54, v238
    v_accvgpr_read_b32 v238, a55
    v_mul_f32 v238, v238, v237
    v_accvgpr_write_b32 a55, v238
    v_accvgpr_read_b32 v238, a56
    v_mul_f32 v238, v238, v237
    v_accvgpr_write_b32 a56, v238
    v_accvgpr_read_b32 v238, a57
    v_mul_f32 v238, v238, v237
    v_accvgpr_write_b32 a57, v238
    v_accvgpr_read_b32 v238, a58
    v_mul_f32 v238, v238, v237
    v_accvgpr_write_b32 a58, v238
    v_accvgpr_read_b32 v238, a59
    v_mul_f32 v238, v238, v237
    v_accvgpr_write_b32 a59, v238
    v_accvgpr_read_b32 v238, a60
    v_mul_f32 v238, v238, v237
    v_accvgpr_write_b32 a60, v238
    v_accvgpr_read_b32 v238, a61
    v_mul_f32 v238, v238, v237
    v_accvgpr_write_b32 a61, v238
    v_accvgpr_read_b32 v238, a62
    v_mul_f32 v238, v238, v237
    v_accvgpr_write_b32 a62, v238
    v_accvgpr_read_b32 v238, a63
    v_mul_f32 v238, v238, v237
    v_accvgpr_write_b32 a63, v238
    v_accvgpr_read_b32 v238, a80
    v_mul_f32 v238, v238, v237
    v_accvgpr_write_b32 a80, v238
    v_accvgpr_read_b32 v238, a81
    v_mul_f32 v238, v238, v237
    v_accvgpr_write_b32 a81, v238
    v_accvgpr_read_b32 v238, a82
    v_mul_f32 v238, v238, v237
    v_accvgpr_write_b32 a82, v238
    v_accvgpr_read_b32 v238, a83
    v_mul_f32 v238, v238, v237
    v_accvgpr_write_b32 a83, v238
    v_accvgpr_read_b32 v238, a84
    v_mul_f32 v238, v238, v237
    v_accvgpr_write_b32 a84, v238
    v_accvgpr_read_b32 v238, a85
    v_mul_f32 v238, v238, v237
    v_accvgpr_write_b32 a85, v238
    v_accvgpr_read_b32 v238, a86
    v_mul_f32 v238, v238, v237
    v_accvgpr_write_b32 a86, v238
    v_accvgpr_read_b32 v238, a87
    v_mul_f32 v238, v238, v237
    v_accvgpr_write_b32 a87, v238
    v_accvgpr_read_b32 v238, a88
    v_mul_f32 v238, v238, v237
    v_accvgpr_write_b32 a88, v238
    v_accvgpr_read_b32 v238, a89
    v_mul_f32 v238, v238, v237
    v_accvgpr_write_b32 a89, v238
    v_accvgpr_read_b32 v238, a90
    v_mul_f32 v238, v238, v237
    v_accvgpr_write_b32 a90, v238
    v_accvgpr_read_b32 v238, a91
    v_mul_f32 v238, v238, v237
    v_accvgpr_write_b32 a91, v238
    v_accvgpr_read_b32 v238, a92
    v_mul_f32 v238, v238, v237
    v_accvgpr_write_b32 a92, v238
    v_accvgpr_read_b32 v238, a93
    v_mul_f32 v238, v238, v237
    v_accvgpr_write_b32 a93, v238
    v_accvgpr_read_b32 v238, a94
    v_mul_f32 v238, v238, v237
    v_accvgpr_write_b32 a94, v238
    v_accvgpr_read_b32 v238, a95
    v_mul_f32 v238, v238, v237
    v_accvgpr_write_b32 a95, v238
    v_accvgpr_read_b32 v238, a112
    v_mul_f32 v238, v238, v237
    v_accvgpr_write_b32 a112, v238
    v_accvgpr_read_b32 v238, a113
    v_mul_f32 v238, v238, v237
    v_accvgpr_write_b32 a113, v238
    v_accvgpr_read_b32 v238, a114
    v_mul_f32 v238, v238, v237
    v_accvgpr_write_b32 a114, v238
    v_accvgpr_read_b32 v238, a115
    v_mul_f32 v238, v238, v237
    v_accvgpr_write_b32 a115, v238
    v_accvgpr_read_b32 v238, a116
    v_mul_f32 v238, v238, v237
    v_accvgpr_write_b32 a116, v238
    v_accvgpr_read_b32 v238, a117
    v_mul_f32 v238, v238, v237
    v_accvgpr_write_b32 a117, v238
    v_accvgpr_read_b32 v238, a118
    v_mul_f32 v238, v238, v237
    v_accvgpr_write_b32 a118, v238
    v_accvgpr_read_b32 v238, a119
    v_mul_f32 v238, v238, v237
    v_accvgpr_write_b32 a119, v238
    v_accvgpr_read_b32 v238, a120
    v_mul_f32 v238, v238, v237
    v_accvgpr_write_b32 a120, v238
    v_accvgpr_read_b32 v238, a121
    v_mul_f32 v238, v238, v237
    v_accvgpr_write_b32 a121, v238
    v_accvgpr_read_b32 v238, a122
    v_mul_f32 v238, v238, v237
    v_accvgpr_write_b32 a122, v238
    v_accvgpr_read_b32 v238, a123
    v_mul_f32 v238, v238, v237
    v_accvgpr_write_b32 a123, v238
    v_accvgpr_read_b32 v238, a124
    v_mul_f32 v238, v238, v237
    v_accvgpr_write_b32 a124, v238
    v_accvgpr_read_b32 v238, a125
    v_mul_f32 v238, v238, v237
    v_accvgpr_write_b32 a125, v238
    v_accvgpr_read_b32 v238, a126
    v_mul_f32 v238, v238, v237
    v_accvgpr_write_b32 a126, v238
    v_accvgpr_read_b32 v238, a127
    v_mul_f32 v238, v238, v237
    v_accvgpr_write_b32 a127, v238
    v_exp_f32 v224, v112
    v_exp_f32 v225, v113
    s_nop 0
    v_cvt_pk_bf16_f32 v200, v224, v225
    v_add_f32 v224, v224, v225
    v_mov_b32 v235, v224
    v_exp_f32 v224, v114
    v_exp_f32 v225, v115
    s_nop 0
    v_cvt_pk_bf16_f32 v201, v224, v225
    v_add_f32 v224, v224, v225
    v_add_f32 v235, v235, v224
    v_exp_f32 v224, v116
    v_exp_f32 v225, v117
    s_nop 0
    v_cvt_pk_bf16_f32 v202, v224, v225
    v_add_f32 v224, v224, v225
    v_add_f32 v235, v235, v224
    v_exp_f32 v224, v118
    v_exp_f32 v225, v119
    s_nop 0
    v_cvt_pk_bf16_f32 v203, v224, v225
    v_add_f32 v224, v224, v225
    v_add_f32 v235, v235, v224
    v_exp_f32 v224, v120
    v_exp_f32 v225, v121
    s_nop 0
    v_cvt_pk_bf16_f32 v204, v224, v225
    v_add_f32 v224, v224, v225
    v_add_f32 v235, v235, v224
    v_exp_f32 v224, v122
    v_exp_f32 v225, v123
    s_nop 0
    v_cvt_pk_bf16_f32 v205, v224, v225
    v_add_f32 v224, v224, v225
    v_add_f32 v235, v235, v224
    v_exp_f32 v224, v124
    v_exp_f32 v225, v125
    s_nop 0
    v_cvt_pk_bf16_f32 v206, v224, v225
    v_add_f32 v224, v224, v225
    v_add_f32 v235, v235, v224
    v_exp_f32 v224, v126
    v_exp_f32 v225, v127
    s_nop 0
    v_cvt_pk_bf16_f32 v207, v224, v225
    v_add_f32 v224, v224, v225
    v_add_f32 v235, v235, v224
    s_nop 3
    s_setpc_b64 s[6:7]
recurrent_scan__sliding_block_cached__glu_gated_glu__prompt_kernel_rare1:
    s_nop 15
    s_nop 15
    v_max3_f32 v236, v128, v129, v130
    v_max3_f32 v236, v236, v131, v132
    v_max3_f32 v236, v236, v133, v134
    v_max3_f32 v236, v236, v135, v136
    v_max3_f32 v236, v236, v137, v138
    v_max3_f32 v236, v236, v139, v140
    v_max3_f32 v236, v236, v141, v142
    v_max_f32 v236, v236, v143
    v_mov_b32 v238, v236
    s_nop 1
    v_permlane32_swap_b32 v238, v236
    v_max_f32 v236, v236, v238
    v_max_f32 v236, 0, v236
    v_exp_f32 v237, -v236
    v_sub_f32 v160, v160, v236
    v_sub_f32 v161, v161, v236
    v_sub_f32 v162, v162, v236
    v_sub_f32 v163, v163, v236
    v_sub_f32 v164, v164, v236
    v_sub_f32 v165, v165, v236
    v_sub_f32 v166, v166, v236
    v_sub_f32 v167, v167, v236
    v_sub_f32 v168, v168, v236
    v_sub_f32 v169, v169, v236
    v_sub_f32 v170, v170, v236
    v_sub_f32 v171, v171, v236
    v_sub_f32 v172, v172, v236
    v_sub_f32 v173, v173, v236
    v_sub_f32 v174, v174, v236
    v_sub_f32 v175, v175, v236
    v_sub_f32 v128, v128, v236
    v_sub_f32 v129, v129, v236
    v_sub_f32 v130, v130, v236
    v_sub_f32 v131, v131, v236
    v_sub_f32 v132, v132, v236
    v_sub_f32 v133, v133, v236
    v_sub_f32 v134, v134, v236
    v_sub_f32 v135, v135, v236
    v_sub_f32 v136, v136, v236
    v_sub_f32 v137, v137, v236
    v_sub_f32 v138, v138, v236
    v_sub_f32 v139, v139, v236
    v_sub_f32 v140, v140, v236
    v_sub_f32 v141, v141, v236
    v_sub_f32 v142, v142, v236
    v_sub_f32 v143, v143, v236
    v_sub_f32 v96, v96, v236
    v_sub_f32 v97, v97, v236
    v_sub_f32 v98, v98, v236
    v_sub_f32 v99, v99, v236
    v_sub_f32 v100, v100, v236
    v_sub_f32 v101, v101, v236
    v_sub_f32 v102, v102, v236
    v_sub_f32 v103, v103, v236
    v_sub_f32 v104, v104, v236
    v_sub_f32 v105, v105, v236
    v_sub_f32 v106, v106, v236
    v_sub_f32 v107, v107, v236
    v_sub_f32 v108, v108, v236
    v_sub_f32 v109, v109, v236
    v_sub_f32 v110, v110, v236
    v_sub_f32 v111, v111, v236
    v_mul_f32 v232, v232, v237
    v_accvgpr_read_b32 v238, a0
    v_mul_f32 v238, v238, v237
    v_accvgpr_write_b32 a0, v238
    v_accvgpr_read_b32 v238, a1
    v_mul_f32 v238, v238, v237
    v_accvgpr_write_b32 a1, v238
    v_accvgpr_read_b32 v238, a2
    v_mul_f32 v238, v238, v237
    v_accvgpr_write_b32 a2, v238
    v_accvgpr_read_b32 v238, a3
    v_mul_f32 v238, v238, v237
    v_accvgpr_write_b32 a3, v238
    v_accvgpr_read_b32 v238, a4
    v_mul_f32 v238, v238, v237
    v_accvgpr_write_b32 a4, v238
    v_accvgpr_read_b32 v238, a5
    v_mul_f32 v238, v238, v237
    v_accvgpr_write_b32 a5, v238
    v_accvgpr_read_b32 v238, a6
    v_mul_f32 v238, v238, v237
    v_accvgpr_write_b32 a6, v238
    v_accvgpr_read_b32 v238, a7
    v_mul_f32 v238, v238, v237
    v_accvgpr_write_b32 a7, v238
    v_accvgpr_read_b32 v238, a8
    v_mul_f32 v238, v238, v237
    v_accvgpr_write_b32 a8, v238
    v_accvgpr_read_b32 v238, a9
    v_mul_f32 v238, v238, v237
    v_accvgpr_write_b32 a9, v238
    v_accvgpr_read_b32 v238, a10
    v_mul_f32 v238, v238, v237
    v_accvgpr_write_b32 a10, v238
    v_accvgpr_read_b32 v238, a11
    v_mul_f32 v238, v238, v237
    v_accvgpr_write_b32 a11, v238
    v_accvgpr_read_b32 v238, a12
    v_mul_f32 v238, v238, v237
    v_accvgpr_write_b32 a12, v238
    v_accvgpr_read_b32 v238, a13
    v_mul_f32 v238, v238, v237
    v_accvgpr_write_b32 a13, v238
    v_accvgpr_read_b32 v238, a14
    v_mul_f32 v238, v238, v237
    v_accvgpr_write_b32 a14, v238
    v_accvgpr_read_b32 v238, a15
    v_mul_f32 v238, v238, v237
    v_accvgpr_write_b32 a15, v238
    v_accvgpr_read_b32 v238, a32
    v_mul_f32 v238, v238, v237
    v_accvgpr_write_b32 a32, v238
    v_accvgpr_read_b32 v238, a33
    v_mul_f32 v238, v238, v237
    v_accvgpr_write_b32 a33, v238
    v_accvgpr_read_b32 v238, a34
    v_mul_f32 v238, v238, v237
    v_accvgpr_write_b32 a34, v238
    v_accvgpr_read_b32 v238, a35
    v_mul_f32 v238, v238, v237
    v_accvgpr_write_b32 a35, v238
    v_accvgpr_read_b32 v238, a36
    v_mul_f32 v238, v238, v237
    v_accvgpr_write_b32 a36, v238
    v_accvgpr_read_b32 v238, a37
    v_mul_f32 v238, v238, v237
    v_accvgpr_write_b32 a37, v238
    v_accvgpr_read_b32 v238, a38
    v_mul_f32 v238, v238, v237
    v_accvgpr_write_b32 a38, v238
    v_accvgpr_read_b32 v238, a39
    v_mul_f32 v238, v238, v237
    v_accvgpr_write_b32 a39, v238
    v_accvgpr_read_b32 v238, a40
    v_mul_f32 v238, v238, v237
    v_accvgpr_write_b32 a40, v238
    v_accvgpr_read_b32 v238, a41
    v_mul_f32 v238, v238, v237
    v_accvgpr_write_b32 a41, v238
    v_accvgpr_read_b32 v238, a42
    v_mul_f32 v238, v238, v237
    v_accvgpr_write_b32 a42, v238
    v_accvgpr_read_b32 v238, a43
    v_mul_f32 v238, v238, v237
    v_accvgpr_write_b32 a43, v238
    v_accvgpr_read_b32 v238, a44
    v_mul_f32 v238, v238, v237
    v_accvgpr_write_b32 a44, v238
    v_accvgpr_read_b32 v238, a45
    v_mul_f32 v238, v238, v237
    v_accvgpr_write_b32 a45, v238
    v_accvgpr_read_b32 v238, a46
    v_mul_f32 v238, v238, v237
    v_accvgpr_write_b32 a46, v238
    v_accvgpr_read_b32 v238, a47
    v_mul_f32 v238, v238, v237
    v_accvgpr_write_b32 a47, v238
    v_accvgpr_read_b32 v238, a64
    v_mul_f32 v238, v238, v237
    v_accvgpr_write_b32 a64, v238
    v_accvgpr_read_b32 v238, a65
    v_mul_f32 v238, v238, v237
    v_accvgpr_write_b32 a65, v238
    v_accvgpr_read_b32 v238, a66
    v_mul_f32 v238, v238, v237
    v_accvgpr_write_b32 a66, v238
    v_accvgpr_read_b32 v238, a67
    v_mul_f32 v238, v238, v237
    v_accvgpr_write_b32 a67, v238
    v_accvgpr_read_b32 v238, a68
    v_mul_f32 v238, v238, v237
    v_accvgpr_write_b32 a68, v238
    v_accvgpr_read_b32 v238, a69
    v_mul_f32 v238, v238, v237
    v_accvgpr_write_b32 a69, v238
    v_accvgpr_read_b32 v238, a70
    v_mul_f32 v238, v238, v237
    v_accvgpr_write_b32 a70, v238
    v_accvgpr_read_b32 v238, a71
    v_mul_f32 v238, v238, v237
    v_accvgpr_write_b32 a71, v238
    v_accvgpr_read_b32 v238, a72
    v_mul_f32 v238, v238, v237
    v_accvgpr_write_b32 a72, v238
    v_accvgpr_read_b32 v238, a73
    v_mul_f32 v238, v238, v237
    v_accvgpr_write_b32 a73, v238
    v_accvgpr_read_b32 v238, a74
    v_mul_f32 v238, v238, v237
    v_accvgpr_write_b32 a74, v238
    v_accvgpr_read_b32 v238, a75
    v_mul_f32 v238, v238, v237
    v_accvgpr_write_b32 a75, v238
    v_accvgpr_read_b32 v238, a76
    v_mul_f32 v238, v238, v237
    v_accvgpr_write_b32 a76, v238
    v_accvgpr_read_b32 v238, a77
    v_mul_f32 v238, v238, v237
    v_accvgpr_write_b32 a77, v238
    v_accvgpr_read_b32 v238, a78
    v_mul_f32 v238, v238, v237
    v_accvgpr_write_b32 a78, v238
    v_accvgpr_read_b32 v238, a79
    v_mul_f32 v238, v238, v237
    v_accvgpr_write_b32 a79, v238
    v_accvgpr_read_b32 v238, a96
    v_mul_f32 v238, v238, v237
    v_accvgpr_write_b32 a96, v238
    v_accvgpr_read_b32 v238, a97
    v_mul_f32 v238, v238, v237
    v_accvgpr_write_b32 a97, v238
    v_accvgpr_read_b32 v238, a98
    v_mul_f32 v238, v238, v237
    v_accvgpr_write_b32 a98, v238
    v_accvgpr_read_b32 v238, a99
    v_mul_f32 v238, v238, v237
    v_accvgpr_write_b32 a99, v238
    v_accvgpr_read_b32 v238, a100
    v_mul_f32 v238, v238, v237
    v_accvgpr_write_b32 a100, v238
    v_accvgpr_read_b32 v238, a101
    v_mul_f32 v238, v238, v237
    v_accvgpr_write_b32 a101, v238
    v_accvgpr_read_b32 v238, a102
    v_mul_f32 v238, v238, v237
    v_accvgpr_write_b32 a102, v238
    v_accvgpr_read_b32 v238, a103
    v_mul_f32 v238, v238, v237
    v_accvgpr_write_b32 a103, v238
    v_accvgpr_read_b32 v238, a104
    v_mul_f32 v238, v238, v237
    v_accvgpr_write_b32 a104, v238
    v_accvgpr_read_b32 v238, a105
    v_mul_f32 v238, v238, v237
    v_accvgpr_write_b32 a105, v238
    v_accvgpr_read_b32 v238, a106
    v_mul_f32 v238, v238, v237
    v_accvgpr_write_b32 a106, v238
    v_accvgpr_read_b32 v238, a107
    v_mul_f32 v238, v238, v237
    v_accvgpr_write_b32 a107, v238
    v_accvgpr_read_b32 v238, a108
    v_mul_f32 v238, v238, v237
    v_accvgpr_write_b32 a108, v238
    v_accvgpr_read_b32 v238, a109
    v_mul_f32 v238, v238, v237
    v_accvgpr_write_b32 a109, v238
    v_accvgpr_read_b32 v238, a110
    v_mul_f32 v238, v238, v237
    v_accvgpr_write_b32 a110, v238
    v_accvgpr_read_b32 v238, a111
    v_mul_f32 v238, v238, v237
    v_accvgpr_write_b32 a111, v238
    v_exp_f32 v224, v128
    v_exp_f32 v225, v129
    s_nop 0
    v_cvt_pk_bf16_f32 v208, v224, v225
    v_add_f32 v224, v224, v225
    v_mov_b32 v234, v224
    v_exp_f32 v224, v130
    v_exp_f32 v225, v131
    s_nop 0
    v_cvt_pk_bf16_f32 v209, v224, v225
    v_add_f32 v224, v224, v225
    v_add_f32 v234, v234, v224
    v_exp_f32 v224, v132
    v_exp_f32 v225, v133
    s_nop 0
    v_cvt_pk_bf16_f32 v210, v224, v225
    v_add_f32 v224, v224, v225
    v_add_f32 v234, v234, v224
    v_exp_f32 v224, v134
    v_exp_f32 v225, v135
    s_nop 0
    v_cvt_pk_bf16_f32 v211, v224, v225
    v_add_f32 v224, v224, v225
    v_add_f32 v234, v234, v224
    v_exp_f32 v224, v136
    v_exp_f32 v225, v137
    s_nop 0
    v_cvt_pk_bf16_f32 v212, v224, v225
    v_add_f32 v224, v224, v225
    v_add_f32 v234, v234, v224
    v_exp_f32 v224, v138
    v_exp_f32 v225, v139
    s_nop 0
    v_cvt_pk_bf16_f32 v213, v224, v225
    v_add_f32 v224, v224, v225
    v_add_f32 v234, v234, v224
    v_exp_f32 v224, v140
    v_exp_f32 v225, v141
    s_nop 0
    v_cvt_pk_bf16_f32 v214, v224, v225
    v_add_f32 v224, v224, v225
    v_add_f32 v234, v234, v224
    v_exp_f32 v224, v142
    v_exp_f32 v225, v143
    s_nop 0
    v_cvt_pk_bf16_f32 v215, v224, v225
    v_add_f32 v224, v224, v225
    v_add_f32 v234, v234, v224
    v_max3_f32 v236, v144, v145, v146
    v_max3_f32 v236, v236, v147, v148
    v_max3_f32 v236, v236, v149, v150
    v_max3_f32 v236, v236, v151, v152
    v_max3_f32 v236, v236, v153, v154
    v_max3_f32 v236, v236, v155, v156
    v_max3_f32 v236, v236, v157, v158
    v_max_f32 v236, v236, v159
    v_mov_b32 v238, v236
    s_nop 1
    v_permlane32_swap_b32 v238, v236
    v_max_f32 v236, v236, v238
    v_max_f32 v236, 0, v236
    v_exp_f32 v237, -v236
    v_sub_f32 v176, v176, v236
    v_sub_f32 v177, v177, v236
    v_sub_f32 v178, v178, v236
    v_sub_f32 v179, v179, v236
    v_sub_f32 v180, v180, v236
    v_sub_f32 v181, v181, v236
    v_sub_f32 v182, v182, v236
    v_sub_f32 v183, v183, v236
    v_sub_f32 v184, v184, v236
    v_sub_f32 v185, v185, v236
    v_sub_f32 v186, v186, v236
    v_sub_f32 v187, v187, v236
    v_sub_f32 v188, v188, v236
    v_sub_f32 v189, v189, v236
    v_sub_f32 v190, v190, v236
    v_sub_f32 v191, v191, v236
    v_sub_f32 v144, v144, v236
    v_sub_f32 v145, v145, v236
    v_sub_f32 v146, v146, v236
    v_sub_f32 v147, v147, v236
    v_sub_f32 v148, v148, v236
    v_sub_f32 v149, v149, v236
    v_sub_f32 v150, v150, v236
    v_sub_f32 v151, v151, v236
    v_sub_f32 v152, v152, v236
    v_sub_f32 v153, v153, v236
    v_sub_f32 v154, v154, v236
    v_sub_f32 v155, v155, v236
    v_sub_f32 v156, v156, v236
    v_sub_f32 v157, v157, v236
    v_sub_f32 v158, v158, v236
    v_sub_f32 v159, v159, v236
    v_sub_f32 v112, v112, v236
    v_sub_f32 v113, v113, v236
    v_sub_f32 v114, v114, v236
    v_sub_f32 v115, v115, v236
    v_sub_f32 v116, v116, v236
    v_sub_f32 v117, v117, v236
    v_sub_f32 v118, v118, v236
    v_sub_f32 v119, v119, v236
    v_sub_f32 v120, v120, v236
    v_sub_f32 v121, v121, v236
    v_sub_f32 v122, v122, v236
    v_sub_f32 v123, v123, v236
    v_sub_f32 v124, v124, v236
    v_sub_f32 v125, v125, v236
    v_sub_f32 v126, v126, v236
    v_sub_f32 v127, v127, v236
    v_mul_f32 v233, v233, v237
    v_accvgpr_read_b32 v238, a16
    v_mul_f32 v238, v238, v237
    v_accvgpr_write_b32 a16, v238
    v_accvgpr_read_b32 v238, a17
    v_mul_f32 v238, v238, v237
    v_accvgpr_write_b32 a17, v238
    v_accvgpr_read_b32 v238, a18
    v_mul_f32 v238, v238, v237
    v_accvgpr_write_b32 a18, v238
    v_accvgpr_read_b32 v238, a19
    v_mul_f32 v238, v238, v237
    v_accvgpr_write_b32 a19, v238
    v_accvgpr_read_b32 v238, a20
    v_mul_f32 v238, v238, v237
    v_accvgpr_write_b32 a20, v238
    v_accvgpr_read_b32 v238, a21
    v_mul_f32 v238, v238, v237
    v_accvgpr_write_b32 a21, v238
    v_accvgpr_read_b32 v238, a22
    v_mul_f32 v238, v238, v237
    v_accvgpr_write_b32 a22, v238
    v_accvgpr_read_b32 v238, a23
    v_mul_f32 v238, v238, v237
    v_accvgpr_write_b32 a23, v238
    v_accvgpr_read_b32 v238, a24
    v_mul_f32 v238, v238, v237
    v_accvgpr_write_b32 a24, v238
    v_accvgpr_read_b32 v238, a25
    v_mul_f32 v238, v238, v237
    v_accvgpr_write_b32 a25, v238
    v_accvgpr_read_b32 v238, a26
    v_mul_f32 v238, v238, v237
    v_accvgpr_write_b32 a26, v238
    v_accvgpr_read_b32 v238, a27
    v_mul_f32 v238, v238, v237
    v_accvgpr_write_b32 a27, v238
    v_accvgpr_read_b32 v238, a28
    v_mul_f32 v238, v238, v237
    v_accvgpr_write_b32 a28, v238
    v_accvgpr_read_b32 v238, a29
    v_mul_f32 v238, v238, v237
    v_accvgpr_write_b32 a29, v238
    v_accvgpr_read_b32 v238, a30
    v_mul_f32 v238, v238, v237
    v_accvgpr_write_b32 a30, v238
    v_accvgpr_read_b32 v238, a31
    v_mul_f32 v238, v238, v237
    v_accvgpr_write_b32 a31, v238
    v_accvgpr_read_b32 v238, a48
    v_mul_f32 v238, v238, v237
    v_accvgpr_write_b32 a48, v238
    v_accvgpr_read_b32 v238, a49
    v_mul_f32 v238, v238, v237
    v_accvgpr_write_b32 a49, v238
    v_accvgpr_read_b32 v238, a50
    v_mul_f32 v238, v238, v237
    v_accvgpr_write_b32 a50, v238
    v_accvgpr_read_b32 v238, a51
    v_mul_f32 v238, v238, v237
    v_accvgpr_write_b32 a51, v238
    v_accvgpr_read_b32 v238, a52
    v_mul_f32 v238, v238, v237
    v_accvgpr_write_b32 a52, v238
    v_accvgpr_read_b32 v238, a53
    v_mul_f32 v238, v238, v237
    v_accvgpr_write_b32 a53, v238
    v_accvgpr_read_b32 v238, a54
    v_mul_f32 v238, v238, v237
    v_accvgpr_write_b32 a54, v238
    v_accvgpr_read_b32 v238, a55
    v_mul_f32 v238, v238, v237
    v_accvgpr_write_b32 a55, v238
    v_accvgpr_read_b32 v238, a56
    v_mul_f32 v238, v238, v237
    v_accvgpr_write_b32 a56, v238
    v_accvgpr_read_b32 v238, a57
    v_mul_f32 v238, v238, v237
    v_accvgpr_write_b32 a57, v238
    v_accvgpr_read_b32 v238, a58
    v_mul_f32 v238, v238, v237
    v_accvgpr_write_b32 a58, v238
    v_accvgpr_read_b32 v238, a59
    v_mul_f32 v238, v238, v237
    v_accvgpr_write_b32 a59, v238
    v_accvgpr_read_b32 v238, a60
    v_mul_f32 v238, v238, v237
    v_accvgpr_write_b32 a60, v238
    v_accvgpr_read_b32 v238, a61
    v_mul_f32 v238, v238, v237
    v_accvgpr_write_b32 a61, v238
    v_accvgpr_read_b32 v238, a62
    v_mul_f32 v238, v238, v237
    v_accvgpr_write_b32 a62, v238
    v_accvgpr_read_b32 v238, a63
    v_mul_f32 v238, v238, v237
    v_accvgpr_write_b32 a63, v238
    v_accvgpr_read_b32 v238, a80
    v_mul_f32 v238, v238, v237
    v_accvgpr_write_b32 a80, v238
    v_accvgpr_read_b32 v238, a81
    v_mul_f32 v238, v238, v237
    v_accvgpr_write_b32 a81, v238
    v_accvgpr_read_b32 v238, a82
    v_mul_f32 v238, v238, v237
    v_accvgpr_write_b32 a82, v238
    v_accvgpr_read_b32 v238, a83
    v_mul_f32 v238, v238, v237
    v_accvgpr_write_b32 a83, v238
    v_accvgpr_read_b32 v238, a84
    v_mul_f32 v238, v238, v237
    v_accvgpr_write_b32 a84, v238
    v_accvgpr_read_b32 v238, a85
    v_mul_f32 v238, v238, v237
    v_accvgpr_write_b32 a85, v238
    v_accvgpr_read_b32 v238, a86
    v_mul_f32 v238, v238, v237
    v_accvgpr_write_b32 a86, v238
    v_accvgpr_read_b32 v238, a87
    v_mul_f32 v238, v238, v237
    v_accvgpr_write_b32 a87, v238
    v_accvgpr_read_b32 v238, a88
    v_mul_f32 v238, v238, v237
    v_accvgpr_write_b32 a88, v238
    v_accvgpr_read_b32 v238, a89
    v_mul_f32 v238, v238, v237
    v_accvgpr_write_b32 a89, v238
    v_accvgpr_read_b32 v238, a90
    v_mul_f32 v238, v238, v237
    v_accvgpr_write_b32 a90, v238
    v_accvgpr_read_b32 v238, a91
    v_mul_f32 v238, v238, v237
    v_accvgpr_write_b32 a91, v238
    v_accvgpr_read_b32 v238, a92
    v_mul_f32 v238, v238, v237
    v_accvgpr_write_b32 a92, v238
    v_accvgpr_read_b32 v238, a93
    v_mul_f32 v238, v238, v237
    v_accvgpr_write_b32 a93, v238
    v_accvgpr_read_b32 v238, a94
    v_mul_f32 v238, v238, v237
    v_accvgpr_write_b32 a94, v238
    v_accvgpr_read_b32 v238, a95
    v_mul_f32 v238, v238, v237
    v_accvgpr_write_b32 a95, v238
    v_accvgpr_read_b32 v238, a112
    v_mul_f32 v238, v238, v237
    v_accvgpr_write_b32 a112, v238
    v_accvgpr_read_b32 v238, a113
    v_mul_f32 v238, v238, v237
    v_accvgpr_write_b32 a113, v238
    v_accvgpr_read_b32 v238, a114
    v_mul_f32 v238, v238, v237
    v_accvgpr_write_b32 a114, v238
    v_accvgpr_read_b32 v238, a115
    v_mul_f32 v238, v238, v237
    v_accvgpr_write_b32 a115, v238
    v_accvgpr_read_b32 v238, a116
    v_mul_f32 v238, v238, v237
    v_accvgpr_write_b32 a116, v238
    v_accvgpr_read_b32 v238, a117
    v_mul_f32 v238, v238, v237
    v_accvgpr_write_b32 a117, v238
    v_accvgpr_read_b32 v238, a118
    v_mul_f32 v238, v238, v237
    v_accvgpr_write_b32 a118, v238
    v_accvgpr_read_b32 v238, a119
    v_mul_f32 v238, v238, v237
    v_accvgpr_write_b32 a119, v238
    v_accvgpr_read_b32 v238, a120
    v_mul_f32 v238, v238, v237
    v_accvgpr_write_b32 a120, v238
    v_accvgpr_read_b32 v238, a121
    v_mul_f32 v238, v238, v237
    v_accvgpr_write_b32 a121, v238
    v_accvgpr_read_b32 v238, a122
    v_mul_f32 v238, v238, v237
    v_accvgpr_write_b32 a122, v238
    v_accvgpr_read_b32 v238, a123
    v_mul_f32 v238, v238, v237
    v_accvgpr_write_b32 a123, v238
    v_accvgpr_read_b32 v238, a124
    v_mul_f32 v238, v238, v237
    v_accvgpr_write_b32 a124, v238
    v_accvgpr_read_b32 v238, a125
    v_mul_f32 v238, v238, v237
    v_accvgpr_write_b32 a125, v238
    v_accvgpr_read_b32 v238, a126
    v_mul_f32 v238, v238, v237
    v_accvgpr_write_b32 a126, v238
    v_accvgpr_read_b32 v238, a127
    v_mul_f32 v238, v238, v237
    v_accvgpr_write_b32 a127, v238
    v_exp_f32 v224, v144
    v_exp_f32 v225, v145
    s_nop 0
    v_cvt_pk_bf16_f32 v216, v224, v225
    v_add_f32 v224, v224, v225
    v_mov_b32 v235, v224
    v_exp_f32 v224, v146
    v_exp_f32 v225, v147
    s_nop 0
    v_cvt_pk_bf16_f32 v217, v224, v225
    v_add_f32 v224, v224, v225
    v_add_f32 v235, v235, v224
    v_exp_f32 v224, v148
    v_exp_f32 v225, v149
    s_nop 0
    v_cvt_pk_bf16_f32 v218, v224, v225
    v_add_f32 v224, v224, v225
    v_add_f32 v235, v235, v224
    v_exp_f32 v224, v150
    v_exp_f32 v225, v151
    s_nop 0
    v_cvt_pk_bf16_f32 v219, v224, v225
    v_add_f32 v224, v224, v225
    v_add_f32 v235, v235, v224
    v_exp_f32 v224, v152
    v_exp_f32 v225, v153
    s_nop 0
    v_cvt_pk_bf16_f32 v220, v224, v225
    v_add_f32 v224, v224, v225
    v_add_f32 v235, v235, v224
    v_exp_f32 v224, v154
    v_exp_f32 v225, v155
    s_nop 0
    v_cvt_pk_bf16_f32 v221, v224, v225
    v_add_f32 v224, v224, v225
    v_add_f32 v235, v235, v224
    v_exp_f32 v224, v156
    v_exp_f32 v225, v157
    s_nop 0
    v_cvt_pk_bf16_f32 v222, v224, v225
    v_add_f32 v224, v224, v225
    v_add_f32 v235, v235, v224
    v_exp_f32 v224, v158
    v_exp_f32 v225, v159
    s_nop 0
    v_cvt_pk_bf16_f32 v223, v224, v225
    v_add_f32 v224, v224, v225
    v_add_f32 v235, v235, v224
    s_nop 3
    s_setpc_b64 s[6:7]
recurrent_scan__sliding_block_cached__glu_gated_glu__prompt_kernel_codeend:
.section .rodata,"a"
.p2align 6
.amdhsa_kernel recurrent_scan__sliding_block_cached__glu_gated_glu__prompt_kernel
  .amdhsa_next_free_vgpr 512
  .amdhsa_next_free_sgpr 102
  .amdhsa_accum_offset 256
  .amdhsa_group_segment_fixed_size 0
  .amdhsa_kernarg_size 96
  .amdhsa_user_sgpr_count 2
  .amdhsa_user_sgpr_kernarg_segment_ptr 1
  .amdhsa_system_sgpr_workgroup_id_x 1
  .amdhsa_float_denorm_mode_32 3
.end_amdhsa_kernel
.text
```
